```python
import torch

def _softmax(x, axis=-1):
    return torch.softmax(x, dim=axis)

def _gelu(x):
    return torch.nn.functional.gelu(x, approximate='tanh')

def _silu(x):
    return torch.nn.functional.silu(x)

def _sigmoid(x):
    return torch.sigmoid(x)

def _layernorm(x, axis=-1, eps=1e-05):
    m = x.mean(dim=axis, keepdim=True)
    v = x.var(dim=axis, keepdim=True, unbiased=False)
    return (x - m) / torch.sqrt(v + eps)

def _scatter_add(tgt, idx, src, axis=0):
    return tgt.clone().index_add_(axis, idx, src)

def _segment_sum(src, seg, n):
    out = torch.zeros((n,) + src.shape[1:], dtype=src.dtype)
    return out.index_add_(0, seg, src)

def _pad(x, pw):
    flat = tuple((v for pair in reversed(pw) for v in pair))
    return torch.nn.functional.pad(x, flat)
kernel_name = 'adaLN_cond__linear_kernel_hedgehog__glu_gated_swiglu__prompt'

def setup_inputs():

    _w = lambda a: (lambda t: t.to(torch.bfloat16) if t.is_floating_point() else t)(torch.as_tensor(a))

    def _A_setup():
        B, S, D, H = (1, 2048, 1024, 32)
        Dh = D // H
        return {'x': _w((lambda *s: torch.randn(*s, dtype=torch.bfloat16) * 0.05)(B, S, D)), 'wqkv': _w((lambda *s: torch.randn(*s, dtype=torch.bfloat16) * 0.4)(D, 3 * D)), 'w_phi': _w((lambda *s: torch.randn(*s, dtype=torch.bfloat16) * 0.4)(H, Dh, Dh) * Dh ** (-0.5)), 'wo': _w((lambda *s: torch.randn(*s, dtype=torch.bfloat16) * 0.1)(D, D))}
    _A_in = _A_setup()

    def _B_setup():
        B, S, D, F = (1, 2048, 1024, 3584)
        return {'x': _w((lambda *s: torch.randn(*s, dtype=torch.bfloat16) * 0.05)(B, S, D)), 'w1': _w((lambda *s: torch.randn(*s, dtype=torch.bfloat16) * 1.6)(D, F) * (2.0 / D) ** 0.5), 'w3': _w((lambda *s: torch.randn(*s, dtype=torch.bfloat16) * 1.6)(D, F) * (2.0 / D) ** 0.5), 'w2': _w((lambda *s: torch.randn(*s, dtype=torch.bfloat16) * 1.6)(F, D) * (2.0 / F) ** 0.5)}
    _B_in = _B_setup()
    return {'A_x': _A_in['x'], 'A_wqkv': _A_in['wqkv'], 'A_w_phi': _A_in['w_phi'], 'A_wo': _A_in['wo'], 'B_x': _B_in['x'], 'B_w1': _B_in['w1'], 'B_w3': _B_in['w3'], 'B_w2': _B_in['w2'], 'c': _w((lambda *s: torch.randn(*s, dtype=torch.bfloat16) * 0.1)(1, 1024) * 8.0), 'w_mod': _w((lambda *s: torch.randn(*s, dtype=torch.bfloat16) * 0.1)(1024, 6 * 1024) * 1024 ** (-0.5) * 8.0)}

def reference(A_x, A_wqkv, A_w_phi, A_wo, B_x, B_w1, B_w3, B_w2, c, w_mod):

    def _A_ref(x, wqkv, w_phi, wo):
        B, S, D = x.shape
        H = 32
        Dh = D // H
        qkv = (lambda x, *d: x.permute(*d))((x @ wqkv).reshape(B, S, 3, H, Dh), 2, 0, 3, 1, 4)
        q, k, v = (qkv[0], qkv[1], qkv[2])
        pq = torch.einsum('bhsd,hdf->bhsf', q, w_phi)
        pk = torch.einsum('bhsd,hdf->bhsf', k, w_phi)
        phi_q = torch.concatenate([_softmax(pq, axis=-1), _softmax(-pq, axis=-1)], axis=-1)
        phi_k = torch.concatenate([_softmax(pk, axis=-1), _softmax(-pk, axis=-1)], axis=-1)
        kv = torch.einsum('bhsf,bhsd->bhfd', phi_k, v)
        z = torch.einsum('bhsf->bhf', phi_k)
        num = torch.einsum('bhqf,bhfd->bhqd', phi_q, kv)
        den = torch.einsum('bhqf,bhf->bhq', phi_q, z)[..., None] + 1e-06
        o = num / den
        return (lambda x, *d: x.permute(*d))(o, 0, 2, 1, 3).reshape(B, S, D) @ wo

    def _B_ref(x, w1, w3, w2):
        gate = torch.einsum('bsd,df->bsf', x, w1)
        up = torch.einsum('bsd,df->bsf', x, w3)
        h = _silu(gate) * up
        out = torch.einsum('bsf,fd->bsd', h, w2)
        return out
    x = A_x
    mod = (_silu(c) @ w_mod).reshape(c.shape[0], 6, 1, -1)
    sa, ca, ga, sb, cb, gb = (mod[:, 0].clone(), mod[:, 1].clone(), mod[:, 2].clone(), mod[:, 3].clone(), mod[:, 4].clone(), mod[:, 5].clone())
    h = _layernorm(x, axis=-1) * (1 + ca) + sa
    x = x + ga * _A_ref(h, A_wqkv, A_w_phi, A_wo)
    h = _layernorm(x, axis=-1) * (1 + cb) + sb
    x = x + gb * _B_ref(h, B_w1, B_w3, B_w2)
    return x
```

```asm
; @launch grid=(256,1,1) block=(256,1,1) lds=163584
.amdgcn_target "amdgcn-amd-amdhsa--gfx950"
.text
.globl adaLN_cond__linear_kernel_hedgehog__glu_gated_swiglu__prompt_kernel
.p2align 8
.type adaLN_cond__linear_kernel_hedgehog__glu_gated_swiglu__prompt_kernel,@function
adaLN_cond__linear_kernel_hedgehog__glu_gated_swiglu__prompt_kernel:
  s_cmp_lt_u32 s2, 256
  s_cbranch_scc1 L_go_2
  s_endpgm
L_go_2:
  s_getpc_b64 s[100:101]
L_pc_3:
  s_sub_u32 s100, s100, L_pc_3-adaLN_cond__linear_kernel_hedgehog__glu_gated_swiglu__prompt_kernel
  s_subb_u32 s101, s101, 0
  v_and_b32 v104, 63, v0
  v_lshlrev_b32 v105, 4, v104
  v_lshlrev_b32_e64 v254, 5, v0
  global_load_dword a232, v254, s[100:101]
  s_load_dwordx2 s[96:97], s[0:1], 88
  s_load_dwordx8 s[4:11], s[0:1], 0
  s_load_dwordx2 s[12:13], s[0:1], 64
  s_load_dwordx2 s[14:15], s[0:1], 40
  s_load_dwordx4 s[16:19], s[0:1], 48
  s_load_dwordx2 s[98:99], s[0:1], 72
  s_load_dwordx2 s[24:25], s[0:1], 80
  s_load_dwordx2 s[28:29], s[0:1], 96
  v_lshrrev_b32 v1, 6, v0
  s_and_b32 s30, s2, 7
  s_lshr_b32 s31, s2, 3
  v_readfirstlane_b32 s3, v1
  s_bfe_u32 s26, s30, 0x10001
  s_lshl_b32 s26, s26, 3
  s_lshr_b32 s80, s31, 2
  s_add_u32 s26, s26, s80
  s_lshr_b32 s27, s30, 2
  s_lshl_b32 s27, s27, 2
  s_and_b32 s80, s31, 3
  s_add_u32 s27, s27, s80
  s_lshl_b32 s27, s27, 1
  s_and_b32 s80, s30, 1
  s_add_u32 s27, s27, s80
  s_lshr_b32 s80, s31, 2
  s_add_u32 s21, s80, s31
  s_and_b32 s81, s31, 3
  s_lshl_b32 s81, s81, 1
  s_add_u32 s20, s80, s81
  s_and_b32 s80, s31, 3
  s_lshl_b32 s23, s30, 2
  s_add_u32 s23, s23, s80
  s_lshr_b32 s22, s31, 2
  s_lshl_b32 s80, s31, 2
  s_add_u32 s80, s80, s3
  s_lshl_b32 s80, s80, 10
  v_add_u32_e64 v254, s80, v105
  v_min_u32 v254, adaLN_cond__linear_kernel_hedgehog__glu_gated_swiglu__prompt_kernel_end-adaLN_cond__linear_kernel_hedgehog__glu_gated_swiglu__prompt_kernel-4, v254
  global_load_dword a232, v254, s[100:101]
  v_lshrrev_b32 v49, 3, v104
  v_and_b32 v50, 7, v104
  v_mul_u32_u24 v115, 12288, v49
  v_lshl_add_u32 v115, v50, 4, v115
  s_lshl_b32 s84, s26, 6
  v_add_u32 v109, s84, v49
  v_lshlrev_b32 v109, 1, v109
  s_lshl_b32 s85, s3, 5
  v_add_u32 v51, s85, v109
  s_mul_i32 s86, s84, 12288
  s_lshl_b32 s87, s27, 7
  s_add_u32 s86, s86, s87
  s_mul_i32 s87, s3, 196608
  s_add_u32 s87, s87, s86
  s_add_u32 s88, s87, 98304
  v_lshrrev_b32 v52, 5, v104
  v_lshlrev_b32 v52, 11, v52
  v_and_b32 v53, 31, v104
  v_lshl_add_u32 v52, v53, 4, v52
  s_lshl_b32 s89, s26, 4
  s_add_u32 s89, s89, s27
  s_lshl_b32 s90, s89, 14
  s_lshl_b32 s91, s3, 12
  s_add_u32 s90, s90, s91
  v_mov_b32 v56, 0
  v_mov_b32 v57, 0
  v_mov_b32 v58, 0
  v_mov_b32 v59, 0
  v_mov_b32 v60, 1
  v_lshlrev_b32 v55, 6, v104
  s_lshl_b32 s93, s2, 12
  s_add_u32 s93, s93, 524288
  s_cmp_lt_u32 s2, 4
  s_cselect_b32 s93, s93, 0x7ff00000
  s_cmp_eq_u32 s3, 3
  s_cselect_b32 s93, s93, 0x7ff00000
  s_waitcnt lgkmcnt(0)
  s_add_u32 s56, s28, 10485760
  s_addc_u32 s57, s29, 0
  s_mov_b32 s58, 589824
  s_mov_b32 s59, 0x20000
  buffer_store_dword v56, v55, s[56:59], s93 offen sc1
  s_mov_b32 s36, s96
  s_mov_b32 s37, s97
  s_mov_b32 s38, 256
  s_mov_b32 s39, 0x20000
  s_mov_b32 s95, s93
  s_mov_b32 s52, s98
  s_mov_b32 s53, s99
  s_mov_b32 s54, 12582912
  s_mov_b32 s55, 0x20000
  s_mov_b32 s40, s4
  s_mov_b32 s41, s5
  s_mov_b32 s42, 4194304
  s_mov_b32 s43, 0x20000
  global_load_ushort v80, v51, s[12:13] offset:0
  global_load_ushort v82, v51, s[12:13] offset:16
  buffer_load_dwordx4 v[64:67], v115, s[52:55], s87 offen offset:0 nt
  buffer_load_dwordx4 v[68:71], v115, s[52:55], s87 offen offset:2048 nt
  buffer_load_dwordx4 v[72:75], v115, s[52:55], s88 offen offset:0 nt
  buffer_load_dwordx4 v[76:79], v115, s[52:55], s88 offen offset:2048 nt
  buffer_load_dwordx4 v[128:131], v52, s[40:43], s90 offen offset:0
  buffer_load_dwordx4 v[132:135], v52, s[40:43], s90 offen offset:512
  buffer_load_dwordx4 v[136:139], v52, s[40:43], s90 offen offset:1024
  buffer_load_dwordx4 v[140:143], v52, s[40:43], s90 offen offset:1536
  s_mov_b32 s44, s28
  s_mov_b32 s45, s29
  s_mov_b32 s46, 409600
  s_mov_b32 s47, 0x20000
  s_add_u32 s48, s28, 2097152
  s_addc_u32 s49, s29, 0
  s_mov_b32 s50, 262144
  s_mov_b32 s51, 0x20000
  s_cmp_eq_u32 s3, 3
  s_cbranch_scc1 L_w3_4
  s_lshl_b32 s92, s2, 1
  s_add_u32 s92, s92, s3
  s_sub_u32 s92, s92, 1
  s_mov_b32 s93, 0x7ff00000
  buffer_load_dword a233, v115, s[52:55], s93 offen
  buffer_load_dword a233, v115, s[52:55], s93 offen
  s_cmp_eq_u32 s3, 0
  s_cbranch_scc1 L_notouch_6
  s_mul_i32 s93, s92, 12
  v_min_u32 v62, 11, v104
  v_add_u32 v62, s93, v62
  v_lshlrev_b32 v62, 10, v62
  global_load_dword a232, v62, s[6:7] offset:384
  s_mul_i32 s93, s92, 4
  v_min_u32 v62, 3, v104
  v_add_u32 v62, s93, v62
  v_lshlrev_b32 v62, 10, v62
  global_load_dword a232, v62, s[10:11] offset:384
  s_mul_i32 s93, s92, 24
  v_min_u32 v62, 23, v104
  v_add_u32 v62, s93, v62
  v_lshlrev_b32 v62, 10, v62
  global_load_dword a232, v62, s[98:99] offset:384
  s_branch L_join_5
L_notouch_6:
  buffer_load_dword a233, v115, s[52:55], s93 offen
  buffer_load_dword a233, v115, s[52:55], s93 offen
  buffer_load_dword a233, v115, s[52:55], s93 offen
  s_branch L_join_5
L_w3_4:
  s_cmp_eq_u32 s95, 0x7ff00000
  s_cbranch_scc1 L_nboot_7
  s_lshl_b32 s93, s2, 2
  s_waitcnt vmcnt(10)
  buffer_store_dword v60, v56, s[36:39], s93 offen sc1
L_nboot_7:
  v_and_b32 v62, 3, v104
  v_lshlrev_b32 v62, 4, v62
  s_lshl_b32 s93, s26, 6
  s_add_u32 s93, s93, s27
  v_add_u32 v63, s93, v62
  s_lshl_b32 s93, s27, 6
  s_add_u32 s93, s93, s26
  s_add_u32 s93, s93, 1024
  v_add_u32 v62, s93, v62
  v_cmp_gt_u32 vcc, 4, v104
  s_mul_i32 s93, s2, 24
  s_add_u32 s93, s93, 2040
  v_cndmask_b32 v62, v62, v63, vcc
  v_add_u32 v63, s93, v104
  v_cmp_gt_u32 vcc, 8, v104
  s_nop 1
  v_cndmask_b32 v62, v63, v62, vcc
  v_cmp_gt_u32 vcc, 32, v104
  v_mov_b32 v63, 0x100000
  s_nop 0
  v_cndmask_b32 v62, v63, v62, vcc
  v_lshlrev_b32 v62, 6, v62
  buffer_store_dword v56, v62, s[56:59], 0 offen sc1
  s_mov_b32 s93, 0x7ff00000
  buffer_load_dword a233, v115, s[52:55], s93 offen
  buffer_load_dword a233, v115, s[52:55], s93 offen
  s_lshl_b32 s93, s2, 10
  buffer_store_dwordx4 v[56:59], v105, s[48:51], s93 offen sc1
  s_add_u32 s93, s93, 131072
  buffer_store_dwordx4 v[56:59], v105, s[44:47], s93 offen sc1
L_join_5:
  v_lshlrev_b32 v53, 11, v49
  v_lshl_add_u32 v53, v50, 4, v53
  s_lshl_b32 s91, s26, 18
  s_lshl_b32 s92, s3, 16
  s_add_u32 s91, s91, s92
  s_lshl_b32 s92, s27, 7
  s_add_u32 s91, s91, s92
  s_nop 0
  buffer_load_dwordx4 v[144:147], v53, s[40:43], s91 offen
  s_add_u32 s91, s91, 16384
  buffer_load_dwordx4 v[148:151], v53, s[40:43], s91 offen
  s_add_u32 s91, s91, 16384
  buffer_load_dwordx4 v[152:155], v53, s[40:43], s91 offen
  s_add_u32 s91, s91, 16384
  buffer_load_dwordx4 v[156:159], v53, s[40:43], s91 offen
  s_lshl_b32 s94, s3, 11
  s_add_u32 s77, s86, s94
  s_add_u32 s77, s77, 4096
  s_lshl_b32 s94, s3, 16
  s_lshl_b32 s95, s27, 12
  s_add_u32 s94, s94, s95
  s_lshl_b32 s95, s26, 8
  s_add_u32 s94, s94, s95
  s_add_u32 s79, s94, 131072
  s_waitcnt vmcnt(17)
  v_lshlrev_b32 v80, 16, v80
  v_mul_f32 v81, -1.4426950408889634, v80
  v_lshlrev_b32 v82, 16, v82
  v_mul_f32 v83, -1.4426950408889634, v82
  v_exp_f32 v81, v81
  v_exp_f32 v83, v83
  s_nop 0
  v_add_f32 v81, 1.0, v81
  v_add_f32 v83, 1.0, v83
  v_rcp_f32 v81, v81
  v_rcp_f32 v83, v83
  s_nop 0
  v_mul_f32_e64 v80, v80, v81
  v_cvt_pk_bf16_f32 v80, v80, v80
  v_and_b32 v80, 0xffff0000, v80
  v_mul_f32_e64 v82, v82, v83
  v_cvt_pk_bf16_f32 v82, v82, v82
  v_and_b32 v82, 0xffff0000, v82
  s_waitcnt vmcnt(13)
  v_lshlrev_b32 v62, 16, v64
  v_and_b32 v63, 0xffff0000, v64
  v_pk_mul_f32 v[200:201], v[62:63], v[80:81] op_sel_hi:[1,0]
  v_lshlrev_b32_e64 v62, 16, v65
  v_and_b32 v63, 0xffff0000, v65
  v_pk_mul_f32 v[202:203], v[62:63], v[80:81] op_sel_hi:[1,0]
  v_lshlrev_b32_e64 v62, 16, v66
  v_and_b32 v63, 0xffff0000, v66
  v_pk_mul_f32 v[204:205], v[62:63], v[80:81] op_sel_hi:[1,0]
  v_lshlrev_b32_e64 v62, 16, v67
  v_and_b32 v63, 0xffff0000, v67
  v_pk_mul_f32 v[206:207], v[62:63], v[80:81] op_sel_hi:[1,0]
  v_lshlrev_b32_e64 v62, 16, v68
  v_and_b32 v63, 0xffff0000, v68
  v_pk_mul_f32 v[208:209], v[62:63], v[80:81] op_sel_hi:[1,0]
  v_lshlrev_b32_e64 v62, 16, v69
  v_and_b32 v63, 0xffff0000, v69
  v_pk_mul_f32 v[210:211], v[62:63], v[80:81] op_sel_hi:[1,0]
  v_lshlrev_b32_e64 v62, 16, v70
  v_and_b32 v63, 0xffff0000, v70
  v_pk_mul_f32 v[212:213], v[62:63], v[80:81] op_sel_hi:[1,0]
  v_lshlrev_b32_e64 v62, 16, v71
  v_and_b32 v63, 0xffff0000, v71
  v_pk_mul_f32 v[214:215], v[62:63], v[80:81] op_sel_hi:[1,0]
  v_lshlrev_b32_e64 v62, 16, v72
  v_and_b32 v63, 0xffff0000, v72
  v_pk_fma_f32 v[200:201], v[62:63], v[82:83], v[200:201] op_sel_hi:[1,0,1]
  v_lshlrev_b32_e64 v62, 16, v73
  v_and_b32 v63, 0xffff0000, v73
  v_pk_fma_f32 v[202:203], v[62:63], v[82:83], v[202:203] op_sel_hi:[1,0,1]
  v_lshlrev_b32_e64 v62, 16, v74
  v_and_b32 v63, 0xffff0000, v74
  v_pk_fma_f32 v[204:205], v[62:63], v[82:83], v[204:205] op_sel_hi:[1,0,1]
  v_lshlrev_b32_e64 v62, 16, v75
  v_and_b32 v63, 0xffff0000, v75
  v_pk_fma_f32 v[206:207], v[62:63], v[82:83], v[206:207] op_sel_hi:[1,0,1]
  v_lshlrev_b32_e64 v62, 16, v76
  v_and_b32 v63, 0xffff0000, v76
  v_pk_fma_f32 v[208:209], v[62:63], v[82:83], v[208:209] op_sel_hi:[1,0,1]
  v_lshlrev_b32_e64 v62, 16, v77
  v_and_b32 v63, 0xffff0000, v77
  v_pk_fma_f32 v[210:211], v[62:63], v[82:83], v[210:211] op_sel_hi:[1,0,1]
  v_lshlrev_b32_e64 v62, 16, v78
  v_and_b32 v63, 0xffff0000, v78
  v_pk_fma_f32 v[212:213], v[62:63], v[82:83], v[212:213] op_sel_hi:[1,0,1]
  v_lshlrev_b32_e64 v62, 16, v79
  v_and_b32 v63, 0xffff0000, v79
  v_pk_fma_f32 v[214:215], v[62:63], v[82:83], v[214:215] op_sel_hi:[1,0,1]
  s_nop 1
  v_permlane32_swap_b32 v200, v208
  v_permlane32_swap_b32 v201, v209
  v_permlane32_swap_b32 v202, v210
  v_permlane32_swap_b32 v203, v211
  v_permlane32_swap_b32 v204, v212
  v_permlane32_swap_b32 v205, v213
  v_permlane32_swap_b32 v206, v214
  v_permlane32_swap_b32 v207, v215
  s_nop 1
  v_add_f32 v200, v200, v208
  v_add_f32 v201, v201, v209
  v_add_f32 v202, v202, v210
  v_add_f32 v203, v203, v211
  v_add_f32 v204, v204, v212
  v_add_f32 v205, v205, v213
  v_add_f32 v206, v206, v214
  v_add_f32 v207, v207, v215
  s_nop 1
  v_permlane16_swap_b32 v200, v204
  v_permlane16_swap_b32 v201, v205
  v_permlane16_swap_b32 v202, v206
  v_permlane16_swap_b32 v203, v207
  s_nop 1
  v_add_f32 v200, v200, v204
  v_add_f32 v201, v201, v205
  v_add_f32 v202, v202, v206
  v_add_f32 v203, v203, v207
  s_nop 0
  s_nop 0
  v_add_f32_dpp v200, v200, v200 row_ror:8 row_mask:0xf bank_mask:0xf
  v_add_f32_dpp v201, v201, v201 row_ror:8 row_mask:0xf bank_mask:0xf
  v_add_f32_dpp v202, v202, v202 row_ror:8 row_mask:0xf bank_mask:0xf
  v_add_f32_dpp v203, v203, v203 row_ror:8 row_mask:0xf bank_mask:0xf
  v_lshrrev_b32 v61, 5, v104
  v_lshlrev_b32 v62, 8, v61
  v_lshl_add_u32 v62, v50, 5, v62
  v_bfe_u32 v63, v104, 4, 1
  v_lshl_add_u32 v62, v63, 4, v62
  s_lshl_b32 s94, s3, 9
  v_add_u32 v62, s94, v62
  ds_write_b128 v62, v[200:203] offset:50688
  s_waitcnt vmcnt(9)
  v_lshlrev_b32 v0, 16, v128
  v_and_b32 v1, 0xffff0000, v128
  v_lshlrev_b32 v2, 16, v129
  v_and_b32 v3, 0xffff0000, v129
  v_lshlrev_b32 v4, 16, v130
  v_and_b32 v5, 0xffff0000, v130
  v_lshlrev_b32 v6, 16, v131
  v_and_b32 v7, 0xffff0000, v131
  v_lshlrev_b32 v8, 16, v132
  v_and_b32 v9, 0xffff0000, v132
  v_lshlrev_b32 v10, 16, v133
  v_and_b32 v11, 0xffff0000, v133
  v_lshlrev_b32 v12, 16, v134
  v_and_b32 v13, 0xffff0000, v134
  v_lshlrev_b32 v14, 16, v135
  v_and_b32 v15, 0xffff0000, v135
  v_lshlrev_b32 v16, 16, v136
  v_and_b32 v17, 0xffff0000, v136
  v_lshlrev_b32 v18, 16, v137
  v_and_b32 v19, 0xffff0000, v137
  v_lshlrev_b32 v20, 16, v138
  v_and_b32 v21, 0xffff0000, v138
  v_lshlrev_b32 v22, 16, v139
  v_and_b32 v23, 0xffff0000, v139
  v_lshlrev_b32 v24, 16, v140
  v_and_b32 v25, 0xffff0000, v140
  v_lshlrev_b32 v26, 16, v141
  v_and_b32 v27, 0xffff0000, v141
  v_lshlrev_b32 v28, 16, v142
  v_and_b32 v29, 0xffff0000, v142
  v_lshlrev_b32_e64 v30, 16, v143
  v_and_b32 v31, 0xffff0000, v143
  v_pk_add_f32 v[216:217], v[0:1], v[2:3]
  v_pk_add_f32 v[216:217], v[216:217], v[4:5]
  v_pk_add_f32 v[216:217], v[216:217], v[6:7]
  v_pk_add_f32 v[216:217], v[216:217], v[8:9]
  v_pk_add_f32 v[216:217], v[216:217], v[10:11]
  v_pk_add_f32 v[216:217], v[216:217], v[12:13]
  v_pk_add_f32 v[216:217], v[216:217], v[14:15]
  v_pk_add_f32 v[216:217], v[216:217], v[16:17]
  v_pk_add_f32 v[216:217], v[216:217], v[18:19]
  v_pk_add_f32 v[216:217], v[216:217], v[20:21]
  v_pk_add_f32 v[216:217], v[216:217], v[22:23]
  v_pk_add_f32 v[216:217], v[216:217], v[24:25]
  v_pk_add_f32 v[216:217], v[216:217], v[26:27]
  v_pk_add_f32 v[216:217], v[216:217], v[28:29]
  v_pk_add_f32 v[216:217], v[216:217], v[30:31]
  v_add_f32 v216, v216, v217
  s_nop 1
  v_add_f32_dpp v216, v216, v216 quad_perm:[1,0,3,2] row_mask:0xf bank_mask:0xf
  s_nop 1
  v_add_f32_dpp v216, v216, v216 quad_perm:[2,3,0,1] row_mask:0xf bank_mask:0xf
  s_nop 1
  v_add_f32_dpp v216, v216, v216 row_half_mirror row_mask:0xf bank_mask:0xf
  s_nop 1
  v_add_f32_dpp v216, v216, v216 row_mirror row_mask:0xf bank_mask:0xf
  v_mov_b32 v217, v216
  s_nop 1
  v_permlane16_swap_b32 v216, v217
  s_nop 1
  v_add_f32 v216, v216, v217
  v_mul_f32 v218, -0.0009765625, v216
  v_mov_b32 v216, 0
  v_mov_b32 v217, 0
  v_pk_add_f32 v[0:1], v[0:1], v[218:219] op_sel_hi:[1,0]
  v_pk_fma_f32 v[216:217], v[0:1], v[0:1], v[216:217]
  v_pk_add_f32 v[2:3], v[2:3], v[218:219] op_sel_hi:[1,0]
  v_pk_fma_f32 v[216:217], v[2:3], v[2:3], v[216:217]
  v_pk_add_f32 v[4:5], v[4:5], v[218:219] op_sel_hi:[1,0]
  v_pk_fma_f32 v[216:217], v[4:5], v[4:5], v[216:217]
  v_pk_add_f32 v[6:7], v[6:7], v[218:219] op_sel_hi:[1,0]
  v_pk_fma_f32 v[216:217], v[6:7], v[6:7], v[216:217]
  v_pk_add_f32 v[8:9], v[8:9], v[218:219] op_sel_hi:[1,0]
  v_pk_fma_f32 v[216:217], v[8:9], v[8:9], v[216:217]
  v_pk_add_f32 v[10:11], v[10:11], v[218:219] op_sel_hi:[1,0]
  v_pk_fma_f32 v[216:217], v[10:11], v[10:11], v[216:217]
  v_pk_add_f32 v[12:13], v[12:13], v[218:219] op_sel_hi:[1,0]
  v_pk_fma_f32 v[216:217], v[12:13], v[12:13], v[216:217]
  v_pk_add_f32 v[14:15], v[14:15], v[218:219] op_sel_hi:[1,0]
  v_pk_fma_f32 v[216:217], v[14:15], v[14:15], v[216:217]
  v_pk_add_f32 v[16:17], v[16:17], v[218:219] op_sel_hi:[1,0]
  v_pk_fma_f32 v[216:217], v[16:17], v[16:17], v[216:217]
  v_pk_add_f32 v[18:19], v[18:19], v[218:219] op_sel_hi:[1,0]
  v_pk_fma_f32 v[216:217], v[18:19], v[18:19], v[216:217]
  v_pk_add_f32 v[20:21], v[20:21], v[218:219] op_sel_hi:[1,0]
  v_pk_fma_f32 v[216:217], v[20:21], v[20:21], v[216:217]
  v_pk_add_f32 v[22:23], v[22:23], v[218:219] op_sel_hi:[1,0]
  v_pk_fma_f32 v[216:217], v[22:23], v[22:23], v[216:217]
  v_pk_add_f32 v[24:25], v[24:25], v[218:219] op_sel_hi:[1,0]
  v_pk_fma_f32 v[216:217], v[24:25], v[24:25], v[216:217]
  v_pk_add_f32 v[26:27], v[26:27], v[218:219] op_sel_hi:[1,0]
  v_pk_fma_f32 v[216:217], v[26:27], v[26:27], v[216:217]
  v_pk_add_f32 v[28:29], v[28:29], v[218:219] op_sel_hi:[1,0]
  v_pk_fma_f32 v[216:217], v[28:29], v[28:29], v[216:217]
  v_pk_add_f32 v[30:31], v[30:31], v[218:219] op_sel_hi:[1,0]
  v_pk_fma_f32 v[216:217], v[30:31], v[30:31], v[216:217]
  v_add_f32 v216, v216, v217
  s_nop 1
  v_add_f32_dpp v216, v216, v216 quad_perm:[1,0,3,2] row_mask:0xf bank_mask:0xf
  s_nop 1
  v_add_f32_dpp v216, v216, v216 quad_perm:[2,3,0,1] row_mask:0xf bank_mask:0xf
  s_nop 1
  v_add_f32_dpp v216, v216, v216 row_half_mirror row_mask:0xf bank_mask:0xf
  s_nop 1
  v_add_f32_dpp v216, v216, v216 row_mirror row_mask:0xf bank_mask:0xf
  v_mov_b32 v217, v216
  s_nop 1
  v_permlane16_swap_b32 v216, v217
  s_nop 1
  v_add_f32 v216, v216, v217
  v_mov_b32 v217, 0x3727c5ac
  v_fmac_f32 v217, 0.0009765625, v216
  v_rsq_f32 v219, v217
  s_lshl_b32 s94, s3, 4
  v_lshlrev_b32 v61, 3, v61
  v_add_u32 v61, s94, v61
  ds_write_b64 v61, v[218:219] offset:52736
  s_cmp_lg_u32 s3, 3
  s_cbranch_scc1 L_not3_8
  v_and_b32 v62, 3, v104
  v_lshlrev_b32 v62, 2, v62
  s_mov_b32 s96, 0
L_poll_9:
  buffer_load_dword v61, v62, s[36:39], 0 offen sc1
  s_waitcnt vmcnt(0)
  v_cmp_eq_u32 vcc, 0, v61
  s_add_u32 s96, s96, 1
  s_cmp_eq_u64 vcc, 0
  s_cbranch_scc1 L_ok_10
  s_sleep 2
  s_cmp_lt_u32 s96, 0x200000
  s_cbranch_scc1 L_poll_9
L_ok_10:
L_not3_8:
  s_waitcnt lgkmcnt(0)
  s_barrier
  v_lshlrev_b32 v54, 3, v104
  s_cmp_lg_u32 s3, 0
  s_cbranch_scc1 L_notw0_11
  ds_read_b64 v[200:201], v54 offset:50688
  ds_read_b64 v[202:203], v54 offset:51200
  ds_read_b64 v[204:205], v54 offset:51712
  ds_read_b64 v[206:207], v54 offset:52224
  v_and_b32 v57, 0x38, v54
  ds_read_b64 v[208:209], v57 offset:52736
  s_lshl_b32 s94, s27, 13
  s_lshl_b32 s95, s26, 9
  s_add_u32 s95, s95, s94
  s_lshl_b32 s90, s89, 6
  s_add_u32 s90, s90, 393216
  s_waitcnt lgkmcnt(0)
  v_pk_add_f32 v[200:201], v[200:201], v[202:203]
  v_pk_add_f32 v[204:205], v[204:205], v[206:207]
  v_pk_add_f32 v[200:201], v[200:201], v[204:205]
  buffer_store_dwordx2 v[200:201], v54, s[44:47], s95 offen sc1
  buffer_store_dwordx2 v[208:209], v57, s[44:47], s90 offen sc1
  s_lshl_b32 s90, s89, 6
  s_add_u32 s90, s90, 524288
  s_waitcnt vmcnt(0)
  buffer_store_dword v60, v56, s[56:59], s90 offen sc1
L_notw0_11:
  v_lshlrev_b32 v105, 4, v104
  s_lshr_b32 s80, s3, 1
  s_and_b32 s81, s3, 1
  v_lshrrev_b32 v111, 3, v104
  v_and_b32 v112, 4, v111
  v_bfe_u32 v113, v111, 1, 1
  v_or_b32 v112, v112, v113
  v_and_b32 v113, 1, v111
  v_lshl_or_b32 v112, v113, 1, v112
  v_mul_u32_u24 v112, 24576, v112
  v_and_b32 v113, 7, v104
  v_lshl_add_u32 v112, v113, 4, v112
  s_lshl_b32 s82, s80, 5
  s_lshl_b32 s83, s81, 1
  s_add_u32 s82, s82, s83
  s_mul_i32 s82, s82, 6144
  s_lshl_b32 s83, s27, 7
  s_add_u32 s82, s82, s83
  v_add_u32_e64 v98, s82, v112
  v_add_u32 v99, 5088, v98
  v_add_u32 v100, 2048, v98
  v_add_u32 v101, 7136, v98
  v_bfe_u32 v111, v104, 2, 2
  v_mul_u32_u24 v111, 1056, v111
  v_lshrrev_b32_e64 v112, 5, v104
  v_lshl_add_u32 v111, v112, 9, v111
  v_bfe_u32 v112, v104, 4, 1
  v_lshl_add_u32 v111, v112, 7, v111
  v_and_b32_e64 v113, 3, v104
  v_lshl_add_u32 v96, v113, 3, v111
  v_add_u32 v97, 33792, v96
  s_lshl_b32 s82, s26, 3
  s_lshl_b32 s83, s3, 1
  s_add_u32 s82, s82, s83
  s_lshl_b32 s82, s82, 15
  v_add_u32_e64 v102, s82, v105
  v_add_u32 v103, 0x8000, v102
  s_mul_i32 s76, s80, 4224
  s_mul_i32 s82, s81, 2112
  s_add_u32 s76, s76, s82
  s_mov_b32 s32, s6
  s_mov_b32 s33, s7
  s_mov_b32 s34, 6291456
  s_mov_b32 s35, 0x20000
  s_waitcnt vmcnt(1)
  s_cmp_eq_u32 s3, 0
  s_cbranch_scc1 1
  s_waitcnt vmcnt(0)
  v_lshlrev_b32 v0, 16, v144
  v_and_b32 v1, 0xffff0000, v144
  v_lshlrev_b32 v2, 16, v145
  v_and_b32 v3, 0xffff0000, v145
  v_lshlrev_b32 v4, 16, v146
  v_and_b32 v5, 0xffff0000, v146
  v_lshlrev_b32 v6, 16, v147
  v_and_b32 v7, 0xffff0000, v147
  v_lshlrev_b32 v8, 16, v148
  v_and_b32 v9, 0xffff0000, v148
  v_lshlrev_b32 v10, 16, v149
  v_and_b32 v11, 0xffff0000, v149
  v_lshlrev_b32 v12, 16, v150
  v_and_b32 v13, 0xffff0000, v150
  v_lshlrev_b32 v14, 16, v151
  v_and_b32 v15, 0xffff0000, v151
  v_lshlrev_b32 v16, 16, v152
  v_and_b32 v17, 0xffff0000, v152
  v_lshlrev_b32 v18, 16, v153
  v_and_b32 v19, 0xffff0000, v153
  v_lshlrev_b32 v20, 16, v154
  v_and_b32 v21, 0xffff0000, v154
  v_lshlrev_b32 v22, 16, v155
  v_and_b32 v23, 0xffff0000, v155
  v_lshlrev_b32 v24, 16, v156
  v_and_b32 v25, 0xffff0000, v156
  v_lshlrev_b32 v26, 16, v157
  v_and_b32 v27, 0xffff0000, v157
  v_lshlrev_b32 v28, 16, v158
  v_and_b32 v29, 0xffff0000, v158
  v_lshlrev_b32 v30, 16, v159
  v_and_b32 v31, 0xffff0000, v159
  v_lshrrev_b32 v52, 2, v50
  v_lshlrev_b32 v52, 10, v52
  v_and_b32 v51, 3, v50
  v_lshl_add_u32 v52, v51, 8, v52
  v_lshl_add_u32 v52, v49, 4, v52
  s_lshl_b32 s86, s26, 3
  s_lshl_b32 s87, s3, 1
  s_add_u32 s86, s86, s87
  s_lshl_b32 s86, s86, 15
  s_lshl_b32 s87, s27, 11
  s_add_u32 s86, s86, s87
  s_add_u32 s87, s86, 0x8000
  s_lshl_b32 s88, s26, 2
  s_add_u32 s88, s88, s3
  s_lshl_b32 s88, s88, 10
  s_add_u32 s88, s88, 0
  s_lshl_b32 s89, s27, 6
  s_add_u32 s89, s89, s88
  v_lshlrev_b32 v53, 5, v50
  s_lshl_b32 s92, s3, 8
  v_lshlrev_b32 v55, 3, v49
  v_add_u32 v55, s92, v55
  s_cmp_lg_u32 s3, 0
  s_cbranch_scc1 L_notw0b_12
  v_and_b32 v57, 15, v104
  s_lshl_b32 s92, s26, 4
  v_add_u32 v58, s92, v57
  v_lshlrev_b32 v57, 4, v57
  v_add_u32 v57, s27, v57
  v_and_b32 v59, 16, v104
  v_cmp_eq_u32 vcc, 0, v59
  s_mov_b32 s92, 524288
  s_nop 0
  v_cndmask_b32 v57, v57, v58, vcc
  v_lshlrev_b32 v57, 6, v57
  s_mov_b32 s96, 0
L_poll_13:
  buffer_load_dword v61, v57, s[56:59], s92 offen sc1
  s_waitcnt vmcnt(0)
  v_cmp_eq_u32 vcc, 0, v61
  s_add_u32 s96, s96, 1
  s_cmp_eq_u64 vcc, 0
  s_cbranch_scc1 L_ok_14
  s_sleep 2
  s_cmp_lt_u32 s96, 0x200000
  s_cbranch_scc1 L_poll_13
L_ok_14:
  s_lshl_b32 s94, s27, 13
  s_nop 0
  s_add_u32 s95, s94, 4096
  buffer_load_dwordx2 v[160:161], v54, s[44:47], s94 offen offset:0 sc1
  buffer_load_dwordx2 v[162:163], v54, s[44:47], s94 offen offset:512 sc1
  buffer_load_dwordx2 v[164:165], v54, s[44:47], s94 offen offset:1024 sc1
  buffer_load_dwordx2 v[166:167], v54, s[44:47], s94 offen offset:1536 sc1
  buffer_load_dwordx2 v[168:169], v54, s[44:47], s94 offen offset:2048 sc1
  buffer_load_dwordx2 v[170:171], v54, s[44:47], s94 offen offset:2560 sc1
  buffer_load_dwordx2 v[172:173], v54, s[44:47], s94 offen offset:3072 sc1
  buffer_load_dwordx2 v[174:175], v54, s[44:47], s94 offen offset:3584 sc1
  buffer_load_dwordx2 v[176:177], v54, s[44:47], s95 offen offset:0 sc1
  buffer_load_dwordx2 v[178:179], v54, s[44:47], s95 offen offset:512 sc1
  buffer_load_dwordx2 v[180:181], v54, s[44:47], s95 offen offset:1024 sc1
  buffer_load_dwordx2 v[182:183], v54, s[44:47], s95 offen offset:1536 sc1
  buffer_load_dwordx2 v[184:185], v54, s[44:47], s95 offen offset:2048 sc1
  buffer_load_dwordx2 v[186:187], v54, s[44:47], s95 offen offset:2560 sc1
  buffer_load_dwordx2 v[188:189], v54, s[44:47], s95 offen offset:3072 sc1
  buffer_load_dwordx2 v[190:191], v54, s[44:47], s95 offen offset:3584 sc1
  s_lshl_b32 s90, s26, 10
  s_add_u32 s90, s90, 393216
  buffer_load_dwordx4 v[208:211], v105, s[44:47], s90 offen sc1
  v_cmp_lt_u32 vcc, 31, v104
  s_waitcnt vmcnt(1)
  s_nop 0
  v_pk_add_f32 v[160:161], v[160:161], v[176:177]
  v_pk_add_f32 v[162:163], v[162:163], v[178:179]
  v_pk_add_f32 v[164:165], v[164:165], v[180:181]
  v_pk_add_f32 v[166:167], v[166:167], v[182:183]
  v_pk_add_f32 v[168:169], v[168:169], v[184:185]
  v_pk_add_f32 v[170:171], v[170:171], v[186:187]
  v_pk_add_f32 v[172:173], v[172:173], v[188:189]
  v_pk_add_f32 v[174:175], v[174:175], v[190:191]
  v_pk_add_f32 v[160:161], v[160:161], v[168:169]
  v_pk_add_f32 v[162:163], v[162:163], v[170:171]
  v_pk_add_f32 v[164:165], v[164:165], v[172:173]
  v_pk_add_f32 v[166:167], v[166:167], v[174:175]
  v_pk_add_f32 v[160:161], v[160:161], v[164:165]
  v_pk_add_f32 v[162:163], v[162:163], v[166:167]
  v_pk_add_f32 v[160:161], v[160:161], v[162:163]
  v_cvt_pk_bf16_f32 v162, v160, v161
  v_lshlrev_b32_e64 v160, 16, v162
  v_and_b32 v161, 0xffff0000, v162
  v_pk_add_f32 v[164:165], v[160:161], 1.0 op_sel_hi:[1,0]
  v_cvt_pk_bf16_f32 v162, v164, v165
  v_lshlrev_b32 v164, 16, v162
  v_and_b32 v165, 0xffff0000, v162
  v_cndmask_b32 v160, v160, v164, vcc
  v_cndmask_b32 v161, v161, v165, vcc
  ds_write_b64 v54, v[160:161] offset:54784
  s_waitcnt vmcnt(0)
  ds_write_b128 v105, v[208:211] offset:55808
  s_waitcnt lgkmcnt(0)
L_notw0b_12:
  s_add_u32 s36, s28, 16777216
  s_addc_u32 s37, s29, 0
  s_mov_b32 s38, 4194304
  s_mov_b32 s39, 0x20000
  s_barrier
  s_nop 0
  ds_read_b128 v[32:35], v53 offset:54784
  ds_read_b128 v[40:43], v53 offset:55040
  ds_read_b128 v[36:39], v53 offset:54800
  ds_read_b128 v[44:47], v53 offset:55056
  ds_read_b64 v[84:85], v55 offset:55808
  ds_read_b64 v[86:87], v55 offset:55872
  ds_read_b64 v[88:89], v55 offset:55936
  ds_read_b64 v[90:91], v55 offset:56000
  s_waitcnt lgkmcnt(0)
  s_nop 0
  v_pk_add_f32 v[0:1], v[0:1], v[84:85] op_sel_hi:[1,0]
  v_pk_add_f32 v[2:3], v[2:3], v[84:85] op_sel_hi:[1,0]
  v_pk_add_f32 v[4:5], v[4:5], v[84:85] op_sel_hi:[1,0]
  v_pk_add_f32 v[6:7], v[6:7], v[84:85] op_sel_hi:[1,0]
  v_pk_mul_f32 v[0:1], v[0:1], v[84:85] op_sel:[0,1] op_sel_hi:[1,1]
  v_pk_mul_f32 v[2:3], v[2:3], v[84:85] op_sel:[0,1] op_sel_hi:[1,1]
  v_pk_mul_f32 v[4:5], v[4:5], v[84:85] op_sel:[0,1] op_sel_hi:[1,1]
  v_pk_mul_f32 v[6:7], v[6:7], v[84:85] op_sel:[0,1] op_sel_hi:[1,1]
  v_pk_fma_f32 v[0:1], v[0:1], v[40:41], v[32:33]
  v_pk_fma_f32 v[2:3], v[2:3], v[42:43], v[34:35]
  v_pk_fma_f32 v[4:5], v[4:5], v[44:45], v[36:37]
  v_pk_fma_f32 v[6:7], v[6:7], v[46:47], v[38:39]
  v_cvt_pk_bf16_f32 v128, v0, v1
  v_cvt_pk_bf16_f32 v129, v2, v3
  v_cvt_pk_bf16_f32 v130, v4, v5
  v_cvt_pk_bf16_f32 v131, v6, v7
  buffer_store_dwordx4 v[128:131], v52, s[36:39], s86 offen offset:0 sc1
  v_pk_add_f32 v[8:9], v[8:9], v[86:87] op_sel_hi:[1,0]
  v_pk_add_f32 v[10:11], v[10:11], v[86:87] op_sel_hi:[1,0]
  v_pk_add_f32 v[12:13], v[12:13], v[86:87] op_sel_hi:[1,0]
  v_pk_add_f32 v[14:15], v[14:15], v[86:87] op_sel_hi:[1,0]
  v_pk_mul_f32 v[8:9], v[8:9], v[86:87] op_sel:[0,1] op_sel_hi:[1,1]
  v_pk_mul_f32 v[10:11], v[10:11], v[86:87] op_sel:[0,1] op_sel_hi:[1,1]
  v_pk_mul_f32 v[12:13], v[12:13], v[86:87] op_sel:[0,1] op_sel_hi:[1,1]
  v_pk_mul_f32 v[14:15], v[14:15], v[86:87] op_sel:[0,1] op_sel_hi:[1,1]
  v_pk_fma_f32 v[8:9], v[8:9], v[40:41], v[32:33]
  v_pk_fma_f32 v[10:11], v[10:11], v[42:43], v[34:35]
  v_pk_fma_f32 v[12:13], v[12:13], v[44:45], v[36:37]
  v_pk_fma_f32 v[14:15], v[14:15], v[46:47], v[38:39]
  v_cvt_pk_bf16_f32 v132, v8, v9
  v_cvt_pk_bf16_f32 v133, v10, v11
  v_cvt_pk_bf16_f32 v134, v12, v13
  v_cvt_pk_bf16_f32 v135, v14, v15
  buffer_store_dwordx4 v[132:135], v52, s[36:39], s86 offen offset:128 sc1
  v_pk_add_f32 v[16:17], v[16:17], v[88:89] op_sel_hi:[1,0]
  v_pk_add_f32 v[18:19], v[18:19], v[88:89] op_sel_hi:[1,0]
  v_pk_add_f32 v[20:21], v[20:21], v[88:89] op_sel_hi:[1,0]
  v_pk_add_f32 v[22:23], v[22:23], v[88:89] op_sel_hi:[1,0]
  v_pk_mul_f32 v[16:17], v[16:17], v[88:89] op_sel:[0,1] op_sel_hi:[1,1]
  v_pk_mul_f32 v[18:19], v[18:19], v[88:89] op_sel:[0,1] op_sel_hi:[1,1]
  v_pk_mul_f32 v[20:21], v[20:21], v[88:89] op_sel:[0,1] op_sel_hi:[1,1]
  v_pk_mul_f32 v[22:23], v[22:23], v[88:89] op_sel:[0,1] op_sel_hi:[1,1]
  v_pk_fma_f32 v[16:17], v[16:17], v[40:41], v[32:33]
  v_pk_fma_f32 v[18:19], v[18:19], v[42:43], v[34:35]
  v_pk_fma_f32 v[20:21], v[20:21], v[44:45], v[36:37]
  v_pk_fma_f32 v[22:23], v[22:23], v[46:47], v[38:39]
  v_cvt_pk_bf16_f32 v136, v16, v17
  v_cvt_pk_bf16_f32 v137, v18, v19
  v_cvt_pk_bf16_f32 v138, v20, v21
  v_cvt_pk_bf16_f32 v139, v22, v23
  buffer_store_dwordx4 v[136:139], v52, s[36:39], s87 offen offset:0 sc1
  v_pk_add_f32 v[24:25], v[24:25], v[90:91] op_sel_hi:[1,0]
  v_pk_add_f32 v[26:27], v[26:27], v[90:91] op_sel_hi:[1,0]
  v_pk_add_f32 v[28:29], v[28:29], v[90:91] op_sel_hi:[1,0]
  v_pk_add_f32 v[30:31], v[30:31], v[90:91] op_sel_hi:[1,0]
  v_pk_mul_f32 v[24:25], v[24:25], v[90:91] op_sel:[0,1] op_sel_hi:[1,1]
  v_pk_mul_f32 v[26:27], v[26:27], v[90:91] op_sel:[0,1] op_sel_hi:[1,1]
  v_pk_mul_f32 v[28:29], v[28:29], v[90:91] op_sel:[0,1] op_sel_hi:[1,1]
  v_pk_mul_f32 v[30:31], v[30:31], v[90:91] op_sel:[0,1] op_sel_hi:[1,1]
  v_pk_fma_f32 v[24:25], v[24:25], v[40:41], v[32:33]
  v_pk_fma_f32 v[26:27], v[26:27], v[42:43], v[34:35]
  v_pk_fma_f32 v[28:29], v[28:29], v[44:45], v[36:37]
  v_pk_fma_f32 v[30:31], v[30:31], v[46:47], v[38:39]
  v_cvt_pk_bf16_f32 v140, v24, v25
  v_cvt_pk_bf16_f32 v141, v26, v27
  v_cvt_pk_bf16_f32 v142, v28, v29
  v_cvt_pk_bf16_f32 v143, v30, v31
  buffer_store_dwordx4 v[140:143], v52, s[36:39], s87 offen offset:128 sc1
  s_add_u32 s60, s22, 0
  s_add_u32 s75, s60, s31
  s_and_b32 s75, s75, 3
  s_and_b32 s60, s60, 4
  s_or_b32 s60, s60, s75
  s_mul_i32 s60, s60, 393216
  s_add_u32 m0, s76, 0
  s_nop 0
  buffer_load_dwordx4 v100, s[32:35], s60 offen lds
  s_nop 0
  buffer_load_dwordx4 v101, s[32:35], s60 offen offset:1056 lds
  s_add_u32 m0, s76, 6400
  s_nop 0
  buffer_load_dwordx4 v100, s[32:35], s60 offen offset:2048 lds
  s_nop 0
  buffer_load_dwordx4 v101, s[32:35], s60 offen offset:3104 lds
  v_mov_b32 v48, 1
  v_mov_b32 v49, 0
  s_waitcnt vmcnt(4)
  buffer_store_dword v48, v49, s[56:59], s89 offen sc1
  s_add_u32 s61, s22, 1
  s_add_u32 s75, s61, s31
  s_and_b32 s75, s75, 3
  s_and_b32 s61, s61, 4
  s_or_b32 s61, s61, s75
  s_mul_i32 s61, s61, 393216
  s_add_u32 m0, s76, 16896
  s_nop 0
  buffer_load_dwordx4 v100, s[32:35], s61 offen lds
  s_nop 0
  buffer_load_dwordx4 v101, s[32:35], s61 offen offset:1056 lds
  s_add_u32 m0, s76, 23296
  s_nop 0
  buffer_load_dwordx4 v100, s[32:35], s61 offen offset:2048 lds
  s_nop 0
  buffer_load_dwordx4 v101, s[32:35], s61 offen offset:3104 lds
  s_add_u32 s60, s22, 2
  s_add_u32 s75, s60, s31
  s_and_b32 s75, s75, 3
  s_and_b32 s60, s60, 4
  s_or_b32 s60, s60, s75
  s_mul_i32 s60, s60, 393216
  s_add_u32 m0, s76, 33792
  s_nop 0
  buffer_load_dwordx4 v100, s[32:35], s60 offen lds
  s_nop 0
  buffer_load_dwordx4 v101, s[32:35], s60 offen offset:1056 lds
  s_add_u32 m0, s76, 40192
  s_nop 0
  buffer_load_dwordx4 v100, s[32:35], s60 offen offset:2048 lds
  s_nop 0
  buffer_load_dwordx4 v101, s[32:35], s60 offen offset:3104 lds
  v_and_b32 v252, 15, v104
  v_lshlrev_b32 v252, 6, v252
  s_mov_b32 s93, s88
  s_mov_b32 s97, 0
  s_add_u32 s80, s22, 0
  s_add_u32 s75, s80, s31
  s_and_b32 s75, s75, 3
  s_and_b32 s80, s80, 4
  s_or_b32 s80, s80, s75
  s_lshl_b32 s81, 1, s80
  s_or_b32 s97, s97, s81
  s_add_u32 s80, s22, 1
  s_add_u32 s75, s80, s31
  s_and_b32 s75, s75, 3
  s_and_b32 s80, s80, 4
  s_or_b32 s80, s80, s75
  s_lshl_b32 s81, 1, s80
  s_or_b32 s97, s97, s81
  s_add_u32 s80, s22, 2
  s_add_u32 s75, s80, s31
  s_and_b32 s75, s75, 3
  s_and_b32 s80, s80, 4
  s_or_b32 s80, s80, s75
  s_lshl_b32 s81, 1, s80
  s_or_b32 s97, s97, s81
  s_add_u32 s80, s22, 3
  s_add_u32 s75, s80, s31
  s_and_b32 s75, s75, 3
  s_and_b32 s80, s80, 4
  s_or_b32 s80, s80, s75
  s_lshl_b32 s81, 1, s80
  s_or_b32 s97, s97, s81
  s_mov_b32 s96, 0
L_poll_15:
  buffer_load_dword v253, v252, s[56:59], s93 offen sc1
  s_waitcnt vmcnt(0)
  v_cmp_eq_u32 vcc, 0, v253
  s_add_u32 s96, s96, 1
  s_and_b32 s81, vcc_lo, s97
  s_cbranch_scc0 L_ok_16
  s_sleep 2
  s_cmp_lt_u32 s96, 0x200000
  s_cbranch_scc1 L_poll_15
L_ok_16:
  s_add_u32 s62, s22, 0
  s_add_u32 s75, s62, s31
  s_and_b32 s75, s75, 3
  s_and_b32 s62, s62, 4
  s_or_b32 s62, s62, s75
  s_mul_i32 s62, s62, 2048
  buffer_load_dwordx4 a[0:3], v102, s[36:39], s62 offen offset:0 sc1
  buffer_load_dwordx4 a[4:7], v103, s[36:39], s62 offen offset:0 sc1
  buffer_load_dwordx4 a[8:11], v102, s[36:39], s62 offen offset:1024 sc1
  buffer_load_dwordx4 a[12:15], v103, s[36:39], s62 offen offset:1024 sc1
  s_add_u32 s63, s22, 1
  s_add_u32 s75, s63, s31
  s_and_b32 s75, s75, 3
  s_and_b32 s63, s63, 4
  s_or_b32 s63, s63, s75
  s_mul_i32 s63, s63, 2048
  buffer_load_dwordx4 a[16:19], v102, s[36:39], s63 offen offset:0 sc1
  buffer_load_dwordx4 a[20:23], v103, s[36:39], s63 offen offset:0 sc1
  buffer_load_dwordx4 a[24:27], v102, s[36:39], s63 offen offset:1024 sc1
  buffer_load_dwordx4 a[28:31], v103, s[36:39], s63 offen offset:1024 sc1
  v_add_u32 v28, s22, v104
  v_add_u32 v29, s31, v28
  v_and_b32 v29, 3, v29
  v_and_b32 v28, 4, v28
  v_or_b32 v28, v28, v29
  v_and_b32 v29, 8, v104
  v_or_b32 v28, v28, v29
  v_lshlrev_b32 v29, 11, v28
  v_mul_u32_u24 v28, 393216, v28
  s_mov_b32 s40, s8
  s_mov_b32 s41, s9
  s_mov_b32 s42, 65536
  s_mov_b32 s43, 0x20000
  s_add_u32 s44, s28, 4194304
  s_addc_u32 s45, s29, 0
  s_mov_b32 s46, 2097152
  s_mov_b32 s47, 0x20000
  s_add_u32 s48, s28, 8388608
  s_addc_u32 s49, s29, 0
  s_mov_b32 s50, 131072
  s_mov_b32 s51, 0x20000
  s_lshr_b32 s80, s3, 1
  s_and_b32 s81, s3, 1
  v_and_b32 v106, 15, v104
  s_lshl_b32 s82, s3, 5
  v_add_u32 v106, s82, v106
  v_lshrrev_b32 v107, 4, v104
  v_lshlrev_b32 v107, 3, v107
  v_mul_u32_u24 v110, 136, v106
  v_add_u32 v110, v110, v107
  v_mul_u32_u24 v111, 72, v106
  v_add_u32 v111, v111, v107
  v_lshrrev_b32 v106, 2, v104
  v_and_b32 v107, 3, v104
  v_lshlrev_b32 v107, 3, v107
  s_mul_i32 s82, s80, 17408
  s_lshl_b32 s83, s81, 6
  s_add_u32 s82, s82, s83
  v_mul_u32_u24 v112, 136, v106
  v_add_u32 v112, v112, v107
  v_add_u32_e64 v112, s82, v112
  s_mul_i32 s82, s80, 9216
  v_mul_u32_u24 v113, 72, v106
  v_add_u32 v113, v113, v107
  v_add_u32 v113, s82, v113
  v_lshl_add_u32 v114, v106, 6, v107
  v_add_u32 v114, 110592, v114
  v_mov_b32 v116, 0x3f803f80
  v_mov_b32 v117, 0x3f803f80
  v_mov_b32 v118, 0x3f803f80
  v_mov_b32 v119, 0x3f803f80
  v_bfe_u32 v106, v104, 2, 2
  v_lshrrev_b32 v107, 4, v104
  v_cmp_eq_u32 vcc, v106, v107
  v_and_b32 v106, 1, v104
  v_lshlrev_b32 v106, 4, v106
  v_mov_b32 v107, 0x3f80
  v_lshlrev_b32 v107, v106, v107
  v_cndmask_b32 v107, 0, v107, vcc
  v_and_b32 v106, 2, v104
  v_cmp_eq_u32 vcc, 0, v106
  v_mov_b32 v120, 0
  v_mov_b32 v121, 0
  v_mov_b32 v124, 0
  v_mov_b32 v125, 0
  v_cndmask_b32_e64 v122, 0, v107, vcc
  v_cndmask_b32 v123, v107, 0, vcc
  s_mov_b32 s94, 1.4426950408889634
  s_mov_b32 s95, 1.4426950408889634
  s_lshl_b32 s84, s27, 12
  s_lshl_b32 s85, s3, 10
  s_add_u32 s84, s84, s85
  s_add_u32 s85, s85, 110592
  s_waitcnt vmcnt(8)
  s_barrier
  s_nop 0
  ds_read_b64_tr_b16 v[128:129], v96 offset:0
  ds_read_b64_tr_b16 v[130:131], v96 offset:256
  ds_read_b64_tr_b16 v[132:133], v96 offset:32
  ds_read_b64_tr_b16 v[134:135], v96 offset:288
  ds_read_b64_tr_b16 v[136:137], v96 offset:64
  ds_read_b64_tr_b16 v[138:139], v96 offset:320
  ds_read_b64_tr_b16 v[140:141], v96 offset:96
  ds_read_b64_tr_b16 v[142:143], v96 offset:352
  ds_read_b64_tr_b16 v[144:145], v96 offset:8448
  ds_read_b64_tr_b16 v[146:147], v96 offset:8704
  ds_read_b64_tr_b16 v[148:149], v96 offset:8480
  ds_read_b64_tr_b16 v[150:151], v96 offset:8736
  ds_read_b64_tr_b16 v[152:153], v96 offset:8512
  ds_read_b64_tr_b16 v[154:155], v96 offset:8768
  ds_read_b64_tr_b16 v[156:157], v96 offset:8544
  ds_read_b64_tr_b16 v[158:159], v96 offset:8800
  s_waitcnt vmcnt(6) lgkmcnt(0)
  v_mfma_f32_16x16x32_bf16 v[32:35], v[128:131], a[0:3], 0
  ds_read_b64_tr_b16 v[160:161], v96 offset:4224
  s_add_u32 s62, s22, 2
  ds_read_b64_tr_b16 v[162:163], v96 offset:4480
  v_mfma_f32_16x16x32_bf16 v[36:39], v[128:131], a[4:7], 0
  s_add_u32 s75, s62, s31
  ds_read_b64_tr_b16 v[164:165], v96 offset:4256
  v_mfma_f32_16x16x32_bf16 v[44:47], v[132:135], a[4:7], 0
  s_and_b32 s75, s75, 3
  ds_read_b64_tr_b16 v[166:167], v96 offset:4512
  s_and_b32 s62, s62, 4
  v_mfma_f32_16x16x32_bf16 v[40:43], v[132:135], a[0:3], 0
  ds_read_b64_tr_b16 v[168:169], v96 offset:4288
  s_or_b32 s62, s62, s75
  ds_read_b64_tr_b16 v[170:171], v96 offset:4544
  v_mfma_f32_16x16x32_bf16 v[48:51], v[136:139], a[0:3], 0
  s_mul_i32 s62, s62, 2048
  ds_read_b64_tr_b16 v[172:173], v96 offset:4320
  v_mfma_f32_16x16x32_bf16 v[52:55], v[136:139], a[4:7], 0
  buffer_load_dwordx4 a[32:35], v102, s[36:39], s62 offen offset:0 sc1
  ds_read_b64_tr_b16 v[174:175], v96 offset:4576
  v_mfma_f32_16x16x32_bf16 v[60:63], v[140:143], a[4:7], 0
  ds_read_b64_tr_b16 v[176:177], v96 offset:12672
  s_add_u32 s61, s22, 3
  ds_read_b64_tr_b16 v[178:179], v96 offset:12928
  v_mfma_f32_16x16x32_bf16 v[56:59], v[140:143], a[0:3], 0
  s_add_u32 s75, s61, s31
  ds_read_b64_tr_b16 v[180:181], v96 offset:12704
  s_and_b32 s75, s75, 3
  v_mfma_f32_16x16x32_bf16 v[64:67], v[144:147], a[0:3], 0
  ds_read_b64_tr_b16 v[182:183], v96 offset:12960
  s_and_b32 s61, s61, 4
  v_mfma_f32_16x16x32_bf16 v[68:71], v[144:147], a[4:7], 0
  ds_read_b64_tr_b16 v[184:185], v96 offset:12736
  s_or_b32 s61, s61, s75
  ds_read_b64_tr_b16 v[186:187], v96 offset:12992
  v_mfma_f32_16x16x32_bf16 v[76:79], v[148:151], a[4:7], 0
  s_mul_i32 s61, s61, 393216
  ds_read_b64_tr_b16 v[188:189], v96 offset:12768
  s_add_u32 m0, s76, 50688
  v_mfma_f32_16x16x32_bf16 v[72:75], v[148:151], a[0:3], 0
  ds_read_b64_tr_b16 v[190:191], v96 offset:13024
  buffer_load_dwordx4 v100, s[32:35], s61 offen lds
  v_mfma_f32_16x16x32_bf16 v[80:83], v[152:155], a[0:3], 0
  buffer_load_dwordx4 a[36:39], v103, s[36:39], s62 offen offset:0 sc1
  v_mfma_f32_16x16x32_bf16 v[84:87], v[152:155], a[4:7], 0
  v_mfma_f32_16x16x32_bf16 v[92:95], v[156:159], a[4:7], 0
  buffer_load_dwordx4 v101, s[32:35], s61 offen offset:1056 lds
  s_add_u32 m0, s76, 57088
  v_mfma_f32_16x16x32_bf16 v[88:91], v[156:159], a[0:3], 0
  buffer_load_dwordx4 v100, s[32:35], s61 offen offset:2048 lds
  s_waitcnt vmcnt(9) lgkmcnt(0)
  v_mfma_f32_16x16x32_bf16 v[32:35], v[160:163], a[8:11], v[32:35]
  s_waitcnt vmcnt(13)
  s_barrier
  v_mfma_f32_16x16x32_bf16 v[36:39], v[160:163], a[12:15], v[36:39]
  ds_read_b64_tr_b16 v[128:129], v96 offset:16896
  buffer_load_dwordx4 a[40:43], v102, s[36:39], s62 offen offset:1024 sc1
  ds_read_b64_tr_b16 v[130:131], v96 offset:17152
  v_mfma_f32_16x16x32_bf16 v[44:47], v[164:167], a[12:15], v[44:47]
  ds_read_b64_tr_b16 v[132:133], v96 offset:16928
  v_mfma_f32_16x16x32_bf16 v[40:43], v[164:167], a[8:11], v[40:43]
  ds_read_b64_tr_b16 v[134:135], v96 offset:17184
  buffer_load_dwordx4 v101, s[32:35], s61 offen offset:3104 lds
  ds_read_b64_tr_b16 v[136:137], v96 offset:16960
  v_mfma_f32_16x16x32_bf16 v[48:51], v[168:171], a[8:11], v[48:51]
  ds_read_b64_tr_b16 v[138:139], v96 offset:17216
  buffer_load_dwordx4 a[44:47], v103, s[36:39], s62 offen offset:1024 sc1
  v_mfma_f32_16x16x32_bf16 v[52:55], v[168:171], a[12:15], v[52:55]
  ds_read_b64_tr_b16 v[140:141], v96 offset:16992
  s_add_u32 s60, s22, 4
  ds_read_b64_tr_b16 v[142:143], v96 offset:17248
  v_mfma_f32_16x16x32_bf16 v[60:63], v[172:175], a[12:15], v[60:63]
  ds_read_b64_tr_b16 v[144:145], v96 offset:25344
  s_add_u32 s75, s60, s31
  v_mfma_f32_16x16x32_bf16 v[56:59], v[172:175], a[8:11], v[56:59]
  ds_read_b64_tr_b16 v[146:147], v96 offset:25600
  s_and_b32 s75, s75, 3
  ds_read_b64_tr_b16 v[148:149], v96 offset:25376
  v_mfma_f32_16x16x32_bf16 v[64:67], v[176:179], a[8:11], v[64:67]
  s_and_b32 s60, s60, 4
  ds_read_b64_tr_b16 v[150:151], v96 offset:25632
  v_mfma_f32_16x16x32_bf16 v[68:71], v[176:179], a[12:15], v[68:71]
  ds_read_b64_tr_b16 v[152:153], v96 offset:25408
  s_or_b32 s60, s60, s75
  ds_read_b64_tr_b16 v[154:155], v96 offset:25664
  v_mfma_f32_16x16x32_bf16 v[76:79], v[180:183], a[12:15], v[76:79]
  s_mul_i32 s60, s60, 393216
  ds_read_b64_tr_b16 v[156:157], v96 offset:25440
  v_mfma_f32_16x16x32_bf16 v[72:75], v[180:183], a[8:11], v[72:75]
  ds_read_b64_tr_b16 v[158:159], v96 offset:25696
  s_add_u32 m0, s76, 0
  v_mfma_f32_16x16x32_bf16 v[80:83], v[184:187], a[8:11], v[80:83]
  buffer_load_dwordx4 v100, s[32:35], s60 offen lds
  v_mfma_f32_16x16x32_bf16 v[84:87], v[184:187], a[12:15], v[84:87]
  v_readlane_b32 s61, v28, 5
  v_mfma_f32_16x16x32_bf16 v[92:95], v[188:191], a[12:15], v[92:95]
  v_mfma_f32_16x16x32_bf16 v[88:91], v[188:191], a[8:11], v[88:91]
  buffer_load_dwordx4 v101, s[32:35], s60 offen offset:1056 lds
  s_waitcnt vmcnt(12) lgkmcnt(0)
  v_mfma_f32_16x16x32_bf16 v[32:35], v[128:131], a[16:19], v[32:35]
  ds_read_b64_tr_b16 v[160:161], v96 offset:21120
  s_add_u32 s63, s22, 3
  v_mfma_f32_16x16x32_bf16 v[36:39], v[128:131], a[20:23], v[36:39]
  ds_read_b64_tr_b16 v[162:163], v96 offset:21376
  ds_read_b64_tr_b16 v[164:165], v96 offset:21152
  v_mfma_f32_16x16x32_bf16 v[44:47], v[132:135], a[20:23], v[44:47]
  s_add_u32 s75, s63, s31
  ds_read_b64_tr_b16 v[166:167], v96 offset:21408
  v_mfma_f32_16x16x32_bf16 v[40:43], v[132:135], a[16:19], v[40:43]
  ds_read_b64_tr_b16 v[168:169], v96 offset:21184
  s_and_b32 s75, s75, 3
  v_mfma_f32_16x16x32_bf16 v[48:51], v[136:139], a[16:19], v[48:51]
  ds_read_b64_tr_b16 v[170:171], v96 offset:21440
  ds_read_b64_tr_b16 v[172:173], v96 offset:21216
  v_mfma_f32_16x16x32_bf16 v[52:55], v[136:139], a[20:23], v[52:55]
  s_and_b32 s63, s63, 4
  ds_read_b64_tr_b16 v[174:175], v96 offset:21472
  v_mfma_f32_16x16x32_bf16 v[60:63], v[140:143], a[20:23], v[60:63]
  ds_read_b64_tr_b16 v[176:177], v96 offset:29568
  s_or_b32 s63, s63, s75
  v_mfma_f32_16x16x32_bf16 v[56:59], v[140:143], a[16:19], v[56:59]
  ds_read_b64_tr_b16 v[178:179], v96 offset:29824
  s_mul_i32 s63, s63, 2048
  v_mfma_f32_16x16x32_bf16 v[64:67], v[144:147], a[16:19], v[64:67]
  ds_read_b64_tr_b16 v[180:181], v96 offset:29600
  ds_read_b64_tr_b16 v[182:183], v96 offset:29856
  v_mfma_f32_16x16x32_bf16 v[68:71], v[144:147], a[20:23], v[68:71]
  buffer_load_dwordx4 a[48:51], v102, s[36:39], s63 offen offset:0 sc1
  ds_read_b64_tr_b16 v[184:185], v96 offset:29632
  v_mfma_f32_16x16x32_bf16 v[76:79], v[148:151], a[20:23], v[76:79]
  ds_read_b64_tr_b16 v[186:187], v96 offset:29888
  s_add_u32 m0, s76, 6400
  v_mfma_f32_16x16x32_bf16 v[72:75], v[148:151], a[16:19], v[72:75]
  ds_read_b64_tr_b16 v[188:189], v96 offset:29664
  ds_read_b64_tr_b16 v[190:191], v96 offset:29920
  v_mfma_f32_16x16x32_bf16 v[80:83], v[152:155], a[16:19], v[80:83]
  buffer_load_dwordx4 v100, s[32:35], s60 offen offset:2048 lds
  buffer_load_dwordx4 a[52:55], v103, s[36:39], s63 offen offset:0 sc1
  v_mfma_f32_16x16x32_bf16 v[84:87], v[152:155], a[20:23], v[84:87]
  v_mfma_f32_16x16x32_bf16 v[92:95], v[156:159], a[20:23], v[92:95]
  v_mfma_f32_16x16x32_bf16 v[88:91], v[156:159], a[16:19], v[88:91]
  buffer_load_dwordx4 v101, s[32:35], s60 offen offset:3104 lds
  s_waitcnt vmcnt(14) lgkmcnt(0)
  v_mfma_f32_16x16x32_bf16 v[32:35], v[160:163], a[24:27], v[32:35]
  s_waitcnt vmcnt(22)
  s_barrier
  v_mfma_f32_16x16x32_bf16 v[36:39], v[160:163], a[28:31], v[36:39]
  ds_read_b64_tr_b16 v[128:129], v97 offset:0
  ds_read_b64_tr_b16 v[130:131], v97 offset:256
  v_mfma_f32_16x16x32_bf16 v[44:47], v[164:167], a[28:31], v[44:47]
  buffer_load_dword v253, v252, s[56:59], s93 offen sc1
  ds_read_b64_tr_b16 v[132:133], v97 offset:32
  v_mfma_f32_16x16x32_bf16 v[40:43], v[164:167], a[24:27], v[40:43]
  ds_read_b64_tr_b16 v[134:135], v97 offset:288
  buffer_load_dwordx4 a[56:59], v102, s[36:39], s63 offen offset:1024 sc1
  v_mfma_f32_16x16x32_bf16 v[48:51], v[168:171], a[24:27], v[48:51]
  ds_read_b64_tr_b16 v[136:137], v97 offset:64
  ds_read_b64_tr_b16 v[138:139], v97 offset:320
  v_mfma_f32_16x16x32_bf16 v[52:55], v[168:171], a[28:31], v[52:55]
  s_add_u32 m0, s76, 16896
  ds_read_b64_tr_b16 v[140:141], v97 offset:96
  v_mfma_f32_16x16x32_bf16 v[60:63], v[172:175], a[28:31], v[60:63]
  ds_read_b64_tr_b16 v[142:143], v97 offset:352
  buffer_load_dwordx4 v100, s[32:35], s61 offen lds
  v_mfma_f32_16x16x32_bf16 v[56:59], v[172:175], a[24:27], v[56:59]
  ds_read_b64_tr_b16 v[144:145], v97 offset:8448
  ds_read_b64_tr_b16 v[146:147], v97 offset:8704
  v_mfma_f32_16x16x32_bf16 v[64:67], v[176:179], a[24:27], v[64:67]
  v_readlane_b32 s60, v28, 6
  ds_read_b64_tr_b16 v[148:149], v97 offset:8480
  v_mfma_f32_16x16x32_bf16 v[68:71], v[176:179], a[28:31], v[68:71]
  ds_read_b64_tr_b16 v[150:151], v97 offset:8736
  ds_read_b64_tr_b16 v[152:153], v97 offset:8512
  v_mfma_f32_16x16x32_bf16 v[76:79], v[180:183], a[28:31], v[76:79]
  buffer_load_dwordx4 a[60:63], v103, s[36:39], s63 offen offset:1024 sc1
  ds_read_b64_tr_b16 v[154:155], v97 offset:8768
  v_mfma_f32_16x16x32_bf16 v[72:75], v[180:183], a[24:27], v[72:75]
  ds_read_b64_tr_b16 v[156:157], v97 offset:8544
  v_mfma_f32_16x16x32_bf16 v[80:83], v[184:187], a[24:27], v[80:83]
  ds_read_b64_tr_b16 v[158:159], v97 offset:8800
  buffer_load_dwordx4 v101, s[32:35], s61 offen offset:1056 lds
  v_mfma_f32_16x16x32_bf16 v[84:87], v[184:187], a[28:31], v[84:87]
  s_add_u32 m0, s76, 23296
  v_mfma_f32_16x16x32_bf16 v[92:95], v[188:191], a[28:31], v[92:95]
  v_mfma_f32_16x16x32_bf16 v[88:91], v[188:191], a[24:27], v[88:91]
  buffer_load_dwordx4 v100, s[32:35], s61 offen offset:2048 lds
  s_waitcnt vmcnt(17) lgkmcnt(0)
  v_mfma_f32_16x16x32_bf16 v[32:35], v[128:131], a[32:35], v[32:35]
  ds_read_b64_tr_b16 v[160:161], v97 offset:4224
  s_waitcnt vmcnt(5)
  v_mfma_f32_16x16x32_bf16 v[36:39], v[128:131], a[36:39], v[36:39]
  ds_read_b64_tr_b16 v[162:163], v97 offset:4480
  ds_read_b64_tr_b16 v[164:165], v97 offset:4256
  v_mfma_f32_16x16x32_bf16 v[44:47], v[132:135], a[36:39], v[44:47]
  v_cmp_eq_u32 vcc, 0, v253
  s_cmp_eq_u64 vcc, 0
  s_cbranch_scc1 L_gok_17
  s_mov_b32 s96, 0
L_poll_18:
  buffer_load_dword v253, v252, s[56:59], s93 offen sc1
  s_waitcnt vmcnt(0)
  v_cmp_eq_u32 vcc, 0, v253
  s_add_u32 s96, s96, 1
  s_cmp_eq_u64 vcc, 0
  s_cbranch_scc1 L_ok_19
  s_sleep 2
  s_cmp_lt_u32 s96, 0x200000
  s_cbranch_scc1 L_poll_18
L_ok_19:
L_gok_17:
  ds_read_b64_tr_b16 v[166:167], v97 offset:4512
  v_mfma_f32_16x16x32_bf16 v[40:43], v[132:135], a[32:35], v[40:43]
  s_add_u32 s62, s22, 4
  ds_read_b64_tr_b16 v[168:169], v97 offset:4288
  v_mfma_f32_16x16x32_bf16 v[48:51], v[136:139], a[32:35], v[48:51]
  s_add_u32 s75, s62, s31
  ds_read_b64_tr_b16 v[170:171], v97 offset:4544
  v_mfma_f32_16x16x32_bf16 v[52:55], v[136:139], a[36:39], v[52:55]
  ds_read_b64_tr_b16 v[172:173], v97 offset:4320
  s_and_b32 s75, s75, 3
  v_mfma_f32_16x16x32_bf16 v[60:63], v[140:143], a[36:39], v[60:63]
  ds_read_b64_tr_b16 v[174:175], v97 offset:4576
  s_and_b32 s62, s62, 4
  v_mfma_f32_16x16x32_bf16 v[56:59], v[140:143], a[32:35], v[56:59]
  ds_read_b64_tr_b16 v[176:177], v97 offset:12672
  ds_read_b64_tr_b16 v[178:179], v97 offset:12928
  v_mfma_f32_16x16x32_bf16 v[64:67], v[144:147], a[32:35], v[64:67]
  s_or_b32 s62, s62, s75
  ds_read_b64_tr_b16 v[180:181], v97 offset:12704
  v_mfma_f32_16x16x32_bf16 v[68:71], v[144:147], a[36:39], v[68:71]
  s_mul_i32 s62, s62, 2048
  ds_read_b64_tr_b16 v[182:183], v97 offset:12960
  v_mfma_f32_16x16x32_bf16 v[76:79], v[148:151], a[36:39], v[76:79]
  ds_read_b64_tr_b16 v[184:185], v97 offset:12736
  buffer_load_dwordx4 a[64:67], v102, s[36:39], s62 offen offset:0 sc1
  v_mfma_f32_16x16x32_bf16 v[72:75], v[148:151], a[32:35], v[72:75]
  ds_read_b64_tr_b16 v[186:187], v97 offset:12992
  v_readlane_b32 s63, v29, 5
  v_mfma_f32_16x16x32_bf16 v[80:83], v[152:155], a[32:35], v[80:83]
  ds_read_b64_tr_b16 v[188:189], v97 offset:12768
  s_add_u32 m0, s76, 23296
  v_mfma_f32_16x16x32_bf16 v[84:87], v[152:155], a[36:39], v[84:87]
  ds_read_b64_tr_b16 v[190:191], v97 offset:13024
  buffer_load_dwordx4 v101, s[32:35], s61 offen offset:3104 lds
  v_mfma_f32_16x16x32_bf16 v[92:95], v[156:159], a[36:39], v[92:95]
  buffer_load_dwordx4 a[68:71], v103, s[36:39], s62 offen offset:0 sc1
  s_mov_b32 m0, s85
  v_mfma_f32_16x16x32_bf16 v[88:91], v[156:159], a[32:35], v[88:91]
  buffer_load_dwordx4 v105, s[40:43], s84 offen lds
  s_waitcnt vmcnt(16) lgkmcnt(0)
  v_mfma_f32_16x16x32_bf16 v[32:35], v[160:163], a[40:43], v[32:35]
  s_waitcnt vmcnt(17)
  s_barrier
  v_mfma_f32_16x16x32_bf16 v[36:39], v[160:163], a[44:47], v[36:39]
  ds_read_b64_tr_b16 v[128:129], v97 offset:16896
  ds_read_b64_tr_b16 v[130:131], v97 offset:17152
  v_mfma_f32_16x16x32_bf16 v[44:47], v[164:167], a[44:47], v[44:47]
  buffer_load_dwordx4 a[72:75], v102, s[36:39], s62 offen offset:1024 sc1
  ds_read_b64_tr_b16 v[132:133], v97 offset:16928
  v_mfma_f32_16x16x32_bf16 v[40:43], v[164:167], a[40:43], v[40:43]
  ds_read_b64_tr_b16 v[134:135], v97 offset:17184
  s_add_u32 m0, s76, 33792
  v_mfma_f32_16x16x32_bf16 v[48:51], v[168:171], a[40:43], v[48:51]
  ds_read_b64_tr_b16 v[136:137], v97 offset:16960
  ds_read_b64_tr_b16 v[138:139], v97 offset:17216
  v_mfma_f32_16x16x32_bf16 v[52:55], v[168:171], a[44:47], v[52:55]
  ds_read_b64_tr_b16 v[140:141], v97 offset:16992
  buffer_load_dwordx4 v100, s[32:35], s60 offen lds
  v_mfma_f32_16x16x32_bf16 v[60:63], v[172:175], a[44:47], v[60:63]
  ds_read_b64_tr_b16 v[142:143], v97 offset:17248
  ds_read_b64_tr_b16 v[144:145], v97 offset:25344
  v_mfma_f32_16x16x32_bf16 v[56:59], v[172:175], a[40:43], v[56:59]
  v_readlane_b32 s61, v28, 7
  ds_read_b64_tr_b16 v[146:147], v97 offset:25600
  v_mfma_f32_16x16x32_bf16 v[64:67], v[176:179], a[40:43], v[64:67]
  ds_read_b64_tr_b16 v[148:149], v97 offset:25376
  buffer_load_dwordx4 a[76:79], v103, s[36:39], s62 offen offset:1024 sc1
  v_mfma_f32_16x16x32_bf16 v[68:71], v[176:179], a[44:47], v[68:71]
  ds_read_b64_tr_b16 v[150:151], v97 offset:25632
  ds_read_b64_tr_b16 v[152:153], v97 offset:25408
  v_mfma_f32_16x16x32_bf16 v[76:79], v[180:183], a[44:47], v[76:79]
  ds_read_b64_tr_b16 v[154:155], v97 offset:25664
  v_mfma_f32_16x16x32_bf16 v[72:75], v[180:183], a[40:43], v[72:75]
  ds_read_b64_tr_b16 v[156:157], v97 offset:25440
  ds_read_b64_tr_b16 v[158:159], v97 offset:25696
  v_mfma_f32_16x16x32_bf16 v[80:83], v[184:187], a[40:43], v[80:83]
  buffer_load_dwordx4 v101, s[32:35], s60 offen offset:1056 lds
  v_mfma_f32_16x16x32_bf16 v[84:87], v[184:187], a[44:47], v[84:87]
  s_add_u32 m0, s76, 40192
  v_mfma_f32_16x16x32_bf16 v[92:95], v[188:191], a[44:47], v[92:95]
  v_mfma_f32_16x16x32_bf16 v[88:91], v[188:191], a[40:43], v[88:91]
  buffer_load_dwordx4 v100, s[32:35], s60 offen offset:2048 lds
  s_waitcnt vmcnt(16) lgkmcnt(0)
  v_mfma_f32_16x16x32_bf16 v[32:35], v[128:131], a[48:51], v[32:35]
  ds_read_b64_tr_b16 v[160:161], v97 offset:21120
  ds_read_b64_tr_b16 v[162:163], v97 offset:21376
  v_mfma_f32_16x16x32_bf16 v[36:39], v[128:131], a[52:55], v[36:39]
  ds_read_b64_tr_b16 v[164:165], v97 offset:21152
  buffer_load_dwordx4 a[80:83], v102, s[36:39], s63 offen offset:0 sc1
  v_mfma_f32_16x16x32_bf16 v[44:47], v[132:135], a[52:55], v[44:47]
  ds_read_b64_tr_b16 v[166:167], v97 offset:21408
  v_mfma_f32_16x16x32_bf16 v[40:43], v[132:135], a[48:51], v[40:43]
  ds_read_b64_tr_b16 v[168:169], v97 offset:21184
  ds_read_b64_tr_b16 v[170:171], v97 offset:21440
  v_mfma_f32_16x16x32_bf16 v[48:51], v[136:139], a[48:51], v[48:51]
  ds_read_b64_tr_b16 v[172:173], v97 offset:21216
  v_readlane_b32 s62, v29, 6
  v_mfma_f32_16x16x32_bf16 v[52:55], v[136:139], a[52:55], v[52:55]
  ds_read_b64_tr_b16 v[174:175], v97 offset:21472
  v_mfma_f32_16x16x32_bf16 v[60:63], v[140:143], a[52:55], v[60:63]
  ds_read_b64_tr_b16 v[176:177], v97 offset:29568
  ds_read_b64_tr_b16 v[178:179], v97 offset:29824
  v_mfma_f32_16x16x32_bf16 v[56:59], v[140:143], a[48:51], v[56:59]
  ds_read_b64_tr_b16 v[180:181], v97 offset:29600
  v_mfma_f32_16x16x32_bf16 v[64:67], v[144:147], a[48:51], v[64:67]
  ds_read_b64_tr_b16 v[182:183], v97 offset:29856
  v_mfma_f32_16x16x32_bf16 v[68:71], v[144:147], a[52:55], v[68:71]
  ds_read_b64_tr_b16 v[184:185], v97 offset:29632
  ds_read_b64_tr_b16 v[186:187], v97 offset:29888
  v_mfma_f32_16x16x32_bf16 v[76:79], v[148:151], a[52:55], v[76:79]
  ds_read_b64_tr_b16 v[188:189], v97 offset:29664
  v_mfma_f32_16x16x32_bf16 v[72:75], v[148:151], a[48:51], v[72:75]
  buffer_load_dwordx4 v101, s[32:35], s60 offen offset:3104 lds
  ds_read_b64_tr_b16 v[190:191], v97 offset:29920
  v_mfma_f32_16x16x32_bf16 v[80:83], v[152:155], a[48:51], v[80:83]
  v_mfma_f32_16x16x32_bf16 v[84:87], v[152:155], a[52:55], v[84:87]
  v_mfma_f32_16x16x32_bf16 v[92:95], v[156:159], a[52:55], v[92:95]
  buffer_load_dwordx4 a[84:87], v103, s[36:39], s63 offen offset:0 sc1
  v_mfma_f32_16x16x32_bf16 v[88:91], v[156:159], a[48:51], v[88:91]
  s_waitcnt vmcnt(14) lgkmcnt(0)
  v_mfma_f32_16x16x32_bf16 v[32:35], v[160:163], a[56:59], v[32:35]
  s_waitcnt vmcnt(18)
  s_barrier
  v_mfma_f32_16x16x32_bf16 v[36:39], v[160:163], a[60:63], v[36:39]
  ds_read_b64_tr_b16 v[128:129], v96 offset:0
  ds_read_b64_tr_b16 v[130:131], v96 offset:256
  v_mfma_f32_16x16x32_bf16 v[44:47], v[164:167], a[60:63], v[44:47]
  buffer_load_dwordx4 a[88:91], v102, s[36:39], s63 offen offset:1024 sc1
  ds_read_b64_tr_b16 v[132:133], v96 offset:32
  v_mfma_f32_16x16x32_bf16 v[40:43], v[164:167], a[56:59], v[40:43]
  ds_read_b64_tr_b16 v[134:135], v96 offset:288
  s_add_u32 m0, s76, 50688
  v_mfma_f32_16x16x32_bf16 v[48:51], v[168:171], a[56:59], v[48:51]
  ds_read_b64_tr_b16 v[136:137], v96 offset:64
  ds_read_b64_tr_b16 v[138:139], v96 offset:320
  v_mfma_f32_16x16x32_bf16 v[52:55], v[168:171], a[60:63], v[52:55]
  ds_read_b64_tr_b16 v[140:141], v96 offset:96
  buffer_load_dwordx4 v100, s[32:35], s61 offen lds
  v_mfma_f32_16x16x32_bf16 v[60:63], v[172:175], a[60:63], v[60:63]
  ds_read_b64_tr_b16 v[142:143], v96 offset:352
  ds_read_b64_tr_b16 v[144:145], v96 offset:8448
  v_mfma_f32_16x16x32_bf16 v[56:59], v[172:175], a[56:59], v[56:59]
  v_readlane_b32 s60, v28, 8
  ds_read_b64_tr_b16 v[146:147], v96 offset:8704
  v_mfma_f32_16x16x32_bf16 v[64:67], v[176:179], a[56:59], v[64:67]
  ds_read_b64_tr_b16 v[148:149], v96 offset:8480
  buffer_load_dwordx4 a[92:95], v103, s[36:39], s63 offen offset:1024 sc1
  v_mfma_f32_16x16x32_bf16 v[68:71], v[176:179], a[60:63], v[68:71]
  ds_read_b64_tr_b16 v[150:151], v96 offset:8736
  ds_read_b64_tr_b16 v[152:153], v96 offset:8512
  v_mfma_f32_16x16x32_bf16 v[76:79], v[180:183], a[60:63], v[76:79]
  ds_read_b64_tr_b16 v[154:155], v96 offset:8768
  v_mfma_f32_16x16x32_bf16 v[72:75], v[180:183], a[56:59], v[72:75]
  ds_read_b64_tr_b16 v[156:157], v96 offset:8544
  ds_read_b64_tr_b16 v[158:159], v96 offset:8800
  v_mfma_f32_16x16x32_bf16 v[80:83], v[184:187], a[56:59], v[80:83]
  buffer_load_dwordx4 v101, s[32:35], s61 offen offset:1056 lds
  v_mfma_f32_16x16x32_bf16 v[84:87], v[184:187], a[60:63], v[84:87]
  s_add_u32 m0, s76, 57088
  v_mfma_f32_16x16x32_bf16 v[92:95], v[188:191], a[60:63], v[92:95]
  v_mfma_f32_16x16x32_bf16 v[88:91], v[188:191], a[56:59], v[88:91]
  buffer_load_dwordx4 v100, s[32:35], s61 offen offset:2048 lds
  s_waitcnt vmcnt(14) lgkmcnt(0)
  v_mfma_f32_16x16x32_bf16 v[32:35], v[128:131], a[64:67], v[32:35]
  ds_read_b64_tr_b16 v[160:161], v96 offset:4224
  ds_read_b64_tr_b16 v[162:163], v96 offset:4480
  v_mfma_f32_16x16x32_bf16 v[36:39], v[128:131], a[68:71], v[36:39]
  ds_read_b64_tr_b16 v[164:165], v96 offset:4256
  buffer_load_dwordx4 a[96:99], v102, s[36:39], s62 offen offset:0 sc1
  v_mfma_f32_16x16x32_bf16 v[44:47], v[132:135], a[68:71], v[44:47]
  ds_read_b64_tr_b16 v[166:167], v96 offset:4512
  v_mfma_f32_16x16x32_bf16 v[40:43], v[132:135], a[64:67], v[40:43]
  ds_read_b64_tr_b16 v[168:169], v96 offset:4288
  ds_read_b64_tr_b16 v[170:171], v96 offset:4544
  v_mfma_f32_16x16x32_bf16 v[48:51], v[136:139], a[64:67], v[48:51]
  ds_read_b64_tr_b16 v[172:173], v96 offset:4320
  v_readlane_b32 s63, v29, 7
  v_mfma_f32_16x16x32_bf16 v[52:55], v[136:139], a[68:71], v[52:55]
  ds_read_b64_tr_b16 v[174:175], v96 offset:4576
  v_mfma_f32_16x16x32_bf16 v[60:63], v[140:143], a[68:71], v[60:63]
  ds_read_b64_tr_b16 v[176:177], v96 offset:12672
  ds_read_b64_tr_b16 v[178:179], v96 offset:12928
  v_mfma_f32_16x16x32_bf16 v[56:59], v[140:143], a[64:67], v[56:59]
  ds_read_b64_tr_b16 v[180:181], v96 offset:12704
  v_mfma_f32_16x16x32_bf16 v[64:67], v[144:147], a[64:67], v[64:67]
  ds_read_b64_tr_b16 v[182:183], v96 offset:12960
  v_mfma_f32_16x16x32_bf16 v[68:71], v[144:147], a[68:71], v[68:71]
  ds_read_b64_tr_b16 v[184:185], v96 offset:12736
  ds_read_b64_tr_b16 v[186:187], v96 offset:12992
  v_mfma_f32_16x16x32_bf16 v[76:79], v[148:151], a[68:71], v[76:79]
  ds_read_b64_tr_b16 v[188:189], v96 offset:12768
  v_mfma_f32_16x16x32_bf16 v[72:75], v[148:151], a[64:67], v[72:75]
  buffer_load_dwordx4 v101, s[32:35], s61 offen offset:3104 lds
  ds_read_b64_tr_b16 v[190:191], v96 offset:13024
  v_mfma_f32_16x16x32_bf16 v[80:83], v[152:155], a[64:67], v[80:83]
  v_mfma_f32_16x16x32_bf16 v[84:87], v[152:155], a[68:71], v[84:87]
  v_mfma_f32_16x16x32_bf16 v[92:95], v[156:159], a[68:71], v[92:95]
  buffer_load_dwordx4 a[100:103], v103, s[36:39], s62 offen offset:0 sc1
  v_mfma_f32_16x16x32_bf16 v[88:91], v[156:159], a[64:67], v[88:91]
  s_waitcnt vmcnt(13) lgkmcnt(0)
  v_mfma_f32_16x16x32_bf16 v[32:35], v[160:163], a[72:75], v[32:35]
  s_waitcnt vmcnt(18)
  s_barrier
  v_mfma_f32_16x16x32_bf16 v[36:39], v[160:163], a[76:79], v[36:39]
  ds_read_b64_tr_b16 v[128:129], v96 offset:16896
  ds_read_b64_tr_b16 v[130:131], v96 offset:17152
  v_mfma_f32_16x16x32_bf16 v[44:47], v[164:167], a[76:79], v[44:47]
  buffer_load_dwordx4 a[104:107], v102, s[36:39], s62 offen offset:1024 sc1
  ds_read_b64_tr_b16 v[132:133], v96 offset:16928
  v_mfma_f32_16x16x32_bf16 v[40:43], v[164:167], a[72:75], v[40:43]
  ds_read_b64_tr_b16 v[134:135], v96 offset:17184
  s_add_u32 m0, s76, 0
  v_mfma_f32_16x16x32_bf16 v[48:51], v[168:171], a[72:75], v[48:51]
  ds_read_b64_tr_b16 v[136:137], v96 offset:16960
  ds_read_b64_tr_b16 v[138:139], v96 offset:17216
  v_mfma_f32_16x16x32_bf16 v[52:55], v[168:171], a[76:79], v[52:55]
  ds_read_b64_tr_b16 v[140:141], v96 offset:16992
  buffer_load_dwordx4 v100, s[32:35], s60 offen lds
  v_mfma_f32_16x16x32_bf16 v[60:63], v[172:175], a[76:79], v[60:63]
  ds_read_b64_tr_b16 v[142:143], v96 offset:17248
  ds_read_b64_tr_b16 v[144:145], v96 offset:25344
  v_mfma_f32_16x16x32_bf16 v[56:59], v[172:175], a[72:75], v[56:59]
  v_readlane_b32 s61, v28, 9
  ds_read_b64_tr_b16 v[146:147], v96 offset:25600
  v_mfma_f32_16x16x32_bf16 v[64:67], v[176:179], a[72:75], v[64:67]
  ds_read_b64_tr_b16 v[148:149], v96 offset:25376
  buffer_load_dwordx4 a[108:111], v103, s[36:39], s62 offen offset:1024 sc1
  v_mfma_f32_16x16x32_bf16 v[68:71], v[176:179], a[76:79], v[68:71]
  ds_read_b64_tr_b16 v[150:151], v96 offset:25632
  ds_read_b64_tr_b16 v[152:153], v96 offset:25408
  v_mfma_f32_16x16x32_bf16 v[76:79], v[180:183], a[76:79], v[76:79]
  ds_read_b64_tr_b16 v[154:155], v96 offset:25664
  v_mfma_f32_16x16x32_bf16 v[72:75], v[180:183], a[72:75], v[72:75]
  ds_read_b64_tr_b16 v[156:157], v96 offset:25440
  ds_read_b64_tr_b16 v[158:159], v96 offset:25696
  v_mfma_f32_16x16x32_bf16 v[80:83], v[184:187], a[72:75], v[80:83]
  buffer_load_dwordx4 v101, s[32:35], s60 offen offset:1056 lds
  v_mfma_f32_16x16x32_bf16 v[84:87], v[184:187], a[76:79], v[84:87]
  s_add_u32 m0, s76, 6400
  v_mfma_f32_16x16x32_bf16 v[92:95], v[188:191], a[76:79], v[92:95]
  v_mfma_f32_16x16x32_bf16 v[88:91], v[188:191], a[72:75], v[88:91]
  buffer_load_dwordx4 v100, s[32:35], s60 offen offset:2048 lds
  s_waitcnt vmcnt(13) lgkmcnt(0)
  v_mfma_f32_16x16x32_bf16 v[32:35], v[128:131], a[80:83], v[32:35]
  ds_read_b64_tr_b16 v[160:161], v96 offset:21120
  ds_read_b64_tr_b16 v[162:163], v96 offset:21376
  v_mfma_f32_16x16x32_bf16 v[36:39], v[128:131], a[84:87], v[36:39]
  ds_read_b64_tr_b16 v[164:165], v96 offset:21152
  buffer_load_dwordx4 a[112:115], v102, s[36:39], s63 offen offset:0 sc1
  v_mfma_f32_16x16x32_bf16 v[44:47], v[132:135], a[84:87], v[44:47]
  ds_read_b64_tr_b16 v[166:167], v96 offset:21408
  v_mfma_f32_16x16x32_bf16 v[40:43], v[132:135], a[80:83], v[40:43]
  ds_read_b64_tr_b16 v[168:169], v96 offset:21184
  ds_read_b64_tr_b16 v[170:171], v96 offset:21440
  v_mfma_f32_16x16x32_bf16 v[48:51], v[136:139], a[80:83], v[48:51]
  ds_read_b64_tr_b16 v[172:173], v96 offset:21216
  v_readlane_b32 s62, v29, 8
  v_mfma_f32_16x16x32_bf16 v[52:55], v[136:139], a[84:87], v[52:55]
  ds_read_b64_tr_b16 v[174:175], v96 offset:21472
  v_mfma_f32_16x16x32_bf16 v[60:63], v[140:143], a[84:87], v[60:63]
  ds_read_b64_tr_b16 v[176:177], v96 offset:29568
  ds_read_b64_tr_b16 v[178:179], v96 offset:29824
  v_mfma_f32_16x16x32_bf16 v[56:59], v[140:143], a[80:83], v[56:59]
  ds_read_b64_tr_b16 v[180:181], v96 offset:29600
  v_mfma_f32_16x16x32_bf16 v[64:67], v[144:147], a[80:83], v[64:67]
  ds_read_b64_tr_b16 v[182:183], v96 offset:29856
  v_mfma_f32_16x16x32_bf16 v[68:71], v[144:147], a[84:87], v[68:71]
  ds_read_b64_tr_b16 v[184:185], v96 offset:29632
  ds_read_b64_tr_b16 v[186:187], v96 offset:29888
  v_mfma_f32_16x16x32_bf16 v[76:79], v[148:151], a[84:87], v[76:79]
  ds_read_b64_tr_b16 v[188:189], v96 offset:29664
  v_mfma_f32_16x16x32_bf16 v[72:75], v[148:151], a[80:83], v[72:75]
  buffer_load_dwordx4 v101, s[32:35], s60 offen offset:3104 lds
  ds_read_b64_tr_b16 v[190:191], v96 offset:29920
  v_mfma_f32_16x16x32_bf16 v[80:83], v[152:155], a[80:83], v[80:83]
  v_mfma_f32_16x16x32_bf16 v[84:87], v[152:155], a[84:87], v[84:87]
  v_mfma_f32_16x16x32_bf16 v[92:95], v[156:159], a[84:87], v[92:95]
  buffer_load_dwordx4 a[116:119], v103, s[36:39], s63 offen offset:0 sc1
  v_mfma_f32_16x16x32_bf16 v[88:91], v[156:159], a[80:83], v[88:91]
  s_waitcnt vmcnt(13) lgkmcnt(0)
  v_mfma_f32_16x16x32_bf16 v[32:35], v[160:163], a[88:91], v[32:35]
  s_waitcnt vmcnt(17)
  s_barrier
  v_mfma_f32_16x16x32_bf16 v[36:39], v[160:163], a[92:95], v[36:39]
  ds_read_b64_tr_b16 v[128:129], v97 offset:0
  ds_read_b64_tr_b16 v[130:131], v97 offset:256
  v_mfma_f32_16x16x32_bf16 v[44:47], v[164:167], a[92:95], v[44:47]
  buffer_load_dwordx4 a[120:123], v102, s[36:39], s63 offen offset:1024 sc1
  ds_read_b64_tr_b16 v[132:133], v97 offset:32
  v_mfma_f32_16x16x32_bf16 v[40:43], v[164:167], a[88:91], v[40:43]
  ds_read_b64_tr_b16 v[134:135], v97 offset:288
  s_add_u32 m0, s76, 16896
  v_mfma_f32_16x16x32_bf16 v[48:51], v[168:171], a[88:91], v[48:51]
  ds_read_b64_tr_b16 v[136:137], v97 offset:64
  ds_read_b64_tr_b16 v[138:139], v97 offset:320
  v_mfma_f32_16x16x32_bf16 v[52:55], v[168:171], a[92:95], v[52:55]
  ds_read_b64_tr_b16 v[140:141], v97 offset:96
  buffer_load_dwordx4 v100, s[32:35], s61 offen lds
  v_mfma_f32_16x16x32_bf16 v[60:63], v[172:175], a[92:95], v[60:63]
  ds_read_b64_tr_b16 v[142:143], v97 offset:352
  ds_read_b64_tr_b16 v[144:145], v97 offset:8448
  v_mfma_f32_16x16x32_bf16 v[56:59], v[172:175], a[88:91], v[56:59]
  v_readlane_b32 s60, v28, 10
  ds_read_b64_tr_b16 v[146:147], v97 offset:8704
  v_mfma_f32_16x16x32_bf16 v[64:67], v[176:179], a[88:91], v[64:67]
  ds_read_b64_tr_b16 v[148:149], v97 offset:8480
  buffer_load_dwordx4 a[124:127], v103, s[36:39], s63 offen offset:1024 sc1
  v_mfma_f32_16x16x32_bf16 v[68:71], v[176:179], a[92:95], v[68:71]
  ds_read_b64_tr_b16 v[150:151], v97 offset:8736
  ds_read_b64_tr_b16 v[152:153], v97 offset:8512
  v_mfma_f32_16x16x32_bf16 v[76:79], v[180:183], a[92:95], v[76:79]
  ds_read_b64_tr_b16 v[154:155], v97 offset:8768
  v_mfma_f32_16x16x32_bf16 v[72:75], v[180:183], a[88:91], v[72:75]
  ds_read_b64_tr_b16 v[156:157], v97 offset:8544
  ds_read_b64_tr_b16 v[158:159], v97 offset:8800
  v_mfma_f32_16x16x32_bf16 v[80:83], v[184:187], a[88:91], v[80:83]
  buffer_load_dwordx4 v101, s[32:35], s61 offen offset:1056 lds
  v_mfma_f32_16x16x32_bf16 v[84:87], v[184:187], a[92:95], v[84:87]
  s_add_u32 m0, s76, 23296
  v_mfma_f32_16x16x32_bf16 v[92:95], v[188:191], a[92:95], v[92:95]
  v_mfma_f32_16x16x32_bf16 v[88:91], v[188:191], a[88:91], v[88:91]
  buffer_load_dwordx4 v100, s[32:35], s61 offen offset:2048 lds
  s_waitcnt vmcnt(13) lgkmcnt(0)
  v_mfma_f32_16x16x32_bf16 v[32:35], v[128:131], a[96:99], v[32:35]
  ds_read_b64_tr_b16 v[160:161], v97 offset:4224
  ds_read_b64_tr_b16 v[162:163], v97 offset:4480
  v_mfma_f32_16x16x32_bf16 v[36:39], v[128:131], a[100:103], v[36:39]
  ds_read_b64_tr_b16 v[164:165], v97 offset:4256
  buffer_load_dwordx4 a[128:131], v102, s[36:39], s62 offen offset:0 sc1
  v_mfma_f32_16x16x32_bf16 v[44:47], v[132:135], a[100:103], v[44:47]
  ds_read_b64_tr_b16 v[166:167], v97 offset:4512
  v_mfma_f32_16x16x32_bf16 v[40:43], v[132:135], a[96:99], v[40:43]
  ds_read_b64_tr_b16 v[168:169], v97 offset:4288
  ds_read_b64_tr_b16 v[170:171], v97 offset:4544
  v_mfma_f32_16x16x32_bf16 v[48:51], v[136:139], a[96:99], v[48:51]
  ds_read_b64_tr_b16 v[172:173], v97 offset:4320
  v_readlane_b32 s63, v29, 9
  v_mfma_f32_16x16x32_bf16 v[52:55], v[136:139], a[100:103], v[52:55]
  ds_read_b64_tr_b16 v[174:175], v97 offset:4576
  v_mfma_f32_16x16x32_bf16 v[60:63], v[140:143], a[100:103], v[60:63]
  ds_read_b64_tr_b16 v[176:177], v97 offset:12672
  ds_read_b64_tr_b16 v[178:179], v97 offset:12928
  v_mfma_f32_16x16x32_bf16 v[56:59], v[140:143], a[96:99], v[56:59]
  ds_read_b64_tr_b16 v[180:181], v97 offset:12704
  v_mfma_f32_16x16x32_bf16 v[64:67], v[144:147], a[96:99], v[64:67]
  ds_read_b64_tr_b16 v[182:183], v97 offset:12960
  v_mfma_f32_16x16x32_bf16 v[68:71], v[144:147], a[100:103], v[68:71]
  ds_read_b64_tr_b16 v[184:185], v97 offset:12736
  ds_read_b64_tr_b16 v[186:187], v97 offset:12992
  v_mfma_f32_16x16x32_bf16 v[76:79], v[148:151], a[100:103], v[76:79]
  ds_read_b64_tr_b16 v[188:189], v97 offset:12768
  v_mfma_f32_16x16x32_bf16 v[72:75], v[148:151], a[96:99], v[72:75]
  buffer_load_dwordx4 v101, s[32:35], s61 offen offset:3104 lds
  ds_read_b64_tr_b16 v[190:191], v97 offset:13024
  v_mfma_f32_16x16x32_bf16 v[80:83], v[152:155], a[96:99], v[80:83]
  v_mfma_f32_16x16x32_bf16 v[84:87], v[152:155], a[100:103], v[84:87]
  v_mfma_f32_16x16x32_bf16 v[92:95], v[156:159], a[100:103], v[92:95]
  buffer_load_dwordx4 a[132:135], v103, s[36:39], s62 offen offset:0 sc1
  v_mfma_f32_16x16x32_bf16 v[88:91], v[156:159], a[96:99], v[88:91]
  s_waitcnt vmcnt(13) lgkmcnt(0)
  v_mfma_f32_16x16x32_bf16 v[32:35], v[160:163], a[104:107], v[32:35]
  s_waitcnt vmcnt(17)
  s_barrier
  v_mfma_f32_16x16x32_bf16 v[36:39], v[160:163], a[108:111], v[36:39]
  ds_read_b64_tr_b16 v[128:129], v97 offset:16896
  ds_read_b64_tr_b16 v[130:131], v97 offset:17152
  v_mfma_f32_16x16x32_bf16 v[44:47], v[164:167], a[108:111], v[44:47]
  buffer_load_dwordx4 a[136:139], v102, s[36:39], s62 offen offset:1024 sc1
  ds_read_b64_tr_b16 v[132:133], v97 offset:16928
  v_mfma_f32_16x16x32_bf16 v[40:43], v[164:167], a[104:107], v[40:43]
  ds_read_b64_tr_b16 v[134:135], v97 offset:17184
  s_add_u32 m0, s76, 33792
  v_mfma_f32_16x16x32_bf16 v[48:51], v[168:171], a[104:107], v[48:51]
  ds_read_b64_tr_b16 v[136:137], v97 offset:16960
  ds_read_b64_tr_b16 v[138:139], v97 offset:17216
  v_mfma_f32_16x16x32_bf16 v[52:55], v[168:171], a[108:111], v[52:55]
  ds_read_b64_tr_b16 v[140:141], v97 offset:16992
  buffer_load_dwordx4 v100, s[32:35], s60 offen lds
  v_mfma_f32_16x16x32_bf16 v[60:63], v[172:175], a[108:111], v[60:63]
  ds_read_b64_tr_b16 v[142:143], v97 offset:17248
  ds_read_b64_tr_b16 v[144:145], v97 offset:25344
  v_mfma_f32_16x16x32_bf16 v[56:59], v[172:175], a[104:107], v[56:59]
  v_readlane_b32 s61, v28, 11
  ds_read_b64_tr_b16 v[146:147], v97 offset:25600
  v_mfma_f32_16x16x32_bf16 v[64:67], v[176:179], a[104:107], v[64:67]
  ds_read_b64_tr_b16 v[148:149], v97 offset:25376
  buffer_load_dwordx4 a[140:143], v103, s[36:39], s62 offen offset:1024 sc1
  v_mfma_f32_16x16x32_bf16 v[68:71], v[176:179], a[108:111], v[68:71]
  ds_read_b64_tr_b16 v[150:151], v97 offset:25632
  ds_read_b64_tr_b16 v[152:153], v97 offset:25408
  v_mfma_f32_16x16x32_bf16 v[76:79], v[180:183], a[108:111], v[76:79]
  ds_read_b64_tr_b16 v[154:155], v97 offset:25664
  v_mfma_f32_16x16x32_bf16 v[72:75], v[180:183], a[104:107], v[72:75]
  ds_read_b64_tr_b16 v[156:157], v97 offset:25440
  ds_read_b64_tr_b16 v[158:159], v97 offset:25696
  v_mfma_f32_16x16x32_bf16 v[80:83], v[184:187], a[104:107], v[80:83]
  buffer_load_dwordx4 v101, s[32:35], s60 offen offset:1056 lds
  v_mfma_f32_16x16x32_bf16 v[84:87], v[184:187], a[108:111], v[84:87]
  s_add_u32 m0, s76, 40192
  v_mfma_f32_16x16x32_bf16 v[92:95], v[188:191], a[108:111], v[92:95]
  v_mfma_f32_16x16x32_bf16 v[88:91], v[188:191], a[104:107], v[88:91]
  buffer_load_dwordx4 v100, s[32:35], s60 offen offset:2048 lds
  s_waitcnt vmcnt(13) lgkmcnt(0)
  v_mfma_f32_16x16x32_bf16 v[32:35], v[128:131], a[112:115], v[32:35]
  ds_read_b64_tr_b16 v[160:161], v97 offset:21120
  ds_read_b64_tr_b16 v[162:163], v97 offset:21376
  v_mfma_f32_16x16x32_bf16 v[36:39], v[128:131], a[116:119], v[36:39]
  ds_read_b64_tr_b16 v[164:165], v97 offset:21152
  buffer_load_dwordx4 a[144:147], v102, s[36:39], s63 offen offset:0 sc1
  v_mfma_f32_16x16x32_bf16 v[44:47], v[132:135], a[116:119], v[44:47]
  ds_read_b64_tr_b16 v[166:167], v97 offset:21408
  v_mfma_f32_16x16x32_bf16 v[40:43], v[132:135], a[112:115], v[40:43]
  ds_read_b64_tr_b16 v[168:169], v97 offset:21184
  ds_read_b64_tr_b16 v[170:171], v97 offset:21440
  v_mfma_f32_16x16x32_bf16 v[48:51], v[136:139], a[112:115], v[48:51]
  ds_read_b64_tr_b16 v[172:173], v97 offset:21216
  v_readlane_b32 s62, v29, 10
  v_mfma_f32_16x16x32_bf16 v[52:55], v[136:139], a[116:119], v[52:55]
  ds_read_b64_tr_b16 v[174:175], v97 offset:21472
  v_mfma_f32_16x16x32_bf16 v[60:63], v[140:143], a[116:119], v[60:63]
  ds_read_b64_tr_b16 v[176:177], v97 offset:29568
  ds_read_b64_tr_b16 v[178:179], v97 offset:29824
  v_mfma_f32_16x16x32_bf16 v[56:59], v[140:143], a[112:115], v[56:59]
  ds_read_b64_tr_b16 v[180:181], v97 offset:29600
  v_mfma_f32_16x16x32_bf16 v[64:67], v[144:147], a[112:115], v[64:67]
  ds_read_b64_tr_b16 v[182:183], v97 offset:29856
  v_mfma_f32_16x16x32_bf16 v[68:71], v[144:147], a[116:119], v[68:71]
  ds_read_b64_tr_b16 v[184:185], v97 offset:29632
  ds_read_b64_tr_b16 v[186:187], v97 offset:29888
  v_mfma_f32_16x16x32_bf16 v[76:79], v[148:151], a[116:119], v[76:79]
  ds_read_b64_tr_b16 v[188:189], v97 offset:29664
  v_mfma_f32_16x16x32_bf16 v[72:75], v[148:151], a[112:115], v[72:75]
  buffer_load_dwordx4 v101, s[32:35], s60 offen offset:3104 lds
  ds_read_b64_tr_b16 v[190:191], v97 offset:29920
  v_mfma_f32_16x16x32_bf16 v[80:83], v[152:155], a[112:115], v[80:83]
  v_mfma_f32_16x16x32_bf16 v[84:87], v[152:155], a[116:119], v[84:87]
  v_mfma_f32_16x16x32_bf16 v[92:95], v[156:159], a[116:119], v[92:95]
  buffer_load_dwordx4 a[148:151], v103, s[36:39], s63 offen offset:0 sc1
  v_mfma_f32_16x16x32_bf16 v[88:91], v[156:159], a[112:115], v[88:91]
  s_waitcnt vmcnt(13) lgkmcnt(0)
  v_mfma_f32_16x16x32_bf16 v[32:35], v[160:163], a[120:123], v[32:35]
  s_waitcnt vmcnt(17)
  s_barrier
  v_mfma_f32_16x16x32_bf16 v[36:39], v[160:163], a[124:127], v[36:39]
  ds_read_b64_tr_b16 v[128:129], v96 offset:0
  ds_read_b64_tr_b16 v[130:131], v96 offset:256
  v_mfma_f32_16x16x32_bf16 v[44:47], v[164:167], a[124:127], v[44:47]
  buffer_load_dwordx4 a[152:155], v102, s[36:39], s63 offen offset:1024 sc1
  ds_read_b64_tr_b16 v[132:133], v96 offset:32
  v_mfma_f32_16x16x32_bf16 v[40:43], v[164:167], a[120:123], v[40:43]
  ds_read_b64_tr_b16 v[134:135], v96 offset:288
  s_add_u32 m0, s76, 50688
  v_mfma_f32_16x16x32_bf16 v[48:51], v[168:171], a[120:123], v[48:51]
  ds_read_b64_tr_b16 v[136:137], v96 offset:64
  ds_read_b64_tr_b16 v[138:139], v96 offset:320
  v_mfma_f32_16x16x32_bf16 v[52:55], v[168:171], a[124:127], v[52:55]
  ds_read_b64_tr_b16 v[140:141], v96 offset:96
  buffer_load_dwordx4 v100, s[32:35], s61 offen lds
  v_mfma_f32_16x16x32_bf16 v[60:63], v[172:175], a[124:127], v[60:63]
  ds_read_b64_tr_b16 v[142:143], v96 offset:352
  ds_read_b64_tr_b16 v[144:145], v96 offset:8448
  v_mfma_f32_16x16x32_bf16 v[56:59], v[172:175], a[120:123], v[56:59]
  v_readlane_b32 s60, v28, 12
  ds_read_b64_tr_b16 v[146:147], v96 offset:8704
  v_mfma_f32_16x16x32_bf16 v[64:67], v[176:179], a[120:123], v[64:67]
  ds_read_b64_tr_b16 v[148:149], v96 offset:8480
  buffer_load_dwordx4 a[156:159], v103, s[36:39], s63 offen offset:1024 sc1
  v_mfma_f32_16x16x32_bf16 v[68:71], v[176:179], a[124:127], v[68:71]
  ds_read_b64_tr_b16 v[150:151], v96 offset:8736
  ds_read_b64_tr_b16 v[152:153], v96 offset:8512
  v_mfma_f32_16x16x32_bf16 v[76:79], v[180:183], a[124:127], v[76:79]
  ds_read_b64_tr_b16 v[154:155], v96 offset:8768
  v_mfma_f32_16x16x32_bf16 v[72:75], v[180:183], a[120:123], v[72:75]
  ds_read_b64_tr_b16 v[156:157], v96 offset:8544
  ds_read_b64_tr_b16 v[158:159], v96 offset:8800
  v_mfma_f32_16x16x32_bf16 v[80:83], v[184:187], a[120:123], v[80:83]
  buffer_load_dwordx4 v101, s[32:35], s61 offen offset:1056 lds
  v_mfma_f32_16x16x32_bf16 v[84:87], v[184:187], a[124:127], v[84:87]
  s_add_u32 m0, s76, 57088
  v_mfma_f32_16x16x32_bf16 v[92:95], v[188:191], a[124:127], v[92:95]
  v_mfma_f32_16x16x32_bf16 v[88:91], v[188:191], a[120:123], v[88:91]
  buffer_load_dwordx4 v100, s[32:35], s61 offen offset:2048 lds
  s_waitcnt vmcnt(13) lgkmcnt(0)
  v_mfma_f32_16x16x32_bf16 v[32:35], v[128:131], a[128:131], v[32:35]
  ds_read_b64_tr_b16 v[160:161], v96 offset:4224
  ds_read_b64_tr_b16 v[162:163], v96 offset:4480
  v_mfma_f32_16x16x32_bf16 v[36:39], v[128:131], a[132:135], v[36:39]
  ds_read_b64_tr_b16 v[164:165], v96 offset:4256
  buffer_load_dwordx4 a[160:163], v102, s[36:39], s62 offen offset:0 sc1
  v_mfma_f32_16x16x32_bf16 v[44:47], v[132:135], a[132:135], v[44:47]
  ds_read_b64_tr_b16 v[166:167], v96 offset:4512
  v_mfma_f32_16x16x32_bf16 v[40:43], v[132:135], a[128:131], v[40:43]
  ds_read_b64_tr_b16 v[168:169], v96 offset:4288
  ds_read_b64_tr_b16 v[170:171], v96 offset:4544
  v_mfma_f32_16x16x32_bf16 v[48:51], v[136:139], a[128:131], v[48:51]
  ds_read_b64_tr_b16 v[172:173], v96 offset:4320
  v_readlane_b32 s63, v29, 11
  v_mfma_f32_16x16x32_bf16 v[52:55], v[136:139], a[132:135], v[52:55]
  ds_read_b64_tr_b16 v[174:175], v96 offset:4576
  v_mfma_f32_16x16x32_bf16 v[60:63], v[140:143], a[132:135], v[60:63]
  ds_read_b64_tr_b16 v[176:177], v96 offset:12672
  ds_read_b64_tr_b16 v[178:179], v96 offset:12928
  v_mfma_f32_16x16x32_bf16 v[56:59], v[140:143], a[128:131], v[56:59]
  ds_read_b64_tr_b16 v[180:181], v96 offset:12704
  v_mfma_f32_16x16x32_bf16 v[64:67], v[144:147], a[128:131], v[64:67]
  ds_read_b64_tr_b16 v[182:183], v96 offset:12960
  v_mfma_f32_16x16x32_bf16 v[68:71], v[144:147], a[132:135], v[68:71]
  ds_read_b64_tr_b16 v[184:185], v96 offset:12736
  ds_read_b64_tr_b16 v[186:187], v96 offset:12992
  v_mfma_f32_16x16x32_bf16 v[76:79], v[148:151], a[132:135], v[76:79]
  ds_read_b64_tr_b16 v[188:189], v96 offset:12768
  v_mfma_f32_16x16x32_bf16 v[72:75], v[148:151], a[128:131], v[72:75]
  buffer_load_dwordx4 v101, s[32:35], s61 offen offset:3104 lds
  ds_read_b64_tr_b16 v[190:191], v96 offset:13024
  v_mfma_f32_16x16x32_bf16 v[80:83], v[152:155], a[128:131], v[80:83]
  v_mfma_f32_16x16x32_bf16 v[84:87], v[152:155], a[132:135], v[84:87]
  v_mfma_f32_16x16x32_bf16 v[92:95], v[156:159], a[132:135], v[92:95]
  buffer_load_dwordx4 a[164:167], v103, s[36:39], s62 offen offset:0 sc1
  v_mfma_f32_16x16x32_bf16 v[88:91], v[156:159], a[128:131], v[88:91]
  s_waitcnt vmcnt(13) lgkmcnt(0)
  v_mfma_f32_16x16x32_bf16 v[32:35], v[160:163], a[136:139], v[32:35]
  s_waitcnt vmcnt(17)
  s_barrier
  v_mfma_f32_16x16x32_bf16 v[36:39], v[160:163], a[140:143], v[36:39]
  ds_read_b64_tr_b16 v[128:129], v96 offset:16896
  ds_read_b64_tr_b16 v[130:131], v96 offset:17152
  v_mfma_f32_16x16x32_bf16 v[44:47], v[164:167], a[140:143], v[44:47]
  buffer_load_dwordx4 a[168:171], v102, s[36:39], s62 offen offset:1024 sc1
  ds_read_b64_tr_b16 v[132:133], v96 offset:16928
  v_mfma_f32_16x16x32_bf16 v[40:43], v[164:167], a[136:139], v[40:43]
  ds_read_b64_tr_b16 v[134:135], v96 offset:17184
  s_add_u32 m0, s76, 0
  v_mfma_f32_16x16x32_bf16 v[48:51], v[168:171], a[136:139], v[48:51]
  ds_read_b64_tr_b16 v[136:137], v96 offset:16960
  ds_read_b64_tr_b16 v[138:139], v96 offset:17216
  v_mfma_f32_16x16x32_bf16 v[52:55], v[168:171], a[140:143], v[52:55]
  ds_read_b64_tr_b16 v[140:141], v96 offset:16992
  buffer_load_dwordx4 v100, s[32:35], s60 offen lds
  v_mfma_f32_16x16x32_bf16 v[60:63], v[172:175], a[140:143], v[60:63]
  ds_read_b64_tr_b16 v[142:143], v96 offset:17248
  ds_read_b64_tr_b16 v[144:145], v96 offset:25344
  v_mfma_f32_16x16x32_bf16 v[56:59], v[172:175], a[136:139], v[56:59]
  v_readlane_b32 s61, v28, 13
  ds_read_b64_tr_b16 v[146:147], v96 offset:25600
  v_mfma_f32_16x16x32_bf16 v[64:67], v[176:179], a[136:139], v[64:67]
  ds_read_b64_tr_b16 v[148:149], v96 offset:25376
  buffer_load_dwordx4 a[172:175], v103, s[36:39], s62 offen offset:1024 sc1
  v_mfma_f32_16x16x32_bf16 v[68:71], v[176:179], a[140:143], v[68:71]
  ds_read_b64_tr_b16 v[150:151], v96 offset:25632
  ds_read_b64_tr_b16 v[152:153], v96 offset:25408
  v_mfma_f32_16x16x32_bf16 v[76:79], v[180:183], a[140:143], v[76:79]
  ds_read_b64_tr_b16 v[154:155], v96 offset:25664
  v_mfma_f32_16x16x32_bf16 v[72:75], v[180:183], a[136:139], v[72:75]
  ds_read_b64_tr_b16 v[156:157], v96 offset:25440
  ds_read_b64_tr_b16 v[158:159], v96 offset:25696
  v_mfma_f32_16x16x32_bf16 v[80:83], v[184:187], a[136:139], v[80:83]
  buffer_load_dwordx4 v101, s[32:35], s60 offen offset:1056 lds
  v_mfma_f32_16x16x32_bf16 v[84:87], v[184:187], a[140:143], v[84:87]
  s_add_u32 m0, s76, 6400
  v_mfma_f32_16x16x32_bf16 v[92:95], v[188:191], a[140:143], v[92:95]
  v_mfma_f32_16x16x32_bf16 v[88:91], v[188:191], a[136:139], v[88:91]
  buffer_load_dwordx4 v100, s[32:35], s60 offen offset:2048 lds
  s_waitcnt vmcnt(13) lgkmcnt(0)
  v_mfma_f32_16x16x32_bf16 v[32:35], v[128:131], a[144:147], v[32:35]
  ds_read_b64_tr_b16 v[160:161], v96 offset:21120
  ds_read_b64_tr_b16 v[162:163], v96 offset:21376
  v_mfma_f32_16x16x32_bf16 v[36:39], v[128:131], a[148:151], v[36:39]
  ds_read_b64_tr_b16 v[164:165], v96 offset:21152
  buffer_load_dwordx4 a[176:179], v102, s[36:39], s63 offen offset:0 sc1
  v_mfma_f32_16x16x32_bf16 v[44:47], v[132:135], a[148:151], v[44:47]
  ds_read_b64_tr_b16 v[166:167], v96 offset:21408
  v_mfma_f32_16x16x32_bf16 v[40:43], v[132:135], a[144:147], v[40:43]
  ds_read_b64_tr_b16 v[168:169], v96 offset:21184
  ds_read_b64_tr_b16 v[170:171], v96 offset:21440
  v_mfma_f32_16x16x32_bf16 v[48:51], v[136:139], a[144:147], v[48:51]
  ds_read_b64_tr_b16 v[172:173], v96 offset:21216
  v_readlane_b32 s62, v29, 12
  v_mfma_f32_16x16x32_bf16 v[52:55], v[136:139], a[148:151], v[52:55]
  ds_read_b64_tr_b16 v[174:175], v96 offset:21472
  v_mfma_f32_16x16x32_bf16 v[60:63], v[140:143], a[148:151], v[60:63]
  ds_read_b64_tr_b16 v[176:177], v96 offset:29568
  ds_read_b64_tr_b16 v[178:179], v96 offset:29824
  v_mfma_f32_16x16x32_bf16 v[56:59], v[140:143], a[144:147], v[56:59]
  ds_read_b64_tr_b16 v[180:181], v96 offset:29600
  v_mfma_f32_16x16x32_bf16 v[64:67], v[144:147], a[144:147], v[64:67]
  ds_read_b64_tr_b16 v[182:183], v96 offset:29856
  v_mfma_f32_16x16x32_bf16 v[68:71], v[144:147], a[148:151], v[68:71]
  ds_read_b64_tr_b16 v[184:185], v96 offset:29632
  ds_read_b64_tr_b16 v[186:187], v96 offset:29888
  v_mfma_f32_16x16x32_bf16 v[76:79], v[148:151], a[148:151], v[76:79]
  ds_read_b64_tr_b16 v[188:189], v96 offset:29664
  v_mfma_f32_16x16x32_bf16 v[72:75], v[148:151], a[144:147], v[72:75]
  buffer_load_dwordx4 v101, s[32:35], s60 offen offset:3104 lds
  ds_read_b64_tr_b16 v[190:191], v96 offset:29920
  v_mfma_f32_16x16x32_bf16 v[80:83], v[152:155], a[144:147], v[80:83]
  v_mfma_f32_16x16x32_bf16 v[84:87], v[152:155], a[148:151], v[84:87]
  v_mfma_f32_16x16x32_bf16 v[92:95], v[156:159], a[148:151], v[92:95]
  buffer_load_dwordx4 a[180:183], v103, s[36:39], s63 offen offset:0 sc1
  v_mfma_f32_16x16x32_bf16 v[88:91], v[156:159], a[144:147], v[88:91]
  s_waitcnt vmcnt(13) lgkmcnt(0)
  v_mfma_f32_16x16x32_bf16 v[32:35], v[160:163], a[152:155], v[32:35]
  s_waitcnt vmcnt(17)
  s_barrier
  v_mfma_f32_16x16x32_bf16 v[36:39], v[160:163], a[156:159], v[36:39]
  ds_read_b64_tr_b16 v[128:129], v97 offset:0
  ds_read_b64_tr_b16 v[130:131], v97 offset:256
  v_mfma_f32_16x16x32_bf16 v[44:47], v[164:167], a[156:159], v[44:47]
  buffer_load_dwordx4 a[184:187], v102, s[36:39], s63 offen offset:1024 sc1
  ds_read_b64_tr_b16 v[132:133], v97 offset:32
  v_mfma_f32_16x16x32_bf16 v[40:43], v[164:167], a[152:155], v[40:43]
  ds_read_b64_tr_b16 v[134:135], v97 offset:288
  s_add_u32 m0, s76, 16896
  v_mfma_f32_16x16x32_bf16 v[48:51], v[168:171], a[152:155], v[48:51]
  ds_read_b64_tr_b16 v[136:137], v97 offset:64
  ds_read_b64_tr_b16 v[138:139], v97 offset:320
  v_mfma_f32_16x16x32_bf16 v[52:55], v[168:171], a[156:159], v[52:55]
  ds_read_b64_tr_b16 v[140:141], v97 offset:96
  buffer_load_dwordx4 v100, s[32:35], s61 offen lds
  v_mfma_f32_16x16x32_bf16 v[60:63], v[172:175], a[156:159], v[60:63]
  ds_read_b64_tr_b16 v[142:143], v97 offset:352
  ds_read_b64_tr_b16 v[144:145], v97 offset:8448
  v_mfma_f32_16x16x32_bf16 v[56:59], v[172:175], a[152:155], v[56:59]
  v_readlane_b32 s60, v28, 14
  ds_read_b64_tr_b16 v[146:147], v97 offset:8704
  v_mfma_f32_16x16x32_bf16 v[64:67], v[176:179], a[152:155], v[64:67]
  ds_read_b64_tr_b16 v[148:149], v97 offset:8480
  buffer_load_dwordx4 a[188:191], v103, s[36:39], s63 offen offset:1024 sc1
  v_mfma_f32_16x16x32_bf16 v[68:71], v[176:179], a[156:159], v[68:71]
  ds_read_b64_tr_b16 v[150:151], v97 offset:8736
  ds_read_b64_tr_b16 v[152:153], v97 offset:8512
  v_mfma_f32_16x16x32_bf16 v[76:79], v[180:183], a[156:159], v[76:79]
  ds_read_b64_tr_b16 v[154:155], v97 offset:8768
  v_mfma_f32_16x16x32_bf16 v[72:75], v[180:183], a[152:155], v[72:75]
  ds_read_b64_tr_b16 v[156:157], v97 offset:8544
  ds_read_b64_tr_b16 v[158:159], v97 offset:8800
  v_mfma_f32_16x16x32_bf16 v[80:83], v[184:187], a[152:155], v[80:83]
  buffer_load_dwordx4 v101, s[32:35], s61 offen offset:1056 lds
  v_mfma_f32_16x16x32_bf16 v[84:87], v[184:187], a[156:159], v[84:87]
  s_add_u32 m0, s76, 23296
  v_mfma_f32_16x16x32_bf16 v[92:95], v[188:191], a[156:159], v[92:95]
  v_mfma_f32_16x16x32_bf16 v[88:91], v[188:191], a[152:155], v[88:91]
  buffer_load_dwordx4 v100, s[32:35], s61 offen offset:2048 lds
  s_waitcnt vmcnt(13) lgkmcnt(0)
  v_mfma_f32_16x16x32_bf16 v[32:35], v[128:131], a[160:163], v[32:35]
  ds_read_b64_tr_b16 v[160:161], v97 offset:4224
  buffer_load_dwordx4 a[192:195], v102, s[36:39], s62 offen offset:0 sc1
  v_mfma_f32_16x16x32_bf16 v[36:39], v[128:131], a[164:167], v[36:39]
  ds_read_b64_tr_b16 v[162:163], v97 offset:4480
  ds_read_b64_tr_b16 v[164:165], v97 offset:4256
  v_mfma_f32_16x16x32_bf16 v[44:47], v[132:135], a[164:167], v[44:47]
  v_readlane_b32 s63, v29, 13
  ds_read_b64_tr_b16 v[166:167], v97 offset:4512
  v_mfma_f32_16x16x32_bf16 v[40:43], v[132:135], a[160:163], v[40:43]
  ds_read_b64_tr_b16 v[168:169], v97 offset:4288
  v_mfma_f32_16x16x32_bf16 v[48:51], v[136:139], a[160:163], v[48:51]
  ds_read_b64_tr_b16 v[170:171], v97 offset:4544
  ds_read_b64_tr_b16 v[172:173], v97 offset:4320
  v_mfma_f32_16x16x32_bf16 v[52:55], v[136:139], a[164:167], v[52:55]
  buffer_load_dwordx4 v101, s[32:35], s61 offen offset:3104 lds
  ds_read_b64_tr_b16 v[174:175], v97 offset:4576
  v_mfma_f32_16x16x32_bf16 v[60:63], v[140:143], a[164:167], v[60:63]
  ds_read_b64_tr_b16 v[176:177], v97 offset:12672
  buffer_load_dwordx4 a[196:199], v103, s[36:39], s62 offen offset:0 sc1
  v_mfma_f32_16x16x32_bf16 v[56:59], v[140:143], a[160:163], v[56:59]
  ds_read_b64_tr_b16 v[178:179], v97 offset:12928
  ds_read_b64_tr_b16 v[180:181], v97 offset:12704
  v_mfma_f32_16x16x32_bf16 v[64:67], v[144:147], a[160:163], v[64:67]
  s_lshl_b32 s80, s31, 2
  ds_read_b64_tr_b16 v[182:183], v97 offset:12960
  v_mfma_f32_16x16x32_bf16 v[68:71], v[144:147], a[164:167], v[68:71]
  ds_read_b64_tr_b16 v[184:185], v97 offset:12736
  s_add_u32 s80, s80, s3
  v_mfma_f32_16x16x32_bf16 v[76:79], v[148:151], a[164:167], v[76:79]
  ds_read_b64_tr_b16 v[186:187], v97 offset:12992
  ds_read_b64_tr_b16 v[188:189], v97 offset:12768
  v_mfma_f32_16x16x32_bf16 v[72:75], v[148:151], a[160:163], v[72:75]
  s_lshl_b32 s80, s80, 10
  ds_read_b64_tr_b16 v[190:191], v97 offset:13024
  v_mfma_f32_16x16x32_bf16 v[80:83], v[152:155], a[160:163], v[80:83]
  v_add_u32 v254, s80, v105
  v_mfma_f32_16x16x32_bf16 v[84:87], v[152:155], a[164:167], v[84:87]
  v_min_u32 v254, adaLN_cond__linear_kernel_hedgehog__glu_gated_swiglu__prompt_kernel_end-adaLN_cond__linear_kernel_hedgehog__glu_gated_swiglu__prompt_kernel-4, v254
  v_mfma_f32_16x16x32_bf16 v[92:95], v[156:159], a[164:167], v[92:95]
  v_mfma_f32_16x16x32_bf16 v[88:91], v[156:159], a[160:163], v[88:91]
  global_load_dword v31, v254, s[100:101]
  s_waitcnt vmcnt(14) lgkmcnt(0)
  v_mfma_f32_16x16x32_bf16 v[32:35], v[160:163], a[168:171], v[32:35]
  s_waitcnt vmcnt(18)
  s_barrier
  v_mfma_f32_16x16x32_bf16 v[36:39], v[160:163], a[172:175], v[36:39]
  ds_read_b64_tr_b16 v[128:129], v97 offset:16896
  ds_read_b64_tr_b16 v[130:131], v97 offset:17152
  v_mfma_f32_16x16x32_bf16 v[44:47], v[164:167], a[172:175], v[44:47]
  buffer_load_dwordx4 a[200:203], v102, s[36:39], s62 offen offset:1024 sc1
  ds_read_b64_tr_b16 v[132:133], v97 offset:16928
  v_mfma_f32_16x16x32_bf16 v[40:43], v[164:167], a[168:171], v[40:43]
  ds_read_b64_tr_b16 v[134:135], v97 offset:17184
  s_add_u32 m0, s76, 33792
  v_mfma_f32_16x16x32_bf16 v[48:51], v[168:171], a[168:171], v[48:51]
  ds_read_b64_tr_b16 v[136:137], v97 offset:16960
  ds_read_b64_tr_b16 v[138:139], v97 offset:17216
  v_mfma_f32_16x16x32_bf16 v[52:55], v[168:171], a[172:175], v[52:55]
  ds_read_b64_tr_b16 v[140:141], v97 offset:16992
  buffer_load_dwordx4 v100, s[32:35], s60 offen lds
  v_mfma_f32_16x16x32_bf16 v[60:63], v[172:175], a[172:175], v[60:63]
  ds_read_b64_tr_b16 v[142:143], v97 offset:17248
  ds_read_b64_tr_b16 v[144:145], v97 offset:25344
  v_mfma_f32_16x16x32_bf16 v[56:59], v[172:175], a[168:171], v[56:59]
  v_readlane_b32 s61, v28, 15
  ds_read_b64_tr_b16 v[146:147], v97 offset:25600
  v_mfma_f32_16x16x32_bf16 v[64:67], v[176:179], a[168:171], v[64:67]
  ds_read_b64_tr_b16 v[148:149], v97 offset:25376
  buffer_load_dwordx4 a[204:207], v103, s[36:39], s62 offen offset:1024 sc1
  v_mfma_f32_16x16x32_bf16 v[68:71], v[176:179], a[172:175], v[68:71]
  ds_read_b64_tr_b16 v[150:151], v97 offset:25632
  ds_read_b64_tr_b16 v[152:153], v97 offset:25408
  v_mfma_f32_16x16x32_bf16 v[76:79], v[180:183], a[172:175], v[76:79]
  ds_read_b64_tr_b16 v[154:155], v97 offset:25664
  v_mfma_f32_16x16x32_bf16 v[72:75], v[180:183], a[168:171], v[72:75]
  ds_read_b64_tr_b16 v[156:157], v97 offset:25440
  ds_read_b64_tr_b16 v[158:159], v97 offset:25696
  v_mfma_f32_16x16x32_bf16 v[80:83], v[184:187], a[168:171], v[80:83]
  buffer_load_dwordx4 v101, s[32:35], s60 offen offset:1056 lds
  v_mfma_f32_16x16x32_bf16 v[84:87], v[184:187], a[172:175], v[84:87]
  s_add_u32 m0, s76, 40192
  v_mfma_f32_16x16x32_bf16 v[92:95], v[188:191], a[172:175], v[92:95]
  v_mfma_f32_16x16x32_bf16 v[88:91], v[188:191], a[168:171], v[88:91]
  buffer_load_dwordx4 v100, s[32:35], s60 offen offset:2048 lds
  s_waitcnt vmcnt(14) lgkmcnt(0)
  v_mfma_f32_16x16x32_bf16 v[32:35], v[128:131], a[176:179], v[32:35]
  ds_read_b64_tr_b16 v[160:161], v97 offset:21120
  ds_read_b64_tr_b16 v[162:163], v97 offset:21376
  v_mfma_f32_16x16x32_bf16 v[36:39], v[128:131], a[180:183], v[36:39]
  ds_read_b64_tr_b16 v[164:165], v97 offset:21152
  buffer_load_dwordx4 a[208:211], v102, s[36:39], s63 offen offset:0 sc1
  v_mfma_f32_16x16x32_bf16 v[44:47], v[132:135], a[180:183], v[44:47]
  ds_read_b64_tr_b16 v[166:167], v97 offset:21408
  v_mfma_f32_16x16x32_bf16 v[40:43], v[132:135], a[176:179], v[40:43]
  ds_read_b64_tr_b16 v[168:169], v97 offset:21184
  ds_read_b64_tr_b16 v[170:171], v97 offset:21440
  v_mfma_f32_16x16x32_bf16 v[48:51], v[136:139], a[176:179], v[48:51]
  ds_read_b64_tr_b16 v[172:173], v97 offset:21216
  v_readlane_b32 s62, v29, 14
  v_mfma_f32_16x16x32_bf16 v[52:55], v[136:139], a[180:183], v[52:55]
  ds_read_b64_tr_b16 v[174:175], v97 offset:21472
  v_mfma_f32_16x16x32_bf16 v[60:63], v[140:143], a[180:183], v[60:63]
  ds_read_b64_tr_b16 v[176:177], v97 offset:29568
  ds_read_b64_tr_b16 v[178:179], v97 offset:29824
  v_mfma_f32_16x16x32_bf16 v[56:59], v[140:143], a[176:179], v[56:59]
  ds_read_b64_tr_b16 v[180:181], v97 offset:29600
  v_mfma_f32_16x16x32_bf16 v[64:67], v[144:147], a[176:179], v[64:67]
  ds_read_b64_tr_b16 v[182:183], v97 offset:29856
  v_mfma_f32_16x16x32_bf16 v[68:71], v[144:147], a[180:183], v[68:71]
  ds_read_b64_tr_b16 v[184:185], v97 offset:29632
  ds_read_b64_tr_b16 v[186:187], v97 offset:29888
  v_mfma_f32_16x16x32_bf16 v[76:79], v[148:151], a[180:183], v[76:79]
  ds_read_b64_tr_b16 v[188:189], v97 offset:29664
  v_mfma_f32_16x16x32_bf16 v[72:75], v[148:151], a[176:179], v[72:75]
  buffer_load_dwordx4 v101, s[32:35], s60 offen offset:3104 lds
  ds_read_b64_tr_b16 v[190:191], v97 offset:29920
  v_mfma_f32_16x16x32_bf16 v[80:83], v[152:155], a[176:179], v[80:83]
  v_mfma_f32_16x16x32_bf16 v[84:87], v[152:155], a[180:183], v[84:87]
  v_mfma_f32_16x16x32_bf16 v[92:95], v[156:159], a[180:183], v[92:95]
  buffer_load_dwordx4 a[212:215], v103, s[36:39], s63 offen offset:0 sc1
  v_mfma_f32_16x16x32_bf16 v[88:91], v[156:159], a[176:179], v[88:91]
  s_waitcnt vmcnt(14) lgkmcnt(0)
  v_mfma_f32_16x16x32_bf16 v[32:35], v[160:163], a[184:187], v[32:35]
  s_waitcnt vmcnt(18)
  s_barrier
  v_mfma_f32_16x16x32_bf16 v[36:39], v[160:163], a[188:191], v[36:39]
  ds_read_b64_tr_b16 v[128:129], v96 offset:0
  ds_read_b64_tr_b16 v[130:131], v96 offset:256
  v_mfma_f32_16x16x32_bf16 v[44:47], v[164:167], a[188:191], v[44:47]
  buffer_load_dwordx4 a[216:219], v102, s[36:39], s63 offen offset:1024 sc1
  ds_read_b64_tr_b16 v[132:133], v96 offset:32
  v_mfma_f32_16x16x32_bf16 v[40:43], v[164:167], a[184:187], v[40:43]
  ds_read_b64_tr_b16 v[134:135], v96 offset:288
  ds_read_b64_tr_b16 v[136:137], v96 offset:64
  v_mfma_f32_16x16x32_bf16 v[48:51], v[168:171], a[184:187], v[48:51]
  s_add_u32 m0, s76, 50688
  ds_read_b64_tr_b16 v[138:139], v96 offset:320
  v_mfma_f32_16x16x32_bf16 v[52:55], v[168:171], a[188:191], v[52:55]
  ds_read_b64_tr_b16 v[140:141], v96 offset:96
  buffer_load_dwordx4 v100, s[32:35], s61 offen lds
  v_mfma_f32_16x16x32_bf16 v[60:63], v[172:175], a[188:191], v[60:63]
  ds_read_b64_tr_b16 v[142:143], v96 offset:352
  ds_read_b64_tr_b16 v[144:145], v96 offset:8448
  v_mfma_f32_16x16x32_bf16 v[56:59], v[172:175], a[184:187], v[56:59]
  ds_read_b64_tr_b16 v[146:147], v96 offset:8704
  buffer_load_dwordx4 a[220:223], v103, s[36:39], s63 offen offset:1024 sc1
  v_mfma_f32_16x16x32_bf16 v[64:67], v[176:179], a[184:187], v[64:67]
  ds_read_b64_tr_b16 v[148:149], v96 offset:8480
  ds_read_b64_tr_b16 v[150:151], v96 offset:8736
  v_mfma_f32_16x16x32_bf16 v[68:71], v[176:179], a[188:191], v[68:71]
  ds_read_b64_tr_b16 v[152:153], v96 offset:8512
  v_mfma_f32_16x16x32_bf16 v[76:79], v[180:183], a[188:191], v[76:79]
  ds_read_b64_tr_b16 v[154:155], v96 offset:8768
  ds_read_b64_tr_b16 v[156:157], v96 offset:8544
  v_mfma_f32_16x16x32_bf16 v[72:75], v[180:183], a[184:187], v[72:75]
  ds_read_b64_tr_b16 v[158:159], v96 offset:8800
  buffer_load_dwordx4 v101, s[32:35], s61 offen offset:1056 lds
  v_mfma_f32_16x16x32_bf16 v[80:83], v[184:187], a[184:187], v[80:83]
  v_mfma_f32_16x16x32_bf16 v[84:87], v[184:187], a[188:191], v[84:87]
  s_add_u32 m0, s76, 57088
  v_mfma_f32_16x16x32_bf16 v[92:95], v[188:191], a[188:191], v[92:95]
  v_mfma_f32_16x16x32_bf16 v[88:91], v[188:191], a[184:187], v[88:91]
  buffer_load_dwordx4 v100, s[32:35], s61 offen offset:2048 lds
  s_waitcnt vmcnt(14) lgkmcnt(0)
  v_mfma_f32_16x16x32_bf16 v[32:35], v[128:131], a[192:195], v[32:35]
  ds_read_b64_tr_b16 v[160:161], v96 offset:4224
  ds_read_b64_tr_b16 v[162:163], v96 offset:4480
  v_mfma_f32_16x16x32_bf16 v[36:39], v[128:131], a[196:199], v[36:39]
  ds_read_b64_tr_b16 v[164:165], v96 offset:4256
  buffer_load_dwordx4 a[224:227], v102, s[36:39], s62 offen offset:0 sc1
  v_mfma_f32_16x16x32_bf16 v[44:47], v[132:135], a[196:199], v[44:47]
  ds_read_b64_tr_b16 v[166:167], v96 offset:4512
  v_mfma_f32_16x16x32_bf16 v[40:43], v[132:135], a[192:195], v[40:43]
  ds_read_b64_tr_b16 v[168:169], v96 offset:4288
  ds_read_b64_tr_b16 v[170:171], v96 offset:4544
  v_mfma_f32_16x16x32_bf16 v[48:51], v[136:139], a[192:195], v[48:51]
  ds_read_b64_tr_b16 v[172:173], v96 offset:4320
  v_readlane_b32 s63, v29, 15
  v_mfma_f32_16x16x32_bf16 v[52:55], v[136:139], a[196:199], v[52:55]
  ds_read_b64_tr_b16 v[174:175], v96 offset:4576
  v_mfma_f32_16x16x32_bf16 v[60:63], v[140:143], a[196:199], v[60:63]
  ds_read_b64_tr_b16 v[176:177], v96 offset:12672
  ds_read_b64_tr_b16 v[178:179], v96 offset:12928
  v_mfma_f32_16x16x32_bf16 v[56:59], v[140:143], a[192:195], v[56:59]
  ds_read_b64_tr_b16 v[180:181], v96 offset:12704
  v_mfma_f32_16x16x32_bf16 v[64:67], v[144:147], a[192:195], v[64:67]
  ds_read_b64_tr_b16 v[182:183], v96 offset:12960
  v_mfma_f32_16x16x32_bf16 v[68:71], v[144:147], a[196:199], v[68:71]
  ds_read_b64_tr_b16 v[184:185], v96 offset:12736
  ds_read_b64_tr_b16 v[186:187], v96 offset:12992
  v_mfma_f32_16x16x32_bf16 v[76:79], v[148:151], a[196:199], v[76:79]
  ds_read_b64_tr_b16 v[188:189], v96 offset:12768
  v_mfma_f32_16x16x32_bf16 v[72:75], v[148:151], a[192:195], v[72:75]
  buffer_load_dwordx4 v101, s[32:35], s61 offen offset:3104 lds
  ds_read_b64_tr_b16 v[190:191], v96 offset:13024
  v_mfma_f32_16x16x32_bf16 v[80:83], v[152:155], a[192:195], v[80:83]
  v_mfma_f32_16x16x32_bf16 v[84:87], v[152:155], a[196:199], v[84:87]
  v_mfma_f32_16x16x32_bf16 v[92:95], v[156:159], a[196:199], v[92:95]
  buffer_load_dwordx4 a[228:231], v103, s[36:39], s62 offen offset:0 sc1
  v_mfma_f32_16x16x32_bf16 v[88:91], v[156:159], a[192:195], v[88:91]
  s_waitcnt vmcnt(13) lgkmcnt(0)
  v_mfma_f32_16x16x32_bf16 v[32:35], v[160:163], a[200:203], v[32:35]
  s_waitcnt vmcnt(18)
  s_barrier
  v_mfma_f32_16x16x32_bf16 v[36:39], v[160:163], a[204:207], v[36:39]
  ds_read_b64_tr_b16 v[128:129], v96 offset:16896
  ds_read_b64_tr_b16 v[130:131], v96 offset:17152
  v_mfma_f32_16x16x32_bf16 v[44:47], v[164:167], a[204:207], v[44:47]
  ds_read_b64_tr_b16 v[132:133], v96 offset:16928
  v_mfma_f32_16x16x32_bf16 v[40:43], v[164:167], a[200:203], v[40:43]
  ds_read_b64_tr_b16 v[134:135], v96 offset:17184
  ds_read_b64_tr_b16 v[136:137], v96 offset:16960
  v_mfma_f32_16x16x32_bf16 v[48:51], v[168:171], a[200:203], v[48:51]
  ds_read_b64_tr_b16 v[138:139], v96 offset:17216
  buffer_load_dwordx4 a[232:235], v102, s[36:39], s62 offen offset:1024 sc1
  v_mfma_f32_16x16x32_bf16 v[52:55], v[168:171], a[204:207], v[52:55]
  ds_read_b64_tr_b16 v[140:141], v96 offset:16992
  ds_read_b64_tr_b16 v[142:143], v96 offset:17248
  v_mfma_f32_16x16x32_bf16 v[60:63], v[172:175], a[204:207], v[60:63]
  ds_read_b64_tr_b16 v[144:145], v96 offset:25344
  v_mfma_f32_16x16x32_bf16 v[56:59], v[172:175], a[200:203], v[56:59]
  ds_read_b64_tr_b16 v[146:147], v96 offset:25600
  ds_read_b64_tr_b16 v[148:149], v96 offset:25376
  v_mfma_f32_16x16x32_bf16 v[64:67], v[176:179], a[200:203], v[64:67]
  ds_read_b64_tr_b16 v[150:151], v96 offset:25632
  v_mfma_f32_16x16x32_bf16 v[68:71], v[176:179], a[204:207], v[68:71]
  ds_read_b64_tr_b16 v[152:153], v96 offset:25408
  ds_read_b64_tr_b16 v[154:155], v96 offset:25664
  v_mfma_f32_16x16x32_bf16 v[76:79], v[180:183], a[204:207], v[76:79]
  ds_read_b64_tr_b16 v[156:157], v96 offset:25440
  v_mfma_f32_16x16x32_bf16 v[72:75], v[180:183], a[200:203], v[72:75]
  ds_read_b64_tr_b16 v[158:159], v96 offset:25696
  v_mfma_f32_16x16x32_bf16 v[80:83], v[184:187], a[200:203], v[80:83]
  buffer_load_dwordx4 a[236:239], v103, s[36:39], s62 offen offset:1024 sc1
  v_mfma_f32_16x16x32_bf16 v[84:87], v[184:187], a[204:207], v[84:87]
  v_mfma_f32_16x16x32_bf16 v[92:95], v[188:191], a[204:207], v[92:95]
  v_mfma_f32_16x16x32_bf16 v[88:91], v[188:191], a[200:203], v[88:91]
  s_waitcnt vmcnt(10) lgkmcnt(0)
  v_mfma_f32_16x16x32_bf16 v[32:35], v[128:131], a[208:211], v[32:35]
  ds_read_b64_tr_b16 v[160:161], v96 offset:21120
  ds_read_b64_tr_b16 v[162:163], v96 offset:21376
  v_mfma_f32_16x16x32_bf16 v[36:39], v[128:131], a[212:215], v[36:39]
  ds_read_b64_tr_b16 v[164:165], v96 offset:21152
  v_mfma_f32_16x16x32_bf16 v[44:47], v[132:135], a[212:215], v[44:47]
  ds_read_b64_tr_b16 v[166:167], v96 offset:21408
  v_mfma_f32_16x16x32_bf16 v[40:43], v[132:135], a[208:211], v[40:43]
  ds_read_b64_tr_b16 v[168:169], v96 offset:21184
  ds_read_b64_tr_b16 v[170:171], v96 offset:21440
  v_mfma_f32_16x16x32_bf16 v[48:51], v[136:139], a[208:211], v[48:51]
  buffer_load_dwordx4 a[240:243], v102, s[36:39], s63 offen offset:0 sc1
  ds_read_b64_tr_b16 v[172:173], v96 offset:21216
  v_mfma_f32_16x16x32_bf16 v[52:55], v[136:139], a[212:215], v[52:55]
  ds_read_b64_tr_b16 v[174:175], v96 offset:21472
  v_mfma_f32_16x16x32_bf16 v[60:63], v[140:143], a[212:215], v[60:63]
  ds_read_b64_tr_b16 v[176:177], v96 offset:29568
  ds_read_b64_tr_b16 v[178:179], v96 offset:29824
  v_mfma_f32_16x16x32_bf16 v[56:59], v[140:143], a[208:211], v[56:59]
  ds_read_b64_tr_b16 v[180:181], v96 offset:29600
  v_mfma_f32_16x16x32_bf16 v[64:67], v[144:147], a[208:211], v[64:67]
  ds_read_b64_tr_b16 v[182:183], v96 offset:29856
  v_mfma_f32_16x16x32_bf16 v[68:71], v[144:147], a[212:215], v[68:71]
  ds_read_b64_tr_b16 v[184:185], v96 offset:29632
  ds_read_b64_tr_b16 v[186:187], v96 offset:29888
  v_mfma_f32_16x16x32_bf16 v[76:79], v[148:151], a[212:215], v[76:79]
  ds_read_b64_tr_b16 v[188:189], v96 offset:29664
  v_mfma_f32_16x16x32_bf16 v[72:75], v[148:151], a[208:211], v[72:75]
  ds_read_b64_tr_b16 v[190:191], v96 offset:29920
  v_mfma_f32_16x16x32_bf16 v[80:83], v[152:155], a[208:211], v[80:83]
  buffer_load_dwordx4 a[244:247], v103, s[36:39], s63 offen offset:0 sc1
  v_mfma_f32_16x16x32_bf16 v[84:87], v[152:155], a[212:215], v[84:87]
  v_mfma_f32_16x16x32_bf16 v[92:95], v[156:159], a[212:215], v[92:95]
  v_mfma_f32_16x16x32_bf16 v[88:91], v[156:159], a[208:211], v[88:91]
  s_waitcnt vmcnt(9) lgkmcnt(0)
  v_mfma_f32_16x16x32_bf16 v[32:35], v[160:163], a[216:219], v[32:35]
  s_waitcnt vmcnt(13)
  s_barrier
  v_mfma_f32_16x16x32_bf16 v[36:39], v[160:163], a[220:223], v[36:39]
  ds_read_b64_tr_b16 v[128:129], v97 offset:0
  buffer_load_dwordx4 a[248:251], v102, s[36:39], s63 offen offset:1024 sc1
  v_mfma_f32_16x16x32_bf16 v[44:47], v[164:167], a[220:223], v[44:47]
  ds_read_b64_tr_b16 v[130:131], v97 offset:256
  ds_read_b64_tr_b16 v[132:133], v97 offset:32
  v_mfma_f32_16x16x32_bf16 v[40:43], v[164:167], a[216:219], v[40:43]
  buffer_load_dwordx4 a[252:255], v103, s[36:39], s63 offen offset:1024 sc1
  ds_read_b64_tr_b16 v[134:135], v97 offset:288
  v_mfma_f32_16x16x32_bf16 v[48:51], v[168:171], a[216:219], v[48:51]
  ds_read_b64_tr_b16 v[136:137], v97 offset:64
  s_add_u32 s70, s22, 0
  v_mfma_f32_16x16x32_bf16 v[52:55], v[168:171], a[220:223], v[52:55]
  ds_read_b64_tr_b16 v[138:139], v97 offset:320
  ds_read_b64_tr_b16 v[140:141], v97 offset:96
  v_mfma_f32_16x16x32_bf16 v[60:63], v[172:175], a[220:223], v[60:63]
  s_add_u32 s75, s70, s31
  ds_read_b64_tr_b16 v[142:143], v97 offset:352
  v_mfma_f32_16x16x32_bf16 v[56:59], v[172:175], a[216:219], v[56:59]
  ds_read_b64_tr_b16 v[144:145], v97 offset:8448
  s_and_b32 s75, s75, 3
  v_mfma_f32_16x16x32_bf16 v[64:67], v[176:179], a[216:219], v[64:67]
  ds_read_b64_tr_b16 v[146:147], v97 offset:8704
  ds_read_b64_tr_b16 v[148:149], v97 offset:8480
  v_mfma_f32_16x16x32_bf16 v[68:71], v[176:179], a[220:223], v[68:71]
  s_and_b32 s70, s70, 4
  ds_read_b64_tr_b16 v[150:151], v97 offset:8736
  v_mfma_f32_16x16x32_bf16 v[76:79], v[180:183], a[220:223], v[76:79]
  s_or_b32 s70, s70, s75
  ds_read_b64_tr_b16 v[152:153], v97 offset:8512
  v_mfma_f32_16x16x32_bf16 v[72:75], v[180:183], a[216:219], v[72:75]
  ds_read_b64_tr_b16 v[154:155], v97 offset:8768
  s_mul_i32 s70, s70, 393216
  v_mfma_f32_16x16x32_bf16 v[80:83], v[184:187], a[216:219], v[80:83]
  ds_read_b64_tr_b16 v[156:157], v97 offset:8544
  ds_read_b64_tr_b16 v[158:159], v97 offset:8800
  v_mfma_f32_16x16x32_bf16 v[84:87], v[184:187], a[220:223], v[84:87]
  s_add_u32 m0, s76, 67584
  s_nop 0
  buffer_load_dwordx4 v98, s[32:35], s70 offen lds
  v_mfma_f32_16x16x32_bf16 v[92:95], v[188:191], a[220:223], v[92:95]
  v_mfma_f32_16x16x32_bf16 v[88:91], v[188:191], a[216:219], v[88:91]
  buffer_load_dwordx4 v99, s[32:35], s70 offen offset:1056 lds
  s_waitcnt vmcnt(8) lgkmcnt(0)
  v_mfma_f32_16x16x32_bf16 v[32:35], v[128:131], a[224:227], v[32:35]
  ds_read_b64_tr_b16 v[160:161], v97 offset:4224
  ds_read_b64_tr_b16 v[162:163], v97 offset:4480
  v_mfma_f32_16x16x32_bf16 v[36:39], v[128:131], a[228:231], v[36:39]
  s_add_u32 s71, s22, 1
  ds_read_b64_tr_b16 v[164:165], v97 offset:4256
  v_mfma_f32_16x16x32_bf16 v[44:47], v[132:135], a[228:231], v[44:47]
  ds_read_b64_tr_b16 v[166:167], v97 offset:4512
  s_add_u32 s75, s71, s31
  v_mfma_f32_16x16x32_bf16 v[40:43], v[132:135], a[224:227], v[40:43]
  ds_read_b64_tr_b16 v[168:169], v97 offset:4288
  ds_read_b64_tr_b16 v[170:171], v97 offset:4544
  v_mfma_f32_16x16x32_bf16 v[48:51], v[136:139], a[224:227], v[48:51]
  s_and_b32 s75, s75, 3
  ds_read_b64_tr_b16 v[172:173], v97 offset:4320
  v_mfma_f32_16x16x32_bf16 v[52:55], v[136:139], a[228:231], v[52:55]
  ds_read_b64_tr_b16 v[174:175], v97 offset:4576
  s_and_b32 s71, s71, 4
  v_mfma_f32_16x16x32_bf16 v[60:63], v[140:143], a[228:231], v[60:63]
  ds_read_b64_tr_b16 v[176:177], v97 offset:12672
  ds_read_b64_tr_b16 v[178:179], v97 offset:12928
  v_mfma_f32_16x16x32_bf16 v[56:59], v[140:143], a[224:227], v[56:59]
  s_or_b32 s71, s71, s75
  ds_read_b64_tr_b16 v[180:181], v97 offset:12704
  v_mfma_f32_16x16x32_bf16 v[64:67], v[144:147], a[224:227], v[64:67]
  ds_read_b64_tr_b16 v[182:183], v97 offset:12960
  s_mul_i32 s71, s71, 393216
  v_mfma_f32_16x16x32_bf16 v[68:71], v[144:147], a[228:231], v[68:71]
  ds_read_b64_tr_b16 v[184:185], v97 offset:12736
  ds_read_b64_tr_b16 v[186:187], v97 offset:12992
  v_mfma_f32_16x16x32_bf16 v[76:79], v[148:151], a[228:231], v[76:79]
  s_add_u32 m0, s76, 76032
  ds_read_b64_tr_b16 v[188:189], v97 offset:12768
  v_mfma_f32_16x16x32_bf16 v[72:75], v[148:151], a[224:227], v[72:75]
  ds_read_b64_tr_b16 v[190:191], v97 offset:13024
  v_mfma_f32_16x16x32_bf16 v[80:83], v[152:155], a[224:227], v[80:83]
  buffer_load_dwordx4 v98, s[32:35], s71 offen lds
  v_mfma_f32_16x16x32_bf16 v[84:87], v[152:155], a[228:231], v[84:87]
  v_mfma_f32_16x16x32_bf16 v[92:95], v[156:159], a[228:231], v[92:95]
  v_mfma_f32_16x16x32_bf16 v[88:91], v[156:159], a[224:227], v[88:91]
  buffer_load_dwordx4 v99, s[32:35], s71 offen offset:1056 lds
  s_waitcnt vmcnt(8) lgkmcnt(0)
  v_mfma_f32_16x16x32_bf16 v[32:35], v[160:163], a[232:235], v[32:35]
  s_waitcnt vmcnt(11)
  s_barrier
  v_mfma_f32_16x16x32_bf16 v[36:39], v[160:163], a[236:239], v[36:39]
  ds_read_b64_tr_b16 v[128:129], v97 offset:16896
  ds_read_b64_tr_b16 v[130:131], v97 offset:17152
  v_mfma_f32_16x16x32_bf16 v[44:47], v[164:167], a[236:239], v[44:47]
  s_add_u32 s70, s22, 2
  ds_read_b64_tr_b16 v[132:133], v97 offset:16928
  v_mfma_f32_16x16x32_bf16 v[40:43], v[164:167], a[232:235], v[40:43]
  ds_read_b64_tr_b16 v[134:135], v97 offset:17184
  s_add_u32 s75, s70, s31
  v_mfma_f32_16x16x32_bf16 v[48:51], v[168:171], a[232:235], v[48:51]
  ds_read_b64_tr_b16 v[136:137], v97 offset:16960
  ds_read_b64_tr_b16 v[138:139], v97 offset:17216
  v_mfma_f32_16x16x32_bf16 v[52:55], v[168:171], a[236:239], v[52:55]
  s_and_b32 s75, s75, 3
  ds_read_b64_tr_b16 v[140:141], v97 offset:16992
  v_mfma_f32_16x16x32_bf16 v[60:63], v[172:175], a[236:239], v[60:63]
  ds_read_b64_tr_b16 v[142:143], v97 offset:17248
  s_and_b32 s70, s70, 4
  v_mfma_f32_16x16x32_bf16 v[56:59], v[172:175], a[232:235], v[56:59]
  ds_read_b64_tr_b16 v[144:145], v97 offset:25344
  ds_read_b64_tr_b16 v[146:147], v97 offset:25600
  v_mfma_f32_16x16x32_bf16 v[64:67], v[176:179], a[232:235], v[64:67]
  s_or_b32 s70, s70, s75
  ds_read_b64_tr_b16 v[148:149], v97 offset:25376
  v_mfma_f32_16x16x32_bf16 v[68:71], v[176:179], a[236:239], v[68:71]
  ds_read_b64_tr_b16 v[150:151], v97 offset:25632
  ds_read_b64_tr_b16 v[152:153], v97 offset:25408
  v_mfma_f32_16x16x32_bf16 v[76:79], v[180:183], a[236:239], v[76:79]
  s_mul_i32 s70, s70, 393216
  ds_read_b64_tr_b16 v[154:155], v97 offset:25664
  v_mfma_f32_16x16x32_bf16 v[72:75], v[180:183], a[232:235], v[72:75]
  ds_read_b64_tr_b16 v[156:157], v97 offset:25440
  s_add_u32 m0, s76, 84480
  v_mfma_f32_16x16x32_bf16 v[80:83], v[184:187], a[232:235], v[80:83]
  ds_read_b64_tr_b16 v[158:159], v97 offset:25696
  buffer_load_dwordx4 v98, s[32:35], s70 offen lds
  v_mfma_f32_16x16x32_bf16 v[84:87], v[184:187], a[236:239], v[84:87]
  v_mfma_f32_16x16x32_bf16 v[92:95], v[188:191], a[236:239], v[92:95]
  v_mfma_f32_16x16x32_bf16 v[88:91], v[188:191], a[232:235], v[88:91]
  buffer_load_dwordx4 v99, s[32:35], s70 offen offset:1056 lds
  s_waitcnt vmcnt(8) lgkmcnt(0)
  v_mfma_f32_16x16x32_bf16 v[32:35], v[128:131], a[240:243], v[32:35]
  ds_read_b64_tr_b16 v[160:161], v97 offset:21120
  ds_read_b64_tr_b16 v[162:163], v97 offset:21376
  v_mfma_f32_16x16x32_bf16 v[36:39], v[128:131], a[244:247], v[36:39]
  s_add_u32 s71, s22, 3
  ds_read_b64_tr_b16 v[164:165], v97 offset:21152
  v_mfma_f32_16x16x32_bf16 v[44:47], v[132:135], a[244:247], v[44:47]
  ds_read_b64_tr_b16 v[166:167], v97 offset:21408
  s_add_u32 s75, s71, s31
  v_mfma_f32_16x16x32_bf16 v[40:43], v[132:135], a[240:243], v[40:43]
  ds_read_b64_tr_b16 v[168:169], v97 offset:21184
  ds_read_b64_tr_b16 v[170:171], v97 offset:21440
  v_mfma_f32_16x16x32_bf16 v[48:51], v[136:139], a[240:243], v[48:51]
  s_and_b32 s75, s75, 3
  ds_read_b64_tr_b16 v[172:173], v97 offset:21216
  v_mfma_f32_16x16x32_bf16 v[52:55], v[136:139], a[244:247], v[52:55]
  ds_read_b64_tr_b16 v[174:175], v97 offset:21472
  s_and_b32 s71, s71, 4
  v_mfma_f32_16x16x32_bf16 v[60:63], v[140:143], a[244:247], v[60:63]
  ds_read_b64_tr_b16 v[176:177], v97 offset:29568
  ds_read_b64_tr_b16 v[178:179], v97 offset:29824
  v_mfma_f32_16x16x32_bf16 v[56:59], v[140:143], a[240:243], v[56:59]
  s_or_b32 s71, s71, s75
  ds_read_b64_tr_b16 v[180:181], v97 offset:29600
  v_mfma_f32_16x16x32_bf16 v[64:67], v[144:147], a[240:243], v[64:67]
  ds_read_b64_tr_b16 v[182:183], v97 offset:29856
  s_mul_i32 s71, s71, 393216
  v_mfma_f32_16x16x32_bf16 v[68:71], v[144:147], a[244:247], v[68:71]
  ds_read_b64_tr_b16 v[184:185], v97 offset:29632
  ds_read_b64_tr_b16 v[186:187], v97 offset:29888
  v_mfma_f32_16x16x32_bf16 v[76:79], v[148:151], a[244:247], v[76:79]
  s_add_u32 m0, s76, 92928
  ds_read_b64_tr_b16 v[188:189], v97 offset:29664
  v_mfma_f32_16x16x32_bf16 v[72:75], v[148:151], a[240:243], v[72:75]
  ds_read_b64_tr_b16 v[190:191], v97 offset:29920
  v_mfma_f32_16x16x32_bf16 v[80:83], v[152:155], a[240:243], v[80:83]
  buffer_load_dwordx4 v98, s[32:35], s71 offen lds
  v_mfma_f32_16x16x32_bf16 v[84:87], v[152:155], a[244:247], v[84:87]
  v_mfma_f32_16x16x32_bf16 v[92:95], v[156:159], a[244:247], v[92:95]
  v_mfma_f32_16x16x32_bf16 v[88:91], v[156:159], a[240:243], v[88:91]
  buffer_load_dwordx4 v99, s[32:35], s71 offen offset:1056 lds
  s_waitcnt vmcnt(8) lgkmcnt(0)
  v_mfma_f32_16x16x32_bf16 v[32:35], v[160:163], a[248:251], v[32:35]
  ds_read_b64_tr_b16 v[0:1], v114 offset:0
  s_add_u32 s70, s22, 4
  v_mfma_f32_16x16x32_bf16 v[36:39], v[160:163], a[252:255], v[36:39]
  ds_read_b64_tr_b16 v[2:3], v114 offset:1024
  v_mfma_f32_16x16x32_bf16 v[44:47], v[164:167], a[252:255], v[44:47]
  s_add_u32 s75, s70, s31
  v_mfma_f32_16x16x32_bf16 v[40:43], v[164:167], a[248:251], v[40:43]
  ds_read_b64_tr_b16 v[4:5], v114 offset:32
  v_mfma_f32_16x16x32_bf16 v[48:51], v[168:171], a[248:251], v[48:51]
  s_and_b32 s75, s75, 3
  ds_read_b64_tr_b16 v[6:7], v114 offset:1056
  v_mfma_f32_16x16x32_bf16 v[52:55], v[168:171], a[252:255], v[52:55]
  s_and_b32 s70, s70, 4
  v_mfma_f32_16x16x32_bf16 v[60:63], v[172:175], a[252:255], v[60:63]
  ds_read_b64_tr_b16 v[8:9], v114 offset:2048
  v_mfma_f32_16x16x32_bf16 v[56:59], v[172:175], a[248:251], v[56:59]
  s_or_b32 s70, s70, s75
  ds_read_b64_tr_b16 v[10:11], v114 offset:3072
  v_mfma_f32_16x16x32_bf16 v[64:67], v[176:179], a[248:251], v[64:67]
  s_mul_i32 s70, s70, 393216
  v_mfma_f32_16x16x32_bf16 v[68:71], v[176:179], a[252:255], v[68:71]
  ds_read_b64_tr_b16 v[12:13], v114 offset:2080
  v_mfma_f32_16x16x32_bf16 v[76:79], v[180:183], a[252:255], v[76:79]
  s_add_u32 m0, s76, 101376
  ds_read_b64_tr_b16 v[14:15], v114 offset:3104
  v_mfma_f32_16x16x32_bf16 v[72:75], v[180:183], a[248:251], v[72:75]
  v_mfma_f32_16x16x32_bf16 v[80:83], v[184:187], a[248:251], v[80:83]
  buffer_load_dwordx4 v98, s[32:35], s70 offen lds
  v_mfma_f32_16x16x32_bf16 v[84:87], v[184:187], a[252:255], v[84:87]
  v_mfma_f32_16x16x32_bf16 v[92:95], v[188:191], a[252:255], v[92:95]
  v_mfma_f32_16x16x32_bf16 v[88:91], v[188:191], a[248:251], v[88:91]
  buffer_load_dwordx4 v99, s[32:35], s70 offen offset:1056 lds
  s_waitcnt lgkmcnt(0)
  s_nop 6
  s_nop 0
  v_cvt_pk_bf16_f32 v126, v32, v33
  v_cvt_pk_bf16_f32 v127, v34, v35
  v_cvt_pk_bf16_f32 v128, v40, v41
  v_cvt_pk_bf16_f32 v129, v42, v43
  v_cvt_pk_bf16_f32 v130, v36, v37
  v_cvt_pk_bf16_f32 v131, v38, v39
  v_cvt_pk_bf16_f32 v132, v44, v45
  v_cvt_pk_bf16_f32 v133, v46, v47
  v_cvt_pk_bf16_f32 v134, v48, v49
  v_cvt_pk_bf16_f32 v135, v50, v51
  v_cvt_pk_bf16_f32 v136, v56, v57
  s_add_u32 s71, s22, 5
  s_add_u32 s75, s71, s31
  s_and_b32 s75, s75, 3
  s_and_b32 s71, s71, 4
  s_or_b32 s71, s71, s75
  s_mul_i32 s71, s71, 393216
  s_add_u32 m0, s76, 129792
  s_nop 0
  buffer_load_dwordx4 v98, s[32:35], s71 offen lds
  v_cvt_pk_bf16_f32 v137, v58, v59
  v_cvt_pk_bf16_f32 v138, v52, v53
  v_cvt_pk_bf16_f32 v139, v54, v55
  v_cvt_pk_bf16_f32 v140, v60, v61
  v_cvt_pk_bf16_f32 v141, v62, v63
  s_nop 1
  v_mfma_f32_16x16x32_bf16 v[142:145], v[0:3], v[126:129], 0
  v_mfma_f32_16x16x32_bf16 v[146:149], v[4:7], v[126:129], 0
  v_mfma_f32_16x16x32_bf16 v[150:153], v[0:3], v[130:133], 0
  v_mfma_f32_16x16x32_bf16 v[154:157], v[4:7], v[130:133], 0
  v_mfma_f32_16x16x32_bf16 v[158:161], v[8:11], v[134:137], 0
  v_mfma_f32_16x16x32_bf16 v[162:165], v[12:15], v[134:137], 0
  v_mfma_f32_16x16x32_bf16 v[166:169], v[8:11], v[138:141], 0
  v_mfma_f32_16x16x32_bf16 v[170:173], v[12:15], v[138:141], 0
  s_nop 0
  buffer_load_dwordx4 v99, s[32:35], s71 offen offset:1056 lds
  s_barrier
  s_nop 0
  v_cvt_pk_bf16_f32 v64, v64, v65
  v_cvt_pk_bf16_f32 v65, v66, v67
  ds_write_b64 v111, v[64:65] offset:34816
  v_cvt_pk_bf16_f32 v72, v72, v73
  v_cvt_pk_bf16_f32 v73, v74, v75
  ds_write_b64 v111, v[72:73] offset:34848
  v_cvt_pk_bf16_f32 v68, v68, v69
  v_cvt_pk_bf16_f32 v69, v70, v71
  ds_write_b64 v111, v[68:69] offset:35968
  v_cvt_pk_bf16_f32 v76, v76, v77
  v_cvt_pk_bf16_f32 v77, v78, v79
  ds_write_b64 v111, v[76:77] offset:36000
  v_cvt_pk_bf16_f32 v80, v80, v81
  s_add_u32 s70, s22, 6
  s_add_u32 s75, s70, s31
  s_and_b32 s75, s75, 3
  s_and_b32 s70, s70, 4
  s_or_b32 s70, s70, s75
  s_mul_i32 s70, s70, 393216
  s_add_u32 m0, s76, 138240
  s_nop 0
  buffer_load_dwordx4 v98, s[32:35], s70 offen lds
  v_cvt_pk_bf16_f32 v81, v82, v83
  ds_write_b64 v111, v[80:81] offset:44032
  v_cvt_pk_bf16_f32 v88, v88, v89
  v_cvt_pk_bf16_f32 v89, v90, v91
  ds_write_b64 v111, v[88:89] offset:44064
  v_cvt_pk_bf16_f32 v84, v84, v85
  v_cvt_pk_bf16_f32 v85, v86, v87
  ds_write_b64 v111, v[84:85] offset:45184
  v_cvt_pk_bf16_f32 v92, v92, v93
  v_cvt_pk_bf16_f32 v93, v94, v95
  ds_write_b64 v111, v[92:93] offset:45216
  v_max3_f32 v206, v142, v143, v144
  v_max3_f32 v206, v206, v145, v146
  v_max3_f32 v206, v206, v147, v148
  s_nop 0
  buffer_load_dwordx4 v99, s[32:35], s70 offen offset:1056 lds
  v_max_f32 v206, v206, v149
  v_max3_f32 v208, v150, v151, v152
  v_max3_f32 v208, v208, v153, v154
  v_max3_f32 v208, v208, v155, v156
  v_max_f32_e64 v208, v208, v157
  v_max3_f32 v210, v158, v159, v160
  v_max3_f32 v210, v210, v161, v162
  v_max3_f32 v210, v210, v163, v164
  v_max_f32_e64 v210, v210, v165
  v_max3_f32 v212, v166, v167, v168
  v_max3_f32 v212, v212, v169, v170
  v_max3_f32 v212, v212, v171, v172
  v_max_f32 v212, v212, v173
  v_min3_f32 v214, v142, v143, v144
  s_add_u32 s71, s22, 7
  s_add_u32 s75, s71, s31
  s_and_b32 s75, s75, 3
  s_and_b32 s71, s71, 4
  s_or_b32 s71, s71, s75
  s_mul_i32 s71, s71, 393216
  s_add_u32 m0, s76, 146688
  s_nop 0
  buffer_load_dwordx4 v98, s[32:35], s71 offen lds
  v_min3_f32 v214, v214, v145, v146
  v_min3_f32 v214, v214, v147, v148
  v_min_f32 v214, v214, v149
  v_min3_f32 v216, v150, v151, v152
  v_min3_f32 v216, v216, v153, v154
  v_min3_f32 v216, v216, v155, v156
  v_min_f32_e64 v216, v216, v157
  v_min3_f32 v218, v158, v159, v160
  v_min3_f32 v218, v218, v161, v162
  v_min3_f32 v218, v218, v163, v164
  v_min_f32_e64 v218, v218, v165
  v_min3_f32 v220, v166, v167, v168
  v_min3_f32 v220, v220, v169, v170
  v_min3_f32 v220, v220, v171, v172
  s_nop 0
  buffer_load_dwordx4 v99, s[32:35], s71 offen offset:1056 lds
  v_min_f32 v220, v220, v173
  s_nop 1
  v_permlane32_swap_b32 v206, v208
  v_permlane32_swap_b32 v210, v212
  v_permlane32_swap_b32 v214, v216
  v_permlane32_swap_b32 v218, v220
  s_nop 0
  v_max_f32 v206, v206, v208
  v_max_f32 v210, v210, v212
  v_min_f32 v214, v214, v216
  v_min_f32 v218, v218, v220
  s_nop 0
  v_permlane16_swap_b32 v206, v210
  v_permlane16_swap_b32 v214, v218
  s_add_u32 s70, s22, 0
  s_add_u32 s75, s70, s31
  s_and_b32 s75, s75, 3
  s_and_b32 s70, s70, 4
  s_or_b32 s70, s70, s75
  s_add_u32 s70, s70, 8
  s_mul_i32 s70, s70, 393216
  s_add_u32 m0, s76, 155136
  s_nop 0
  buffer_load_dwordx4 v98, s[32:35], s70 offen lds
  s_nop 0
  v_max_f32 v206, v206, v210
  v_mov_b32 v210, v206
  v_min_f32 v214, v214, v218
  v_mov_b32 v218, v214
  s_nop 0
  v_permlane16_swap_b32 v206, v210
  v_permlane16_swap_b32 v214, v218
  s_nop 0
  v_mov_b32 v208, v206
  v_mov_b32 v212, v210
  v_mov_b32 v216, v214
  v_mov_b32 v220, v218
  s_nop 0
  s_nop 0
  buffer_load_dwordx4 v99, s[32:35], s70 offen offset:1056 lds
  v_permlane32_swap_b32 v206, v208
  v_permlane32_swap_b32 v210, v212
  v_permlane32_swap_b32 v214, v216
  v_permlane32_swap_b32 v218, v220
  s_nop 0
  s_nop 0
  s_nop 0
  v_mul_f32 v206, -1.4426950408889634, v206
  v_mul_f32 v214, 1.4426950408889634, v214
  v_mul_f32 v208, -1.4426950408889634, v208
  v_mul_f32 v216, 1.4426950408889634, v216
  v_mul_f32 v210, -1.4426950408889634, v210
  v_mul_f32 v218, 1.4426950408889634, v218
  v_mul_f32 v212, -1.4426950408889634, v212
  v_mul_f32 v220, 1.4426950408889634, v220
  v_pk_fma_f32 v[174:175], v[142:143], s[94:95], v[214:215] op_sel_hi:[1,1,0] neg_lo:[1,0,0] neg_hi:[1,0,0]
  v_pk_fma_f32 v[142:143], v[142:143], s[94:95], v[206:207] op_sel_hi:[1,1,0]
  v_pk_fma_f32 v[176:177], v[144:145], s[94:95], v[214:215] op_sel_hi:[1,1,0] neg_lo:[1,0,0] neg_hi:[1,0,0]
  v_pk_fma_f32 v[144:145], v[144:145], s[94:95], v[206:207] op_sel_hi:[1,1,0]
  v_pk_fma_f32 v[178:179], v[146:147], s[94:95], v[214:215] op_sel_hi:[1,1,0] neg_lo:[1,0,0] neg_hi:[1,0,0]
  v_pk_fma_f32 v[146:147], v[146:147], s[94:95], v[206:207] op_sel_hi:[1,1,0]
  v_pk_fma_f32 v[180:181], v[148:149], s[94:95], v[214:215] op_sel_hi:[1,1,0] neg_lo:[1,0,0] neg_hi:[1,0,0]
  v_pk_fma_f32 v[148:149], v[148:149], s[94:95], v[206:207] op_sel_hi:[1,1,0]
  v_exp_f32 v142, v142
  v_exp_f32 v143, v143
  v_exp_f32 v144, v144
  v_exp_f32 v145, v145
  v_exp_f32 v146, v146
  v_exp_f32 v147, v147
  v_exp_f32 v148, v148
  v_exp_f32 v149, v149
  v_exp_f32 v174, v174
  v_exp_f32 v175, v175
  v_exp_f32 v176, v176
  v_exp_f32 v177, v177
  v_exp_f32 v178, v178
  v_exp_f32 v179, v179
  v_exp_f32 v180, v180
  v_exp_f32 v181, v181
  s_nop 0
  s_nop 0
  v_cvt_pk_bf16_f32 v222, v142, v143
  v_cvt_pk_bf16_f32 v223, v144, v145
  v_cvt_pk_bf16_f32 v224, v146, v147
  v_cvt_pk_bf16_f32 v225, v148, v149
  v_cvt_pk_bf16_f32 v226, v174, v175
  v_cvt_pk_bf16_f32 v227, v176, v177
  v_cvt_pk_bf16_f32 v228, v178, v179
  v_cvt_pk_bf16_f32 v229, v180, v181
  v_pk_fma_f32 v[182:183], v[150:151], s[94:95], v[216:217] op_sel_hi:[1,1,0] neg_lo:[1,0,0] neg_hi:[1,0,0]
  v_pk_fma_f32 v[150:151], v[150:151], s[94:95], v[208:209] op_sel_hi:[1,1,0]
  v_pk_fma_f32 v[184:185], v[152:153], s[94:95], v[216:217] op_sel_hi:[1,1,0] neg_lo:[1,0,0] neg_hi:[1,0,0]
  v_pk_fma_f32 v[152:153], v[152:153], s[94:95], v[208:209] op_sel_hi:[1,1,0]
  v_pk_fma_f32 v[186:187], v[154:155], s[94:95], v[216:217] op_sel_hi:[1,1,0] neg_lo:[1,0,0] neg_hi:[1,0,0]
  v_pk_fma_f32 v[154:155], v[154:155], s[94:95], v[208:209] op_sel_hi:[1,1,0]
  v_pk_fma_f32 v[188:189], v[156:157], s[94:95], v[216:217] op_sel_hi:[1,1,0] neg_lo:[1,0,0] neg_hi:[1,0,0]
  v_pk_fma_f32 v[156:157], v[156:157], s[94:95], v[208:209] op_sel_hi:[1,1,0]
  v_exp_f32 v150, v150
  v_exp_f32 v151, v151
  v_exp_f32 v152, v152
  v_exp_f32 v153, v153
  v_exp_f32 v154, v154
  v_exp_f32 v155, v155
  v_exp_f32 v156, v156
  v_exp_f32 v157, v157
  v_exp_f32 v182, v182
  v_exp_f32 v183, v183
  v_exp_f32 v184, v184
  v_exp_f32 v185, v185
  v_exp_f32 v186, v186
  v_exp_f32 v187, v187
  v_exp_f32 v188, v188
  v_exp_f32 v189, v189
  s_nop 0
  s_nop 0
  v_cvt_pk_bf16_f32 v230, v150, v151
  v_cvt_pk_bf16_f32 v231, v152, v153
  v_cvt_pk_bf16_f32 v232, v154, v155
  v_cvt_pk_bf16_f32 v233, v156, v157
  v_cvt_pk_bf16_f32 v234, v182, v183
  v_cvt_pk_bf16_f32 v235, v184, v185
  v_cvt_pk_bf16_f32 v236, v186, v187
  v_cvt_pk_bf16_f32 v237, v188, v189
  v_pk_fma_f32 v[190:191], v[158:159], s[94:95], v[218:219] op_sel_hi:[1,1,0] neg_lo:[1,0,0] neg_hi:[1,0,0]
  v_pk_fma_f32 v[158:159], v[158:159], s[94:95], v[210:211] op_sel_hi:[1,1,0]
  v_pk_fma_f32 v[192:193], v[160:161], s[94:95], v[218:219] op_sel_hi:[1,1,0] neg_lo:[1,0,0] neg_hi:[1,0,0]
  v_pk_fma_f32 v[160:161], v[160:161], s[94:95], v[210:211] op_sel_hi:[1,1,0]
  v_pk_fma_f32 v[194:195], v[162:163], s[94:95], v[218:219] op_sel_hi:[1,1,0] neg_lo:[1,0,0] neg_hi:[1,0,0]
  v_pk_fma_f32 v[162:163], v[162:163], s[94:95], v[210:211] op_sel_hi:[1,1,0]
  v_pk_fma_f32 v[196:197], v[164:165], s[94:95], v[218:219] op_sel_hi:[1,1,0] neg_lo:[1,0,0] neg_hi:[1,0,0]
  v_pk_fma_f32 v[164:165], v[164:165], s[94:95], v[210:211] op_sel_hi:[1,1,0]
  v_exp_f32 v158, v158
  v_exp_f32 v159, v159
  v_exp_f32 v160, v160
  v_exp_f32 v161, v161
  v_exp_f32 v162, v162
  v_exp_f32 v163, v163
  v_exp_f32 v164, v164
  v_exp_f32 v165, v165
  v_exp_f32 v190, v190
  v_exp_f32 v191, v191
  v_exp_f32 v192, v192
  v_exp_f32 v193, v193
  v_exp_f32 v194, v194
  v_exp_f32 v195, v195
  v_exp_f32 v196, v196
  v_exp_f32 v197, v197
  s_nop 0
  s_nop 0
  v_cvt_pk_bf16_f32 v238, v158, v159
  v_cvt_pk_bf16_f32 v239, v160, v161
  v_cvt_pk_bf16_f32 v240, v162, v163
  v_cvt_pk_bf16_f32 v241, v164, v165
  v_cvt_pk_bf16_f32 v242, v190, v191
  v_cvt_pk_bf16_f32 v243, v192, v193
  v_cvt_pk_bf16_f32 v244, v194, v195
  v_cvt_pk_bf16_f32 v245, v196, v197
  v_pk_fma_f32 v[198:199], v[166:167], s[94:95], v[220:221] op_sel_hi:[1,1,0] neg_lo:[1,0,0] neg_hi:[1,0,0]
  v_pk_fma_f32 v[166:167], v[166:167], s[94:95], v[212:213] op_sel_hi:[1,1,0]
  v_pk_fma_f32 v[200:201], v[168:169], s[94:95], v[220:221] op_sel_hi:[1,1,0] neg_lo:[1,0,0] neg_hi:[1,0,0]
  v_pk_fma_f32 v[168:169], v[168:169], s[94:95], v[212:213] op_sel_hi:[1,1,0]
  v_pk_fma_f32 v[202:203], v[170:171], s[94:95], v[220:221] op_sel_hi:[1,1,0] neg_lo:[1,0,0] neg_hi:[1,0,0]
  v_pk_fma_f32 v[170:171], v[170:171], s[94:95], v[212:213] op_sel_hi:[1,1,0]
  v_pk_fma_f32 v[204:205], v[172:173], s[94:95], v[220:221] op_sel_hi:[1,1,0] neg_lo:[1,0,0] neg_hi:[1,0,0]
  v_pk_fma_f32 v[172:173], v[172:173], s[94:95], v[212:213] op_sel_hi:[1,1,0]
  v_exp_f32 v166, v166
  v_exp_f32 v167, v167
  v_exp_f32 v168, v168
  v_exp_f32 v169, v169
  v_exp_f32 v170, v170
  v_exp_f32 v171, v171
  v_exp_f32 v172, v172
  v_exp_f32 v173, v173
  v_exp_f32 v198, v198
  v_exp_f32 v199, v199
  v_exp_f32 v200, v200
  v_exp_f32 v201, v201
  v_exp_f32 v202, v202
  v_exp_f32 v203, v203
  v_exp_f32 v204, v204
  v_exp_f32 v205, v205
  s_nop 0
  s_nop 0
  v_cvt_pk_bf16_f32 v246, v166, v167
  v_cvt_pk_bf16_f32 v247, v168, v169
  v_cvt_pk_bf16_f32 v248, v170, v171
  v_cvt_pk_bf16_f32 v249, v172, v173
  v_cvt_pk_bf16_f32 v250, v198, v199
  v_cvt_pk_bf16_f32 v251, v200, v201
  v_cvt_pk_bf16_f32 v252, v202, v203
  v_cvt_pk_bf16_f32 v253, v204, v205
  s_nop 0
  s_nop 0
  v_mfma_f32_16x16x32_bf16 v[32:35], v[116:119], v[222:225], 0
  v_mfma_f32_16x16x32_bf16 v[36:39], v[116:119], v[226:229], 0
  v_mfma_f32_16x16x32_bf16 v[40:43], v[116:119], v[230:233], 0
  v_mfma_f32_16x16x32_bf16 v[44:47], v[116:119], v[234:237], 0
  v_mfma_f32_16x16x32_bf16 v[48:51], v[116:119], v[238:241], 0
  v_mfma_f32_16x16x32_bf16 v[52:55], v[116:119], v[242:245], 0
  v_mfma_f32_16x16x32_bf16 v[56:59], v[116:119], v[246:249], 0
  v_mfma_f32_16x16x32_bf16 v[60:63], v[116:119], v[250:253], 0
  v_add_u32 v97, 67584, v96
  v_add_u32 v102, 129792, v96
  s_nop 5
  v_rcp_f32 v32, v32
  v_rcp_f32 v36, v36
  v_rcp_f32 v40, v40
  v_rcp_f32 v44, v44
  v_rcp_f32 v48, v48
  v_rcp_f32 v52, v52
  v_rcp_f32 v56, v56
  v_rcp_f32_e64 v60, v60
  v_pk_mul_f32 v[142:143], v[142:143], v[32:33] op_sel_hi:[1,0]
  v_pk_mul_f32 v[144:145], v[144:145], v[32:33] op_sel_hi:[1,0]
  v_pk_mul_f32 v[146:147], v[146:147], v[32:33] op_sel_hi:[1,0]
  v_pk_mul_f32 v[148:149], v[148:149], v[32:33] op_sel_hi:[1,0]
  v_cvt_pk_bf16_f32 v142, v142, v143
  v_cvt_pk_bf16_f32 v143, v144, v145
  ds_write_b64 v110, v[142:143] offset:0
  v_cvt_pk_bf16_f32 v146, v146, v147
  v_cvt_pk_bf16_f32 v147, v148, v149
  ds_write_b64 v110, v[146:147] offset:32
  v_pk_mul_f32 v[174:175], v[174:175], v[36:37] op_sel_hi:[1,0]
  v_pk_mul_f32 v[176:177], v[176:177], v[36:37] op_sel_hi:[1,0]
  v_pk_mul_f32 v[178:179], v[178:179], v[36:37] op_sel_hi:[1,0]
  v_pk_mul_f32 v[180:181], v[180:181], v[36:37] op_sel_hi:[1,0]
  v_cvt_pk_bf16_f32 v174, v174, v175
  v_cvt_pk_bf16_f32 v175, v176, v177
  ds_write_b64 v110, v[174:175] offset:64
  v_cvt_pk_bf16_f32 v178, v178, v179
  v_cvt_pk_bf16_f32 v179, v180, v181
  ds_write_b64 v110, v[178:179] offset:96
  v_pk_mul_f32 v[150:151], v[150:151], v[40:41] op_sel_hi:[1,0]
  v_pk_mul_f32 v[152:153], v[152:153], v[40:41] op_sel_hi:[1,0]
  v_pk_mul_f32 v[154:155], v[154:155], v[40:41] op_sel_hi:[1,0]
  v_pk_mul_f32 v[156:157], v[156:157], v[40:41] op_sel_hi:[1,0]
  v_cvt_pk_bf16_f32 v150, v150, v151
  v_cvt_pk_bf16_f32 v151, v152, v153
  ds_write_b64 v110, v[150:151] offset:2176
  v_cvt_pk_bf16_f32 v154, v154, v155
  v_cvt_pk_bf16_f32 v155, v156, v157
  ds_write_b64 v110, v[154:155] offset:2208
  v_pk_mul_f32 v[182:183], v[182:183], v[44:45] op_sel_hi:[1,0]
  v_pk_mul_f32 v[184:185], v[184:185], v[44:45] op_sel_hi:[1,0]
  v_pk_mul_f32 v[186:187], v[186:187], v[44:45] op_sel_hi:[1,0]
  v_pk_mul_f32 v[188:189], v[188:189], v[44:45] op_sel_hi:[1,0]
  v_cvt_pk_bf16_f32 v182, v182, v183
  v_cvt_pk_bf16_f32 v183, v184, v185
  ds_write_b64 v110, v[182:183] offset:2240
  v_cvt_pk_bf16_f32 v186, v186, v187
  v_cvt_pk_bf16_f32 v187, v188, v189
  ds_write_b64 v110, v[186:187] offset:2272
  v_pk_mul_f32 v[158:159], v[158:159], v[48:49] op_sel_hi:[1,0]
  v_pk_mul_f32 v[160:161], v[160:161], v[48:49] op_sel_hi:[1,0]
  v_pk_mul_f32 v[162:163], v[162:163], v[48:49] op_sel_hi:[1,0]
  v_pk_mul_f32 v[164:165], v[164:165], v[48:49] op_sel_hi:[1,0]
  v_cvt_pk_bf16_f32 v158, v158, v159
  v_cvt_pk_bf16_f32 v159, v160, v161
  ds_write_b64 v110, v[158:159] offset:17408
  v_cvt_pk_bf16_f32 v162, v162, v163
  v_cvt_pk_bf16_f32 v163, v164, v165
  ds_write_b64 v110, v[162:163] offset:17440
  v_pk_mul_f32 v[190:191], v[190:191], v[52:53] op_sel_hi:[1,0]
  v_pk_mul_f32 v[192:193], v[192:193], v[52:53] op_sel_hi:[1,0]
  v_pk_mul_f32 v[194:195], v[194:195], v[52:53] op_sel_hi:[1,0]
  v_pk_mul_f32 v[196:197], v[196:197], v[52:53] op_sel_hi:[1,0]
  v_cvt_pk_bf16_f32 v190, v190, v191
  v_cvt_pk_bf16_f32 v191, v192, v193
  ds_write_b64 v110, v[190:191] offset:17472
  v_cvt_pk_bf16_f32 v194, v194, v195
  v_cvt_pk_bf16_f32 v195, v196, v197
  ds_write_b64 v110, v[194:195] offset:17504
  v_pk_mul_f32 v[166:167], v[166:167], v[56:57] op_sel_hi:[1,0]
  v_pk_mul_f32 v[168:169], v[168:169], v[56:57] op_sel_hi:[1,0]
  v_pk_mul_f32 v[170:171], v[170:171], v[56:57] op_sel_hi:[1,0]
  v_pk_mul_f32 v[172:173], v[172:173], v[56:57] op_sel_hi:[1,0]
  v_cvt_pk_bf16_f32 v166, v166, v167
  v_cvt_pk_bf16_f32 v167, v168, v169
  ds_write_b64 v110, v[166:167] offset:19584
  v_cvt_pk_bf16_f32 v170, v170, v171
  v_cvt_pk_bf16_f32 v171, v172, v173
  ds_write_b64 v110, v[170:171] offset:19616
  v_pk_mul_f32 v[198:199], v[198:199], v[60:61] op_sel_hi:[1,0]
  v_pk_mul_f32 v[200:201], v[200:201], v[60:61] op_sel_hi:[1,0]
  v_pk_mul_f32 v[202:203], v[202:203], v[60:61] op_sel_hi:[1,0]
  v_pk_mul_f32 v[204:205], v[204:205], v[60:61] op_sel_hi:[1,0]
  v_cvt_pk_bf16_f32 v198, v198, v199
  v_cvt_pk_bf16_f32 v199, v200, v201
  ds_write_b64 v110, v[198:199] offset:19648
  v_cvt_pk_bf16_f32 v202, v202, v203
  v_cvt_pk_bf16_f32 v203, v204, v205
  ds_write_b64 v110, v[202:203] offset:19680
  s_waitcnt lgkmcnt(0)
  s_barrier
  ds_read_b64_tr_b16 v[190:191], v112 offset:0
  ds_read_b64_tr_b16 v[194:195], v112 offset:32
  ds_read_b64_tr_b16 v[198:199], v113 offset:34816
  ds_read_b64_tr_b16 v[202:203], v113 offset:34848
  ds_read_b64_tr_b16 v[192:193], v112 offset:2176
  ds_read_b64_tr_b16 v[196:197], v112 offset:2208
  ds_read_b64_tr_b16 v[200:201], v113 offset:35968
  ds_read_b64_tr_b16 v[204:205], v113 offset:36000
  ds_read_b64_tr_b16 v[206:207], v112 offset:4352
  ds_read_b64_tr_b16 v[210:211], v112 offset:4384
  ds_read_b64_tr_b16 v[214:215], v113 offset:37120
  ds_read_b64_tr_b16 v[218:219], v113 offset:37152
  ds_read_b64_tr_b16 v[208:209], v112 offset:6528
  ds_read_b64_tr_b16 v[212:213], v112 offset:6560
  ds_read_b64_tr_b16 v[216:217], v113 offset:38272
  ds_read_b64_tr_b16 v[220:221], v113 offset:38304
  ds_read_b64_tr_b16 v[222:223], v112 offset:8704
  ds_read_b64_tr_b16 v[226:227], v112 offset:8736
  ds_read_b64_tr_b16 v[230:231], v113 offset:39424
  ds_read_b64_tr_b16 v[234:235], v113 offset:39456
  ds_read_b64_tr_b16 v[224:225], v112 offset:10880
  ds_read_b64_tr_b16 v[228:229], v112 offset:10912
  ds_read_b64_tr_b16 v[232:233], v113 offset:40576
  ds_read_b64_tr_b16 v[236:237], v113 offset:40608
  ds_read_b64_tr_b16 v[238:239], v112 offset:13056
  ds_read_b64_tr_b16 v[242:243], v112 offset:13088
  ds_read_b64_tr_b16 v[246:247], v113 offset:41728
  ds_read_b64_tr_b16 v[250:251], v113 offset:41760
  ds_read_b64_tr_b16 v[240:241], v112 offset:15232
  ds_read_b64_tr_b16 v[244:245], v112 offset:15264
  ds_read_b64_tr_b16 v[248:249], v113 offset:42880
  ds_read_b64_tr_b16 v[252:253], v113 offset:42912
  s_lshl_b32 s82, s27, 2
  s_add_u32 s82, s82, s3
  s_lshl_b32 s86, s82, 15
  s_lshl_b32 s84, s26, 10
  s_add_u32 s84, s84, s86
  s_add_u32 s85, s84, 16384
  s_lshl_b32 s90, s82, 11
  s_lshl_b32 s91, s82, 10
  s_add_u32 s91, s91, 65536
  s_lshl_b32 s92, s26, 6
  s_add_u32 s92, s92, s91
  v_and_b32 v106, 15, v104
  v_cmp_eq_u32 vcc, s26, v106
  s_waitcnt lgkmcnt(15)
  v_mfma_f32_16x16x32_bf16 v[64:67], v[190:193], v[198:201], 0
  v_mfma_f32_16x16x32_bf16 v[72:75], v[190:193], v[202:205], 0
  v_mfma_f32_16x16x32_bf16 v[80:83], v[190:193], v[116:119], 0
  v_mfma_f32_16x16x32_bf16 v[68:71], v[194:197], v[198:201], 0
  v_mfma_f32_16x16x32_bf16 v[76:79], v[194:197], v[202:205], 0
  v_mfma_f32_16x16x32_bf16 v[84:87], v[194:197], v[116:119], 0
  s_waitcnt lgkmcnt(15)
  v_mfma_f32_16x16x32_bf16 v[64:67], v[206:209], v[214:217], v[64:67]
  v_mfma_f32_16x16x32_bf16 v[72:75], v[206:209], v[218:221], v[72:75]
  v_mfma_f32_16x16x32_bf16 v[80:83], v[206:209], v[116:119], v[80:83]
  v_mfma_f32_16x16x32_bf16 v[68:71], v[210:213], v[214:217], v[68:71]
  v_mfma_f32_16x16x32_bf16 v[76:79], v[210:213], v[218:221], v[76:79]
  v_mfma_f32_16x16x32_bf16 v[84:87], v[210:213], v[116:119], v[84:87]
  s_waitcnt lgkmcnt(8)
  v_mfma_f32_16x16x32_bf16 v[64:67], v[222:225], v[230:233], v[64:67]
  v_mfma_f32_16x16x32_bf16 v[72:75], v[222:225], v[234:237], v[72:75]
  v_mfma_f32_16x16x32_bf16 v[80:83], v[222:225], v[116:119], v[80:83]
  v_mfma_f32_16x16x32_bf16 v[68:71], v[226:229], v[230:233], v[68:71]
  v_mfma_f32_16x16x32_bf16 v[76:79], v[226:229], v[234:237], v[76:79]
  v_mfma_f32_16x16x32_bf16 v[84:87], v[226:229], v[116:119], v[84:87]
  s_waitcnt vmcnt(0) lgkmcnt(0)
  s_barrier
  v_mfma_f32_16x16x32_bf16 v[64:67], v[238:241], v[246:249], v[64:67]
  v_mfma_f32_16x16x32_bf16 v[72:75], v[238:241], v[250:253], v[72:75]
  v_mfma_f32_16x16x32_bf16 v[80:83], v[238:241], v[116:119], v[80:83]
  v_mfma_f32_16x16x32_bf16 v[68:71], v[242:245], v[246:249], v[68:71]
  v_mfma_f32_16x16x32_bf16 v[76:79], v[242:245], v[250:253], v[76:79]
  v_mfma_f32_16x16x32_bf16 v[84:87], v[242:245], v[116:119], v[84:87]
  v_lshlrev_b32 v106, 6, v106
  v_mov_b32 v107, 1
  v_mov_b32 v108, 0
  s_nop 5
  v_cvt_pk_bf16_f32 v88, v64, v65
  v_cvt_pk_bf16_f32 v89, v66, v67
  v_cvt_pk_bf16_f32 v90, v68, v69
  v_cvt_pk_bf16_f32 v91, v70, v71
  v_cvt_pk_bf16_f32 v92, v72, v73
  v_cvt_pk_bf16_f32 v93, v74, v75
  v_cvt_pk_bf16_f32 v94, v76, v77
  v_cvt_pk_bf16_f32 v95, v78, v79
  buffer_store_dwordx4 v[88:91], v105, s[44:47], s84 offen sc1
  buffer_store_dwordx4 v[92:95], v105, s[44:47], s85 offen sc1
  s_and_saveexec_b64 s[96:97], vcc
  buffer_store_dwordx4 v[80:83], v105, s[48:51], s90 offen sc1
  buffer_store_dwordx4 v[84:87], v105, s[48:51], s90 offen offset:1024 sc1
  s_mov_b64 exec, s[96:97]
  s_add_u32 s71, s22, 1
  s_add_u32 s75, s71, s31
  s_and_b32 s75, s75, 3
  s_and_b32 s71, s71, 4
  s_or_b32 s71, s71, s75
  s_add_u32 s71, s71, 8
  s_mul_i32 s71, s71, 393216
  s_add_u32 m0, s76, 0
  s_nop 0
  buffer_load_dwordx4 v98, s[32:35], s71 offen lds
  s_nop 0
  s_nop 0
  buffer_load_dwordx4 v99, s[32:35], s71 offen offset:1056 lds
  ds_read_b64_tr_b16 v[128:129], v97 offset:0
  ds_read_b64_tr_b16 v[130:131], v97 offset:256
  ds_read_b64_tr_b16 v[132:133], v97 offset:32
  ds_read_b64_tr_b16 v[134:135], v97 offset:288
  ds_read_b64_tr_b16 v[136:137], v97 offset:64
  ds_read_b64_tr_b16 v[138:139], v97 offset:320
  ds_read_b64_tr_b16 v[140:141], v97 offset:96
  ds_read_b64_tr_b16 v[142:143], v97 offset:352
  ds_read_b64_tr_b16 v[144:145], v97 offset:4224
  ds_read_b64_tr_b16 v[146:147], v97 offset:4480
  ds_read_b64_tr_b16 v[148:149], v97 offset:4256
  ds_read_b64_tr_b16 v[150:151], v97 offset:4512
  ds_read_b64_tr_b16 v[152:153], v97 offset:4288
  ds_read_b64_tr_b16 v[154:155], v97 offset:4544
  ds_read_b64_tr_b16 v[156:157], v97 offset:4320
  ds_read_b64_tr_b16 v[158:159], v97 offset:4576
  s_waitcnt lgkmcnt(0)
  v_mfma_f32_16x16x32_bf16 v[0:3], v[128:131], a[0:3], 0
  ds_read_b64_tr_b16 v[160:161], v97 offset:8448
  s_add_u32 s70, s22, 2
  ds_read_b64_tr_b16 v[162:163], v97 offset:8704
  v_mfma_f32_16x16x32_bf16 v[4:7], v[128:131], a[4:7], 0
  s_add_u32 s75, s70, s31
  ds_read_b64_tr_b16 v[164:165], v97 offset:8480
  v_mfma_f32_16x16x32_bf16 v[12:15], v[132:135], a[4:7], 0
  s_and_b32 s75, s75, 3
  ds_read_b64_tr_b16 v[166:167], v97 offset:8736
  s_and_b32 s70, s70, 4
  v_mfma_f32_16x16x32_bf16 v[8:11], v[132:135], a[0:3], 0
  ds_read_b64_tr_b16 v[168:169], v97 offset:8512
  s_or_b32 s70, s70, s75
  ds_read_b64_tr_b16 v[170:171], v97 offset:8768
  v_mfma_f32_16x16x32_bf16 v[16:19], v[136:139], a[0:3], 0
  s_add_u32 s70, s70, 8
  ds_read_b64_tr_b16 v[172:173], v97 offset:8544
  v_mfma_f32_16x16x32_bf16 v[20:23], v[136:139], a[4:7], 0
  s_mul_i32 s70, s70, 393216
  ds_read_b64_tr_b16 v[174:175], v97 offset:8800
  v_mfma_f32_16x16x32_bf16 v[28:31], v[140:143], a[4:7], 0
  ds_read_b64_tr_b16 v[176:177], v97 offset:12672
  s_add_u32 m0, s76, 8448
  ds_read_b64_tr_b16 v[178:179], v97 offset:12928
  v_mfma_f32_16x16x32_bf16 v[24:27], v[140:143], a[0:3], 0
  buffer_load_dwordx4 v98, s[32:35], s70 offen lds
  ds_read_b64_tr_b16 v[180:181], v97 offset:12704
  v_mfma_f32_16x16x32_bf16 v[0:3], v[144:147], a[8:11], v[0:3]
  ds_read_b64_tr_b16 v[182:183], v97 offset:12960
  buffer_load_dwordx4 v99, s[32:35], s70 offen offset:1056 lds
  v_mfma_f32_16x16x32_bf16 v[4:7], v[144:147], a[12:15], v[4:7]
  ds_read_b64_tr_b16 v[184:185], v97 offset:12736
  s_add_u32 s71, s22, 3
  ds_read_b64_tr_b16 v[186:187], v97 offset:12992
  v_mfma_f32_16x16x32_bf16 v[12:15], v[148:151], a[12:15], v[12:15]
  s_add_u32 s75, s71, s31
  ds_read_b64_tr_b16 v[188:189], v97 offset:12768
  s_and_b32 s75, s75, 3
  v_mfma_f32_16x16x32_bf16 v[8:11], v[148:151], a[8:11], v[8:11]
  ds_read_b64_tr_b16 v[190:191], v97 offset:13024
  s_and_b32 s71, s71, 4
  v_mfma_f32_16x16x32_bf16 v[16:19], v[152:155], a[8:11], v[16:19]
  s_or_b32 s71, s71, s75
  v_mfma_f32_16x16x32_bf16 v[20:23], v[152:155], a[12:15], v[20:23]
  s_add_u32 s71, s71, 8
  v_mfma_f32_16x16x32_bf16 v[28:31], v[156:159], a[12:15], v[28:31]
  s_mul_i32 s71, s71, 393216
  s_add_u32 m0, s76, 16896
  v_mfma_f32_16x16x32_bf16 v[24:27], v[156:159], a[8:11], v[24:27]
  buffer_load_dwordx4 v98, s[32:35], s71 offen lds
  s_waitcnt lgkmcnt(0)
  v_mfma_f32_16x16x32_bf16 v[0:3], v[160:163], a[16:19], v[0:3]
  ds_read_b64_tr_b16 v[128:129], v97 offset:16896
  v_mfma_f32_16x16x32_bf16 v[4:7], v[160:163], a[20:23], v[4:7]
  ds_read_b64_tr_b16 v[130:131], v97 offset:17152
  ds_read_b64_tr_b16 v[132:133], v97 offset:16928
  v_mfma_f32_16x16x32_bf16 v[12:15], v[164:167], a[20:23], v[12:15]
  buffer_load_dwordx4 v99, s[32:35], s71 offen offset:1056 lds
  ds_read_b64_tr_b16 v[134:135], v97 offset:17184
  v_mfma_f32_16x16x32_bf16 v[8:11], v[164:167], a[16:19], v[8:11]
  s_add_u32 s70, s22, 4
  ds_read_b64_tr_b16 v[136:137], v97 offset:16960
  v_mfma_f32_16x16x32_bf16 v[16:19], v[168:171], a[16:19], v[16:19]
  s_add_u32 s75, s70, s31
  ds_read_b64_tr_b16 v[138:139], v97 offset:17216
  v_mfma_f32_16x16x32_bf16 v[20:23], v[168:171], a[20:23], v[20:23]
  ds_read_b64_tr_b16 v[140:141], v97 offset:16992
  s_and_b32 s75, s75, 3
  v_mfma_f32_16x16x32_bf16 v[28:31], v[172:175], a[20:23], v[28:31]
  ds_read_b64_tr_b16 v[142:143], v97 offset:17248
  s_and_b32 s70, s70, 4
  v_mfma_f32_16x16x32_bf16 v[24:27], v[172:175], a[16:19], v[24:27]
  ds_read_b64_tr_b16 v[144:145], v97 offset:21120
  ds_read_b64_tr_b16 v[146:147], v97 offset:21376
  v_mfma_f32_16x16x32_bf16 v[0:3], v[176:179], a[24:27], v[0:3]
  s_or_b32 s70, s70, s75
  ds_read_b64_tr_b16 v[148:149], v97 offset:21152
  v_mfma_f32_16x16x32_bf16 v[4:7], v[176:179], a[28:31], v[4:7]
  s_add_u32 s70, s70, 8
  ds_read_b64_tr_b16 v[150:151], v97 offset:21408
  v_mfma_f32_16x16x32_bf16 v[12:15], v[180:183], a[28:31], v[12:15]
  ds_read_b64_tr_b16 v[152:153], v97 offset:21184
  s_mul_i32 s70, s70, 393216
  v_mfma_f32_16x16x32_bf16 v[8:11], v[180:183], a[24:27], v[8:11]
  ds_read_b64_tr_b16 v[154:155], v97 offset:21440
  s_add_u32 m0, s76, 25344
  v_mfma_f32_16x16x32_bf16 v[16:19], v[184:187], a[24:27], v[16:19]
  ds_read_b64_tr_b16 v[156:157], v97 offset:21216
  buffer_load_dwordx4 v98, s[32:35], s70 offen lds
  v_mfma_f32_16x16x32_bf16 v[20:23], v[184:187], a[28:31], v[20:23]
  ds_read_b64_tr_b16 v[158:159], v97 offset:21472
  v_mfma_f32_16x16x32_bf16 v[28:31], v[188:191], a[28:31], v[28:31]
  buffer_load_dwordx4 v99, s[32:35], s70 offen offset:1056 lds
  s_waitcnt vmcnt(8)
  v_mfma_f32_16x16x32_bf16 v[24:27], v[188:191], a[24:27], v[24:27]
  buffer_store_dword v107, v108, s[56:59], s92 offen sc1
  s_waitcnt lgkmcnt(0)
  v_mfma_f32_16x16x32_bf16 v[0:3], v[128:131], a[32:35], v[0:3]
  ds_read_b64_tr_b16 v[160:161], v97 offset:25344
  s_add_u32 s71, s22, 5
  ds_read_b64_tr_b16 v[162:163], v97 offset:25600
  v_mfma_f32_16x16x32_bf16 v[4:7], v[128:131], a[36:39], v[4:7]
  s_add_u32 s75, s71, s31
  ds_read_b64_tr_b16 v[164:165], v97 offset:25376
  v_mfma_f32_16x16x32_bf16 v[12:15], v[132:135], a[36:39], v[12:15]
  s_and_b32 s75, s75, 3
  ds_read_b64_tr_b16 v[166:167], v97 offset:25632
  s_and_b32 s71, s71, 4
  v_mfma_f32_16x16x32_bf16 v[8:11], v[132:135], a[32:35], v[8:11]
  ds_read_b64_tr_b16 v[168:169], v97 offset:25408
  s_or_b32 s71, s71, s75
  ds_read_b64_tr_b16 v[170:171], v97 offset:25664
  v_mfma_f32_16x16x32_bf16 v[16:19], v[136:139], a[32:35], v[16:19]
  s_add_u32 s71, s71, 8
  ds_read_b64_tr_b16 v[172:173], v97 offset:25440
  v_mfma_f32_16x16x32_bf16 v[20:23], v[136:139], a[36:39], v[20:23]
  s_mul_i32 s71, s71, 393216
  ds_read_b64_tr_b16 v[174:175], v97 offset:25696
  v_mfma_f32_16x16x32_bf16 v[28:31], v[140:143], a[36:39], v[28:31]
  ds_read_b64_tr_b16 v[176:177], v97 offset:29568
  s_add_u32 m0, s76, 33792
  ds_read_b64_tr_b16 v[178:179], v97 offset:29824
  v_mfma_f32_16x16x32_bf16 v[24:27], v[140:143], a[32:35], v[24:27]
  buffer_load_dwordx4 v98, s[32:35], s71 offen lds
  ds_read_b64_tr_b16 v[180:181], v97 offset:29600
  v_mfma_f32_16x16x32_bf16 v[0:3], v[144:147], a[40:43], v[0:3]
  ds_read_b64_tr_b16 v[182:183], v97 offset:29856
  buffer_load_dwordx4 v99, s[32:35], s71 offen offset:1056 lds
  v_mfma_f32_16x16x32_bf16 v[4:7], v[144:147], a[44:47], v[4:7]
  ds_read_b64_tr_b16 v[184:185], v97 offset:29632
  s_add_u32 s70, s22, 6
  ds_read_b64_tr_b16 v[186:187], v97 offset:29888
  v_mfma_f32_16x16x32_bf16 v[12:15], v[148:151], a[44:47], v[12:15]
  s_add_u32 s75, s70, s31
  ds_read_b64_tr_b16 v[188:189], v97 offset:29664
  s_and_b32 s75, s75, 3
  v_mfma_f32_16x16x32_bf16 v[8:11], v[148:151], a[40:43], v[8:11]
  ds_read_b64_tr_b16 v[190:191], v97 offset:29920
  s_and_b32 s70, s70, 4
  v_mfma_f32_16x16x32_bf16 v[16:19], v[152:155], a[40:43], v[16:19]
  s_or_b32 s70, s70, s75
  v_mfma_f32_16x16x32_bf16 v[20:23], v[152:155], a[44:47], v[20:23]
  s_add_u32 s70, s70, 8
  v_mfma_f32_16x16x32_bf16 v[28:31], v[156:159], a[44:47], v[28:31]
  s_mul_i32 s70, s70, 393216
  s_add_u32 m0, s76, 42240
  v_mfma_f32_16x16x32_bf16 v[24:27], v[156:159], a[40:43], v[24:27]
  buffer_load_dwordx4 v98, s[32:35], s70 offen lds
  s_waitcnt lgkmcnt(0)
  v_mfma_f32_16x16x32_bf16 v[0:3], v[160:163], a[48:51], v[0:3]
  ds_read_b64_tr_b16 v[128:129], v97 offset:33792
  v_mfma_f32_16x16x32_bf16 v[4:7], v[160:163], a[52:55], v[4:7]
  ds_read_b64_tr_b16 v[130:131], v97 offset:34048
  ds_read_b64_tr_b16 v[132:133], v97 offset:33824
  v_mfma_f32_16x16x32_bf16 v[12:15], v[164:167], a[52:55], v[12:15]
  buffer_load_dwordx4 v99, s[32:35], s70 offen offset:1056 lds
  ds_read_b64_tr_b16 v[134:135], v97 offset:34080
  v_mfma_f32_16x16x32_bf16 v[8:11], v[164:167], a[48:51], v[8:11]
  ds_read_b64_tr_b16 v[136:137], v97 offset:33856
  s_add_u32 s71, s22, 7
  v_mfma_f32_16x16x32_bf16 v[16:19], v[168:171], a[48:51], v[16:19]
  ds_read_b64_tr_b16 v[138:139], v97 offset:34112
  s_add_u32 s75, s71, s31
  v_mfma_f32_16x16x32_bf16 v[20:23], v[168:171], a[52:55], v[20:23]
  ds_read_b64_tr_b16 v[140:141], v97 offset:33888
  ds_read_b64_tr_b16 v[142:143], v97 offset:34144
  v_mfma_f32_16x16x32_bf16 v[28:31], v[172:175], a[52:55], v[28:31]
  s_and_b32 s75, s75, 3
  ds_read_b64_tr_b16 v[144:145], v97 offset:38016
  v_mfma_f32_16x16x32_bf16 v[24:27], v[172:175], a[48:51], v[24:27]
  ds_read_b64_tr_b16 v[146:147], v97 offset:38272
  s_and_b32 s71, s71, 4
  v_mfma_f32_16x16x32_bf16 v[0:3], v[176:179], a[56:59], v[0:3]
  ds_read_b64_tr_b16 v[148:149], v97 offset:38048
  s_or_b32 s71, s71, s75
  v_mfma_f32_16x16x32_bf16 v[4:7], v[176:179], a[60:63], v[4:7]
  ds_read_b64_tr_b16 v[150:151], v97 offset:38304
  ds_read_b64_tr_b16 v[152:153], v97 offset:38080
  v_mfma_f32_16x16x32_bf16 v[12:15], v[180:183], a[60:63], v[12:15]
  s_add_u32 s71, s71, 8
  ds_read_b64_tr_b16 v[154:155], v97 offset:38336
  v_mfma_f32_16x16x32_bf16 v[8:11], v[180:183], a[56:59], v[8:11]
  s_mul_i32 s71, s71, 393216
  ds_read_b64_tr_b16 v[156:157], v97 offset:38112
  v_mfma_f32_16x16x32_bf16 v[16:19], v[184:187], a[56:59], v[16:19]
  ds_read_b64_tr_b16 v[158:159], v97 offset:38368
  s_add_u32 m0, s76, 50688
  v_mfma_f32_16x16x32_bf16 v[20:23], v[184:187], a[60:63], v[20:23]
  buffer_load_dwordx4 v98, s[32:35], s71 offen lds
  v_mfma_f32_16x16x32_bf16 v[28:31], v[188:191], a[60:63], v[28:31]
  v_mfma_f32_16x16x32_bf16 v[24:27], v[188:191], a[56:59], v[24:27]
  buffer_load_dwordx4 v99, s[32:35], s71 offen offset:1056 lds
  s_waitcnt lgkmcnt(0)
  v_mfma_f32_16x16x32_bf16 v[0:3], v[128:131], a[64:67], v[0:3]
  ds_read_b64_tr_b16 v[160:161], v102 offset:0
  v_mfma_f32_16x16x32_bf16 v[4:7], v[128:131], a[68:71], v[4:7]
  ds_read_b64_tr_b16 v[162:163], v102 offset:256
  v_mfma_f32_16x16x32_bf16 v[12:15], v[132:135], a[68:71], v[12:15]
  ds_read_b64_tr_b16 v[164:165], v102 offset:32
  v_mfma_f32_16x16x32_bf16 v[8:11], v[132:135], a[64:67], v[8:11]
  ds_read_b64_tr_b16 v[166:167], v102 offset:288
  v_mfma_f32_16x16x32_bf16 v[16:19], v[136:139], a[64:67], v[16:19]
  ds_read_b64_tr_b16 v[168:169], v102 offset:64
  v_mfma_f32_16x16x32_bf16 v[20:23], v[136:139], a[68:71], v[20:23]
  ds_read_b64_tr_b16 v[170:171], v102 offset:320
  v_mfma_f32_16x16x32_bf16 v[28:31], v[140:143], a[68:71], v[28:31]
  ds_read_b64_tr_b16 v[172:173], v102 offset:96
  v_mfma_f32_16x16x32_bf16 v[24:27], v[140:143], a[64:67], v[24:27]
  ds_read_b64_tr_b16 v[174:175], v102 offset:352
  v_mfma_f32_16x16x32_bf16 v[0:3], v[144:147], a[72:75], v[0:3]
  ds_read_b64_tr_b16 v[176:177], v102 offset:4224
  v_mfma_f32_16x16x32_bf16 v[4:7], v[144:147], a[76:79], v[4:7]
  ds_read_b64_tr_b16 v[178:179], v102 offset:4480
  v_mfma_f32_16x16x32_bf16 v[12:15], v[148:151], a[76:79], v[12:15]
  ds_read_b64_tr_b16 v[180:181], v102 offset:4256
  v_mfma_f32_16x16x32_bf16 v[8:11], v[148:151], a[72:75], v[8:11]
  ds_read_b64_tr_b16 v[182:183], v102 offset:4512
  v_mfma_f32_16x16x32_bf16 v[16:19], v[152:155], a[72:75], v[16:19]
  ds_read_b64_tr_b16 v[184:185], v102 offset:4288
  v_mfma_f32_16x16x32_bf16 v[20:23], v[152:155], a[76:79], v[20:23]
  ds_read_b64_tr_b16 v[186:187], v102 offset:4544
  v_mfma_f32_16x16x32_bf16 v[28:31], v[156:159], a[76:79], v[28:31]
  ds_read_b64_tr_b16 v[188:189], v102 offset:4320
  v_mfma_f32_16x16x32_bf16 v[24:27], v[156:159], a[72:75], v[24:27]
  ds_read_b64_tr_b16 v[190:191], v102 offset:4576
  s_waitcnt lgkmcnt(0)
  v_mfma_f32_16x16x32_bf16 v[0:3], v[160:163], a[80:83], v[0:3]
  ds_read_b64_tr_b16 v[128:129], v102 offset:8448
  s_lshr_b32 s80, s3, 1
  ds_read_b64_tr_b16 v[130:131], v102 offset:8704
  v_mfma_f32_16x16x32_bf16 v[4:7], v[160:163], a[84:87], v[4:7]
  s_and_b32 s81, s3, 1
  ds_read_b64_tr_b16 v[132:133], v102 offset:8480
  s_lshl_b32 s82, s80, 6
  v_mfma_f32_16x16x32_bf16 v[12:15], v[164:167], a[84:87], v[12:15]
  ds_read_b64_tr_b16 v[134:135], v102 offset:8736
  s_lshl_b32 s83, s81, 1
  v_mfma_f32_16x16x32_bf16 v[8:11], v[164:167], a[80:83], v[8:11]
  ds_read_b64_tr_b16 v[136:137], v102 offset:8512
  s_add_u32 s82, s82, s83
  ds_read_b64_tr_b16 v[138:139], v102 offset:8768
  v_mfma_f32_16x16x32_bf16 v[16:19], v[168:171], a[80:83], v[16:19]
  s_lshl_b32 s82, s82, 11
  ds_read_b64_tr_b16 v[140:141], v102 offset:8544
  s_lshl_b32 s83, s27, 7
  v_mfma_f32_16x16x32_bf16 v[20:23], v[168:171], a[84:87], v[20:23]
  ds_read_b64_tr_b16 v[142:143], v102 offset:8800
  s_add_u32 s82, s82, s83
  v_mfma_f32_16x16x32_bf16 v[28:31], v[172:175], a[84:87], v[28:31]
  ds_read_b64_tr_b16 v[144:145], v102 offset:12672
  v_lshrrev_b32 v98, 3, v104
  ds_read_b64_tr_b16 v[146:147], v102 offset:12928
  v_mfma_f32_16x16x32_bf16 v[24:27], v[172:175], a[80:83], v[24:27]
  v_lshlrev_b32 v98, 13, v98
  ds_read_b64_tr_b16 v[148:149], v102 offset:12704
  v_mfma_f32_16x16x32_bf16 v[0:3], v[176:179], a[88:91], v[0:3]
  v_and_b32 v99, 7, v104
  ds_read_b64_tr_b16 v[150:151], v102 offset:12960
  v_lshl_add_u32 v98, v99, 4, v98
  v_mfma_f32_16x16x32_bf16 v[4:7], v[176:179], a[92:95], v[4:7]
  ds_read_b64_tr_b16 v[152:153], v102 offset:12736
  v_add_u32_e64 v111, s82, v98
  ds_read_b64_tr_b16 v[154:155], v102 offset:12992
  v_mfma_f32_16x16x32_bf16 v[12:15], v[180:183], a[92:95], v[12:15]
  v_add_u32 v101, 992, v111
  ds_read_b64_tr_b16 v[156:157], v102 offset:12768
  v_mfma_f32_16x16x32_bf16 v[8:11], v[180:183], a[88:91], v[8:11]
  v_bfe_u32 v98, v104, 2, 2
  ds_read_b64_tr_b16 v[158:159], v102 offset:13024
  v_mul_u32_u24 v98, 1056, v98
  v_mfma_f32_16x16x32_bf16 v[16:19], v[184:187], a[88:91], v[16:19]
  v_lshrrev_b32 v99, 4, v104
  v_mfma_f32_16x16x32_bf16 v[20:23], v[184:187], a[92:95], v[20:23]
  v_lshl_add_u32 v98, v99, 7, v98
  v_mfma_f32_16x16x32_bf16 v[28:31], v[188:191], a[92:95], v[28:31]
  v_and_b32 v99, 3, v104
  v_lshl_add_u32 v110, v99, 3, v98
  v_mfma_f32_16x16x32_bf16 v[24:27], v[188:191], a[88:91], v[24:27]
  v_add_u32 v110, 129792, v110
  s_waitcnt lgkmcnt(0)
  v_mfma_f32_16x16x32_bf16 v[0:3], v[128:131], a[96:99], v[0:3]
  ds_read_b64_tr_b16 v[160:161], v102 offset:16896
  v_add_u32 v98, s20, v104
  ds_read_b64_tr_b16 v[162:163], v102 offset:17152
  v_mfma_f32_16x16x32_bf16 v[4:7], v[128:131], a[100:103], v[4:7]
  v_and_b32 v98, 7, v98
  v_lshlrev_b32 v98, 2, v98
  ds_read_b64_tr_b16 v[164:165], v102 offset:16928
  v_mfma_f32_16x16x32_bf16 v[12:15], v[132:135], a[100:103], v[12:15]
  v_bfe_u32 v99, v104, 3, 1
  ds_read_b64_tr_b16 v[166:167], v102 offset:17184
  v_or_b32 v98, v98, v99
  v_mfma_f32_16x16x32_bf16 v[8:11], v[132:135], a[96:99], v[8:11]
  ds_read_b64_tr_b16 v[168:169], v102 offset:16960
  v_lshlrev_b32 v99, 10, v98
  v_lshlrev_b32 v98, 16, v98
  v_mfma_f32_16x16x32_bf16 v[16:19], v[136:139], a[96:99], v[16:19]
  ds_read_b64_tr_b16 v[170:171], v102 offset:17216
  s_lshl_b32 s82, s26, 3
  ds_read_b64_tr_b16 v[172:173], v102 offset:16992
  v_mfma_f32_16x16x32_bf16 v[20:23], v[136:139], a[100:103], v[20:23]
  s_lshl_b32 s83, s3, 1
  s_add_u32 s82, s82, s83
  ds_read_b64_tr_b16 v[174:175], v102 offset:17248
  v_mfma_f32_16x16x32_bf16 v[28:31], v[140:143], a[100:103], v[28:31]
  s_mul_i32 s82, s82, 32768
  ds_read_b64_tr_b16 v[176:177], v102 offset:21120
  v_add_u32_e64 v112, s82, v105
  v_mfma_f32_16x16x32_bf16 v[24:27], v[140:143], a[96:99], v[24:27]
  ds_read_b64_tr_b16 v[178:179], v102 offset:21376
  v_add_u32 v113, 32768, v112
  s_mul_i32 s76, s80, 4224
  v_mfma_f32_16x16x32_bf16 v[0:3], v[144:147], a[104:107], v[0:3]
  ds_read_b64_tr_b16 v[180:181], v102 offset:21152
  s_mul_i32 s82, s81, 2112
  ds_read_b64_tr_b16 v[182:183], v102 offset:21408
  v_mfma_f32_16x16x32_bf16 v[4:7], v[144:147], a[108:111], v[4:7]
  s_add_u32 s76, s76, s82
  ds_read_b64_tr_b16 v[184:185], v102 offset:21184
  s_add_u32 s76, s76, 129792
  v_mfma_f32_16x16x32_bf16 v[12:15], v[148:151], a[108:111], v[12:15]
  s_mov_b32 s32, s10
  ds_read_b64_tr_b16 v[186:187], v102 offset:21440
  s_mov_b32 s33, s11
  v_mfma_f32_16x16x32_bf16 v[8:11], v[148:151], a[104:107], v[8:11]
  ds_read_b64_tr_b16 v[188:189], v102 offset:21216
  s_mov_b32 s34, 2097152
  ds_read_b64_tr_b16 v[190:191], v102 offset:21472
  v_mfma_f32_16x16x32_bf16 v[16:19], v[152:155], a[104:107], v[16:19]
  s_mov_b32 s35, 0x20000
  global_load_ushort v64, v109, s[12:13] offset:0
  global_load_ushort v65, v109, s[12:13] offset:16
  v_mfma_f32_16x16x32_bf16 v[20:23], v[152:155], a[108:111], v[20:23]
  global_load_ushort v66, v109, s[12:13] offset:32
  global_load_ushort v67, v109, s[12:13] offset:48
  v_mfma_f32_16x16x32_bf16 v[28:31], v[156:159], a[108:111], v[28:31]
  global_load_ushort v68, v109, s[12:13] offset:64
  global_load_ushort v69, v109, s[12:13] offset:80
  v_mfma_f32_16x16x32_bf16 v[24:27], v[156:159], a[104:107], v[24:27]
  global_load_ushort v70, v109, s[12:13] offset:96
  global_load_ushort v71, v109, s[12:13] offset:112
  s_waitcnt lgkmcnt(0)
  v_mfma_f32_16x16x32_bf16 v[0:3], v[160:163], a[112:115], v[0:3]
  ds_read_b64_tr_b16 v[128:129], v102 offset:25344
  ds_read_b64_tr_b16 v[130:131], v102 offset:25600
  v_mfma_f32_16x16x32_bf16 v[4:7], v[160:163], a[116:119], v[4:7]
  ds_read_b64_tr_b16 v[132:133], v102 offset:25376
  v_mfma_f32_16x16x32_bf16 v[12:15], v[164:167], a[116:119], v[12:15]
  ds_read_b64_tr_b16 v[134:135], v102 offset:25632
  v_mfma_f32_16x16x32_bf16 v[8:11], v[164:167], a[112:115], v[8:11]
  ds_read_b64_tr_b16 v[136:137], v102 offset:25408
  ds_read_b64_tr_b16 v[138:139], v102 offset:25664
  v_mfma_f32_16x16x32_bf16 v[16:19], v[168:171], a[112:115], v[16:19]
  ds_read_b64_tr_b16 v[140:141], v102 offset:25440
  v_mfma_f32_16x16x32_bf16 v[20:23], v[168:171], a[116:119], v[20:23]
  ds_read_b64_tr_b16 v[142:143], v102 offset:25696
  v_mfma_f32_16x16x32_bf16 v[28:31], v[172:175], a[116:119], v[28:31]
  ds_read_b64_tr_b16 v[144:145], v102 offset:29568
  ds_read_b64_tr_b16 v[146:147], v102 offset:29824
  v_mfma_f32_16x16x32_bf16 v[24:27], v[172:175], a[112:115], v[24:27]
  ds_read_b64_tr_b16 v[148:149], v102 offset:29600
  v_mfma_f32_16x16x32_bf16 v[0:3], v[176:179], a[120:123], v[0:3]
  buffer_load_dword v253, v106, s[56:59], s91 offen sc1
  ds_read_b64_tr_b16 v[150:151], v102 offset:29856
  v_mfma_f32_16x16x32_bf16 v[4:7], v[176:179], a[124:127], v[4:7]
  ds_read_b64_tr_b16 v[152:153], v102 offset:29632
  ds_read_b64_tr_b16 v[154:155], v102 offset:29888
  v_mfma_f32_16x16x32_bf16 v[12:15], v[180:183], a[124:127], v[12:15]
  ds_read_b64_tr_b16 v[156:157], v102 offset:29664
  v_mfma_f32_16x16x32_bf16 v[8:11], v[180:183], a[120:123], v[8:11]
  ds_read_b64_tr_b16 v[158:159], v102 offset:29920
  v_mfma_f32_16x16x32_bf16 v[16:19], v[184:187], a[120:123], v[16:19]
  v_mfma_f32_16x16x32_bf16 v[20:23], v[184:187], a[124:127], v[20:23]
  v_mfma_f32_16x16x32_bf16 v[28:31], v[188:191], a[124:127], v[28:31]
  v_mfma_f32_16x16x32_bf16 v[24:27], v[188:191], a[120:123], v[24:27]
  s_waitcnt lgkmcnt(0)
  v_mfma_f32_16x16x32_bf16 v[0:3], v[128:131], a[128:131], v[0:3]
  s_waitcnt vmcnt(9)
  s_barrier
  v_mfma_f32_16x16x32_bf16 v[4:7], v[128:131], a[132:135], v[4:7]
  ds_read_b64_tr_b16 v[160:161], v96 offset:0
  ds_read_b64_tr_b16 v[162:163], v96 offset:256
  v_mfma_f32_16x16x32_bf16 v[12:15], v[132:135], a[132:135], v[12:15]
  ds_read_b64_tr_b16 v[164:165], v96 offset:32
  v_mfma_f32_16x16x32_bf16 v[8:11], v[132:135], a[128:131], v[8:11]
  ds_read_b64_tr_b16 v[166:167], v96 offset:288
  ds_read_b64_tr_b16 v[168:169], v96 offset:64
  v_mfma_f32_16x16x32_bf16 v[16:19], v[136:139], a[128:131], v[16:19]
  ds_read_b64_tr_b16 v[170:171], v96 offset:320
  v_mfma_f32_16x16x32_bf16 v[20:23], v[136:139], a[132:135], v[20:23]
  ds_read_b64_tr_b16 v[172:173], v96 offset:96
  ds_read_b64_tr_b16 v[174:175], v96 offset:352
  v_mfma_f32_16x16x32_bf16 v[28:31], v[140:143], a[132:135], v[28:31]
  ds_read_b64_tr_b16 v[176:177], v96 offset:4224
  v_mfma_f32_16x16x32_bf16 v[24:27], v[140:143], a[128:131], v[24:27]
  ds_read_b64_tr_b16 v[178:179], v96 offset:4480
  ds_read_b64_tr_b16 v[180:181], v96 offset:4256
  v_mfma_f32_16x16x32_bf16 v[0:3], v[144:147], a[136:139], v[0:3]
  ds_read_b64_tr_b16 v[182:183], v96 offset:4512
  v_mfma_f32_16x16x32_bf16 v[4:7], v[144:147], a[140:143], v[4:7]
  ds_read_b64_tr_b16 v[184:185], v96 offset:4288
  ds_read_b64_tr_b16 v[186:187], v96 offset:4544
  v_mfma_f32_16x16x32_bf16 v[12:15], v[148:151], a[140:143], v[12:15]
  ds_read_b64_tr_b16 v[188:189], v96 offset:4320
  v_mfma_f32_16x16x32_bf16 v[8:11], v[148:151], a[136:139], v[8:11]
  ds_read_b64_tr_b16 v[190:191], v96 offset:4576
  v_mfma_f32_16x16x32_bf16 v[16:19], v[152:155], a[136:139], v[16:19]
  v_mfma_f32_16x16x32_bf16 v[20:23], v[152:155], a[140:143], v[20:23]
  v_mfma_f32_16x16x32_bf16 v[28:31], v[156:159], a[140:143], v[28:31]
  v_mfma_f32_16x16x32_bf16 v[24:27], v[156:159], a[136:139], v[24:27]
  s_waitcnt lgkmcnt(0)
  v_mfma_f32_16x16x32_bf16 v[0:3], v[160:163], a[144:147], v[0:3]
  ds_read_b64_tr_b16 v[128:129], v96 offset:8448
  s_waitcnt vmcnt(0)
  v_mfma_f32_16x16x32_bf16 v[4:7], v[160:163], a[148:151], v[4:7]
  ds_read_b64_tr_b16 v[130:131], v96 offset:8704
  ds_read_b64_tr_b16 v[132:133], v96 offset:8480
  v_mfma_f32_16x16x32_bf16 v[12:15], v[164:167], a[148:151], v[12:15]
  v_cmp_eq_u32 vcc, 0, v253
  s_cmp_eq_u64 vcc, 0
  s_cbranch_scc1 L_gok_20
  s_mov_b32 s96, 0
L_poll_21:
  buffer_load_dword v253, v106, s[56:59], s91 offen sc1
  s_waitcnt vmcnt(0)
  v_cmp_eq_u32 vcc, 0, v253
  s_add_u32 s96, s96, 1
  s_cmp_eq_u64 vcc, 0
  s_cbranch_scc1 L_ok_22
  s_sleep 2
  s_cmp_lt_u32 s96, 0x200000
  s_cbranch_scc1 L_poll_21
L_ok_22:
L_gok_20:
  ds_read_b64_tr_b16 v[134:135], v96 offset:8736
  v_mfma_f32_16x16x32_bf16 v[8:11], v[164:167], a[144:147], v[8:11]
  buffer_load_dwordx4 v[88:91], v105, s[48:51], s90 offen sc1
  ds_read_b64_tr_b16 v[136:137], v96 offset:8512
  v_mfma_f32_16x16x32_bf16 v[16:19], v[168:171], a[144:147], v[16:19]
  buffer_load_dwordx4 v[92:95], v105, s[48:51], s90 offen offset:1024 sc1
  ds_read_b64_tr_b16 v[138:139], v96 offset:8768
  v_mfma_f32_16x16x32_bf16 v[20:23], v[168:171], a[148:151], v[20:23]
  ds_read_b64_tr_b16 v[140:141], v96 offset:8544
  buffer_load_dwordx4 a[0:3], v105, s[44:47], s86 offen offset:0 sc1
  v_mfma_f32_16x16x32_bf16 v[28:31], v[172:175], a[148:151], v[28:31]
  ds_read_b64_tr_b16 v[142:143], v96 offset:8800
  buffer_load_dwordx4 a[4:7], v105, s[44:47], s86 offen offset:1024 sc1
  v_mfma_f32_16x16x32_bf16 v[24:27], v[172:175], a[144:147], v[24:27]
  ds_read_b64_tr_b16 v[144:145], v96 offset:12672
  buffer_load_dwordx4 a[8:11], v105, s[44:47], s86 offen offset:2048 sc1
  v_mfma_f32_16x16x32_bf16 v[0:3], v[176:179], a[152:155], v[0:3]
  ds_read_b64_tr_b16 v[146:147], v96 offset:12928
  ds_read_b64_tr_b16 v[148:149], v96 offset:12704
  v_mfma_f32_16x16x32_bf16 v[4:7], v[176:179], a[156:159], v[4:7]
  buffer_load_dwordx4 a[12:15], v105, s[44:47], s86 offen offset:3072 sc1
  ds_read_b64_tr_b16 v[150:151], v96 offset:12960
  v_mfma_f32_16x16x32_bf16 v[12:15], v[180:183], a[156:159], v[12:15]
  s_add_u32 s86, s86, 4096
  ds_read_b64_tr_b16 v[152:153], v96 offset:12736
  v_mfma_f32_16x16x32_bf16 v[8:11], v[180:183], a[152:155], v[8:11]
  buffer_load_dwordx4 a[16:19], v105, s[44:47], s86 offen offset:0 sc1
  ds_read_b64_tr_b16 v[154:155], v96 offset:12992
  v_mfma_f32_16x16x32_bf16 v[16:19], v[184:187], a[152:155], v[16:19]
  ds_read_b64_tr_b16 v[156:157], v96 offset:12768
  buffer_load_dwordx4 a[20:23], v105, s[44:47], s86 offen offset:1024 sc1
  v_mfma_f32_16x16x32_bf16 v[20:23], v[184:187], a[156:159], v[20:23]
  ds_read_b64_tr_b16 v[158:159], v96 offset:13024
  buffer_load_dwordx4 a[24:27], v105, s[44:47], s86 offen offset:2048 sc1
  v_mfma_f32_16x16x32_bf16 v[28:31], v[188:191], a[156:159], v[28:31]
  buffer_load_dwordx4 a[28:31], v105, s[44:47], s86 offen offset:3072 sc1
  s_add_u32 s86, s86, 4096
  v_mfma_f32_16x16x32_bf16 v[24:27], v[188:191], a[152:155], v[24:27]
  buffer_load_dwordx4 a[32:35], v105, s[44:47], s86 offen offset:0 sc1
  buffer_load_dwordx4 a[36:39], v105, s[44:47], s86 offen offset:1024 sc1
  s_waitcnt lgkmcnt(0)
  v_mfma_f32_16x16x32_bf16 v[0:3], v[128:131], a[160:163], v[0:3]
  ds_read_b64_tr_b16 v[160:161], v96 offset:16896
  buffer_load_dwordx4 a[40:43], v105, s[44:47], s86 offen offset:2048 sc1
  v_mfma_f32_16x16x32_bf16 v[4:7], v[128:131], a[164:167], v[4:7]
  ds_read_b64_tr_b16 v[162:163], v96 offset:17152
  ds_read_b64_tr_b16 v[164:165], v96 offset:16928
  v_mfma_f32_16x16x32_bf16 v[12:15], v[132:135], a[164:167], v[12:15]
  buffer_load_dwordx4 a[44:47], v105, s[44:47], s86 offen offset:3072 sc1
  ds_read_b64_tr_b16 v[166:167], v96 offset:17184
  v_mfma_f32_16x16x32_bf16 v[8:11], v[132:135], a[160:163], v[8:11]
  s_add_u32 s86, s86, 4096
  ds_read_b64_tr_b16 v[168:169], v96 offset:16960
  v_mfma_f32_16x16x32_bf16 v[16:19], v[136:139], a[160:163], v[16:19]
  ds_read_b64_tr_b16 v[170:171], v96 offset:17216
  buffer_load_dwordx4 a[48:51], v105, s[44:47], s86 offen offset:0 sc1
  v_mfma_f32_16x16x32_bf16 v[20:23], v[136:139], a[164:167], v[20:23]
  ds_read_b64_tr_b16 v[172:173], v96 offset:16992
  buffer_load_dwordx4 a[52:55], v105, s[44:47], s86 offen offset:1024 sc1
  v_mfma_f32_16x16x32_bf16 v[28:31], v[140:143], a[164:167], v[28:31]
  ds_read_b64_tr_b16 v[174:175], v96 offset:17248
  ds_read_b64_tr_b16 v[176:177], v96 offset:21120
  v_mfma_f32_16x16x32_bf16 v[24:27], v[140:143], a[160:163], v[24:27]
  buffer_load_dwordx4 a[56:59], v105, s[44:47], s86 offen offset:2048 sc1
  ds_read_b64_tr_b16 v[178:179], v96 offset:21376
  v_mfma_f32_16x16x32_bf16 v[0:3], v[144:147], a[168:171], v[0:3]
  buffer_load_dwordx4 a[60:63], v105, s[44:47], s86 offen offset:3072 sc1
  ds_read_b64_tr_b16 v[180:181], v96 offset:21152
  v_mfma_f32_16x16x32_bf16 v[4:7], v[144:147], a[172:175], v[4:7]
  ds_read_b64_tr_b16 v[182:183], v96 offset:21408
  s_add_u32 s86, s86, 4096
  v_mfma_f32_16x16x32_bf16 v[12:15], v[148:151], a[172:175], v[12:15]
  ds_read_b64_tr_b16 v[184:185], v96 offset:21184
  buffer_load_dwordx4 a[64:67], v105, s[44:47], s86 offen offset:0 sc1
  v_mfma_f32_16x16x32_bf16 v[8:11], v[148:151], a[168:171], v[8:11]
  ds_read_b64_tr_b16 v[186:187], v96 offset:21440
  ds_read_b64_tr_b16 v[188:189], v96 offset:21216
  v_mfma_f32_16x16x32_bf16 v[16:19], v[152:155], a[168:171], v[16:19]
  buffer_load_dwordx4 a[68:71], v105, s[44:47], s86 offen offset:1024 sc1
  ds_read_b64_tr_b16 v[190:191], v96 offset:21472
  v_mfma_f32_16x16x32_bf16 v[20:23], v[152:155], a[172:175], v[20:23]
  buffer_load_dwordx4 a[72:75], v105, s[44:47], s86 offen offset:2048 sc1
  buffer_load_dwordx4 a[76:79], v105, s[44:47], s86 offen offset:3072 sc1
  v_mfma_f32_16x16x32_bf16 v[28:31], v[156:159], a[172:175], v[28:31]
  s_add_u32 s86, s86, 4096
  v_mfma_f32_16x16x32_bf16 v[24:27], v[156:159], a[168:171], v[24:27]
  buffer_load_dwordx4 a[80:83], v105, s[44:47], s86 offen offset:0 sc1
  s_waitcnt lgkmcnt(0)
  v_mfma_f32_16x16x32_bf16 v[0:3], v[160:163], a[176:179], v[0:3]
  ds_read_b64_tr_b16 v[128:129], v96 offset:25344
  buffer_load_dwordx4 a[84:87], v105, s[44:47], s86 offen offset:1024 sc1
  v_mfma_f32_16x16x32_bf16 v[4:7], v[160:163], a[180:183], v[4:7]
  ds_read_b64_tr_b16 v[130:131], v96 offset:25600
  ds_read_b64_tr_b16 v[132:133], v96 offset:25376
  v_mfma_f32_16x16x32_bf16 v[12:15], v[164:167], a[180:183], v[12:15]
  buffer_load_dwordx4 a[88:91], v105, s[44:47], s86 offen offset:2048 sc1
  ds_read_b64_tr_b16 v[134:135], v96 offset:25632
  v_mfma_f32_16x16x32_bf16 v[8:11], v[164:167], a[176:179], v[8:11]
  ds_read_b64_tr_b16 v[136:137], v96 offset:25408
  buffer_load_dwordx4 a[92:95], v105, s[44:47], s86 offen offset:3072 sc1
  v_mfma_f32_16x16x32_bf16 v[16:19], v[168:171], a[176:179], v[16:19]
  ds_read_b64_tr_b16 v[138:139], v96 offset:25664
  s_add_u32 s86, s86, 4096
  v_mfma_f32_16x16x32_bf16 v[20:23], v[168:171], a[180:183], v[20:23]
  ds_read_b64_tr_b16 v[140:141], v96 offset:25440
  ds_read_b64_tr_b16 v[142:143], v96 offset:25696
  v_mfma_f32_16x16x32_bf16 v[28:31], v[172:175], a[180:183], v[28:31]
  buffer_load_dwordx4 a[96:99], v105, s[44:47], s86 offen offset:0 sc1
  ds_read_b64_tr_b16 v[144:145], v96 offset:29568
  v_mfma_f32_16x16x32_bf16 v[24:27], v[172:175], a[176:179], v[24:27]
  ds_read_b64_tr_b16 v[146:147], v96 offset:29824
  buffer_load_dwordx4 a[100:103], v105, s[44:47], s86 offen offset:1024 sc1
  v_mfma_f32_16x16x32_bf16 v[0:3], v[176:179], a[184:187], v[0:3]
  ds_read_b64_tr_b16 v[148:149], v96 offset:29600
  buffer_load_dwordx4 a[104:107], v105, s[44:47], s86 offen offset:2048 sc1
  v_mfma_f32_16x16x32_bf16 v[4:7], v[176:179], a[188:191], v[4:7]
  ds_read_b64_tr_b16 v[150:151], v96 offset:29856
  ds_read_b64_tr_b16 v[152:153], v96 offset:29632
  v_mfma_f32_16x16x32_bf16 v[12:15], v[180:183], a[188:191], v[12:15]
  buffer_load_dwordx4 a[108:111], v105, s[44:47], s86 offen offset:3072 sc1
  ds_read_b64_tr_b16 v[154:155], v96 offset:29888
  v_mfma_f32_16x16x32_bf16 v[8:11], v[180:183], a[184:187], v[8:11]
  s_add_u32 s86, s86, 4096
  ds_read_b64_tr_b16 v[156:157], v96 offset:29664
  v_mfma_f32_16x16x32_bf16 v[16:19], v[184:187], a[184:187], v[16:19]
  ds_read_b64_tr_b16 v[158:159], v96 offset:29920
  buffer_load_dwordx4 a[112:115], v105, s[44:47], s86 offen offset:0 sc1
  v_mfma_f32_16x16x32_bf16 v[20:23], v[184:187], a[188:191], v[20:23]
  buffer_load_dwordx4 a[116:119], v105, s[44:47], s86 offen offset:1024 sc1
  v_mfma_f32_16x16x32_bf16 v[28:31], v[188:191], a[188:191], v[28:31]
  buffer_load_dwordx4 a[120:123], v105, s[44:47], s86 offen offset:2048 sc1
  v_mfma_f32_16x16x32_bf16 v[24:27], v[188:191], a[184:187], v[24:27]
  buffer_load_dwordx4 a[124:127], v105, s[44:47], s86 offen offset:3072 sc1
  s_waitcnt lgkmcnt(0)
  v_mfma_f32_16x16x32_bf16 v[0:3], v[128:131], a[192:195], v[0:3]
  ds_read_b64_tr_b16 v[160:161], v96 offset:33792
  s_add_u32 s60, s20, 0
  v_mfma_f32_16x16x32_bf16 v[4:7], v[128:131], a[196:199], v[4:7]
  ds_read_b64_tr_b16 v[162:163], v96 offset:34048
  ds_read_b64_tr_b16 v[164:165], v96 offset:33824
  v_mfma_f32_16x16x32_bf16 v[12:15], v[132:135], a[196:199], v[12:15]
  s_and_b32 s60, s60, 7
  ds_read_b64_tr_b16 v[166:167], v96 offset:34080
  v_mfma_f32_16x16x32_bf16 v[8:11], v[132:135], a[192:195], v[8:11]
  ds_read_b64_tr_b16 v[168:169], v96 offset:33856
  s_mul_i32 s60, s60, 262144
  v_mfma_f32_16x16x32_bf16 v[16:19], v[136:139], a[192:195], v[16:19]
  ds_read_b64_tr_b16 v[170:171], v96 offset:34112
  ds_read_b64_tr_b16 v[172:173], v96 offset:33888
  v_mfma_f32_16x16x32_bf16 v[20:23], v[136:139], a[196:199], v[20:23]
  s_add_u32 m0, s76, 0
  ds_read_b64_tr_b16 v[174:175], v96 offset:34144
  v_mfma_f32_16x16x32_bf16 v[28:31], v[140:143], a[196:199], v[28:31]
  ds_read_b64_tr_b16 v[176:177], v96 offset:38016
  buffer_load_dwordx4 v111, s[32:35], s60 offen lds
  v_mfma_f32_16x16x32_bf16 v[24:27], v[140:143], a[192:195], v[24:27]
  ds_read_b64_tr_b16 v[178:179], v96 offset:38272
  ds_read_b64_tr_b16 v[180:181], v96 offset:38048
  v_mfma_f32_16x16x32_bf16 v[0:3], v[144:147], a[200:203], v[0:3]
  ds_read_b64_tr_b16 v[182:183], v96 offset:38304
  v_mfma_f32_16x16x32_bf16 v[4:7], v[144:147], a[204:207], v[4:7]
  ds_read_b64_tr_b16 v[184:185], v96 offset:38080
  buffer_load_dwordx4 v101, s[32:35], s60 offen offset:1056 lds
  v_mfma_f32_16x16x32_bf16 v[12:15], v[148:151], a[204:207], v[12:15]
  ds_read_b64_tr_b16 v[186:187], v96 offset:38336
  ds_read_b64_tr_b16 v[188:189], v96 offset:38112
  v_mfma_f32_16x16x32_bf16 v[8:11], v[148:151], a[200:203], v[8:11]
  s_add_u32 s61, s20, 1
  ds_read_b64_tr_b16 v[190:191], v96 offset:38368
  v_mfma_f32_16x16x32_bf16 v[16:19], v[152:155], a[200:203], v[16:19]
  s_and_b32 s61, s61, 7
  v_mfma_f32_16x16x32_bf16 v[20:23], v[152:155], a[204:207], v[20:23]
  s_mul_i32 s61, s61, 262144
  v_mfma_f32_16x16x32_bf16 v[28:31], v[156:159], a[204:207], v[28:31]
  v_mfma_f32_16x16x32_bf16 v[24:27], v[156:159], a[200:203], v[24:27]
  s_add_u32 m0, s76, 8448
  s_waitcnt lgkmcnt(0)
  v_mfma_f32_16x16x32_bf16 v[0:3], v[160:163], a[208:211], v[0:3]
  ds_read_b64_tr_b16 v[128:129], v96 offset:42240
  buffer_load_dwordx4 v111, s[32:35], s61 offen lds
  v_mfma_f32_16x16x32_bf16 v[4:7], v[160:163], a[212:215], v[4:7]
  ds_read_b64_tr_b16 v[130:131], v96 offset:42496
  ds_read_b64_tr_b16 v[132:133], v96 offset:42272
  v_mfma_f32_16x16x32_bf16 v[12:15], v[164:167], a[212:215], v[12:15]
  ds_read_b64_tr_b16 v[134:135], v96 offset:42528
  v_mfma_f32_16x16x32_bf16 v[8:11], v[164:167], a[208:211], v[8:11]
  ds_read_b64_tr_b16 v[136:137], v96 offset:42304
  buffer_load_dwordx4 v101, s[32:35], s61 offen offset:1056 lds
  v_mfma_f32_16x16x32_bf16 v[16:19], v[168:171], a[208:211], v[16:19]
  ds_read_b64_tr_b16 v[138:139], v96 offset:42560
  ds_read_b64_tr_b16 v[140:141], v96 offset:42336
  v_mfma_f32_16x16x32_bf16 v[20:23], v[168:171], a[212:215], v[20:23]
  s_add_u32 s60, s20, 2
  ds_read_b64_tr_b16 v[142:143], v96 offset:42592
  v_mfma_f32_16x16x32_bf16 v[28:31], v[172:175], a[212:215], v[28:31]
  ds_read_b64_tr_b16 v[144:145], v96 offset:46464
  s_and_b32 s60, s60, 7
  v_mfma_f32_16x16x32_bf16 v[24:27], v[172:175], a[208:211], v[24:27]
  ds_read_b64_tr_b16 v[146:147], v96 offset:46720
  ds_read_b64_tr_b16 v[148:149], v96 offset:46496
  v_mfma_f32_16x16x32_bf16 v[0:3], v[176:179], a[216:219], v[0:3]
  s_mul_i32 s60, s60, 262144
  ds_read_b64_tr_b16 v[150:151], v96 offset:46752
  v_mfma_f32_16x16x32_bf16 v[4:7], v[176:179], a[220:223], v[4:7]
  ds_read_b64_tr_b16 v[152:153], v96 offset:46528
  s_add_u32 m0, s76, 16896
  v_mfma_f32_16x16x32_bf16 v[12:15], v[180:183], a[220:223], v[12:15]
  ds_read_b64_tr_b16 v[154:155], v96 offset:46784
  ds_read_b64_tr_b16 v[156:157], v96 offset:46560
  v_mfma_f32_16x16x32_bf16 v[8:11], v[180:183], a[216:219], v[8:11]
  buffer_load_dwordx4 v111, s[32:35], s60 offen lds
  ds_read_b64_tr_b16 v[158:159], v96 offset:46816
  v_mfma_f32_16x16x32_bf16 v[16:19], v[184:187], a[216:219], v[16:19]
  v_mfma_f32_16x16x32_bf16 v[20:23], v[184:187], a[220:223], v[20:23]
  buffer_load_dwordx4 v101, s[32:35], s60 offen offset:1056 lds
  v_mfma_f32_16x16x32_bf16 v[28:31], v[188:191], a[220:223], v[28:31]
  v_mfma_f32_16x16x32_bf16 v[24:27], v[188:191], a[216:219], v[24:27]
  s_add_u32 s61, s20, 3
  s_waitcnt lgkmcnt(0)
  v_mfma_f32_16x16x32_bf16 v[0:3], v[128:131], a[224:227], v[0:3]
  ds_read_b64_tr_b16 v[160:161], v96 offset:50688
  s_and_b32 s61, s61, 7
  v_mfma_f32_16x16x32_bf16 v[4:7], v[128:131], a[228:231], v[4:7]
  ds_read_b64_tr_b16 v[162:163], v96 offset:50944
  ds_read_b64_tr_b16 v[164:165], v96 offset:50720
  v_mfma_f32_16x16x32_bf16 v[12:15], v[132:135], a[228:231], v[12:15]
  s_mul_i32 s61, s61, 262144
  ds_read_b64_tr_b16 v[166:167], v96 offset:50976
  v_mfma_f32_16x16x32_bf16 v[8:11], v[132:135], a[224:227], v[8:11]
  ds_read_b64_tr_b16 v[168:169], v96 offset:50752
  s_add_u32 m0, s76, 25344
  v_mfma_f32_16x16x32_bf16 v[16:19], v[136:139], a[224:227], v[16:19]
  ds_read_b64_tr_b16 v[170:171], v96 offset:51008
  ds_read_b64_tr_b16 v[172:173], v96 offset:50784
  v_mfma_f32_16x16x32_bf16 v[20:23], v[136:139], a[228:231], v[20:23]
  buffer_load_dwordx4 v111, s[32:35], s61 offen lds
  ds_read_b64_tr_b16 v[174:175], v96 offset:51040
  v_mfma_f32_16x16x32_bf16 v[28:31], v[140:143], a[228:231], v[28:31]
  ds_read_b64_tr_b16 v[176:177], v96 offset:54912
  v_mfma_f32_16x16x32_bf16 v[24:27], v[140:143], a[224:227], v[24:27]
  ds_read_b64_tr_b16 v[178:179], v96 offset:55168
  ds_read_b64_tr_b16 v[180:181], v96 offset:54944
  v_mfma_f32_16x16x32_bf16 v[0:3], v[144:147], a[232:235], v[0:3]
  buffer_load_dwordx4 v101, s[32:35], s61 offen offset:1056 lds
  ds_read_b64_tr_b16 v[182:183], v96 offset:55200
  v_mfma_f32_16x16x32_bf16 v[4:7], v[144:147], a[236:239], v[4:7]
  ds_read_b64_tr_b16 v[184:185], v96 offset:54976
  buffer_load_dwordx4 v[32:35], v115, s[52:55], s77 offen nt
  v_mfma_f32_16x16x32_bf16 v[12:15], v[148:151], a[236:239], v[12:15]
  ds_read_b64_tr_b16 v[186:187], v96 offset:55232
  ds_read_b64_tr_b16 v[188:189], v96 offset:55008
  v_mfma_f32_16x16x32_bf16 v[8:11], v[148:151], a[232:235], v[8:11]
  s_add_u32 s77, s77, 98304
  ds_read_b64_tr_b16 v[190:191], v96 offset:55264
  v_mfma_f32_16x16x32_bf16 v[16:19], v[152:155], a[232:235], v[16:19]
  buffer_load_dwordx4 v[36:39], v115, s[52:55], s77 offen nt
  v_mfma_f32_16x16x32_bf16 v[20:23], v[152:155], a[236:239], v[20:23]
  s_add_u32 s77, s77, 98304
  v_mfma_f32_16x16x32_bf16 v[28:31], v[156:159], a[236:239], v[28:31]
  v_mfma_f32_16x16x32_bf16 v[24:27], v[156:159], a[232:235], v[24:27]
  buffer_load_dwordx4 v[40:43], v115, s[52:55], s77 offen nt
  s_waitcnt lgkmcnt(0)
  v_mfma_f32_16x16x32_bf16 v[0:3], v[160:163], a[240:243], v[0:3]
  ds_read_b64_tr_b16 a[128:129], v114 offset:0
  s_add_u32 s77, s77, 98304
  v_mfma_f32_16x16x32_bf16 v[4:7], v[160:163], a[244:247], v[4:7]
  ds_read_b64_tr_b16 a[130:131], v114 offset:1024
  v_mfma_f32_16x16x32_bf16 v[12:15], v[164:167], a[244:247], v[12:15]
  buffer_load_dwordx4 v[44:47], v115, s[52:55], s77 offen nt
  v_mfma_f32_16x16x32_bf16 v[8:11], v[164:167], a[240:243], v[8:11]
  ds_read_b64_tr_b16 a[132:133], v114 offset:32
  s_add_u32 s77, s77, 98304
  v_mfma_f32_16x16x32_bf16 v[16:19], v[168:171], a[240:243], v[16:19]
  ds_read_b64_tr_b16 a[134:135], v114 offset:1056
  v_mfma_f32_16x16x32_bf16 v[20:23], v[168:171], a[244:247], v[20:23]
  buffer_load_dwordx4 v[48:51], v115, s[52:55], s77 offen nt
  v_mfma_f32_16x16x32_bf16 v[28:31], v[172:175], a[244:247], v[28:31]
  ds_read_b64_tr_b16 a[136:137], v114 offset:2048
  s_add_u32 s77, s77, 98304
  v_mfma_f32_16x16x32_bf16 v[24:27], v[172:175], a[240:243], v[24:27]
  ds_read_b64_tr_b16 a[138:139], v114 offset:3072
  v_mfma_f32_16x16x32_bf16 v[0:3], v[176:179], a[248:251], v[0:3]
  buffer_load_dwordx4 v[52:55], v115, s[52:55], s77 offen nt
  v_mfma_f32_16x16x32_bf16 v[4:7], v[176:179], a[252:255], v[4:7]
  ds_read_b64_tr_b16 a[140:141], v114 offset:2080
  s_add_u32 s77, s77, 98304
  v_mfma_f32_16x16x32_bf16 v[12:15], v[180:183], a[252:255], v[12:15]
  ds_read_b64_tr_b16 a[142:143], v114 offset:3104
  buffer_load_dwordx4 v[56:59], v115, s[52:55], s77 offen nt
  v_mfma_f32_16x16x32_bf16 v[8:11], v[180:183], a[248:251], v[8:11]
  v_mfma_f32_16x16x32_bf16 v[16:19], v[184:187], a[248:251], v[16:19]
  s_add_u32 s77, s77, 98304
  v_mfma_f32_16x16x32_bf16 v[20:23], v[184:187], a[252:255], v[20:23]
  buffer_load_dwordx4 v[60:63], v115, s[52:55], s77 offen nt
  v_mfma_f32_16x16x32_bf16 v[28:31], v[188:191], a[252:255], v[28:31]
  v_mfma_f32_16x16x32_bf16 v[24:27], v[188:191], a[248:251], v[24:27]
  s_add_u32 s77, s77, 98304
  s_add_u32 s36, s28, 33554432
  s_addc_u32 s37, s29, 0
  s_mov_b32 s38, 4194304
  s_mov_b32 s39, 0x20000
  s_waitcnt lgkmcnt(0)
  s_nop 3
  v_cvt_pk_bf16_f32 v126, v0, v1
  v_cvt_pk_bf16_f32 v127, v2, v3
  v_cvt_pk_bf16_f32 v128, v8, v9
  v_cvt_pk_bf16_f32 v129, v10, v11
  v_cvt_pk_bf16_f32 v130, v4, v5
  v_cvt_pk_bf16_f32 v131, v6, v7
  v_cvt_pk_bf16_f32 v132, v12, v13
  v_cvt_pk_bf16_f32 v133, v14, v15
  v_cvt_pk_bf16_f32 v134, v16, v17
  v_cvt_pk_bf16_f32 v135, v18, v19
  v_cvt_pk_bf16_f32 v136, v24, v25
  v_cvt_pk_bf16_f32 v137, v26, v27
  v_cvt_pk_bf16_f32 v138, v20, v21
  v_cvt_pk_bf16_f32 v139, v22, v23
  v_cvt_pk_bf16_f32 v140, v28, v29
  v_cvt_pk_bf16_f32 v141, v30, v31
  s_nop 1
  v_mfma_f32_16x16x32_bf16 v[142:145], a[128:131], v[126:129], 0
  v_mfma_f32_16x16x32_bf16 v[146:149], a[132:135], v[126:129], 0
  v_mfma_f32_16x16x32_bf16 v[150:153], a[128:131], v[130:133], 0
  v_mfma_f32_16x16x32_bf16 v[154:157], a[132:135], v[130:133], 0
  v_mfma_f32_16x16x32_bf16 v[158:161], a[136:139], v[134:137], 0
  v_mfma_f32_16x16x32_bf16 v[162:165], a[140:143], v[134:137], 0
  v_mfma_f32_16x16x32_bf16 v[166:169], a[136:139], v[138:141], 0
  v_mfma_f32_16x16x32_bf16 v[170:173], a[140:143], v[138:141], 0
  s_waitcnt vmcnt(48)
  v_add_f32_dpp v88, v88, v88 row_ror:8 row_mask:0xf bank_mask:0xf
  v_add_f32_dpp v89, v89, v89 row_ror:8 row_mask:0xf bank_mask:0xf
  v_add_f32_dpp v90, v90, v90 row_ror:8 row_mask:0xf bank_mask:0xf
  v_add_f32_dpp v91, v91, v91 row_ror:8 row_mask:0xf bank_mask:0xf
  v_add_f32_dpp v92, v92, v92 row_ror:8 row_mask:0xf bank_mask:0xf
  v_add_f32_dpp v93, v93, v93 row_ror:8 row_mask:0xf bank_mask:0xf
  v_add_f32_dpp v94, v94, v94 row_ror:8 row_mask:0xf bank_mask:0xf
  v_add_f32_dpp v95, v95, v95 row_ror:8 row_mask:0xf bank_mask:0xf
  v_add_f32_dpp v88, v88, v88 row_ror:4 row_mask:0xf bank_mask:0xf
  v_add_f32_dpp v89, v89, v89 row_ror:4 row_mask:0xf bank_mask:0xf
  v_add_f32_dpp v90, v90, v90 row_ror:4 row_mask:0xf bank_mask:0xf
  v_add_f32_dpp v91, v91, v91 row_ror:4 row_mask:0xf bank_mask:0xf
  v_add_f32_dpp v92, v92, v92 row_ror:4 row_mask:0xf bank_mask:0xf
  v_add_f32_dpp v93, v93, v93 row_ror:4 row_mask:0xf bank_mask:0xf
  v_add_f32_dpp v94, v94, v94 row_ror:4 row_mask:0xf bank_mask:0xf
  v_add_f32_dpp v95, v95, v95 row_ror:4 row_mask:0xf bank_mask:0xf
  v_add_f32_dpp v88, v88, v88 row_ror:2 row_mask:0xf bank_mask:0xf
  v_add_f32_dpp v89, v89, v89 row_ror:2 row_mask:0xf bank_mask:0xf
  v_add_f32_dpp v90, v90, v90 row_ror:2 row_mask:0xf bank_mask:0xf
  v_add_f32_dpp v91, v91, v91 row_ror:2 row_mask:0xf bank_mask:0xf
  v_add_f32_dpp v92, v92, v92 row_ror:2 row_mask:0xf bank_mask:0xf
  v_add_f32_dpp v93, v93, v93 row_ror:2 row_mask:0xf bank_mask:0xf
  v_add_f32_dpp v94, v94, v94 row_ror:2 row_mask:0xf bank_mask:0xf
  v_add_f32_dpp v95, v95, v95 row_ror:2 row_mask:0xf bank_mask:0xf
  v_add_f32_dpp v88, v88, v88 row_ror:1 row_mask:0xf bank_mask:0xf
  v_add_f32_dpp v89, v89, v89 row_ror:1 row_mask:0xf bank_mask:0xf
  v_add_f32_dpp v90, v90, v90 row_ror:1 row_mask:0xf bank_mask:0xf
  v_add_f32_dpp v91, v91, v91 row_ror:1 row_mask:0xf bank_mask:0xf
  v_add_f32_dpp v92, v92, v92 row_ror:1 row_mask:0xf bank_mask:0xf
  v_add_f32_dpp v93, v93, v93 row_ror:1 row_mask:0xf bank_mask:0xf
  v_add_f32_dpp v94, v94, v94 row_ror:1 row_mask:0xf bank_mask:0xf
  v_add_f32_dpp v95, v95, v95 row_ror:1 row_mask:0xf bank_mask:0xf
  v_max3_f32 v206, v142, v143, v144
  v_max3_f32 v206, v206, v145, v146
  s_waitcnt vmcnt(44)
  v_mfma_f32_16x16x32_bf16 v[72:75], v[122:125], a[0:3], 0
  v_max3_f32 v206, v206, v147, v148
  v_max_f32 v206, v206, v149
  v_mfma_f32_16x16x32_bf16 v[76:79], v[120:123], a[0:3], 0
  v_max3_f32 v208, v150, v151, v152
  v_max3_f32 v208, v208, v153, v154
  v_mfma_f32_16x16x32_bf16 v[72:75], v[122:125], a[4:7], v[72:75]
  v_max3_f32 v208, v208, v155, v156
  v_max_f32_e64 v208, v208, v157
  v_mfma_f32_16x16x32_bf16 v[76:79], v[120:123], a[4:7], v[76:79]
  v_max3_f32 v210, v158, v159, v160
  v_max3_f32 v210, v210, v161, v162
  v_mfma_f32_16x16x32_bf16 v[72:75], v[122:125], a[8:11], v[72:75]
  v_max3_f32 v210, v210, v163, v164
  v_max_f32_e64 v210, v210, v165
  v_mfma_f32_16x16x32_bf16 v[76:79], v[120:123], a[8:11], v[76:79]
  v_max3_f32 v212, v166, v167, v168
  v_max3_f32 v212, v212, v169, v170
  v_mfma_f32_16x16x32_bf16 v[72:75], v[122:125], a[12:15], v[72:75]
  v_max3_f32 v212, v212, v171, v172
  v_max_f32_e64 v212, v212, v173
  v_mfma_f32_16x16x32_bf16 v[76:79], v[120:123], a[12:15], v[76:79]
  v_min3_f32 v214, v142, v143, v144
  v_min3_f32 v214, v214, v145, v146
  s_waitcnt vmcnt(40)
  v_mfma_f32_16x16x32_bf16 v[72:75], v[122:125], a[16:19], v[72:75]
  v_min3_f32 v214, v214, v147, v148
  v_min_f32 v214, v214, v149
  v_mfma_f32_16x16x32_bf16 v[76:79], v[120:123], a[16:19], v[76:79]
  v_min3_f32 v216, v150, v151, v152
  v_min3_f32 v216, v216, v153, v154
  v_mfma_f32_16x16x32_bf16 v[72:75], v[122:125], a[20:23], v[72:75]
  v_min3_f32 v216, v216, v155, v156
  v_min_f32_e64 v216, v216, v157
  v_mfma_f32_16x16x32_bf16 v[76:79], v[120:123], a[20:23], v[76:79]
  v_min3_f32 v218, v158, v159, v160
  v_min3_f32 v218, v218, v161, v162
  v_mfma_f32_16x16x32_bf16 v[72:75], v[122:125], a[24:27], v[72:75]
  v_min3_f32 v218, v218, v163, v164
  v_min_f32_e64 v218, v218, v165
  v_mfma_f32_16x16x32_bf16 v[76:79], v[120:123], a[24:27], v[76:79]
  v_min3_f32 v220, v166, v167, v168
  v_min3_f32 v220, v220, v169, v170
  v_mfma_f32_16x16x32_bf16 v[72:75], v[122:125], a[28:31], v[72:75]
  v_min3_f32 v220, v220, v171, v172
  v_min_f32 v220, v220, v173
  v_mfma_f32_16x16x32_bf16 v[76:79], v[120:123], a[28:31], v[76:79]
  s_nop 1
  v_permlane32_swap_b32 v206, v208
  s_waitcnt vmcnt(36)
  v_mfma_f32_16x16x32_bf16 v[72:75], v[122:125], a[32:35], v[72:75]
  v_permlane32_swap_b32 v210, v212
  v_permlane32_swap_b32 v214, v216
  v_mfma_f32_16x16x32_bf16 v[76:79], v[120:123], a[32:35], v[76:79]
  v_permlane32_swap_b32 v218, v220
  s_nop 0
  v_mfma_f32_16x16x32_bf16 v[72:75], v[122:125], a[36:39], v[72:75]
  v_max_f32 v206, v206, v208
  v_max_f32 v210, v210, v212
  v_mfma_f32_16x16x32_bf16 v[76:79], v[120:123], a[36:39], v[76:79]
  v_min_f32 v214, v214, v216
  v_min_f32 v218, v218, v220
  v_mfma_f32_16x16x32_bf16 v[72:75], v[122:125], a[40:43], v[72:75]
  s_nop 0
  v_permlane16_swap_b32 v206, v210
  v_mfma_f32_16x16x32_bf16 v[76:79], v[120:123], a[40:43], v[76:79]
  v_permlane16_swap_b32 v214, v218
  s_nop 0
  v_mfma_f32_16x16x32_bf16 v[72:75], v[122:125], a[44:47], v[72:75]
  v_max_f32 v206, v206, v210
  v_mov_b32 v210, v206
  v_mfma_f32_16x16x32_bf16 v[76:79], v[120:123], a[44:47], v[76:79]
  v_min_f32 v214, v214, v218
  v_mov_b32 v218, v214
  s_waitcnt vmcnt(32)
  v_mfma_f32_16x16x32_bf16 v[72:75], v[122:125], a[48:51], v[72:75]
  s_nop 0
  v_permlane16_swap_b32 v206, v210
  v_mfma_f32_16x16x32_bf16 v[76:79], v[120:123], a[48:51], v[76:79]
  v_permlane16_swap_b32 v214, v218
  s_nop 0
  v_mfma_f32_16x16x32_bf16 v[72:75], v[122:125], a[52:55], v[72:75]
  v_mov_b32 v208, v206
  v_mov_b32 v212, v210
  v_mfma_f32_16x16x32_bf16 v[76:79], v[120:123], a[52:55], v[76:79]
  v_mov_b32 v216, v214
  v_mov_b32 v220, v218
  v_mfma_f32_16x16x32_bf16 v[72:75], v[122:125], a[56:59], v[72:75]
  s_nop 0
  v_permlane32_swap_b32 v206, v208
  v_mfma_f32_16x16x32_bf16 v[76:79], v[120:123], a[56:59], v[76:79]
  v_permlane32_swap_b32 v210, v212
  v_permlane32_swap_b32 v214, v216
  v_mfma_f32_16x16x32_bf16 v[72:75], v[122:125], a[60:63], v[72:75]
  v_permlane32_swap_b32 v218, v220
  s_nop 0
  v_mfma_f32_16x16x32_bf16 v[76:79], v[120:123], a[60:63], v[76:79]
  s_nop 1
  v_mul_f32 v206, -1.4426950408889634, v206
  s_waitcnt vmcnt(28)
  v_mfma_f32_16x16x32_bf16 v[80:83], v[122:125], a[64:67], 0
  v_mul_f32 v214, 1.4426950408889634, v214
  v_mul_f32 v208, -1.4426950408889634, v208
  v_mfma_f32_16x16x32_bf16 v[84:87], v[120:123], a[64:67], 0
  v_mul_f32 v216, 1.4426950408889634, v216
  v_mul_f32 v210, -1.4426950408889634, v210
  v_mfma_f32_16x16x32_bf16 v[80:83], v[122:125], a[68:71], v[80:83]
  v_mul_f32 v218, 1.4426950408889634, v218
  v_mul_f32 v212, -1.4426950408889634, v212
  v_mfma_f32_16x16x32_bf16 v[84:87], v[120:123], a[68:71], v[84:87]
  v_mul_f32 v220, 1.4426950408889634, v220
  v_pk_fma_f32 v[174:175], v[142:143], s[94:95], v[214:215] op_sel_hi:[1,1,0] neg_lo:[1,0,0] neg_hi:[1,0,0]
  v_mfma_f32_16x16x32_bf16 v[80:83], v[122:125], a[72:75], v[80:83]
  v_pk_fma_f32 v[142:143], v[142:143], s[94:95], v[206:207] op_sel_hi:[1,1,0]
  v_pk_fma_f32 v[176:177], v[144:145], s[94:95], v[214:215] op_sel_hi:[1,1,0] neg_lo:[1,0,0] neg_hi:[1,0,0]
  v_mfma_f32_16x16x32_bf16 v[84:87], v[120:123], a[72:75], v[84:87]
  v_pk_fma_f32 v[144:145], v[144:145], s[94:95], v[206:207] op_sel_hi:[1,1,0]
  v_pk_fma_f32 v[178:179], v[146:147], s[94:95], v[214:215] op_sel_hi:[1,1,0] neg_lo:[1,0,0] neg_hi:[1,0,0]
  v_mfma_f32_16x16x32_bf16 v[80:83], v[122:125], a[76:79], v[80:83]
  v_pk_fma_f32 v[146:147], v[146:147], s[94:95], v[206:207] op_sel_hi:[1,1,0]
  v_pk_fma_f32 v[180:181], v[148:149], s[94:95], v[214:215] op_sel_hi:[1,1,0] neg_lo:[1,0,0] neg_hi:[1,0,0]
  v_mfma_f32_16x16x32_bf16 v[84:87], v[120:123], a[76:79], v[84:87]
  v_pk_fma_f32 v[148:149], v[148:149], s[94:95], v[206:207] op_sel_hi:[1,1,0]
  v_exp_f32 v142, v142
  s_waitcnt vmcnt(24)
  v_mfma_f32_16x16x32_bf16 v[80:83], v[122:125], a[80:83], v[80:83]
  v_exp_f32 v143, v143
  v_exp_f32 v144, v144
  v_mfma_f32_16x16x32_bf16 v[84:87], v[120:123], a[80:83], v[84:87]
  v_exp_f32 v145, v145
  v_exp_f32 v146, v146
  v_mfma_f32_16x16x32_bf16 v[80:83], v[122:125], a[84:87], v[80:83]
  v_exp_f32 v147, v147
  v_exp_f32 v148, v148
  v_mfma_f32_16x16x32_bf16 v[84:87], v[120:123], a[84:87], v[84:87]
  v_exp_f32 v149, v149
  v_exp_f32 v174, v174
  v_mfma_f32_16x16x32_bf16 v[80:83], v[122:125], a[88:91], v[80:83]
  v_exp_f32 v175, v175
  v_exp_f32 v176, v176
  v_mfma_f32_16x16x32_bf16 v[84:87], v[120:123], a[88:91], v[84:87]
  v_exp_f32 v177, v177
  v_exp_f32 v178, v178
  v_mfma_f32_16x16x32_bf16 v[80:83], v[122:125], a[92:95], v[80:83]
  v_exp_f32 v179, v179
  v_exp_f32 v180, v180
  v_mfma_f32_16x16x32_bf16 v[84:87], v[120:123], a[92:95], v[84:87]
  v_exp_f32 v181, v181
  s_nop 0
  s_waitcnt vmcnt(20)
  v_mfma_f32_16x16x32_bf16 v[80:83], v[122:125], a[96:99], v[80:83]
  v_cvt_pk_bf16_f32 v222, v142, v143
  v_cvt_pk_bf16_f32 v223, v144, v145
  v_mfma_f32_16x16x32_bf16 v[84:87], v[120:123], a[96:99], v[84:87]
  v_cvt_pk_bf16_f32 v224, v146, v147
  v_cvt_pk_bf16_f32 v225, v148, v149
  v_mfma_f32_16x16x32_bf16 v[80:83], v[122:125], a[100:103], v[80:83]
  v_cvt_pk_bf16_f32 v226, v174, v175
  v_cvt_pk_bf16_f32 v227, v176, v177
  v_mfma_f32_16x16x32_bf16 v[84:87], v[120:123], a[100:103], v[84:87]
  v_cvt_pk_bf16_f32 v228, v178, v179
  v_cvt_pk_bf16_f32 v229, v180, v181
  v_mfma_f32_16x16x32_bf16 v[80:83], v[122:125], a[104:107], v[80:83]
  v_pk_fma_f32 v[182:183], v[150:151], s[94:95], v[216:217] op_sel_hi:[1,1,0] neg_lo:[1,0,0] neg_hi:[1,0,0]
  v_pk_fma_f32 v[150:151], v[150:151], s[94:95], v[208:209] op_sel_hi:[1,1,0]
  v_mfma_f32_16x16x32_bf16 v[84:87], v[120:123], a[104:107], v[84:87]
  v_pk_fma_f32 v[184:185], v[152:153], s[94:95], v[216:217] op_sel_hi:[1,1,0] neg_lo:[1,0,0] neg_hi:[1,0,0]
  v_pk_fma_f32 v[152:153], v[152:153], s[94:95], v[208:209] op_sel_hi:[1,1,0]
  v_mfma_f32_16x16x32_bf16 v[80:83], v[122:125], a[108:111], v[80:83]
  v_pk_fma_f32 v[186:187], v[154:155], s[94:95], v[216:217] op_sel_hi:[1,1,0] neg_lo:[1,0,0] neg_hi:[1,0,0]
  v_pk_fma_f32 v[154:155], v[154:155], s[94:95], v[208:209] op_sel_hi:[1,1,0]
  v_mfma_f32_16x16x32_bf16 v[84:87], v[120:123], a[108:111], v[84:87]
  v_pk_fma_f32 v[188:189], v[156:157], s[94:95], v[216:217] op_sel_hi:[1,1,0] neg_lo:[1,0,0] neg_hi:[1,0,0]
  v_pk_fma_f32 v[156:157], v[156:157], s[94:95], v[208:209] op_sel_hi:[1,1,0]
  s_waitcnt vmcnt(16)
  v_mfma_f32_16x16x32_bf16 v[80:83], v[122:125], a[112:115], v[80:83]
  v_exp_f32 v150, v150
  v_exp_f32 v151, v151
  v_mfma_f32_16x16x32_bf16 v[84:87], v[120:123], a[112:115], v[84:87]
  v_exp_f32 v152, v152
  v_exp_f32 v153, v153
  v_mfma_f32_16x16x32_bf16 v[80:83], v[122:125], a[116:119], v[80:83]
  v_exp_f32 v154, v154
  v_exp_f32 v155, v155
  v_mfma_f32_16x16x32_bf16 v[84:87], v[120:123], a[116:119], v[84:87]
  v_exp_f32 v156, v156
  v_exp_f32 v157, v157
  v_mfma_f32_16x16x32_bf16 v[80:83], v[122:125], a[120:123], v[80:83]
  v_exp_f32 v182, v182
  v_exp_f32 v183, v183
  v_mfma_f32_16x16x32_bf16 v[84:87], v[120:123], a[120:123], v[84:87]
  v_exp_f32 v184, v184
  v_exp_f32 v185, v185
  v_mfma_f32_16x16x32_bf16 v[80:83], v[122:125], a[124:127], v[80:83]
  v_exp_f32 v186, v186
  v_exp_f32 v187, v187
  v_mfma_f32_16x16x32_bf16 v[84:87], v[120:123], a[124:127], v[84:87]
  v_exp_f32 v188, v188
  v_exp_f32 v189, v189
  s_nop 0
  v_cvt_pk_bf16_f32 v230, v150, v151
  v_cvt_pk_bf16_f32 v231, v152, v153
  v_cvt_pk_bf16_f32 v232, v154, v155
  v_cvt_pk_bf16_f32 v233, v156, v157
  v_cvt_pk_bf16_f32 v234, v182, v183
  v_cvt_pk_bf16_f32 v235, v184, v185
  v_cvt_pk_bf16_f32 v236, v186, v187
  v_cvt_pk_bf16_f32 v237, v188, v189
  s_nop 2
  s_nop 0
  s_mul_i32 s82, s3, 3072
  s_add_u32 s82, s82, 114688
  v_add_u32 v107, s82, v105
  v_add_u32 v108, 114688, v105
  v_and_b32 v106, 1, v104
  v_cmp_eq_u32 vcc, 0, v106
  s_nop 4
  v_cvt_pk_bf16_f32 v72, v72, v73
  v_cvt_pk_bf16_f32 v73, v74, v75
  v_cvt_pk_bf16_f32 v74, v76, v77
  v_cvt_pk_bf16_f32 v75, v78, v79
  v_cvt_pk_bf16_f32 v76, v80, v81
  v_cvt_pk_bf16_f32 v77, v82, v83
  v_cvt_pk_bf16_f32 v78, v84, v85
  v_cvt_pk_bf16_f32 v79, v86, v87
  v_cvt_pk_bf16_f32 v80, v88, v89
  v_cvt_pk_bf16_f32 v81, v90, v91
  v_cvt_pk_bf16_f32 v82, v92, v93
  v_cvt_pk_bf16_f32 v83, v94, v95
  v_cndmask_b32 v80, v116, v80, vcc
  v_cndmask_b32 v81, v116, v81, vcc
  v_cndmask_b32 v82, v116, v82, vcc
  v_cndmask_b32 v83, v116, v83, vcc
  ds_write_b128 v107, v[72:75] offset:0
  ds_write_b128 v107, v[76:79] offset:1024
  ds_write_b128 v107, v[80:83] offset:2048
  v_pk_fma_f32 v[190:191], v[158:159], s[94:95], v[218:219] op_sel_hi:[1,1,0] neg_lo:[1,0,0] neg_hi:[1,0,0]
  v_pk_fma_f32 v[158:159], v[158:159], s[94:95], v[210:211] op_sel_hi:[1,1,0]
  v_pk_fma_f32 v[192:193], v[160:161], s[94:95], v[218:219] op_sel_hi:[1,1,0] neg_lo:[1,0,0] neg_hi:[1,0,0]
  v_pk_fma_f32 v[160:161], v[160:161], s[94:95], v[210:211] op_sel_hi:[1,1,0]
  v_pk_fma_f32 v[194:195], v[162:163], s[94:95], v[218:219] op_sel_hi:[1,1,0] neg_lo:[1,0,0] neg_hi:[1,0,0]
  v_pk_fma_f32 v[162:163], v[162:163], s[94:95], v[210:211] op_sel_hi:[1,1,0]
  v_pk_fma_f32 v[196:197], v[164:165], s[94:95], v[218:219] op_sel_hi:[1,1,0] neg_lo:[1,0,0] neg_hi:[1,0,0]
  v_pk_fma_f32 v[164:165], v[164:165], s[94:95], v[210:211] op_sel_hi:[1,1,0]
  v_exp_f32 v158, v158
  v_exp_f32 v159, v159
  v_exp_f32 v160, v160
  v_exp_f32 v161, v161
  v_exp_f32 v162, v162
  v_exp_f32 v163, v163
  v_exp_f32 v164, v164
  v_exp_f32 v165, v165
  v_exp_f32 v190, v190
  v_exp_f32 v191, v191
  v_exp_f32 v192, v192
  v_exp_f32 v193, v193
  v_exp_f32 v194, v194
  v_exp_f32 v195, v195
  v_exp_f32 v196, v196
  v_exp_f32 v197, v197
  s_nop 0
  s_nop 0
  v_cvt_pk_bf16_f32 v238, v158, v159
  v_cvt_pk_bf16_f32 v239, v160, v161
  v_cvt_pk_bf16_f32 v240, v162, v163
  v_cvt_pk_bf16_f32 v241, v164, v165
  v_cvt_pk_bf16_f32 v242, v190, v191
  v_cvt_pk_bf16_f32 v243, v192, v193
  v_cvt_pk_bf16_f32 v244, v194, v195
  v_cvt_pk_bf16_f32 v245, v196, v197
  s_waitcnt lgkmcnt(0)
  s_barrier
  ds_read_b128 a[0:3], v108 offset:0
  ds_read_b128 a[4:7], v108 offset:1024
  ds_read_b128 a[8:11], v108 offset:2048
  ds_read_b128 a[12:15], v108 offset:3072
  ds_read_b128 a[16:19], v108 offset:4096
  ds_read_b128 a[20:23], v108 offset:5120
  ds_read_b128 a[24:27], v108 offset:6144
  ds_read_b128 a[28:31], v108 offset:7168
  ds_read_b128 a[32:35], v108 offset:8192
  ds_read_b128 a[36:39], v108 offset:9216
  ds_read_b128 a[40:43], v108 offset:10240
  ds_read_b128 a[44:47], v108 offset:11264
  s_lshl_b32 s82, s26, 3
  s_lshl_b32 s83, s3, 1
  s_add_u32 s82, s82, s83
  s_lshl_b32 s82, s82, 15
  s_lshl_b32 s83, s27, 11
  s_add_u32 s82, s82, s83
  s_add_u32 s83, s82, 0x8000
  s_lshl_b32 s84, s26, 2
  s_add_u32 s84, s84, s3
  s_lshl_b32 s84, s84, 10
  s_lshl_b32 s85, s27, 6
  s_add_u32 s84, s84, s85
  s_add_u32 s84, s84, 131072
  s_waitcnt lgkmcnt(0)
  v_mfma_f32_16x16x32_bf16 v[0:3], a[0:3], v[222:225], 0
  v_mfma_f32_16x16x32_bf16 v[4:7], a[4:7], v[222:225], 0
  v_mfma_f32_16x16x32_bf16 v[8:11], a[8:11], v[222:225], 0
  v_mfma_f32_16x16x32_bf16 v[12:15], a[12:15], v[226:229], 0
  v_mfma_f32_16x16x32_bf16 v[16:19], a[16:19], v[226:229], 0
  v_mfma_f32_16x16x32_bf16 v[20:23], a[20:23], v[226:229], 0
  v_mfma_f32_16x16x32_bf16 v[72:75], a[0:3], v[230:233], 0
  v_mfma_f32_16x16x32_bf16 v[76:79], a[4:7], v[230:233], 0
  v_mfma_f32_16x16x32_bf16 v[80:83], a[8:11], v[230:233], 0
  v_mfma_f32_16x16x32_bf16 v[84:87], a[12:15], v[234:237], 0
  v_mfma_f32_16x16x32_bf16 v[88:91], a[16:19], v[234:237], 0
  v_mfma_f32_16x16x32_bf16 v[92:95], a[20:23], v[234:237], 0
  s_nop 7
  v_mul_f32 v10, v9, v21
  v_mul_f32 v10, 0x358637bd, v10
  v_fmac_f32 v10, v8, v21
  v_fmac_f32 v10, v20, v9
  v_rcp_f32 v10, v10
  s_nop 0
  v_mul_f32 v8, v21, v10
  v_mul_f32 v20, v9, v10
  v_pk_mul_f32 v[0:1], v[0:1], v[8:9] op_sel_hi:[1,0]
  v_pk_mul_f32 v[2:3], v[2:3], v[8:9] op_sel_hi:[1,0]
  v_pk_mul_f32 v[4:5], v[4:5], v[8:9] op_sel_hi:[1,0]
  v_pk_mul_f32 v[6:7], v[6:7], v[8:9] op_sel_hi:[1,0]
  v_pk_fma_f32 v[0:1], v[12:13], v[20:21], v[0:1] op_sel_hi:[1,0,1]
  v_pk_fma_f32 v[2:3], v[14:15], v[20:21], v[2:3] op_sel_hi:[1,0,1]
  v_pk_fma_f32 v[4:5], v[16:17], v[20:21], v[4:5] op_sel_hi:[1,0,1]
  v_pk_fma_f32 v[6:7], v[18:19], v[20:21], v[6:7] op_sel_hi:[1,0,1]
  v_cvt_pk_bf16_f32 v12, v0, v1
  v_cvt_pk_bf16_f32 v13, v2, v3
  v_cvt_pk_bf16_f32 v14, v4, v5
  v_cvt_pk_bf16_f32 v15, v6, v7
  buffer_store_dwordx4 v[12:15], v105, s[36:39], s82 offen offset:0 sc1
  v_mul_f32 v82, v81, v93
  v_mul_f32 v82, 0x358637bd, v82
  v_fmac_f32 v82, v80, v93
  v_fmac_f32 v82, v92, v81
  v_rcp_f32 v82, v82
  s_nop 0
  v_mul_f32 v80, v93, v82
  v_mul_f32_e64 v92, v81, v82
  v_pk_mul_f32 v[72:73], v[72:73], v[80:81] op_sel_hi:[1,0]
  v_pk_mul_f32 v[74:75], v[74:75], v[80:81] op_sel_hi:[1,0]
  v_pk_mul_f32 v[76:77], v[76:77], v[80:81] op_sel_hi:[1,0]
  v_pk_mul_f32 v[78:79], v[78:79], v[80:81] op_sel_hi:[1,0]
  v_pk_fma_f32 v[72:73], v[84:85], v[92:93], v[72:73] op_sel_hi:[1,0,1]
  v_pk_fma_f32 v[74:75], v[86:87], v[92:93], v[74:75] op_sel_hi:[1,0,1]
  v_pk_fma_f32 v[76:77], v[88:89], v[92:93], v[76:77] op_sel_hi:[1,0,1]
  v_pk_fma_f32 v[78:79], v[90:91], v[92:93], v[78:79] op_sel_hi:[1,0,1]
  v_cvt_pk_bf16_f32 v84, v72, v73
  v_cvt_pk_bf16_f32 v85, v74, v75
  v_cvt_pk_bf16_f32 v86, v76, v77
  v_cvt_pk_bf16_f32 v87, v78, v79
  buffer_store_dwordx4 v[84:87], v105, s[36:39], s83 offen offset:0 sc1
  v_pk_fma_f32 v[198:199], v[166:167], s[94:95], v[220:221] op_sel_hi:[1,1,0] neg_lo:[1,0,0] neg_hi:[1,0,0]
  v_pk_fma_f32 v[166:167], v[166:167], s[94:95], v[212:213] op_sel_hi:[1,1,0]
  v_pk_fma_f32 v[200:201], v[168:169], s[94:95], v[220:221] op_sel_hi:[1,1,0] neg_lo:[1,0,0] neg_hi:[1,0,0]
  v_pk_fma_f32 v[168:169], v[168:169], s[94:95], v[212:213] op_sel_hi:[1,1,0]
  v_pk_fma_f32 v[202:203], v[170:171], s[94:95], v[220:221] op_sel_hi:[1,1,0] neg_lo:[1,0,0] neg_hi:[1,0,0]
  v_pk_fma_f32 v[170:171], v[170:171], s[94:95], v[212:213] op_sel_hi:[1,1,0]
  v_pk_fma_f32 v[204:205], v[172:173], s[94:95], v[220:221] op_sel_hi:[1,1,0] neg_lo:[1,0,0] neg_hi:[1,0,0]
  v_pk_fma_f32 v[172:173], v[172:173], s[94:95], v[212:213] op_sel_hi:[1,1,0]
  v_exp_f32 v166, v166
  v_exp_f32 v167, v167
  v_exp_f32 v168, v168
  v_exp_f32 v169, v169
  v_exp_f32 v170, v170
  v_exp_f32 v171, v171
  v_exp_f32 v172, v172
  v_exp_f32 v173, v173
  v_exp_f32 v198, v198
  v_exp_f32 v199, v199
  v_exp_f32 v200, v200
  v_exp_f32 v201, v201
  v_exp_f32 v202, v202
  v_exp_f32 v203, v203
  v_exp_f32 v204, v204
  v_exp_f32 v205, v205
  s_nop 0
  s_nop 0
  v_cvt_pk_bf16_f32 v246, v166, v167
  v_cvt_pk_bf16_f32 v247, v168, v169
  v_cvt_pk_bf16_f32 v248, v170, v171
  v_cvt_pk_bf16_f32 v249, v172, v173
  v_cvt_pk_bf16_f32 v250, v198, v199
  v_cvt_pk_bf16_f32 v251, v200, v201
  v_cvt_pk_bf16_f32 v252, v202, v203
  v_cvt_pk_bf16_f32 v253, v204, v205
  s_nop 1
  v_mfma_f32_16x16x32_bf16 v[174:177], a[24:27], v[238:241], 0
  v_mfma_f32_16x16x32_bf16 v[178:181], a[28:31], v[238:241], 0
  v_mfma_f32_16x16x32_bf16 v[182:185], a[32:35], v[238:241], 0
  v_mfma_f32_16x16x32_bf16 v[186:189], a[36:39], v[242:245], 0
  v_mfma_f32_16x16x32_bf16 v[190:193], a[40:43], v[242:245], 0
  v_mfma_f32_16x16x32_bf16 v[194:197], a[44:47], v[242:245], 0
  v_mfma_f32_16x16x32_bf16 v[198:201], a[24:27], v[246:249], 0
  v_mfma_f32_16x16x32_bf16 v[202:205], a[28:31], v[246:249], 0
  v_mfma_f32_16x16x32_bf16 v[206:209], a[32:35], v[246:249], 0
  v_mfma_f32_16x16x32_bf16 v[210:213], a[36:39], v[250:253], 0
  v_mfma_f32_16x16x32_bf16 v[214:217], a[40:43], v[250:253], 0
  v_mfma_f32_16x16x32_bf16 v[218:221], a[44:47], v[250:253], 0
  s_nop 7
  v_mov_b32 v107, 1
  v_mov_b32 v108, 0
  s_waitcnt vmcnt(0)
  buffer_store_dword v107, v108, s[56:59], s84 offen sc1
  s_add_u32 s95, s84, 327680
  v_mul_f32 v184, v183, v195
  v_mul_f32 v184, 0x358637bd, v184
  v_fmac_f32 v184, v182, v195
  v_fmac_f32 v184, v194, v183
  v_rcp_f32 v184, v184
  s_nop 0
  v_mul_f32 v182, v195, v184
  v_mul_f32 v194, v183, v184
  v_pk_mul_f32 v[174:175], v[174:175], v[182:183] op_sel_hi:[1,0]
  v_pk_mul_f32 v[176:177], v[176:177], v[182:183] op_sel_hi:[1,0]
  v_pk_mul_f32 v[178:179], v[178:179], v[182:183] op_sel_hi:[1,0]
  v_pk_mul_f32 v[180:181], v[180:181], v[182:183] op_sel_hi:[1,0]
  v_pk_fma_f32 v[174:175], v[186:187], v[194:195], v[174:175] op_sel_hi:[1,0,1]
  v_pk_fma_f32 v[176:177], v[188:189], v[194:195], v[176:177] op_sel_hi:[1,0,1]
  v_pk_fma_f32 v[178:179], v[190:191], v[194:195], v[178:179] op_sel_hi:[1,0,1]
  v_pk_fma_f32 v[180:181], v[192:193], v[194:195], v[180:181] op_sel_hi:[1,0,1]
  v_cvt_pk_bf16_f32 v186, v174, v175
  v_cvt_pk_bf16_f32 v187, v176, v177
  v_cvt_pk_bf16_f32 v188, v178, v179
  v_cvt_pk_bf16_f32 v189, v180, v181
  buffer_store_dwordx4 v[186:189], v105, s[36:39], s82 offen offset:1024 sc1
  v_mul_f32 v208, v207, v219
  v_mul_f32 v208, 0x358637bd, v208
  v_fmac_f32 v208, v206, v219
  v_fmac_f32 v208, v218, v207
  v_rcp_f32 v208, v208
  s_nop 0
  v_mul_f32 v206, v219, v208
  v_mul_f32_e64 v218, v207, v208
  v_pk_mul_f32 v[198:199], v[198:199], v[206:207] op_sel_hi:[1,0]
  v_pk_mul_f32 v[200:201], v[200:201], v[206:207] op_sel_hi:[1,0]
  v_pk_mul_f32 v[202:203], v[202:203], v[206:207] op_sel_hi:[1,0]
  v_pk_mul_f32 v[204:205], v[204:205], v[206:207] op_sel_hi:[1,0]
  v_pk_fma_f32 v[198:199], v[210:211], v[218:219], v[198:199] op_sel_hi:[1,0,1]
  v_pk_fma_f32 v[200:201], v[212:213], v[218:219], v[200:201] op_sel_hi:[1,0,1]
  v_pk_fma_f32 v[202:203], v[214:215], v[218:219], v[202:203] op_sel_hi:[1,0,1]
  v_pk_fma_f32 v[204:205], v[216:217], v[218:219], v[204:205] op_sel_hi:[1,0,1]
  v_cvt_pk_bf16_f32 v210, v198, v199
  v_cvt_pk_bf16_f32 v211, v200, v201
  v_cvt_pk_bf16_f32 v212, v202, v203
  v_cvt_pk_bf16_f32 v213, v204, v205
  buffer_store_dwordx4 v[210:213], v105, s[36:39], s83 offen offset:1024 sc1
  s_mov_b32 s40, s4
  s_mov_b32 s41, s5
  s_mov_b32 s42, 4194304
  s_mov_b32 s43, 0x20000
  v_lshrrev_b32 v107, 4, v104
  v_and_b32 v108, 15, v104
  v_lshlrev_b32 v108, 11, v108
  v_lshl_add_u32 v100, v107, 3, v108
  s_lshl_b32 s82, s26, 3
  s_lshl_b32 s83, s3, 1
  s_add_u32 s82, s82, s83
  s_lshl_b32 s82, s82, 15
  s_lshl_b32 s83, s27, 7
  s_add_u32 s82, s82, s83
  s_nop 0
  s_add_u32 s83, s82, 32768
  buffer_load_dwordx2 v[178:179], v100, s[40:43], s82 offen offset:0
  buffer_load_dwordx2 v[180:181], v100, s[40:43], s82 offen offset:32
  buffer_load_dwordx2 v[182:183], v100, s[40:43], s82 offen offset:64
  buffer_load_dwordx2 v[184:185], v100, s[40:43], s82 offen offset:96
  buffer_load_dwordx2 v[186:187], v100, s[40:43], s83 offen offset:0
  buffer_load_dwordx2 v[188:189], v100, s[40:43], s83 offen offset:32
  buffer_load_dwordx2 v[190:191], v100, s[40:43], s83 offen offset:64
  buffer_load_dwordx2 v[192:193], v100, s[40:43], s83 offen offset:96
  s_lshr_b32 s80, s3, 1
  s_and_b32 s81, s3, 1
  s_mul_i32 s83, s80, 229376
  s_mul_i32 s78, s23, 224
  s_add_u32 s83, s83, s78
  v_add_u32 v22, 0, v104
  v_mul_u32_u24 v23, 4682, v22
  v_lshrrev_b32 v23, 16, v23
  v_mul_u32_u24 v24, 14, v23
  v_sub_u32_e64 v24, v22, v24
  v_mul_u32_u24 v23, 7168, v23
  v_lshl_add_u32 v23, v24, 4, v23
  v_add_u32 v23, s83, v23
  v_accvgpr_write_b32 a224, v23
  v_add_u32 v22, 64, v104
  v_mul_u32_u24 v23, 4682, v22
  v_lshrrev_b32 v23, 16, v23
  v_mul_u32_u24 v24, 14, v23
  v_sub_u32_e64 v24, v22, v24
  v_mul_u32_u24 v23, 7168, v23
  v_lshl_add_u32 v23, v24, 4, v23
  v_add_u32_e64 v23, s83, v23
  v_subrev_u32 v23, 1024, v23
  v_accvgpr_write_b32 a225, v23
  v_add_u32 v22, 128, v104
  v_mul_u32_u24 v23, 4682, v22
  v_lshrrev_b32 v23, 16, v23
  v_mul_u32_u24 v24, 14, v23
  v_sub_u32_e64 v24, v22, v24
  v_mul_u32_u24 v23, 7168, v23
  v_lshl_add_u32 v23, v24, 4, v23
  v_add_u32_e64 v23, s83, v23
  v_subrev_u32 v23, 2048, v23
  v_accvgpr_write_b32 a226, v23
  v_add_u32 v22, 192, v104
  v_mul_u32_u24 v23, 4682, v22
  v_lshrrev_b32 v23, 16, v23
  v_mul_u32_u24 v24, 14, v23
  v_sub_u32_e64 v24, v22, v24
  v_mul_u32_u24 v23, 7168, v23
  v_lshl_add_u32 v23, v24, 4, v23
  v_add_u32_e64 v23, s83, v23
  v_subrev_u32 v23, 3072, v23
  v_accvgpr_write_b32 a227, v23
  v_add_u32 v22, 256, v104
  v_mul_u32_u24 v23, 4682, v22
  v_lshrrev_b32 v23, 16, v23
  v_mul_u32_u24 v24, 14, v23
  v_sub_u32_e64 v24, v22, v24
  v_mul_u32_u24 v23, 7168, v23
  v_lshl_add_u32 v23, v24, 4, v23
  v_add_u32_e64 v23, s83, v23
  v_accvgpr_write_b32 a228, v23
  v_add_u32 v22, 320, v104
  v_mul_u32_u24 v23, 4682, v22
  v_lshrrev_b32 v23, 16, v23
  v_mul_u32_u24 v24, 14, v23
  v_sub_u32_e64 v24, v22, v24
  v_mul_u32_u24 v23, 7168, v23
  v_lshl_add_u32 v23, v24, 4, v23
  v_add_u32_e64 v23, s83, v23
  v_subrev_u32 v23, 1024, v23
  v_accvgpr_write_b32 a229, v23
  v_add_u32 v22, 384, v104
  v_mul_u32_u24 v23, 4682, v22
  v_lshrrev_b32 v23, 16, v23
  v_mul_u32_u24 v24, 14, v23
  v_sub_u32_e64 v24, v22, v24
  v_mul_u32_u24 v23, 7168, v23
  v_lshl_add_u32 v23, v24, 4, v23
  v_add_u32_e64 v23, s83, v23
  v_subrev_u32 v23, 2048, v23
  v_accvgpr_write_b32 a230, v23
  s_mul_i32 s68, s81, 14336
  s_mul_i32 s82, s80, 7168
  s_add_u32 s68, s68, s82
  s_cmp_eq_u32 s81, 0
  s_cselect_b32 s64, s14, s16
  s_cselect_b32 s65, s15, s17
  s_mov_b32 s66, 7340032
  s_mov_b32 s67, 0x20000
  v_mov_b32 v0, v64
  v_mov_b32 v2, v65
  v_mov_b32 v4, v66
  v_mov_b32 v6, v67
  v_mov_b32 v8, v68
  v_mov_b32 v10, v69
  v_mov_b32 v12, v70
  v_mov_b32 v14, v71
  v_lshlrev_b32 v0, 16, v0
  v_mul_f32 v1, -1.4426950408889634, v0
  v_lshlrev_b32 v2, 16, v2
  v_mul_f32 v3, -1.4426950408889634, v2
  v_lshlrev_b32 v4, 16, v4
  v_mul_f32 v5, -1.4426950408889634, v4
  v_lshlrev_b32 v6, 16, v6
  v_mul_f32 v7, -1.4426950408889634, v6
  v_lshlrev_b32 v8, 16, v8
  v_mul_f32 v9, -1.4426950408889634, v8
  v_lshlrev_b32 v10, 16, v10
  v_mul_f32 v11, -1.4426950408889634, v10
  v_lshlrev_b32 v12, 16, v12
  v_mul_f32 v13, -1.4426950408889634, v12
  v_lshlrev_b32 v14, 16, v14
  v_mul_f32 v15, -1.4426950408889634, v14
  v_exp_f32 v1, v1
  v_exp_f32 v3, v3
  v_exp_f32 v5, v5
  v_exp_f32 v7, v7
  v_exp_f32 v9, v9
  v_exp_f32 v11, v11
  v_exp_f32 v13, v13
  v_exp_f32 v15, v15
  s_nop 0
  v_add_f32 v1, 1.0, v1
  v_add_f32 v3, 1.0, v3
  v_add_f32 v5, 1.0, v5
  v_add_f32 v7, 1.0, v7
  v_add_f32 v9, 1.0, v9
  v_add_f32 v11, 1.0, v11
  v_add_f32 v13, 1.0, v13
  v_add_f32 v15, 1.0, v15
  v_rcp_f32 v1, v1
  v_rcp_f32 v3, v3
  v_rcp_f32 v5, v5
  v_rcp_f32 v7, v7
  v_rcp_f32 v9, v9
  v_rcp_f32 v11, v11
  v_rcp_f32 v13, v13
  v_rcp_f32 v15, v15
  s_nop 0
  v_mul_f32_e64 v0, v0, v1
  v_cvt_pk_bf16_f32 v0, v0, v0
  v_and_b32 v0, 0xffff0000, v0
  v_mul_f32_e64 v2, v2, v3
  v_cvt_pk_bf16_f32 v2, v2, v2
  v_and_b32 v2, 0xffff0000, v2
  v_mul_f32_e64 v4, v4, v5
  v_cvt_pk_bf16_f32 v4, v4, v4
  v_and_b32 v4, 0xffff0000, v4
  v_mul_f32_e64 v6, v6, v7
  v_cvt_pk_bf16_f32 v6, v6, v6
  v_and_b32 v6, 0xffff0000, v6
  v_mul_f32_e64 v8, v8, v9
  v_cvt_pk_bf16_f32 v8, v8, v8
  v_and_b32 v8, 0xffff0000, v8
  v_mul_f32_e64 v10, v10, v11
  v_cvt_pk_bf16_f32 v10, v10, v10
  v_and_b32 v10, 0xffff0000, v10
  v_mul_f32_e64 v12, v12, v13
  v_cvt_pk_bf16_f32 v12, v12, v12
  v_and_b32 v12, 0xffff0000, v12
  v_mul_f32_e64 v14, v14, v15
  v_cvt_pk_bf16_f32 v14, v14, v14
  v_and_b32 v14, 0xffff0000, v14
  v_lshlrev_b32_e64 v24, 16, v32
  v_and_b32 v25, 0xffff0000, v32
  v_pk_mul_f32 v[16:17], v[24:25], v[0:1] op_sel_hi:[1,0]
  v_lshlrev_b32_e64 v24, 16, v33
  v_and_b32 v25, 0xffff0000, v33
  v_pk_mul_f32 v[18:19], v[24:25], v[0:1] op_sel_hi:[1,0]
  v_lshlrev_b32_e64 v24, 16, v34
  v_and_b32 v25, 0xffff0000, v34
  v_pk_mul_f32 v[20:21], v[24:25], v[0:1] op_sel_hi:[1,0]
  v_lshlrev_b32_e64 v24, 16, v35
  v_and_b32 v25, 0xffff0000, v35
  v_pk_mul_f32 v[22:23], v[24:25], v[0:1] op_sel_hi:[1,0]
  v_lshlrev_b32_e64 v24, 16, v36
  v_and_b32 v25, 0xffff0000, v36
  v_pk_fma_f32 v[16:17], v[24:25], v[2:3], v[16:17] op_sel_hi:[1,0,1]
  v_lshlrev_b32_e64 v24, 16, v37
  v_and_b32 v25, 0xffff0000, v37
  v_pk_fma_f32 v[18:19], v[24:25], v[2:3], v[18:19] op_sel_hi:[1,0,1]
  v_lshlrev_b32_e64 v24, 16, v38
  v_and_b32 v25, 0xffff0000, v38
  v_pk_fma_f32 v[20:21], v[24:25], v[2:3], v[20:21] op_sel_hi:[1,0,1]
  v_lshlrev_b32_e64 v24, 16, v39
  v_and_b32 v25, 0xffff0000, v39
  v_pk_fma_f32 v[22:23], v[24:25], v[2:3], v[22:23] op_sel_hi:[1,0,1]
  v_lshlrev_b32_e64 v24, 16, v40
  v_and_b32 v25, 0xffff0000, v40
  v_pk_fma_f32 v[16:17], v[24:25], v[4:5], v[16:17] op_sel_hi:[1,0,1]
  v_lshlrev_b32_e64 v24, 16, v41
  v_and_b32 v25, 0xffff0000, v41
  v_pk_fma_f32 v[18:19], v[24:25], v[4:5], v[18:19] op_sel_hi:[1,0,1]
  v_lshlrev_b32_e64 v24, 16, v42
  v_and_b32 v25, 0xffff0000, v42
  v_pk_fma_f32 v[20:21], v[24:25], v[4:5], v[20:21] op_sel_hi:[1,0,1]
  v_lshlrev_b32_e64 v24, 16, v43
  v_and_b32 v25, 0xffff0000, v43
  v_pk_fma_f32 v[22:23], v[24:25], v[4:5], v[22:23] op_sel_hi:[1,0,1]
  v_lshlrev_b32_e64 v24, 16, v44
  v_and_b32 v25, 0xffff0000, v44
  v_pk_fma_f32 v[16:17], v[24:25], v[6:7], v[16:17] op_sel_hi:[1,0,1]
  v_lshlrev_b32_e64 v24, 16, v45
  v_and_b32 v25, 0xffff0000, v45
  v_pk_fma_f32 v[18:19], v[24:25], v[6:7], v[18:19] op_sel_hi:[1,0,1]
  v_lshlrev_b32_e64 v24, 16, v46
  v_and_b32 v25, 0xffff0000, v46
  v_pk_fma_f32 v[20:21], v[24:25], v[6:7], v[20:21] op_sel_hi:[1,0,1]
  v_lshlrev_b32_e64 v24, 16, v47
  v_and_b32 v25, 0xffff0000, v47
  v_pk_fma_f32 v[22:23], v[24:25], v[6:7], v[22:23] op_sel_hi:[1,0,1]
  v_lshlrev_b32_e64 v24, 16, v48
  v_and_b32 v25, 0xffff0000, v48
  v_pk_fma_f32 v[16:17], v[24:25], v[8:9], v[16:17] op_sel_hi:[1,0,1]
  v_lshlrev_b32_e64 v24, 16, v49
  v_and_b32 v25, 0xffff0000, v49
  v_pk_fma_f32 v[18:19], v[24:25], v[8:9], v[18:19] op_sel_hi:[1,0,1]
  v_lshlrev_b32_e64 v24, 16, v50
  v_and_b32 v25, 0xffff0000, v50
  v_pk_fma_f32 v[20:21], v[24:25], v[8:9], v[20:21] op_sel_hi:[1,0,1]
  v_lshlrev_b32_e64 v24, 16, v51
  v_and_b32 v25, 0xffff0000, v51
  v_pk_fma_f32 v[22:23], v[24:25], v[8:9], v[22:23] op_sel_hi:[1,0,1]
  v_lshlrev_b32_e64 v24, 16, v52
  v_and_b32 v25, 0xffff0000, v52
  v_pk_fma_f32 v[16:17], v[24:25], v[10:11], v[16:17] op_sel_hi:[1,0,1]
  v_lshlrev_b32_e64 v24, 16, v53
  v_and_b32 v25, 0xffff0000, v53
  v_pk_fma_f32 v[18:19], v[24:25], v[10:11], v[18:19] op_sel_hi:[1,0,1]
  v_lshlrev_b32_e64 v24, 16, v54
  v_and_b32 v25, 0xffff0000, v54
  v_pk_fma_f32 v[20:21], v[24:25], v[10:11], v[20:21] op_sel_hi:[1,0,1]
  v_lshlrev_b32_e64 v24, 16, v55
  v_and_b32 v25, 0xffff0000, v55
  v_pk_fma_f32 v[22:23], v[24:25], v[10:11], v[22:23] op_sel_hi:[1,0,1]
  v_lshlrev_b32_e64 v24, 16, v56
  v_and_b32 v25, 0xffff0000, v56
  v_pk_fma_f32 v[16:17], v[24:25], v[12:13], v[16:17] op_sel_hi:[1,0,1]
  v_lshlrev_b32_e64 v24, 16, v57
  v_and_b32 v25, 0xffff0000, v57
  v_pk_fma_f32 v[18:19], v[24:25], v[12:13], v[18:19] op_sel_hi:[1,0,1]
  v_lshlrev_b32_e64 v24, 16, v58
  v_and_b32 v25, 0xffff0000, v58
  v_pk_fma_f32 v[20:21], v[24:25], v[12:13], v[20:21] op_sel_hi:[1,0,1]
  v_lshlrev_b32_e64 v24, 16, v59
  v_and_b32 v25, 0xffff0000, v59
  v_pk_fma_f32 v[22:23], v[24:25], v[12:13], v[22:23] op_sel_hi:[1,0,1]
  v_lshlrev_b32_e64 v24, 16, v60
  v_and_b32 v25, 0xffff0000, v60
  v_pk_fma_f32 v[16:17], v[24:25], v[14:15], v[16:17] op_sel_hi:[1,0,1]
  v_lshlrev_b32_e64 v24, 16, v61
  v_and_b32 v25, 0xffff0000, v61
  v_pk_fma_f32 v[18:19], v[24:25], v[14:15], v[18:19] op_sel_hi:[1,0,1]
  v_lshlrev_b32_e64 v24, 16, v62
  v_and_b32 v25, 0xffff0000, v62
  v_pk_fma_f32 v[20:21], v[24:25], v[14:15], v[20:21] op_sel_hi:[1,0,1]
  v_lshlrev_b32_e64 v24, 16, v63
  v_and_b32 v25, 0xffff0000, v63
  v_pk_fma_f32 v[22:23], v[24:25], v[14:15], v[22:23] op_sel_hi:[1,0,1]
  s_nop 1
  v_permlane32_swap_b32 v16, v20
  v_permlane32_swap_b32 v17, v21
  v_permlane32_swap_b32 v18, v22
  v_permlane32_swap_b32 v19, v23
  s_nop 1
  v_add_f32 v16, v16, v20
  v_add_f32 v17, v17, v21
  v_add_f32 v18, v18, v22
  v_add_f32 v19, v19, v23
  s_nop 1
  v_permlane16_swap_b32 v16, v18
  v_permlane16_swap_b32 v17, v19
  s_nop 1
  v_add_f32 v16, v16, v18
  v_add_f32 v17, v17, v19
  s_nop 0
  s_nop 0
  v_add_f32_dpp v16, v16, v16 row_ror:8 row_mask:0xf bank_mask:0xf
  v_add_f32_dpp v17, v17, v17 row_ror:8 row_mask:0xf bank_mask:0xf
  v_and_b32 v24, 7, v104
  v_lshlrev_b32 v24, 5, v24
  v_lshrrev_b32_e64 v25, 5, v104
  v_lshl_add_u32 v24, v25, 4, v24
  v_bfe_u32 v25, v104, 4, 1
  v_lshl_add_u32 v24, v25, 3, v24
  s_mov_b32 s52, s28
  s_mov_b32 s53, s29
  s_mov_b32 s54, 409600
  s_mov_b32 s55, 0x20000
  v_or_b32 v16, 1, v16
  v_or_b32 v17, 1, v17
  buffer_store_dwordx2 v[16:17], v24, s[52:55], s79 offen sc1
  v_and_b32 v252, 15, v104
  v_lshlrev_b32 v252, 6, v252
  s_lshl_b32 s84, s26, 2
  s_add_u32 s84, s84, s3
  s_lshl_b32 s84, s84, 10
  s_add_u32 s85, s84, 131072
  s_add_u32 s94, s85, 327680
  s_mov_b32 s97, 0
  s_add_u32 s80, s20, 0
  s_and_b32 s80, s80, 7
  s_lshl_b32 s81, s80, 1
  s_lshl_b32 s81, 3, s81
  s_or_b32 s97, s97, s81
  s_add_u32 s80, s20, 1
  s_and_b32 s80, s80, 7
  s_lshl_b32 s81, s80, 1
  s_lshl_b32 s81, 3, s81
  s_or_b32 s97, s97, s81
  s_add_u32 s80, s20, 2
  s_and_b32 s80, s80, 7
  s_lshl_b32 s81, s80, 1
  s_lshl_b32 s81, 3, s81
  s_or_b32 s97, s97, s81
  s_add_u32 s80, s20, 3
  s_and_b32 s80, s80, 7
  s_lshl_b32 s81, s80, 1
  s_lshl_b32 s81, 3, s81
  s_or_b32 s97, s97, s81
  s_add_u32 s80, s20, 4
  s_and_b32 s80, s80, 7
  s_lshl_b32 s81, s80, 1
  s_lshl_b32 s81, 3, s81
  s_or_b32 s97, s97, s81
  buffer_load_dword v253, v252, s[56:59], s85 offen sc1
  v_mov_b32 v26, 1
  v_mov_b32 v27, 0
  s_waitcnt vmcnt(1)
  buffer_store_dword v26, v27, s[56:59], s95 offen sc1
  s_waitcnt vmcnt(1)
  v_cmp_eq_u32 vcc, 0, v253
  s_nop 0
  s_and_b32 s81, vcc_lo, s97
  s_cbranch_scc0 L_ok_24
  s_mov_b32 s96, 0
L_poll_23:
  buffer_load_dword v253, v252, s[56:59], s85 offen sc1
  s_waitcnt vmcnt(0)
  v_cmp_eq_u32 vcc, 0, v253
  s_add_u32 s96, s96, 1
  s_and_b32 s81, vcc_lo, s97
  s_cbranch_scc0 L_ok_24
  s_sleep 2
  s_cmp_lt_u32 s96, 0x200000
  s_cbranch_scc1 L_poll_23
L_ok_24:
  s_add_u32 s62, s20, 0
  s_and_b32 s62, s62, 7
  s_lshl_b32 s62, s62, 12
  buffer_load_dwordx4 a[64:67], v112, s[36:39], s62 offen offset:0 sc1
  buffer_load_dwordx4 a[68:71], v113, s[36:39], s62 offen offset:0 sc1
  buffer_load_dwordx4 a[72:75], v112, s[36:39], s62 offen offset:2048 sc1
  buffer_load_dwordx4 a[76:79], v113, s[36:39], s62 offen offset:2048 sc1
  s_add_u32 s63, s20, 1
  s_and_b32 s63, s63, 7
  s_lshl_b32 s63, s63, 12
  buffer_load_dwordx4 a[80:83], v112, s[36:39], s63 offen offset:0 sc1
  buffer_load_dwordx4 a[84:87], v113, s[36:39], s63 offen offset:0 sc1
  buffer_load_dwordx4 a[88:91], v112, s[36:39], s63 offen offset:2048 sc1
  buffer_load_dwordx4 a[92:95], v113, s[36:39], s63 offen offset:2048 sc1
  s_add_u32 s62, s20, 2
  s_and_b32 s62, s62, 7
  s_lshl_b32 s62, s62, 12
  buffer_load_dwordx4 a[96:99], v112, s[36:39], s62 offen offset:0 sc1
  buffer_load_dwordx4 a[100:103], v113, s[36:39], s62 offen offset:0 sc1
  buffer_load_dwordx4 a[104:107], v112, s[36:39], s62 offen offset:2048 sc1
  buffer_load_dwordx4 a[108:111], v113, s[36:39], s62 offen offset:2048 sc1
  s_add_u32 s40, s28, 50331648
  s_addc_u32 s41, s29, 0
  s_mov_b32 s42, 4194304
  s_mov_b32 s43, 0x20000
  s_add_u32 s44, s28, 2097152
  s_addc_u32 s45, s29, 0
  s_mov_b32 s46, 262144
  s_mov_b32 s47, 0x20000
  s_mov_b32 s52, s28
  s_mov_b32 s53, s29
  s_mov_b32 s54, 409600
  s_mov_b32 s55, 0x20000
  v_lshrrev_b32 v44, 4, v104
  v_lshlrev_b32 v44, 4, v44
  v_add_u32 v44, 128000, v44
  s_lshl_b32 s86, s26, 3
  s_lshl_b32 s87, s3, 1
  s_add_u32 s86, s86, s87
  s_lshl_b32 s88, s86, 15
  s_lshl_b32 s87, s27, 11
  s_add_u32 s88, s88, s87
  s_add_u32 s89, s88, 32768
  s_lshl_b32 s87, s27, 6
  s_add_u32 s84, s84, s87
  s_add_u32 s84, s84, 196608
  s_lshl_b32 s91, s86, 11
  s_lshl_b32 s90, s27, 8
  s_add_u32 s90, s90, s91
  s_lshl_b32 s92, s3, 16
  s_lshl_b32 s93, s27, 12
  s_add_u32 s92, s92, s93
  s_add_u32 s92, s92, 131072
  v_lshlrev_b32_e64 v40, 2, v104
  v_add_u32 v42, -62208, v110
  v_add_u32 v43, -128768, v110
  s_waitcnt vmcnt(12)
  s_barrier
  ds_read_b64_tr_b16 a[0:1], v110 offset:0
  ds_read_b64_tr_b16 a[2:3], v110 offset:512
  ds_read_b64_tr_b16 a[4:5], v110 offset:32
  ds_read_b64_tr_b16 a[6:7], v110 offset:544
  ds_read_b64_tr_b16 a[8:9], v110 offset:64
  ds_read_b64_tr_b16 a[10:11], v110 offset:576
  ds_read_b64_tr_b16 a[12:13], v110 offset:96
  ds_read_b64_tr_b16 a[14:15], v110 offset:608
  ds_read_b64_tr_b16 a[16:17], v110 offset:4224
  ds_read_b64_tr_b16 a[18:19], v110 offset:4736
  ds_read_b64_tr_b16 a[20:21], v110 offset:4256
  ds_read_b64_tr_b16 a[22:23], v110 offset:4768
  ds_read_b64_tr_b16 a[24:25], v110 offset:4288
  ds_read_b64_tr_b16 a[26:27], v110 offset:4800
  ds_read_b64_tr_b16 a[28:29], v110 offset:4320
  ds_read_b64_tr_b16 a[30:31], v110 offset:4832
  s_waitcnt vmcnt(8) lgkmcnt(0)
  v_mfma_f32_16x16x32_bf16 v[0:3], a[0:3], a[64:67], 0
  s_waitcnt vmcnt(12)
  s_barrier
  v_mfma_f32_16x16x32_bf16 v[4:7], a[0:3], a[68:71], 0
  ds_read_b64_tr_b16 a[32:33], v110 offset:8448
  s_add_u32 s63, s20, 3
  ds_read_b64_tr_b16 a[34:35], v110 offset:8960
  v_mfma_f32_16x16x32_bf16 v[12:15], a[4:7], a[68:71], 0
  ds_read_b64_tr_b16 a[36:37], v110 offset:8480
  s_and_b32 s63, s63, 7
  v_mfma_f32_16x16x32_bf16 v[8:11], a[4:7], a[64:67], 0
  ds_read_b64_tr_b16 a[38:39], v110 offset:8992
  s_lshl_b32 s63, s63, 12
  ds_read_b64_tr_b16 a[40:41], v110 offset:8512
  v_mfma_f32_16x16x32_bf16 v[16:19], a[8:11], a[64:67], 0
  ds_read_b64_tr_b16 a[42:43], v110 offset:9024
  buffer_load_dwordx4 a[112:115], v112, s[36:39], s63 offen offset:0 sc1
  v_mfma_f32_16x16x32_bf16 v[20:23], a[8:11], a[68:71], 0
  ds_read_b64_tr_b16 a[44:45], v110 offset:8544
  s_add_u32 s60, s20, 4
  ds_read_b64_tr_b16 a[46:47], v110 offset:9056
  v_mfma_f32_16x16x32_bf16 v[28:31], a[12:15], a[68:71], 0
  ds_read_b64_tr_b16 a[48:49], v110 offset:12672
  s_and_b32 s60, s60, 7
  v_mfma_f32_16x16x32_bf16 v[24:27], a[12:15], a[64:67], 0
  ds_read_b64_tr_b16 a[50:51], v110 offset:13184
  s_mul_i32 s60, s60, 262144
  ds_read_b64_tr_b16 a[52:53], v110 offset:12704
  v_mfma_f32_16x16x32_bf16 v[0:3], a[16:19], a[72:75], v[0:3]
  s_add_u32 m0, s76, 0
  ds_read_b64_tr_b16 a[54:55], v110 offset:13216
  v_mfma_f32_16x16x32_bf16 v[4:7], a[16:19], a[76:79], v[4:7]
  ds_read_b64_tr_b16 a[56:57], v110 offset:12736
  buffer_load_dwordx4 v111, s[32:35], s60 offen lds
  ds_read_b64_tr_b16 a[58:59], v110 offset:13248
  v_mfma_f32_16x16x32_bf16 v[12:15], a[20:23], a[76:79], v[12:15]
  v_readlane_b32 s61, v98, 5
  ds_read_b64_tr_b16 a[60:61], v110 offset:12768
  v_mfma_f32_16x16x32_bf16 v[8:11], a[20:23], a[72:75], v[8:11]
  ds_read_b64_tr_b16 a[62:63], v110 offset:13280
  buffer_load_dwordx4 a[116:119], v113, s[36:39], s63 offen offset:0 sc1
  v_mfma_f32_16x16x32_bf16 v[16:19], a[24:27], a[72:75], v[16:19]
  v_mfma_f32_16x16x32_bf16 v[20:23], a[24:27], a[76:79], v[20:23]
  buffer_load_dwordx4 v101, s[32:35], s60 offen offset:1056 lds
  v_mfma_f32_16x16x32_bf16 v[28:31], a[28:31], a[76:79], v[28:31]
  buffer_load_dwordx4 a[120:123], v112, s[36:39], s63 offen offset:2048 sc1
  v_mfma_f32_16x16x32_bf16 v[24:27], a[28:31], a[72:75], v[24:27]
  buffer_load_dwordx4 a[124:127], v113, s[36:39], s63 offen offset:2048 sc1
  s_waitcnt vmcnt(10) lgkmcnt(0)
  v_mfma_f32_16x16x32_bf16 v[0:3], a[32:35], a[80:83], v[0:3]
  s_waitcnt vmcnt(18)
  s_barrier
  v_mfma_f32_16x16x32_bf16 v[4:7], a[32:35], a[84:87], v[4:7]
  ds_read_b64_tr_b16 a[0:1], v110 offset:16896
  buffer_load_dword v253, v252, s[56:59], s85 offen sc1
  v_mfma_f32_16x16x32_bf16 v[12:15], a[36:39], a[84:87], v[12:15]
  ds_read_b64_tr_b16 a[2:3], v110 offset:17408
  ds_read_b64_tr_b16 a[4:5], v110 offset:16928
  v_mfma_f32_16x16x32_bf16 v[8:11], a[36:39], a[80:83], v[8:11]
  s_add_u32 s62, s20, 4
  ds_read_b64_tr_b16 a[6:7], v110 offset:17440
  v_mfma_f32_16x16x32_bf16 v[16:19], a[40:43], a[80:83], v[16:19]
  s_and_b32 s62, s62, 7
  ds_read_b64_tr_b16 a[8:9], v110 offset:16960
  v_mfma_f32_16x16x32_bf16 v[20:23], a[40:43], a[84:87], v[20:23]
  ds_read_b64_tr_b16 a[10:11], v110 offset:17472
  s_lshl_b32 s62, s62, 12
  v_mfma_f32_16x16x32_bf16 v[28:31], a[44:47], a[84:87], v[28:31]
  ds_read_b64_tr_b16 a[12:13], v110 offset:16992
  ds_read_b64_tr_b16 a[14:15], v110 offset:17504
  v_mfma_f32_16x16x32_bf16 v[24:27], a[44:47], a[80:83], v[24:27]
  buffer_load_dwordx4 a[64:67], v112, s[36:39], s62 offen offset:0 sc1
  ds_read_b64_tr_b16 a[16:17], v110 offset:21120
  v_mfma_f32_16x16x32_bf16 v[0:3], a[48:51], a[88:91], v[0:3]
  v_readlane_b32 s63, v99, 5
  ds_read_b64_tr_b16 a[18:19], v110 offset:21632
  v_mfma_f32_16x16x32_bf16 v[4:7], a[48:51], a[92:95], v[4:7]
  ds_read_b64_tr_b16 a[20:21], v110 offset:21152
  s_add_u32 m0, s76, 8448
  v_mfma_f32_16x16x32_bf16 v[12:15], a[52:55], a[92:95], v[12:15]
  ds_read_b64_tr_b16 a[22:23], v110 offset:21664
  buffer_load_dwordx4 v111, s[32:35], s61 offen lds
  v_mfma_f32_16x16x32_bf16 v[8:11], a[52:55], a[88:91], v[8:11]
  ds_read_b64_tr_b16 a[24:25], v110 offset:21184
  ds_read_b64_tr_b16 a[26:27], v110 offset:21696
  v_mfma_f32_16x16x32_bf16 v[16:19], a[56:59], a[88:91], v[16:19]
  v_readlane_b32 s60, v98, 6
  ds_read_b64_tr_b16 a[28:29], v110 offset:21216
  v_mfma_f32_16x16x32_bf16 v[20:23], a[56:59], a[92:95], v[20:23]
  buffer_load_dwordx4 a[68:71], v113, s[36:39], s62 offen offset:0 sc1
  ds_read_b64_tr_b16 a[30:31], v110 offset:21728
  v_mfma_f32_16x16x32_bf16 v[28:31], a[60:63], a[92:95], v[28:31]
  s_nop 0
  buffer_load_dwordx4 v101, s[32:35], s61 offen offset:1056 lds
  v_mfma_f32_16x16x32_bf16 v[24:27], a[60:63], a[88:91], v[24:27]
  buffer_load_dwordx4 a[72:75], v112, s[36:39], s62 offen offset:2048 sc1
  buffer_load_dwordx4 a[76:79], v113, s[36:39], s62 offen offset:2048 sc1
  s_waitcnt vmcnt(13) lgkmcnt(0)
  v_mfma_f32_16x16x32_bf16 v[0:3], a[0:3], a[96:99], v[0:3]
  s_waitcnt vmcnt(25)
  s_barrier
  v_mfma_f32_16x16x32_bf16 v[4:7], a[0:3], a[100:103], v[4:7]
  ds_read_b64_tr_b16 a[32:33], v110 offset:25344
  s_waitcnt vmcnt(6)
  v_mfma_f32_16x16x32_bf16 v[12:15], a[4:7], a[100:103], v[12:15]
  ds_read_b64_tr_b16 a[34:35], v110 offset:25856
  ds_read_b64_tr_b16 a[36:37], v110 offset:25376
  v_mfma_f32_16x16x32_bf16 v[8:11], a[4:7], a[96:99], v[8:11]
  v_cmp_eq_u32 vcc, 0, v253
  s_cmp_eq_u64 vcc, 0
  s_cbranch_scc1 L_gok_25
  s_mov_b32 s96, 0
L_poll_26:
  buffer_load_dword v253, v252, s[56:59], s85 offen sc1
  s_waitcnt vmcnt(0)
  v_cmp_eq_u32 vcc, 0, v253
  s_add_u32 s96, s96, 1
  s_cmp_eq_u64 vcc, 0
  s_cbranch_scc1 L_ok_27
  s_sleep 2
  s_cmp_lt_u32 s96, 0x200000
  s_cbranch_scc1 L_poll_26
L_ok_27:
L_gok_25:
  ds_read_b64_tr_b16 a[38:39], v110 offset:25888
  v_mfma_f32_16x16x32_bf16 v[16:19], a[8:11], a[96:99], v[16:19]
  ds_read_b64_tr_b16 a[40:41], v110 offset:25408
  buffer_load_dwordx4 a[80:83], v112, s[36:39], s63 offen offset:0 sc1
  v_mfma_f32_16x16x32_bf16 v[20:23], a[8:11], a[100:103], v[20:23]
  ds_read_b64_tr_b16 a[42:43], v110 offset:25920
  ds_read_b64_tr_b16 a[44:45], v110 offset:25440
  v_mfma_f32_16x16x32_bf16 v[28:31], a[12:15], a[100:103], v[28:31]
  v_readlane_b32 s62, v99, 6
  ds_read_b64_tr_b16 a[46:47], v110 offset:25952
  v_mfma_f32_16x16x32_bf16 v[24:27], a[12:15], a[96:99], v[24:27]
  ds_read_b64_tr_b16 a[48:49], v110 offset:29568
  s_add_u32 m0, s76, 16896
  v_mfma_f32_16x16x32_bf16 v[0:3], a[16:19], a[104:107], v[0:3]
  ds_read_b64_tr_b16 a[50:51], v110 offset:30080
  ds_read_b64_tr_b16 a[52:53], v110 offset:29600
  v_mfma_f32_16x16x32_bf16 v[4:7], a[16:19], a[108:111], v[4:7]
  buffer_load_dwordx4 v111, s[32:35], s60 offen lds
  ds_read_b64_tr_b16 a[54:55], v110 offset:30112
  v_mfma_f32_16x16x32_bf16 v[12:15], a[20:23], a[108:111], v[12:15]
  v_readlane_b32 s61, v98, 7
  ds_read_b64_tr_b16 a[56:57], v110 offset:29632
  v_mfma_f32_16x16x32_bf16 v[8:11], a[20:23], a[104:107], v[8:11]
  ds_read_b64_tr_b16 a[58:59], v110 offset:30144
  buffer_load_dwordx4 a[84:87], v113, s[36:39], s63 offen offset:0 sc1
  v_mfma_f32_16x16x32_bf16 v[16:19], a[24:27], a[104:107], v[16:19]
  ds_read_b64_tr_b16 a[60:61], v110 offset:29664
  ds_read_b64_tr_b16 a[62:63], v110 offset:30176
  v_mfma_f32_16x16x32_bf16 v[20:23], a[24:27], a[108:111], v[20:23]
  s_nop 0
  buffer_load_dwordx4 v101, s[32:35], s60 offen offset:1056 lds
  v_mfma_f32_16x16x32_bf16 v[28:31], a[28:31], a[108:111], v[28:31]
  buffer_load_dwordx4 a[88:91], v112, s[36:39], s63 offen offset:2048 sc1
  v_mfma_f32_16x16x32_bf16 v[24:27], a[28:31], a[104:107], v[24:27]
  buffer_load_dwordx4 a[92:95], v113, s[36:39], s63 offen offset:2048 sc1
  s_waitcnt vmcnt(13) lgkmcnt(0)
  v_mfma_f32_16x16x32_bf16 v[0:3], a[32:35], a[112:115], v[0:3]
  s_waitcnt vmcnt(15)
  s_barrier
  v_mfma_f32_16x16x32_bf16 v[4:7], a[32:35], a[116:119], v[4:7]
  ds_read_b64_tr_b16 a[0:1], v110 offset:0
  ds_read_b64_tr_b16 a[2:3], v110 offset:512
  v_mfma_f32_16x16x32_bf16 v[12:15], a[36:39], a[116:119], v[12:15]
  buffer_load_dwordx4 a[96:99], v112, s[36:39], s62 offen offset:0 sc1
  ds_read_b64_tr_b16 a[4:5], v110 offset:32
  v_mfma_f32_16x16x32_bf16 v[8:11], a[36:39], a[112:115], v[8:11]
  ds_read_b64_tr_b16 a[6:7], v110 offset:544
  v_readlane_b32 s63, v99, 7
  v_mfma_f32_16x16x32_bf16 v[16:19], a[40:43], a[112:115], v[16:19]
  ds_read_b64_tr_b16 a[8:9], v110 offset:64
  ds_read_b64_tr_b16 a[10:11], v110 offset:576
  v_mfma_f32_16x16x32_bf16 v[20:23], a[40:43], a[116:119], v[20:23]
  s_add_u32 m0, s76, 25344
  ds_read_b64_tr_b16 a[12:13], v110 offset:96
  v_mfma_f32_16x16x32_bf16 v[28:31], a[44:47], a[116:119], v[28:31]
  ds_read_b64_tr_b16 a[14:15], v110 offset:608
  buffer_load_dwordx4 v111, s[32:35], s61 offen lds
  v_mfma_f32_16x16x32_bf16 v[24:27], a[44:47], a[112:115], v[24:27]
  ds_read_b64_tr_b16 a[16:17], v110 offset:4224
  ds_read_b64_tr_b16 a[18:19], v110 offset:4736
  v_mfma_f32_16x16x32_bf16 v[0:3], a[48:51], a[120:123], v[0:3]
  v_readlane_b32 s60, v98, 8
  ds_read_b64_tr_b16 a[20:21], v110 offset:4256
  v_mfma_f32_16x16x32_bf16 v[4:7], a[48:51], a[124:127], v[4:7]
  ds_read_b64_tr_b16 a[22:23], v110 offset:4768
  ds_read_b64_tr_b16 a[24:25], v110 offset:4288
  v_mfma_f32_16x16x32_bf16 v[12:15], a[52:55], a[124:127], v[12:15]
  buffer_load_dwordx4 a[100:103], v113, s[36:39], s62 offen offset:0 sc1
  ds_read_b64_tr_b16 a[26:27], v110 offset:4800
  v_mfma_f32_16x16x32_bf16 v[8:11], a[52:55], a[120:123], v[8:11]
  ds_read_b64_tr_b16 a[28:29], v110 offset:4320
  v_mfma_f32_16x16x32_bf16 v[16:19], a[56:59], a[120:123], v[16:19]
  ds_read_b64_tr_b16 a[30:31], v110 offset:4832
  buffer_load_dwordx4 v101, s[32:35], s61 offen offset:1056 lds
  v_mfma_f32_16x16x32_bf16 v[20:23], a[56:59], a[124:127], v[20:23]
  buffer_load_dwordx4 a[104:107], v112, s[36:39], s62 offen offset:2048 sc1
  v_mfma_f32_16x16x32_bf16 v[28:31], a[60:63], a[124:127], v[28:31]
  v_mfma_f32_16x16x32_bf16 v[24:27], a[60:63], a[120:123], v[24:27]
  buffer_load_dwordx4 a[108:111], v113, s[36:39], s62 offen offset:2048 sc1
  s_waitcnt vmcnt(12) lgkmcnt(0)
  v_mfma_f32_16x16x32_bf16 v[0:3], a[0:3], a[64:67], v[0:3]
  s_waitcnt vmcnt(14)
  s_barrier
  v_mfma_f32_16x16x32_bf16 v[4:7], a[0:3], a[68:71], v[4:7]
  ds_read_b64_tr_b16 a[32:33], v110 offset:8448
  buffer_load_dword v253, v252, s[56:59], s94 offen sc1
  v_mfma_f32_16x16x32_bf16 v[12:15], a[4:7], a[68:71], v[12:15]
  ds_read_b64_tr_b16 a[34:35], v110 offset:8960
  ds_read_b64_tr_b16 a[36:37], v110 offset:8480
  v_mfma_f32_16x16x32_bf16 v[8:11], a[4:7], a[64:67], v[8:11]
  buffer_load_dwordx4 a[112:115], v112, s[36:39], s63 offen offset:0 sc1
  ds_read_b64_tr_b16 a[38:39], v110 offset:8992
  v_mfma_f32_16x16x32_bf16 v[16:19], a[8:11], a[64:67], v[16:19]
  ds_read_b64_tr_b16 a[40:41], v110 offset:8512
  v_readlane_b32 s62, v99, 8
  v_mfma_f32_16x16x32_bf16 v[20:23], a[8:11], a[68:71], v[20:23]
  ds_read_b64_tr_b16 a[42:43], v110 offset:9024
  ds_read_b64_tr_b16 a[44:45], v110 offset:8544
  v_mfma_f32_16x16x32_bf16 v[28:31], a[12:15], a[68:71], v[28:31]
  s_add_u32 m0, s76, 0
  ds_read_b64_tr_b16 a[46:47], v110 offset:9056
  v_mfma_f32_16x16x32_bf16 v[24:27], a[12:15], a[64:67], v[24:27]
  ds_read_b64_tr_b16 a[48:49], v110 offset:12672
  buffer_load_dwordx4 v111, s[32:35], s60 offen lds
  v_mfma_f32_16x16x32_bf16 v[0:3], a[16:19], a[72:75], v[0:3]
  ds_read_b64_tr_b16 a[50:51], v110 offset:13184
  ds_read_b64_tr_b16 a[52:53], v110 offset:12704
  v_mfma_f32_16x16x32_bf16 v[4:7], a[16:19], a[76:79], v[4:7]
  v_readlane_b32 s61, v98, 9
  ds_read_b64_tr_b16 a[54:55], v110 offset:13216
  v_mfma_f32_16x16x32_bf16 v[12:15], a[20:23], a[76:79], v[12:15]
  ds_read_b64_tr_b16 a[56:57], v110 offset:12736
  buffer_load_dwordx4 a[116:119], v113, s[36:39], s63 offen offset:0 sc1
  v_mfma_f32_16x16x32_bf16 v[8:11], a[20:23], a[72:75], v[8:11]
  ds_read_b64_tr_b16 a[58:59], v110 offset:13248
  ds_read_b64_tr_b16 a[60:61], v110 offset:12768
  v_mfma_f32_16x16x32_bf16 v[16:19], a[24:27], a[72:75], v[16:19]
  ds_read_b64_tr_b16 a[62:63], v110 offset:13280
  v_mfma_f32_16x16x32_bf16 v[20:23], a[24:27], a[76:79], v[20:23]
  buffer_load_dwordx4 v101, s[32:35], s60 offen offset:1056 lds
  buffer_load_dwordx4 a[120:123], v112, s[36:39], s63 offen offset:2048 sc1
  v_mfma_f32_16x16x32_bf16 v[28:31], a[28:31], a[76:79], v[28:31]
  v_mfma_f32_16x16x32_bf16 v[24:27], a[28:31], a[72:75], v[24:27]
  buffer_load_dwordx4 a[124:127], v113, s[36:39], s63 offen offset:2048 sc1
  s_waitcnt vmcnt(13) lgkmcnt(0)
  v_mfma_f32_16x16x32_bf16 v[0:3], a[32:35], a[80:83], v[0:3]
  s_waitcnt vmcnt(15)
  s_barrier
  v_mfma_f32_16x16x32_bf16 v[4:7], a[32:35], a[84:87], v[4:7]
  ds_read_b64_tr_b16 a[0:1], v110 offset:16896
  s_waitcnt vmcnt(6)
  v_mfma_f32_16x16x32_bf16 v[12:15], a[36:39], a[84:87], v[12:15]
  ds_read_b64_tr_b16 a[2:3], v110 offset:17408
  ds_read_b64_tr_b16 a[4:5], v110 offset:16928
  v_mfma_f32_16x16x32_bf16 v[8:11], a[36:39], a[80:83], v[8:11]
  v_cmp_eq_u32 vcc, 0, v253
  s_cmp_eq_u64 vcc, 0
  s_cbranch_scc1 L_gok_28
  s_mov_b32 s96, 0
L_poll_29:
  buffer_load_dword v253, v252, s[56:59], s94 offen sc1
  s_waitcnt vmcnt(0)
  v_cmp_eq_u32 vcc, 0, v253
  s_add_u32 s96, s96, 1
  s_cmp_eq_u64 vcc, 0
  s_cbranch_scc1 L_ok_30
  s_sleep 2
  s_cmp_lt_u32 s96, 0x200000
  s_cbranch_scc1 L_poll_29
L_ok_30:
L_gok_28:
  ds_read_b64_tr_b16 a[6:7], v110 offset:17440
  v_mfma_f32_16x16x32_bf16 v[16:19], a[40:43], a[80:83], v[16:19]
  ds_read_b64_tr_b16 a[8:9], v110 offset:16960
  buffer_load_dwordx4 a[64:67], v112, s[36:39], s62 offen offset:0 sc1
  v_mfma_f32_16x16x32_bf16 v[20:23], a[40:43], a[84:87], v[20:23]
  ds_read_b64_tr_b16 a[10:11], v110 offset:17472
  ds_read_b64_tr_b16 a[12:13], v110 offset:16992
  v_mfma_f32_16x16x32_bf16 v[28:31], a[44:47], a[84:87], v[28:31]
  v_readlane_b32 s63, v99, 9
  ds_read_b64_tr_b16 a[14:15], v110 offset:17504
  v_mfma_f32_16x16x32_bf16 v[24:27], a[44:47], a[80:83], v[24:27]
  ds_read_b64_tr_b16 a[16:17], v110 offset:21120
  s_add_u32 m0, s76, 8448
  v_mfma_f32_16x16x32_bf16 v[0:3], a[48:51], a[88:91], v[0:3]
  ds_read_b64_tr_b16 a[18:19], v110 offset:21632
  ds_read_b64_tr_b16 a[20:21], v110 offset:21152
  v_mfma_f32_16x16x32_bf16 v[4:7], a[48:51], a[92:95], v[4:7]
  buffer_load_dwordx4 v111, s[32:35], s61 offen lds
  ds_read_b64_tr_b16 a[22:23], v110 offset:21664
  v_mfma_f32_16x16x32_bf16 v[12:15], a[52:55], a[92:95], v[12:15]
  v_readlane_b32 s60, v98, 10
  ds_read_b64_tr_b16 a[24:25], v110 offset:21184
  v_mfma_f32_16x16x32_bf16 v[8:11], a[52:55], a[88:91], v[8:11]
  ds_read_b64_tr_b16 a[26:27], v110 offset:21696
  buffer_load_dwordx4 a[68:71], v113, s[36:39], s62 offen offset:0 sc1
  v_mfma_f32_16x16x32_bf16 v[16:19], a[56:59], a[88:91], v[16:19]
  ds_read_b64_tr_b16 a[28:29], v110 offset:21216
  ds_read_b64_tr_b16 a[30:31], v110 offset:21728
  v_mfma_f32_16x16x32_bf16 v[20:23], a[56:59], a[92:95], v[20:23]
  s_nop 0
  buffer_load_dwordx4 v101, s[32:35], s61 offen offset:1056 lds
  v_mfma_f32_16x16x32_bf16 v[28:31], a[60:63], a[92:95], v[28:31]
  buffer_load_dwordx4 a[72:75], v112, s[36:39], s62 offen offset:2048 sc1
  v_mfma_f32_16x16x32_bf16 v[24:27], a[60:63], a[88:91], v[24:27]
  buffer_load_dwordx4 a[76:79], v113, s[36:39], s62 offen offset:2048 sc1
  s_waitcnt vmcnt(13) lgkmcnt(0)
  v_mfma_f32_16x16x32_bf16 v[0:3], a[0:3], a[96:99], v[0:3]
  s_waitcnt vmcnt(15)
  s_barrier
  v_mfma_f32_16x16x32_bf16 v[4:7], a[0:3], a[100:103], v[4:7]
  ds_read_b64_tr_b16 a[32:33], v110 offset:25344
  buffer_load_dwordx4 a[80:83], v112, s[36:39], s63 offen offset:0 sc1
  ds_read_b64_tr_b16 a[34:35], v110 offset:25856
  v_mfma_f32_16x16x32_bf16 v[12:15], a[4:7], a[100:103], v[12:15]
  ds_read_b64_tr_b16 a[36:37], v110 offset:25376
  v_readlane_b32 s62, v99, 10
  v_mfma_f32_16x16x32_bf16 v[8:11], a[4:7], a[96:99], v[8:11]
  ds_read_b64_tr_b16 a[38:39], v110 offset:25888
  s_add_u32 m0, s76, 16896
  ds_read_b64_tr_b16 a[40:41], v110 offset:25408
  v_mfma_f32_16x16x32_bf16 v[16:19], a[8:11], a[96:99], v[16:19]
  buffer_load_dwordx4 v111, s[32:35], s60 offen lds
  ds_read_b64_tr_b16 a[42:43], v110 offset:25920
  v_mfma_f32_16x16x32_bf16 v[20:23], a[8:11], a[100:103], v[20:23]
  ds_read_b64_tr_b16 a[44:45], v110 offset:25440
  v_readlane_b32 s61, v98, 11
  ds_read_b64_tr_b16 a[46:47], v110 offset:25952
  v_mfma_f32_16x16x32_bf16 v[28:31], a[12:15], a[100:103], v[28:31]
  buffer_load_dwordx4 a[84:87], v113, s[36:39], s63 offen offset:0 sc1
  ds_read_b64_tr_b16 a[48:49], v110 offset:29568
  v_mfma_f32_16x16x32_bf16 v[24:27], a[12:15], a[96:99], v[24:27]
  ds_read_b64_tr_b16 a[50:51], v110 offset:30080
  ds_read_b64_tr_b16 a[52:53], v110 offset:29600
  v_mfma_f32_16x16x32_bf16 v[0:3], a[16:19], a[104:107], v[0:3]
  buffer_load_dwordx4 v101, s[32:35], s60 offen offset:1056 lds
  ds_read_b64_tr_b16 a[54:55], v110 offset:30112
  buffer_load_dwordx4 a[88:91], v112, s[36:39], s63 offen offset:2048 sc1
  v_mfma_f32_16x16x32_bf16 v[4:7], a[16:19], a[108:111], v[4:7]
  ds_read_b64_tr_b16 a[56:57], v110 offset:29632
  buffer_load_dwordx4 a[92:95], v113, s[36:39], s63 offen offset:2048 sc1
  ds_read_b64_tr_b16 a[58:59], v110 offset:30144
  v_mfma_f32_16x16x32_bf16 v[12:15], a[20:23], a[108:111], v[12:15]
  ds_read_b64_tr_b16 a[60:61], v110 offset:29664
  s_lshl_b32 s80, s31, 2
  v_mfma_f32_16x16x32_bf16 v[8:11], a[20:23], a[104:107], v[8:11]
  ds_read_b64_tr_b16 a[62:63], v110 offset:30176
  s_add_u32 s80, s80, s3
  v_mfma_f32_16x16x32_bf16 v[16:19], a[24:27], a[104:107], v[16:19]
  s_lshl_b32 s80, s80, 10
  v_mfma_f32_16x16x32_bf16 v[20:23], a[24:27], a[108:111], v[20:23]
  v_add_u32 v254, s80, v105
  v_mfma_f32_16x16x32_bf16 v[28:31], a[28:31], a[108:111], v[28:31]
  v_min_u32 v254, adaLN_cond__linear_kernel_hedgehog__glu_gated_swiglu__prompt_kernel_end-adaLN_cond__linear_kernel_hedgehog__glu_gated_swiglu__prompt_kernel-4, v254
  v_mfma_f32_16x16x32_bf16 v[24:27], a[28:31], a[104:107], v[24:27]
  global_load_dword a232, v254, s[100:101]
  s_waitcnt vmcnt(13) lgkmcnt(0)
  v_mfma_f32_16x16x32_bf16 v[0:3], a[32:35], a[112:115], v[0:3]
  s_waitcnt vmcnt(15)
  s_barrier
  v_mfma_f32_16x16x32_bf16 v[4:7], a[32:35], a[116:119], v[4:7]
  ds_read_b64_tr_b16 a[0:1], v110 offset:0
  ds_read_b64_tr_b16 a[2:3], v110 offset:512
  v_mfma_f32_16x16x32_bf16 v[12:15], a[36:39], a[116:119], v[12:15]
  buffer_load_dwordx4 a[96:99], v112, s[36:39], s62 offen offset:0 sc1
  ds_read_b64_tr_b16 a[4:5], v110 offset:32
  v_mfma_f32_16x16x32_bf16 v[8:11], a[36:39], a[112:115], v[8:11]
  ds_read_b64_tr_b16 a[6:7], v110 offset:544
  v_readlane_b32 s63, v99, 11
  v_mfma_f32_16x16x32_bf16 v[16:19], a[40:43], a[112:115], v[16:19]
  ds_read_b64_tr_b16 a[8:9], v110 offset:64
  ds_read_b64_tr_b16 a[10:11], v110 offset:576
  v_mfma_f32_16x16x32_bf16 v[20:23], a[40:43], a[116:119], v[20:23]
  s_add_u32 m0, s76, 25344
  ds_read_b64_tr_b16 a[12:13], v110 offset:96
  v_mfma_f32_16x16x32_bf16 v[28:31], a[44:47], a[116:119], v[28:31]
  ds_read_b64_tr_b16 a[14:15], v110 offset:608
  buffer_load_dwordx4 v111, s[32:35], s61 offen lds
  v_mfma_f32_16x16x32_bf16 v[24:27], a[44:47], a[112:115], v[24:27]
  ds_read_b64_tr_b16 a[16:17], v110 offset:4224
  ds_read_b64_tr_b16 a[18:19], v110 offset:4736
  v_mfma_f32_16x16x32_bf16 v[0:3], a[48:51], a[120:123], v[0:3]
  v_readlane_b32 s60, v98, 12
  ds_read_b64_tr_b16 a[20:21], v110 offset:4256
  v_mfma_f32_16x16x32_bf16 v[4:7], a[48:51], a[124:127], v[4:7]
  ds_read_b64_tr_b16 a[22:23], v110 offset:4768
  ds_read_b64_tr_b16 a[24:25], v110 offset:4288
  v_mfma_f32_16x16x32_bf16 v[12:15], a[52:55], a[124:127], v[12:15]
  buffer_load_dwordx4 a[100:103], v113, s[36:39], s62 offen offset:0 sc1
  ds_read_b64_tr_b16 a[26:27], v110 offset:4800
  v_mfma_f32_16x16x32_bf16 v[8:11], a[52:55], a[120:123], v[8:11]
  ds_read_b64_tr_b16 a[28:29], v110 offset:4320
  v_mfma_f32_16x16x32_bf16 v[16:19], a[56:59], a[120:123], v[16:19]
  ds_read_b64_tr_b16 a[30:31], v110 offset:4832
  buffer_load_dwordx4 v101, s[32:35], s61 offen offset:1056 lds
  v_mfma_f32_16x16x32_bf16 v[20:23], a[56:59], a[124:127], v[20:23]
  buffer_load_dwordx4 a[104:107], v112, s[36:39], s62 offen offset:2048 sc1
  v_mfma_f32_16x16x32_bf16 v[28:31], a[60:63], a[124:127], v[28:31]
  v_mfma_f32_16x16x32_bf16 v[24:27], a[60:63], a[120:123], v[24:27]
  buffer_load_dwordx4 a[108:111], v113, s[36:39], s62 offen offset:2048 sc1
  s_waitcnt vmcnt(13) lgkmcnt(0)
  v_mfma_f32_16x16x32_bf16 v[0:3], a[0:3], a[64:67], v[0:3]
  s_waitcnt vmcnt(15)
  s_barrier
  v_mfma_f32_16x16x32_bf16 v[4:7], a[0:3], a[68:71], v[4:7]
  ds_read_b64_tr_b16 a[32:33], v110 offset:8448
  ds_read_b64_tr_b16 a[34:35], v110 offset:8960
  v_mfma_f32_16x16x32_bf16 v[12:15], a[4:7], a[68:71], v[12:15]
  buffer_load_dwordx4 a[112:115], v112, s[36:39], s63 offen offset:0 sc1
  ds_read_b64_tr_b16 a[36:37], v110 offset:8480
  v_mfma_f32_16x16x32_bf16 v[8:11], a[4:7], a[64:67], v[8:11]
  ds_read_b64_tr_b16 a[38:39], v110 offset:8992
  v_readlane_b32 s62, v99, 12
  v_mfma_f32_16x16x32_bf16 v[16:19], a[8:11], a[64:67], v[16:19]
  ds_read_b64_tr_b16 a[40:41], v110 offset:8512
  ds_read_b64_tr_b16 a[42:43], v110 offset:9024
  v_mfma_f32_16x16x32_bf16 v[20:23], a[8:11], a[68:71], v[20:23]
  s_add_u32 m0, s76, 0
  ds_read_b64_tr_b16 a[44:45], v110 offset:8544
  v_mfma_f32_16x16x32_bf16 v[28:31], a[12:15], a[68:71], v[28:31]
  ds_read_b64_tr_b16 a[46:47], v110 offset:9056
  buffer_load_dwordx4 v111, s[32:35], s60 offen lds
  v_mfma_f32_16x16x32_bf16 v[24:27], a[12:15], a[64:67], v[24:27]
  ds_read_b64_tr_b16 a[48:49], v110 offset:12672
  ds_read_b64_tr_b16 a[50:51], v110 offset:13184
  v_mfma_f32_16x16x32_bf16 v[0:3], a[16:19], a[72:75], v[0:3]
  v_readlane_b32 s61, v98, 13
  ds_read_b64_tr_b16 a[52:53], v110 offset:12704
  v_mfma_f32_16x16x32_bf16 v[4:7], a[16:19], a[76:79], v[4:7]
  ds_read_b64_tr_b16 a[54:55], v110 offset:13216
  ds_read_b64_tr_b16 a[56:57], v110 offset:12736
  v_mfma_f32_16x16x32_bf16 v[12:15], a[20:23], a[76:79], v[12:15]
  buffer_load_dwordx4 a[116:119], v113, s[36:39], s63 offen offset:0 sc1
  ds_read_b64_tr_b16 a[58:59], v110 offset:13248
  v_mfma_f32_16x16x32_bf16 v[8:11], a[20:23], a[72:75], v[8:11]
  ds_read_b64_tr_b16 a[60:61], v110 offset:12768
  v_mfma_f32_16x16x32_bf16 v[16:19], a[24:27], a[72:75], v[16:19]
  ds_read_b64_tr_b16 a[62:63], v110 offset:13280
  buffer_load_dwordx4 v101, s[32:35], s60 offen offset:1056 lds
  v_mfma_f32_16x16x32_bf16 v[20:23], a[24:27], a[76:79], v[20:23]
  buffer_load_dwordx4 a[120:123], v112, s[36:39], s63 offen offset:2048 sc1
  v_mfma_f32_16x16x32_bf16 v[28:31], a[28:31], a[76:79], v[28:31]
  v_mfma_f32_16x16x32_bf16 v[24:27], a[28:31], a[72:75], v[24:27]
  buffer_load_dwordx4 a[124:127], v113, s[36:39], s63 offen offset:2048 sc1
  s_waitcnt vmcnt(13) lgkmcnt(0)
  v_mfma_f32_16x16x32_bf16 v[0:3], a[32:35], a[80:83], v[0:3]
  s_waitcnt vmcnt(15)
  s_barrier
  v_mfma_f32_16x16x32_bf16 v[4:7], a[32:35], a[84:87], v[4:7]
  ds_read_b64_tr_b16 a[0:1], v110 offset:16896
  ds_read_b64_tr_b16 a[2:3], v110 offset:17408
  v_mfma_f32_16x16x32_bf16 v[12:15], a[36:39], a[84:87], v[12:15]
  buffer_load_dwordx4 a[64:67], v112, s[36:39], s62 offen offset:0 sc1
  ds_read_b64_tr_b16 a[4:5], v110 offset:16928
  v_mfma_f32_16x16x32_bf16 v[8:11], a[36:39], a[80:83], v[8:11]
  ds_read_b64_tr_b16 a[6:7], v110 offset:17440
  v_readlane_b32 s63, v99, 13
  v_mfma_f32_16x16x32_bf16 v[16:19], a[40:43], a[80:83], v[16:19]
  ds_read_b64_tr_b16 a[8:9], v110 offset:16960
  ds_read_b64_tr_b16 a[10:11], v110 offset:17472
  v_mfma_f32_16x16x32_bf16 v[20:23], a[40:43], a[84:87], v[20:23]
  s_add_u32 m0, s76, 8448
  ds_read_b64_tr_b16 a[12:13], v110 offset:16992
  v_mfma_f32_16x16x32_bf16 v[28:31], a[44:47], a[84:87], v[28:31]
  ds_read_b64_tr_b16 a[14:15], v110 offset:17504
  buffer_load_dwordx4 v111, s[32:35], s61 offen lds
  v_mfma_f32_16x16x32_bf16 v[24:27], a[44:47], a[80:83], v[24:27]
  ds_read_b64_tr_b16 a[16:17], v110 offset:21120
  ds_read_b64_tr_b16 a[18:19], v110 offset:21632
  v_mfma_f32_16x16x32_bf16 v[0:3], a[48:51], a[88:91], v[0:3]
  v_readlane_b32 s60, v98, 14
  ds_read_b64_tr_b16 a[20:21], v110 offset:21152
  v_mfma_f32_16x16x32_bf16 v[4:7], a[48:51], a[92:95], v[4:7]
  ds_read_b64_tr_b16 a[22:23], v110 offset:21664
  ds_read_b64_tr_b16 a[24:25], v110 offset:21184
  v_mfma_f32_16x16x32_bf16 v[12:15], a[52:55], a[92:95], v[12:15]
  buffer_load_dwordx4 a[68:71], v113, s[36:39], s62 offen offset:0 sc1
  ds_read_b64_tr_b16 a[26:27], v110 offset:21696
  v_mfma_f32_16x16x32_bf16 v[8:11], a[52:55], a[88:91], v[8:11]
  ds_read_b64_tr_b16 a[28:29], v110 offset:21216
  v_mfma_f32_16x16x32_bf16 v[16:19], a[56:59], a[88:91], v[16:19]
  ds_read_b64_tr_b16 a[30:31], v110 offset:21728
  buffer_load_dwordx4 v101, s[32:35], s61 offen offset:1056 lds
  v_mfma_f32_16x16x32_bf16 v[20:23], a[56:59], a[92:95], v[20:23]
  buffer_load_dwordx4 a[72:75], v112, s[36:39], s62 offen offset:2048 sc1
  v_mfma_f32_16x16x32_bf16 v[28:31], a[60:63], a[92:95], v[28:31]
  v_mfma_f32_16x16x32_bf16 v[24:27], a[60:63], a[88:91], v[24:27]
  buffer_load_dwordx4 a[76:79], v113, s[36:39], s62 offen offset:2048 sc1
  s_waitcnt vmcnt(12) lgkmcnt(0)
  v_mfma_f32_16x16x32_bf16 v[0:3], a[0:3], a[96:99], v[0:3]
  s_waitcnt vmcnt(14)
  s_barrier
  v_mfma_f32_16x16x32_bf16 v[4:7], a[0:3], a[100:103], v[4:7]
  ds_read_b64_tr_b16 a[32:33], v110 offset:25344
  ds_read_b64_tr_b16 a[34:35], v110 offset:25856
  v_mfma_f32_16x16x32_bf16 v[12:15], a[4:7], a[100:103], v[12:15]
  buffer_load_dwordx4 a[80:83], v112, s[36:39], s63 offen offset:0 sc1
  ds_read_b64_tr_b16 a[36:37], v110 offset:25376
  v_mfma_f32_16x16x32_bf16 v[8:11], a[4:7], a[96:99], v[8:11]
  ds_read_b64_tr_b16 a[38:39], v110 offset:25888
  v_readlane_b32 s62, v99, 14
  v_mfma_f32_16x16x32_bf16 v[16:19], a[8:11], a[96:99], v[16:19]
  ds_read_b64_tr_b16 a[40:41], v110 offset:25408
  ds_read_b64_tr_b16 a[42:43], v110 offset:25920
  v_mfma_f32_16x16x32_bf16 v[20:23], a[8:11], a[100:103], v[20:23]
  s_add_u32 m0, s76, 16896
  ds_read_b64_tr_b16 a[44:45], v110 offset:25440
  v_mfma_f32_16x16x32_bf16 v[28:31], a[12:15], a[100:103], v[28:31]
  ds_read_b64_tr_b16 a[46:47], v110 offset:25952
  buffer_load_dwordx4 v111, s[32:35], s60 offen lds
  v_mfma_f32_16x16x32_bf16 v[24:27], a[12:15], a[96:99], v[24:27]
  ds_read_b64_tr_b16 a[48:49], v110 offset:29568
  ds_read_b64_tr_b16 a[50:51], v110 offset:30080
  v_mfma_f32_16x16x32_bf16 v[0:3], a[16:19], a[104:107], v[0:3]
  v_readlane_b32 s61, v98, 15
  ds_read_b64_tr_b16 a[52:53], v110 offset:29600
  v_mfma_f32_16x16x32_bf16 v[4:7], a[16:19], a[108:111], v[4:7]
  ds_read_b64_tr_b16 a[54:55], v110 offset:30112
  ds_read_b64_tr_b16 a[56:57], v110 offset:29632
  v_mfma_f32_16x16x32_bf16 v[12:15], a[20:23], a[108:111], v[12:15]
  buffer_load_dwordx4 a[84:87], v113, s[36:39], s63 offen offset:0 sc1
  ds_read_b64_tr_b16 a[58:59], v110 offset:30144
  v_mfma_f32_16x16x32_bf16 v[8:11], a[20:23], a[104:107], v[8:11]
  ds_read_b64_tr_b16 a[60:61], v110 offset:29664
  v_mfma_f32_16x16x32_bf16 v[16:19], a[24:27], a[104:107], v[16:19]
  ds_read_b64_tr_b16 a[62:63], v110 offset:30176
  buffer_load_dwordx4 v101, s[32:35], s60 offen offset:1056 lds
  v_mfma_f32_16x16x32_bf16 v[20:23], a[24:27], a[108:111], v[20:23]
  buffer_load_dwordx4 a[88:91], v112, s[36:39], s63 offen offset:2048 sc1
  v_mfma_f32_16x16x32_bf16 v[28:31], a[28:31], a[108:111], v[28:31]
  v_mfma_f32_16x16x32_bf16 v[24:27], a[28:31], a[104:107], v[24:27]
  buffer_load_dwordx4 a[92:95], v113, s[36:39], s63 offen offset:2048 sc1
  s_waitcnt vmcnt(12) lgkmcnt(0)
  v_mfma_f32_16x16x32_bf16 v[0:3], a[32:35], a[112:115], v[0:3]
  s_waitcnt vmcnt(14)
  s_barrier
  v_mfma_f32_16x16x32_bf16 v[4:7], a[32:35], a[116:119], v[4:7]
  ds_read_b64_tr_b16 a[0:1], v110 offset:0
  buffer_load_dwordx4 a[96:99], v112, s[36:39], s62 offen offset:0 sc1
  ds_read_b64_tr_b16 a[2:3], v110 offset:512
  v_mfma_f32_16x16x32_bf16 v[12:15], a[36:39], a[116:119], v[12:15]
  v_readlane_b32 s63, v99, 15
  ds_read_b64_tr_b16 a[4:5], v110 offset:32
  s_add_u32 m0, s76, 25344
  v_mfma_f32_16x16x32_bf16 v[8:11], a[36:39], a[112:115], v[8:11]
  ds_read_b64_tr_b16 a[6:7], v110 offset:544
  buffer_load_dwordx4 v111, s[32:35], s61 offen lds
  buffer_load_dwordx4 a[100:103], v113, s[36:39], s62 offen offset:0 sc1
  v_mfma_f32_16x16x32_bf16 v[16:19], a[40:43], a[112:115], v[16:19]
  ds_read_b64_tr_b16 a[8:9], v110 offset:64
  ds_read_b64_tr_b16 a[10:11], v110 offset:576
  v_mfma_f32_16x16x32_bf16 v[20:23], a[40:43], a[116:119], v[20:23]
  buffer_load_dwordx4 v101, s[32:35], s61 offen offset:1056 lds
  ds_read_b64_tr_b16 a[12:13], v110 offset:96
  buffer_load_dwordx4 a[104:107], v112, s[36:39], s62 offen offset:2048 sc1
  v_mfma_f32_16x16x32_bf16 v[28:31], a[44:47], a[116:119], v[28:31]
  ds_read_b64_tr_b16 a[14:15], v110 offset:608
  buffer_load_dwordx4 a[108:111], v113, s[36:39], s62 offen offset:2048 sc1
  ds_read_b64_tr_b16 a[16:17], v110 offset:4224
  v_mfma_f32_16x16x32_bf16 v[24:27], a[44:47], a[112:115], v[24:27]
  buffer_load_dword v160, v40, s[52:55], s92 offen offset:0 sc1
  ds_read_b64_tr_b16 a[18:19], v110 offset:4736
  buffer_load_dword v161, v40, s[52:55], s92 offen offset:256 sc1
  v_mfma_f32_16x16x32_bf16 v[0:3], a[48:51], a[120:123], v[0:3]
  ds_read_b64_tr_b16 a[20:21], v110 offset:4256
  buffer_load_dword v162, v40, s[52:55], s92 offen offset:512 sc1
  buffer_load_dword v163, v40, s[52:55], s92 offen offset:768 sc1
  v_mfma_f32_16x16x32_bf16 v[4:7], a[48:51], a[124:127], v[4:7]
  ds_read_b64_tr_b16 a[22:23], v110 offset:4768
  buffer_load_dword v164, v40, s[52:55], s92 offen offset:1024 sc1
  ds_read_b64_tr_b16 a[24:25], v110 offset:4288
  v_mfma_f32_16x16x32_bf16 v[12:15], a[52:55], a[124:127], v[12:15]
  buffer_load_dword v165, v40, s[52:55], s92 offen offset:1280 sc1
  ds_read_b64_tr_b16 a[26:27], v110 offset:4800
  buffer_load_dword v166, v40, s[52:55], s92 offen offset:1536 sc1
  v_mfma_f32_16x16x32_bf16 v[8:11], a[52:55], a[120:123], v[8:11]
  ds_read_b64_tr_b16 a[28:29], v110 offset:4320
  buffer_load_dword v167, v40, s[52:55], s92 offen offset:1792 sc1
  ds_read_b64_tr_b16 a[30:31], v110 offset:4832
  v_mfma_f32_16x16x32_bf16 v[16:19], a[56:59], a[120:123], v[16:19]
  buffer_load_dword v168, v40, s[52:55], s92 offen offset:2048 sc1
  buffer_load_dword v169, v40, s[52:55], s92 offen offset:2304 sc1
  buffer_load_dword v170, v40, s[52:55], s92 offen offset:2560 sc1
  v_mfma_f32_16x16x32_bf16 v[20:23], a[56:59], a[124:127], v[20:23]
  buffer_load_dword v171, v40, s[52:55], s92 offen offset:2816 sc1
  buffer_load_dword v172, v40, s[52:55], s92 offen offset:3072 sc1
  v_mfma_f32_16x16x32_bf16 v[28:31], a[60:63], a[124:127], v[28:31]
  buffer_load_dword v173, v40, s[52:55], s92 offen offset:3328 sc1
  v_mfma_f32_16x16x32_bf16 v[24:27], a[60:63], a[120:123], v[24:27]
  buffer_load_dword v174, v40, s[52:55], s92 offen offset:3584 sc1
  buffer_load_dword v175, v40, s[52:55], s92 offen offset:3840 sc1
  s_waitcnt vmcnt(28) lgkmcnt(0)
  v_mfma_f32_16x16x32_bf16 v[0:3], a[0:3], a[64:67], v[0:3]
  s_waitcnt vmcnt(30)
  s_barrier
  v_mfma_f32_16x16x32_bf16 v[4:7], a[0:3], a[68:71], v[4:7]
  ds_read_b64_tr_b16 a[32:33], v110 offset:8448
  ds_read_b64_tr_b16 a[34:35], v110 offset:8960
  v_mfma_f32_16x16x32_bf16 v[12:15], a[4:7], a[68:71], v[12:15]
  ds_read_b64_tr_b16 a[36:37], v110 offset:8480
  buffer_load_dwordx4 a[112:115], v112, s[36:39], s63 offen offset:0 sc1
  v_mfma_f32_16x16x32_bf16 v[8:11], a[4:7], a[64:67], v[8:11]
  ds_read_b64_tr_b16 a[38:39], v110 offset:8992
  ds_read_b64_tr_b16 a[40:41], v110 offset:8512
  v_mfma_f32_16x16x32_bf16 v[16:19], a[8:11], a[64:67], v[16:19]
  ds_read_b64_tr_b16 a[42:43], v110 offset:9024
  v_mfma_f32_16x16x32_bf16 v[20:23], a[8:11], a[68:71], v[20:23]
  ds_read_b64_tr_b16 a[44:45], v110 offset:8544
  ds_read_b64_tr_b16 a[46:47], v110 offset:9056
  v_mfma_f32_16x16x32_bf16 v[28:31], a[12:15], a[68:71], v[28:31]
  ds_read_b64_tr_b16 a[48:49], v110 offset:12672
  buffer_load_dwordx4 a[116:119], v113, s[36:39], s63 offen offset:0 sc1
  v_mfma_f32_16x16x32_bf16 v[24:27], a[12:15], a[64:67], v[24:27]
  ds_read_b64_tr_b16 a[50:51], v110 offset:13184
  ds_read_b64_tr_b16 a[52:53], v110 offset:12704
  v_mfma_f32_16x16x32_bf16 v[0:3], a[16:19], a[72:75], v[0:3]
  ds_read_b64_tr_b16 a[54:55], v110 offset:13216
  v_mfma_f32_16x16x32_bf16 v[4:7], a[16:19], a[76:79], v[4:7]
  ds_read_b64_tr_b16 a[56:57], v110 offset:12736
  ds_read_b64_tr_b16 a[58:59], v110 offset:13248
  v_mfma_f32_16x16x32_bf16 v[12:15], a[20:23], a[76:79], v[12:15]
  buffer_load_dwordx4 a[120:123], v112, s[36:39], s63 offen offset:2048 sc1
  ds_read_b64_tr_b16 a[60:61], v110 offset:12768
  v_mfma_f32_16x16x32_bf16 v[8:11], a[20:23], a[72:75], v[8:11]
  ds_read_b64_tr_b16 a[62:63], v110 offset:13280
  v_mfma_f32_16x16x32_bf16 v[16:19], a[24:27], a[72:75], v[16:19]
  v_mfma_f32_16x16x32_bf16 v[20:23], a[24:27], a[76:79], v[20:23]
  v_mfma_f32_16x16x32_bf16 v[28:31], a[28:31], a[76:79], v[28:31]
  buffer_load_dwordx4 a[124:127], v113, s[36:39], s63 offen offset:2048 sc1
  v_mfma_f32_16x16x32_bf16 v[24:27], a[28:31], a[72:75], v[24:27]
  s_waitcnt vmcnt(26) lgkmcnt(0)
  v_mfma_f32_16x16x32_bf16 v[0:3], a[32:35], a[80:83], v[0:3]
  s_waitcnt vmcnt(28)
  s_barrier
  v_mfma_f32_16x16x32_bf16 v[4:7], a[32:35], a[84:87], v[4:7]
  ds_read_b64_tr_b16 a[0:1], v110 offset:16896
  s_waitcnt vmcnt(4)
  ds_read_b64_tr_b16 a[2:3], v110 offset:17408
  v_mfma_f32_16x16x32_bf16 v[12:15], a[36:39], a[84:87], v[12:15]
  ds_read_b64_tr_b16 a[4:5], v110 offset:16928
  v_min_u32 v176, v160, v161
  v_min3_u32 v176, v176, v162, v163
  v_min3_u32 v176, v176, v164, v165
  v_min3_u32 v176, v176, v166, v167
  v_min3_u32 v176, v176, v168, v169
  v_min3_u32 v176, v176, v170, v171
  v_min3_u32 v176, v176, v172, v173
  v_min3_u32 v176, v176, v174, v175
  v_cmp_eq_u32 vcc, 0, v176
  s_cmp_eq_u64 vcc, 0
  s_cbranch_scc1 L_mok_31
  s_mov_b32 s96, 0
L_poll_32:
  buffer_load_dword v160, v40, s[52:55], s92 offen offset:0 sc1
  buffer_load_dword v161, v40, s[52:55], s92 offen offset:256 sc1
  buffer_load_dword v162, v40, s[52:55], s92 offen offset:512 sc1
  buffer_load_dword v163, v40, s[52:55], s92 offen offset:768 sc1
  buffer_load_dword v164, v40, s[52:55], s92 offen offset:1024 sc1
  buffer_load_dword v165, v40, s[52:55], s92 offen offset:1280 sc1
  buffer_load_dword v166, v40, s[52:55], s92 offen offset:1536 sc1
  buffer_load_dword v167, v40, s[52:55], s92 offen offset:1792 sc1
  buffer_load_dword v168, v40, s[52:55], s92 offen offset:2048 sc1
  buffer_load_dword v169, v40, s[52:55], s92 offen offset:2304 sc1
  buffer_load_dword v170, v40, s[52:55], s92 offen offset:2560 sc1
  buffer_load_dword v171, v40, s[52:55], s92 offen offset:2816 sc1
  buffer_load_dword v172, v40, s[52:55], s92 offen offset:3072 sc1
  buffer_load_dword v173, v40, s[52:55], s92 offen offset:3328 sc1
  buffer_load_dword v174, v40, s[52:55], s92 offen offset:3584 sc1
  buffer_load_dword v175, v40, s[52:55], s92 offen offset:3840 sc1
  s_waitcnt vmcnt(0)
  v_min_u32 v176, v160, v161
  v_min_u32 v176, v176, v162
  v_min_u32 v176, v176, v163
  v_min_u32 v176, v176, v164
  v_min_u32 v176, v176, v165
  v_min_u32 v176, v176, v166
  v_min_u32 v176, v176, v167
  v_min_u32 v176, v176, v168
  v_min_u32 v176, v176, v169
  v_min_u32 v176, v176, v170
  v_min_u32 v176, v176, v171
  v_min_u32 v176, v176, v172
  v_min_u32 v176, v176, v173
  v_min_u32 v176, v176, v174
  v_min_u32 v176, v176, v175
  v_cmp_eq_u32 vcc, 0, v176
  s_add_u32 s96, s96, 1
  s_cmp_eq_u64 vcc, 0
  s_cbranch_scc1 L_ok_33
  s_sleep 2
  s_cmp_lt_u32 s96, 0x200000
  s_cbranch_scc1 L_poll_32
L_ok_33:
L_mok_31:
  v_mfma_f32_16x16x32_bf16 v[8:11], a[36:39], a[80:83], v[8:11]
  ds_read_b64_tr_b16 a[6:7], v110 offset:17440
  v_pk_add_f32 v[160:161], v[160:161], v[168:169]
  ds_read_b64_tr_b16 a[8:9], v110 offset:16960
  v_mfma_f32_16x16x32_bf16 v[16:19], a[40:43], a[80:83], v[16:19]
  v_pk_add_f32 v[162:163], v[162:163], v[170:171]
  ds_read_b64_tr_b16 a[10:11], v110 offset:17472
  v_mfma_f32_16x16x32_bf16 v[20:23], a[40:43], a[84:87], v[20:23]
  ds_read_b64_tr_b16 a[12:13], v110 offset:16992
  v_pk_add_f32 v[164:165], v[164:165], v[172:173]
  ds_read_b64_tr_b16 a[14:15], v110 offset:17504
  v_mfma_f32_16x16x32_bf16 v[28:31], a[44:47], a[84:87], v[28:31]
  v_pk_add_f32 v[166:167], v[166:167], v[174:175]
  ds_read_b64_tr_b16 a[16:17], v110 offset:21120
  v_mfma_f32_16x16x32_bf16 v[24:27], a[44:47], a[80:83], v[24:27]
  v_pk_add_f32 v[160:161], v[160:161], v[164:165]
  ds_read_b64_tr_b16 a[18:19], v110 offset:21632
  ds_read_b64_tr_b16 a[20:21], v110 offset:21152
  v_mfma_f32_16x16x32_bf16 v[0:3], a[48:51], a[88:91], v[0:3]
  v_pk_add_f32 v[162:163], v[162:163], v[166:167]
  ds_read_b64_tr_b16 a[22:23], v110 offset:21664
  v_pk_add_f32 v[160:161], v[160:161], v[162:163]
  v_mfma_f32_16x16x32_bf16 v[4:7], a[48:51], a[92:95], v[4:7]
  ds_read_b64_tr_b16 a[24:25], v110 offset:21184
  v_add_f32_e64 v160, v160, v161
  ds_read_b64_tr_b16 a[26:27], v110 offset:21696
  v_mfma_f32_16x16x32_bf16 v[12:15], a[52:55], a[92:95], v[12:15]
  ds_read_b64_tr_b16 a[28:29], v110 offset:21216
  v_cvt_pk_bf16_f32 v160, v160, v160
  v_mfma_f32_16x16x32_bf16 v[8:11], a[52:55], a[88:91], v[8:11]
  ds_read_b64_tr_b16 a[30:31], v110 offset:21728
  v_and_b32 v160, 0xffff0000, v160
  v_mfma_f32_16x16x32_bf16 v[16:19], a[56:59], a[88:91], v[16:19]
  v_add_f32 v161, 1.0, v160
  v_mfma_f32_16x16x32_bf16 v[20:23], a[56:59], a[92:95], v[20:23]
  v_cvt_pk_bf16_f32 v161, v161, v161
  v_mfma_f32_16x16x32_bf16 v[28:31], a[60:63], a[92:95], v[28:31]
  v_and_b32 v161, 0xffff0000, v161
  v_mfma_f32_16x16x32_bf16 v[24:27], a[60:63], a[88:91], v[24:27]
  s_cmp_eq_u32 s3, 2
  s_cselect_b64 vcc, -1, 0
  v_cndmask_b32 v160, v160, v161, vcc
  s_lshl_b32 s92, s3, 8
  s_add_u32 s92, s92, 128000
  v_add_u32 v40, s92, v40
  ds_write_b32 v40, v160
  s_waitcnt vmcnt(20) lgkmcnt(0)
  v_mfma_f32_16x16x32_bf16 v[0:3], a[0:3], a[96:99], v[0:3]
  s_waitcnt vmcnt(22)
  s_barrier
  v_mfma_f32_16x16x32_bf16 v[4:7], a[0:3], a[100:103], v[4:7]
  ds_read_b64_tr_b16 a[32:33], v110 offset:25344
  ds_read_b64_tr_b16 a[34:35], v110 offset:25856
  v_mfma_f32_16x16x32_bf16 v[12:15], a[4:7], a[100:103], v[12:15]
  ds_read_b64_tr_b16 a[36:37], v110 offset:25376
  v_mfma_f32_16x16x32_bf16 v[8:11], a[4:7], a[96:99], v[8:11]
  ds_read_b64_tr_b16 a[38:39], v110 offset:25888
  ds_read_b64_tr_b16 a[40:41], v110 offset:25408
  v_mfma_f32_16x16x32_bf16 v[16:19], a[8:11], a[96:99], v[16:19]
  ds_read_b64_tr_b16 a[42:43], v110 offset:25920
  v_mfma_f32_16x16x32_bf16 v[20:23], a[8:11], a[100:103], v[20:23]
  ds_read_b64_tr_b16 a[44:45], v110 offset:25440
  ds_read_b64_tr_b16 a[46:47], v110 offset:25952
  v_mfma_f32_16x16x32_bf16 v[28:31], a[12:15], a[100:103], v[28:31]
  ds_read_b64_tr_b16 a[48:49], v110 offset:29568
  v_mfma_f32_16x16x32_bf16 v[24:27], a[12:15], a[96:99], v[24:27]
  ds_read_b64_tr_b16 a[50:51], v110 offset:30080
  ds_read_b64_tr_b16 a[52:53], v110 offset:29600
  v_mfma_f32_16x16x32_bf16 v[0:3], a[16:19], a[104:107], v[0:3]
  ds_read_b64_tr_b16 a[54:55], v110 offset:30112
  v_mfma_f32_16x16x32_bf16 v[4:7], a[16:19], a[108:111], v[4:7]
  ds_read_b64_tr_b16 a[56:57], v110 offset:29632
  ds_read_b64_tr_b16 a[58:59], v110 offset:30144
  v_mfma_f32_16x16x32_bf16 v[12:15], a[20:23], a[108:111], v[12:15]
  ds_read_b64_tr_b16 a[60:61], v110 offset:29664
  v_mfma_f32_16x16x32_bf16 v[8:11], a[20:23], a[104:107], v[8:11]
  ds_read_b64_tr_b16 a[62:63], v110 offset:30176
  v_mfma_f32_16x16x32_bf16 v[16:19], a[24:27], a[104:107], v[16:19]
  v_mfma_f32_16x16x32_bf16 v[20:23], a[24:27], a[108:111], v[20:23]
  v_mfma_f32_16x16x32_bf16 v[28:31], a[28:31], a[108:111], v[28:31]
  v_mfma_f32_16x16x32_bf16 v[24:27], a[28:31], a[104:107], v[24:27]
  s_waitcnt vmcnt(0) lgkmcnt(0)
  v_mfma_f32_16x16x32_bf16 v[0:3], a[32:35], a[112:115], v[0:3]
  ds_read_b128 v[64:67], v44 offset:0
  v_mfma_f32_16x16x32_bf16 v[4:7], a[32:35], a[116:119], v[4:7]
  ds_read_b128 v[68:71], v44 offset:64
  v_mfma_f32_16x16x32_bf16 v[12:15], a[36:39], a[116:119], v[12:15]
  ds_read_b128 v[72:75], v44 offset:128
  v_mfma_f32_16x16x32_bf16 v[8:11], a[36:39], a[112:115], v[8:11]
  ds_read_b128 v[76:79], v44 offset:192
  v_mfma_f32_16x16x32_bf16 v[16:19], a[40:43], a[112:115], v[16:19]
  ds_read_b128 v[80:83], v44 offset:512
  v_mfma_f32_16x16x32_bf16 v[20:23], a[40:43], a[116:119], v[20:23]
  ds_read_b128 v[84:87], v44 offset:576
  v_mfma_f32_16x16x32_bf16 v[28:31], a[44:47], a[116:119], v[28:31]
  ds_read_b128 v[88:91], v44 offset:640
  v_mfma_f32_16x16x32_bf16 v[24:27], a[44:47], a[112:115], v[24:27]
  ds_read_b128 v[92:95], v44 offset:704
  v_mfma_f32_16x16x32_bf16 v[0:3], a[48:51], a[120:123], v[0:3]
  ds_read_b128 v[136:139], v44 offset:256
  v_mfma_f32_16x16x32_bf16 v[4:7], a[48:51], a[124:127], v[4:7]
  ds_read_b128 v[140:143], v44 offset:320
  v_mfma_f32_16x16x32_bf16 v[12:15], a[52:55], a[124:127], v[12:15]
  ds_read_b128 v[144:147], v44 offset:384
  v_mfma_f32_16x16x32_bf16 v[8:11], a[52:55], a[120:123], v[8:11]
  ds_read_b128 v[148:151], v44 offset:448
  v_mfma_f32_16x16x32_bf16 v[16:19], a[56:59], a[120:123], v[16:19]
  v_mfma_f32_16x16x32_bf16 v[20:23], a[56:59], a[124:127], v[20:23]
  v_mfma_f32_16x16x32_bf16 v[28:31], a[60:63], a[124:127], v[28:31]
  v_mfma_f32_16x16x32_bf16 v[24:27], a[60:63], a[120:123], v[24:27]
  s_waitcnt lgkmcnt(0)
  s_nop 7
  v_lshlrev_b32 v194, 16, v178
  v_and_b32 v195, 0xffff0000, v178
  v_lshlrev_b32 v196, 16, v179
  v_and_b32 v197, 0xffff0000, v179
  v_pk_fma_f32 v[0:1], v[0:1], v[64:65], v[194:195]
  v_pk_fma_f32 v[2:3], v[2:3], v[66:67], v[196:197]
  v_lshlrev_b32 v194, 16, v180
  v_and_b32 v195, 0xffff0000, v180
  v_lshlrev_b32 v196, 16, v181
  v_and_b32 v197, 0xffff0000, v181
  v_pk_fma_f32 v[8:9], v[8:9], v[68:69], v[194:195]
  v_pk_fma_f32 v[10:11], v[10:11], v[70:71], v[196:197]
  v_lshlrev_b32 v194, 16, v182
  v_and_b32 v195, 0xffff0000, v182
  v_lshlrev_b32 v196, 16, v183
  v_and_b32 v197, 0xffff0000, v183
  v_pk_fma_f32 v[16:17], v[16:17], v[72:73], v[194:195]
  v_pk_fma_f32 v[18:19], v[18:19], v[74:75], v[196:197]
  v_lshlrev_b32 v194, 16, v184
  v_and_b32 v195, 0xffff0000, v184
  v_lshlrev_b32 v196, 16, v185
  v_and_b32 v197, 0xffff0000, v185
  v_pk_fma_f32 v[24:25], v[24:25], v[76:77], v[194:195]
  v_pk_fma_f32 v[26:27], v[26:27], v[78:79], v[196:197]
  v_cvt_pk_bf16_f32 v198, v0, v1
  v_cvt_pk_bf16_f32 v199, v2, v3
  v_cvt_pk_bf16_f32 v200, v8, v9
  v_cvt_pk_bf16_f32 v201, v10, v11
  v_cvt_pk_bf16_f32 v202, v16, v17
  v_cvt_pk_bf16_f32 v203, v18, v19
  v_cvt_pk_bf16_f32 v204, v24, v25
  v_cvt_pk_bf16_f32 v205, v26, v27
  v_lshlrev_b32 v0, 16, v198
  v_and_b32 v1, 0xffff0000, v198
  v_lshlrev_b32 v2, 16, v199
  v_and_b32 v3, 0xffff0000, v199
  v_lshlrev_b32 v8, 16, v200
  v_and_b32 v9, 0xffff0000, v200
  v_lshlrev_b32 v10, 16, v201
  v_and_b32 v11, 0xffff0000, v201
  v_lshlrev_b32 v16, 16, v202
  v_and_b32 v17, 0xffff0000, v202
  v_lshlrev_b32 v18, 16, v203
  v_and_b32 v19, 0xffff0000, v203
  v_lshlrev_b32 v24, 16, v204
  v_and_b32 v25, 0xffff0000, v204
  v_lshlrev_b32 v26, 16, v205
  v_and_b32 v27, 0xffff0000, v205
  v_lshlrev_b32 v194, 16, v186
  v_and_b32 v195, 0xffff0000, v186
  v_lshlrev_b32 v196, 16, v187
  v_and_b32 v197, 0xffff0000, v187
  v_pk_fma_f32 v[4:5], v[4:5], v[64:65], v[194:195]
  v_pk_fma_f32 v[6:7], v[6:7], v[66:67], v[196:197]
  v_lshlrev_b32 v194, 16, v188
  v_and_b32 v195, 0xffff0000, v188
  v_lshlrev_b32 v196, 16, v189
  v_and_b32 v197, 0xffff0000, v189
  v_pk_fma_f32 v[12:13], v[12:13], v[68:69], v[194:195]
  v_pk_fma_f32 v[14:15], v[14:15], v[70:71], v[196:197]
  v_lshlrev_b32 v194, 16, v190
  v_and_b32 v195, 0xffff0000, v190
  v_lshlrev_b32 v196, 16, v191
  v_and_b32 v197, 0xffff0000, v191
  v_pk_fma_f32 v[20:21], v[20:21], v[72:73], v[194:195]
  v_pk_fma_f32 v[22:23], v[22:23], v[74:75], v[196:197]
  v_lshlrev_b32 v194, 16, v192
  v_and_b32 v195, 0xffff0000, v192
  v_lshlrev_b32 v196, 16, v193
  v_and_b32 v197, 0xffff0000, v193
  v_pk_fma_f32 v[28:29], v[28:29], v[76:77], v[194:195]
  v_pk_fma_f32 v[30:31], v[30:31], v[78:79], v[196:197]
  v_cvt_pk_bf16_f32 v206, v4, v5
  v_cvt_pk_bf16_f32 v207, v6, v7
  v_cvt_pk_bf16_f32 v208, v12, v13
  v_cvt_pk_bf16_f32 v209, v14, v15
  v_cvt_pk_bf16_f32 v210, v20, v21
  v_cvt_pk_bf16_f32 v211, v22, v23
  v_cvt_pk_bf16_f32 v212, v28, v29
  v_cvt_pk_bf16_f32 v213, v30, v31
  v_lshlrev_b32 v4, 16, v206
  v_and_b32 v5, 0xffff0000, v206
  v_lshlrev_b32 v6, 16, v207
  v_and_b32 v7, 0xffff0000, v207
  v_lshlrev_b32 v12, 16, v208
  v_and_b32 v13, 0xffff0000, v208
  v_lshlrev_b32 v14, 16, v209
  v_and_b32 v15, 0xffff0000, v209
  v_lshlrev_b32 v20, 16, v210
  v_and_b32 v21, 0xffff0000, v210
  v_lshlrev_b32 v22, 16, v211
  v_and_b32 v23, 0xffff0000, v211
  v_lshlrev_b32 v28, 16, v212
  v_and_b32 v29, 0xffff0000, v212
  v_lshlrev_b32 v30, 16, v213
  v_and_b32 v31, 0xffff0000, v213
  v_pk_add_f32 v[194:195], v[0:1], v[2:3]
  v_pk_add_f32 v[196:197], v[4:5], v[6:7]
  v_pk_add_f32 v[194:195], v[194:195], v[8:9]
  v_pk_add_f32 v[196:197], v[196:197], v[12:13]
  v_pk_add_f32 v[194:195], v[194:195], v[10:11]
  v_pk_add_f32 v[196:197], v[196:197], v[14:15]
  v_pk_add_f32 v[194:195], v[194:195], v[16:17]
  v_pk_add_f32 v[196:197], v[196:197], v[20:21]
  v_pk_add_f32 v[194:195], v[194:195], v[18:19]
  v_pk_add_f32 v[196:197], v[196:197], v[22:23]
  v_pk_add_f32 v[194:195], v[194:195], v[24:25]
  v_pk_add_f32 v[196:197], v[196:197], v[28:29]
  v_pk_add_f32 v[194:195], v[194:195], v[26:27]
  v_pk_add_f32 v[196:197], v[196:197], v[30:31]
  v_add_f32 v214, v194, v195
  v_add_f32 v216, v196, v197
  v_mov_b32 v218, v214
  v_mov_b32 v219, v216
  s_nop 0
  v_permlane32_swap_b32 v214, v218
  v_permlane32_swap_b32 v216, v219
  s_nop 0
  v_add_f32 v214, v214, v218
  v_add_f32 v216, v216, v219
  v_mov_b32 v218, v214
  v_mov_b32 v219, v216
  s_nop 0
  v_permlane16_swap_b32 v214, v218
  v_permlane16_swap_b32 v216, v219
  s_nop 0
  v_add_f32 v214, v214, v218
  v_add_f32 v216, v216, v219
  v_mul_f32 v220, -0.015625, v214
  v_mov_b32 v194, 0
  v_mov_b32 v195, 0
  v_mul_f32 v222, -0.015625, v216
  v_mov_b32 v196, 0
  v_mov_b32 v197, 0
  v_pk_add_f32 v[32:33], v[0:1], v[220:221] op_sel_hi:[1,0]
  v_pk_add_f32 v[34:35], v[4:5], v[222:223] op_sel_hi:[1,0]
  v_pk_fma_f32 v[194:195], v[32:33], v[32:33], v[194:195]
  v_pk_fma_f32 v[196:197], v[34:35], v[34:35], v[196:197]
  v_pk_add_f32 v[32:33], v[2:3], v[220:221] op_sel_hi:[1,0]
  v_pk_add_f32 v[34:35], v[6:7], v[222:223] op_sel_hi:[1,0]
  v_pk_fma_f32 v[194:195], v[32:33], v[32:33], v[194:195]
  v_pk_fma_f32 v[196:197], v[34:35], v[34:35], v[196:197]
  v_pk_add_f32 v[32:33], v[8:9], v[220:221] op_sel_hi:[1,0]
  v_pk_add_f32 v[34:35], v[12:13], v[222:223] op_sel_hi:[1,0]
  v_pk_fma_f32 v[194:195], v[32:33], v[32:33], v[194:195]
  v_pk_fma_f32 v[196:197], v[34:35], v[34:35], v[196:197]
  v_pk_add_f32 v[32:33], v[10:11], v[220:221] op_sel_hi:[1,0]
  v_pk_add_f32 v[34:35], v[14:15], v[222:223] op_sel_hi:[1,0]
  v_pk_fma_f32 v[194:195], v[32:33], v[32:33], v[194:195]
  v_pk_fma_f32 v[196:197], v[34:35], v[34:35], v[196:197]
  v_pk_add_f32 v[32:33], v[16:17], v[220:221] op_sel_hi:[1,0]
  v_pk_add_f32 v[34:35], v[20:21], v[222:223] op_sel_hi:[1,0]
  v_pk_fma_f32 v[194:195], v[32:33], v[32:33], v[194:195]
  v_pk_fma_f32 v[196:197], v[34:35], v[34:35], v[196:197]
  v_pk_add_f32 v[32:33], v[18:19], v[220:221] op_sel_hi:[1,0]
  v_pk_add_f32 v[34:35], v[22:23], v[222:223] op_sel_hi:[1,0]
  v_pk_fma_f32 v[194:195], v[32:33], v[32:33], v[194:195]
  v_pk_fma_f32 v[196:197], v[34:35], v[34:35], v[196:197]
  v_pk_add_f32 v[32:33], v[24:25], v[220:221] op_sel_hi:[1,0]
  v_pk_add_f32 v[34:35], v[28:29], v[222:223] op_sel_hi:[1,0]
  v_pk_fma_f32 v[194:195], v[32:33], v[32:33], v[194:195]
  v_pk_fma_f32 v[196:197], v[34:35], v[34:35], v[196:197]
  v_pk_add_f32 v[32:33], v[26:27], v[220:221] op_sel_hi:[1,0]
  v_pk_add_f32 v[34:35], v[30:31], v[222:223] op_sel_hi:[1,0]
  v_pk_fma_f32 v[194:195], v[32:33], v[32:33], v[194:195]
  v_pk_fma_f32 v[196:197], v[34:35], v[34:35], v[196:197]
  v_add_f32 v215, v194, v195
  v_add_f32 v217, v196, v197
  v_mov_b32 v218, v215
  v_mov_b32 v219, v217
  s_nop 0
  v_permlane32_swap_b32 v215, v218
  v_permlane32_swap_b32 v217, v219
  s_nop 0
  v_add_f32 v215, v215, v218
  v_add_f32 v217, v217, v219
  v_mov_b32 v218, v215
  v_mov_b32 v219, v217
  s_nop 0
  v_permlane16_swap_b32 v215, v218
  v_permlane16_swap_b32 v217, v219
  s_nop 0
  v_add_f32 v215, v215, v218
  v_add_f32 v217, v217, v219
  v_cmp_gt_u32 vcc, 16, v104
  v_lshlrev_b32 v196, 3, v104
  v_lshrrev_b32 v197, 4, v104
  v_cndmask_b32 v194, v216, v214, vcc
  v_cndmask_b32_e64 v195, v217, v215, vcc
  v_and_b32 v45, 0x78, v196
  v_lshl_add_u32 v45, v197, 10, v45
  v_or_b32 v195, 1, v195
  v_cmp_gt_u32 vcc, 32, v104
  s_and_saveexec_b64 s[96:97], vcc
  buffer_store_dwordx2 v[194:195], v196, s[44:47], s90 offen sc1
  s_mov_b64 exec, s[96:97]
  v_pk_mul_f32 v[0:1], v[0:1], v[80:81]
  v_pk_mul_f32 v[2:3], v[2:3], v[82:83]
  v_pk_mul_f32 v[8:9], v[8:9], v[84:85]
  v_pk_mul_f32 v[10:11], v[10:11], v[86:87]
  v_pk_mul_f32 v[16:17], v[16:17], v[88:89]
  v_pk_mul_f32 v[18:19], v[18:19], v[90:91]
  v_pk_mul_f32 v[24:25], v[24:25], v[92:93]
  v_pk_mul_f32 v[26:27], v[26:27], v[94:95]
  v_pk_mul_f32 v[4:5], v[4:5], v[80:81]
  v_pk_mul_f32 v[6:7], v[6:7], v[82:83]
  v_pk_mul_f32 v[12:13], v[12:13], v[84:85]
  v_pk_mul_f32 v[14:15], v[14:15], v[86:87]
  v_pk_mul_f32 v[20:21], v[20:21], v[88:89]
  v_pk_mul_f32 v[22:23], v[22:23], v[90:91]
  v_pk_mul_f32 v[28:29], v[28:29], v[92:93]
  v_pk_mul_f32 v[30:31], v[30:31], v[94:95]
  v_accvgpr_write_b32 a240, v198
  v_accvgpr_write_b32 a241, v199
  v_accvgpr_write_b32 a242, v200
  v_accvgpr_write_b32 a243, v201
  v_accvgpr_write_b32 a244, v202
  v_accvgpr_write_b32 a245, v203
  v_accvgpr_write_b32 a246, v204
  v_accvgpr_write_b32 a247, v205
  v_accvgpr_write_b32 a248, v206
  v_accvgpr_write_b32 a249, v207
  v_accvgpr_write_b32 a250, v208
  v_accvgpr_write_b32 a251, v209
  v_accvgpr_write_b32 a252, v210
  v_accvgpr_write_b32 a253, v211
  v_accvgpr_write_b32 a254, v212
  v_accvgpr_write_b32 a255, v213
  v_mbcnt_lo_u32_b32 v237, -1, 0
  v_mbcnt_hi_u32_b32 v237, -1, v237
  v_lshlrev_b32_e64 v238, 4, v237
  v_accvgpr_read_b32 v226, a224
  v_accvgpr_read_b32 v227, a225
  v_accvgpr_read_b32 v228, a226
  v_accvgpr_read_b32 v229, a227
  v_accvgpr_read_b32 v230, a228
  v_accvgpr_read_b32 v231, a229
  v_accvgpr_read_b32 v232, a230
  v_lshrrev_b32 v251, 2, v237
  v_mul_u32_u24 v251, 224, v251
  v_and_b32 v252, 3, v237
  v_lshl_add_u32 v224, v252, 3, v251
  v_add_u32 v225, 57344, v224
  s_lshl_b32 s82, s22, 4
  s_lshl_b32 s83, s3, 2
  s_add_u32 s82, s82, s83
  s_lshl_b32 s82, s82, 15
  v_add_u32_e64 v233, s82, v238
  v_add_u32 v234, 32768, v233
  v_add_u32 v235, 65536, v233
  v_add_u32 v236, 98304, v233
  s_add_u32 s69, s21, 0
  s_and_b32 s69, s69, 3
  s_mul_i32 s69, s69, 458752
  s_add_u32 m0, s68, 86016
  s_nop 0
  buffer_load_dwordx4 v226, s[64:67], s69 offen lds
  s_nop 0
  buffer_load_dwordx4 v227, s[64:67], s69 offen offset:1024 lds
  s_nop 0
  buffer_load_dwordx4 v228, s[64:67], s69 offen offset:2048 lds
  s_nop 0
  buffer_load_dwordx4 v229, s[64:67], s69 offen offset:3072 lds
  s_add_u32 m0, s68, 90112
  s_nop 0
  buffer_load_dwordx4 v230, s[64:67], s69 offen lds
  s_nop 0
  buffer_load_dwordx4 v231, s[64:67], s69 offen offset:1024 lds
  s_nop 0
  buffer_load_dwordx4 v232, s[64:67], s69 offen offset:2048 lds
  s_add_u32 s70, s21, 1
  s_and_b32 s70, s70, 3
  s_mul_i32 s70, s70, 458752
  s_add_u32 m0, s68, 57344
  s_nop 0
  buffer_load_dwordx4 v226, s[64:67], s70 offen lds
  s_nop 0
  buffer_load_dwordx4 v227, s[64:67], s70 offen offset:1024 lds
  s_nop 0
  buffer_load_dwordx4 v228, s[64:67], s70 offen offset:2048 lds
  s_nop 0
  buffer_load_dwordx4 v229, s[64:67], s70 offen offset:3072 lds
  s_add_u32 m0, s68, 61440
  s_nop 0
  buffer_load_dwordx4 v230, s[64:67], s70 offen lds
  s_nop 0
  buffer_load_dwordx4 v231, s[64:67], s70 offen offset:1024 lds
  s_nop 0
  buffer_load_dwordx4 v232, s[64:67], s70 offen offset:2048 lds
  s_mov_b32 s96, 0
L_poll_34:
  s_nop 0
  buffer_load_dwordx2 v[48:49], v45, s[44:47], s91 offen offset:0 sc1
  buffer_load_dwordx2 v[50:51], v45, s[44:47], s91 offen offset:256 sc1
  buffer_load_dwordx2 v[52:53], v45, s[44:47], s91 offen offset:512 sc1
  buffer_load_dwordx2 v[54:55], v45, s[44:47], s91 offen offset:768 sc1
  buffer_load_dwordx2 v[56:57], v45, s[44:47], s91 offen offset:128 sc1
  buffer_load_dwordx2 v[58:59], v45, s[44:47], s91 offen offset:384 sc1
  buffer_load_dwordx2 v[60:61], v45, s[44:47], s91 offen offset:640 sc1
  buffer_load_dwordx2 v[62:63], v45, s[44:47], s91 offen offset:896 sc1
  s_waitcnt vmcnt(0)
  v_min_u32 v194, v49, v51
  v_min_u32 v194, v194, v53
  v_min_u32 v194, v194, v55
  v_min_u32 v194, v194, v57
  v_min_u32 v194, v194, v59
  v_min_u32 v194, v194, v61
  v_min_u32 v194, v194, v63
  v_cmp_eq_u32 vcc, 0, v194
  s_add_u32 s96, s96, 1
  s_cmp_eq_u64 vcc, 0
  s_cbranch_scc1 L_ok_35
  s_sleep 2
  s_cmp_lt_u32 s96, 0x200000
  s_cbranch_scc1 L_poll_34
L_ok_35:
  v_add_f32 v214, v48, v50
  v_add_f32 v218, v52, v54
  v_add_f32 v214, v214, v218
  v_add_f32 v215, v49, v51
  v_add_f32 v218, v53, v55
  v_add_f32 v215, v215, v218
  v_add_f32 v216, v56, v58
  v_add_f32 v219, v60, v62
  v_add_f32 v216, v216, v219
  v_add_f32 v217, v57, v59
  v_add_f32 v219, v61, v63
  v_add_f32 v217, v217, v219
  v_mov_b32 v218, v214
  v_mov_b32 v219, v216
  s_nop 0
  v_permlane32_swap_b32 v214, v218
  v_permlane32_swap_b32 v216, v219
  s_nop 0
  v_add_f32 v214, v214, v218
  v_add_f32 v216, v216, v219
  v_mov_b32 v218, v214
  v_mov_b32 v219, v216
  s_nop 0
  v_permlane16_swap_b32 v214, v218
  v_permlane16_swap_b32 v216, v219
  s_nop 0
  v_add_f32 v214, v214, v218
  v_add_f32 v216, v216, v219
  v_mul_f32 v214, -0.0009765625, v214
  v_mul_f32 v216, -0.0009765625, v216
  v_fmamk_f32 v48, v48, 0.015625, v214
  v_fmamk_f32 v56, v56, 0.015625, v216
  v_mul_f32 v48, v48, v48
  v_mul_f32 v56, v56, v56
  v_fmac_f32 v215, 0x42800000, v48
  v_fmac_f32 v217, 0x42800000, v56
  v_fmamk_f32 v50, v50, 0.015625, v214
  v_fmamk_f32 v58, v58, 0.015625, v216
  v_mul_f32 v50, v50, v50
  v_mul_f32 v58, v58, v58
  v_fmac_f32 v215, 0x42800000, v50
  v_fmac_f32 v217, 0x42800000, v58
  v_fmamk_f32 v52, v52, 0.015625, v214
  v_fmamk_f32 v60, v60, 0.015625, v216
  v_mul_f32 v52, v52, v52
  v_mul_f32 v60, v60, v60
  v_fmac_f32 v215, 0x42800000, v52
  v_fmac_f32 v217, 0x42800000, v60
  v_fmamk_f32 v54, v54, 0.015625, v214
  v_fmamk_f32 v62, v62, 0.015625, v216
  v_mul_f32 v54, v54, v54
  v_mul_f32 v62, v62, v62
  v_fmac_f32 v215, 0x42800000, v54
  v_fmac_f32 v217, 0x42800000, v62
  v_mov_b32 v218, v215
  v_mov_b32 v219, v217
  s_nop 0
  v_permlane32_swap_b32 v215, v218
  v_permlane32_swap_b32 v217, v219
  s_nop 0
  v_add_f32 v215, v215, v218
  v_add_f32 v217, v217, v219
  v_mov_b32 v218, v215
  v_mov_b32 v219, v217
  s_nop 0
  v_permlane16_swap_b32 v215, v218
  v_permlane16_swap_b32 v217, v219
  s_nop 0
  v_add_f32 v215, v215, v218
  v_add_f32 v217, v217, v219
  v_mov_b32 v218, 0x3727c5ac
  v_fmac_f32 v218, 0.0009765625, v215
  v_mov_b32 v219, 0x3727c5ac
  v_fmac_f32 v219, 0.0009765625, v217
  v_rsq_f32 v220, v218
  v_rsq_f32 v222, v219
  s_nop 0
  v_mul_f32 v221, v214, v220
  v_mul_f32_e64 v223, v216, v222
  v_pk_fma_f32 v[194:195], v[80:81], v[220:221], v[136:137] op_sel:[0,1,0] op_sel_hi:[1,1,1]
  v_pk_fma_f32 v[196:197], v[82:83], v[220:221], v[138:139] op_sel:[0,1,0] op_sel_hi:[1,1,1]
  v_pk_fma_f32 v[194:195], v[0:1], v[220:221], v[194:195] op_sel_hi:[1,0,1]
  v_pk_fma_f32 v[196:197], v[2:3], v[220:221], v[196:197] op_sel_hi:[1,0,1]
  v_cvt_pk_bf16_f32 v48, v194, v195
  v_cvt_pk_bf16_f32 v49, v196, v197
  v_pk_fma_f32 v[194:195], v[84:85], v[220:221], v[140:141] op_sel:[0,1,0] op_sel_hi:[1,1,1]
  v_pk_fma_f32 v[196:197], v[86:87], v[220:221], v[142:143] op_sel:[0,1,0] op_sel_hi:[1,1,1]
  v_pk_fma_f32 v[194:195], v[8:9], v[220:221], v[194:195] op_sel_hi:[1,0,1]
  v_pk_fma_f32 v[196:197], v[10:11], v[220:221], v[196:197] op_sel_hi:[1,0,1]
  v_cvt_pk_bf16_f32 v50, v194, v195
  v_cvt_pk_bf16_f32 v51, v196, v197
  v_pk_fma_f32 v[194:195], v[88:89], v[220:221], v[144:145] op_sel:[0,1,0] op_sel_hi:[1,1,1]
  v_pk_fma_f32 v[196:197], v[90:91], v[220:221], v[146:147] op_sel:[0,1,0] op_sel_hi:[1,1,1]
  v_pk_fma_f32 v[194:195], v[16:17], v[220:221], v[194:195] op_sel_hi:[1,0,1]
  v_pk_fma_f32 v[196:197], v[18:19], v[220:221], v[196:197] op_sel_hi:[1,0,1]
  v_cvt_pk_bf16_f32 v52, v194, v195
  v_cvt_pk_bf16_f32 v53, v196, v197
  v_pk_fma_f32 v[194:195], v[92:93], v[220:221], v[148:149] op_sel:[0,1,0] op_sel_hi:[1,1,1]
  v_pk_fma_f32 v[196:197], v[94:95], v[220:221], v[150:151] op_sel:[0,1,0] op_sel_hi:[1,1,1]
  v_pk_fma_f32 v[194:195], v[24:25], v[220:221], v[194:195] op_sel_hi:[1,0,1]
  v_pk_fma_f32 v[196:197], v[26:27], v[220:221], v[196:197] op_sel_hi:[1,0,1]
  v_cvt_pk_bf16_f32 v54, v194, v195
  v_cvt_pk_bf16_f32 v55, v196, v197
  buffer_store_dwordx4 v[48:51], v105, s[40:43], s88 offen offset:0 sc1
  buffer_store_dwordx4 v[52:55], v105, s[40:43], s88 offen offset:1024 sc1
  v_pk_fma_f32 v[194:195], v[80:81], v[222:223], v[136:137] op_sel:[0,1,0] op_sel_hi:[1,1,1]
  v_pk_fma_f32 v[196:197], v[82:83], v[222:223], v[138:139] op_sel:[0,1,0] op_sel_hi:[1,1,1]
  v_pk_fma_f32 v[194:195], v[4:5], v[222:223], v[194:195] op_sel_hi:[1,0,1]
  v_pk_fma_f32 v[196:197], v[6:7], v[222:223], v[196:197] op_sel_hi:[1,0,1]
  v_cvt_pk_bf16_f32 v56, v194, v195
  v_cvt_pk_bf16_f32 v57, v196, v197
  v_pk_fma_f32 v[194:195], v[84:85], v[222:223], v[140:141] op_sel:[0,1,0] op_sel_hi:[1,1,1]
  v_pk_fma_f32 v[196:197], v[86:87], v[222:223], v[142:143] op_sel:[0,1,0] op_sel_hi:[1,1,1]
  v_pk_fma_f32 v[194:195], v[12:13], v[222:223], v[194:195] op_sel_hi:[1,0,1]
  v_pk_fma_f32 v[196:197], v[14:15], v[222:223], v[196:197] op_sel_hi:[1,0,1]
  v_cvt_pk_bf16_f32 v58, v194, v195
  v_cvt_pk_bf16_f32 v59, v196, v197
  v_pk_fma_f32 v[194:195], v[88:89], v[222:223], v[144:145] op_sel:[0,1,0] op_sel_hi:[1,1,1]
  v_pk_fma_f32 v[196:197], v[90:91], v[222:223], v[146:147] op_sel:[0,1,0] op_sel_hi:[1,1,1]
  v_pk_fma_f32 v[194:195], v[20:21], v[222:223], v[194:195] op_sel_hi:[1,0,1]
  v_pk_fma_f32 v[196:197], v[22:23], v[222:223], v[196:197] op_sel_hi:[1,0,1]
  v_cvt_pk_bf16_f32 v60, v194, v195
  v_cvt_pk_bf16_f32 v61, v196, v197
  v_pk_fma_f32 v[194:195], v[92:93], v[222:223], v[148:149] op_sel:[0,1,0] op_sel_hi:[1,1,1]
  v_pk_fma_f32 v[196:197], v[94:95], v[222:223], v[150:151] op_sel:[0,1,0] op_sel_hi:[1,1,1]
  v_pk_fma_f32 v[194:195], v[28:29], v[222:223], v[194:195] op_sel_hi:[1,0,1]
  v_pk_fma_f32 v[196:197], v[30:31], v[222:223], v[196:197] op_sel_hi:[1,0,1]
  v_cvt_pk_bf16_f32 v62, v194, v195
  v_cvt_pk_bf16_f32 v63, v196, v197
  buffer_store_dwordx4 v[56:59], v105, s[40:43], s89 offen offset:0 sc1
  buffer_store_dwordx4 v[60:63], v105, s[40:43], s89 offen offset:1024 sc1
  v_mov_b32 v40, 1
  v_mov_b32 v41, 0
  s_waitcnt vmcnt(0)
  buffer_store_dword v40, v41, s[56:59], s84 offen sc1
  s_add_u32 s36, s28, 50331648
  s_addc_u32 s37, s29, 0
  s_mov_b32 s38, 4194304
  s_mov_b32 s39, 0x20000
  s_add_u32 s48, s28, 67108864
  s_addc_u32 s49, s29, 0
  s_mov_b32 s50, 14680064
  s_mov_b32 s51, 0x20000
  v_and_b32 v248, 31, v237
  v_lshlrev_b32 v248, 6, v248
  s_lshl_b32 s84, s22, 2
  s_add_u32 s84, s84, s3
  s_lshl_b32 s85, s84, 11
  s_add_u32 s85, s85, 196608
  s_mov_b32 s97, 0
  s_add_u32 s80, s21, 0
  s_and_b32 s80, s80, 3
  s_lshl_b32 s81, 1, s80
  s_or_b32 s97, s97, s81
  s_add_u32 s80, s21, 1
  s_and_b32 s80, s80, 3
  s_lshl_b32 s81, 1, s80
  s_or_b32 s97, s97, s81
  s_add_u32 s80, s21, 2
  s_and_b32 s80, s80, 3
  s_lshl_b32 s81, 1, s80
  s_or_b32 s97, s97, s81
  s_lshl_b32 s81, s97, 16
  s_or_b32 s97, s97, s81
  s_mov_b32 s96, 0
L_poll_36:
  buffer_load_dword v249, v248, s[56:59], s85 offen sc1
  s_waitcnt vmcnt(0)
  v_cmp_eq_u32 vcc, 0, v249
  s_add_u32 s96, s96, 1
  s_and_b32 s81, vcc_lo, s97
  s_cbranch_scc0 L_ok_37
  s_sleep 2
  s_cmp_lt_u32 s96, 0x200000
  s_cbranch_scc1 L_poll_36
L_ok_37:
  s_add_u32 s62, s21, 0
  s_and_b32 s62, s62, 3
  s_nop 0
  s_mul_i32 s62, s62, 2048
  buffer_load_dwordx4 a[112:115], v233, s[36:39], s62 offen offset:0 sc1
  buffer_load_dwordx4 a[116:119], v234, s[36:39], s62 offen offset:0 sc1
  buffer_load_dwordx4 a[120:123], v235, s[36:39], s62 offen offset:0 sc1
  buffer_load_dwordx4 a[124:127], v236, s[36:39], s62 offen offset:0 sc1
  buffer_load_dwordx4 a[128:131], v233, s[36:39], s62 offen offset:1024 sc1
  buffer_load_dwordx4 a[132:135], v234, s[36:39], s62 offen offset:1024 sc1
  buffer_load_dwordx4 a[136:139], v235, s[36:39], s62 offen offset:1024 sc1
  buffer_load_dwordx4 a[140:143], v236, s[36:39], s62 offen offset:1024 sc1
  s_mul_i32 s8, s84, 458752
  s_mul_i32 s92, s23, 3584
  s_add_u32 s8, s8, s92
  s_add_u32 s9, s8, 114688
  s_add_u32 s10, s8, 229376
  s_add_u32 s11, s8, 344064
  s_lshl_b32 s93, s84, 11
  s_lshl_b32 s94, s23, 6
  s_add_u32 s93, s93, s94
  s_add_u32 s94, s93, 393216
  s_add_u32 s93, s93, 262144
  s_mov_b32 s12, -1.4426950408889634
  s_mov_b32 s13, -1.4426950408889634
  v_lshrrev_b32 v241, 1, v238
  s_waitcnt vmcnt(8)
  s_barrier
  s_nop 0
  ds_read_b64_tr_b16 a[0:1], v225 offset:28672
  ds_read_b64_tr_b16 a[2:3], v225 offset:32256
  ds_read_b64_tr_b16 a[4:5], v225 offset:43008
  ds_read_b64_tr_b16 a[6:7], v225 offset:46592
  ds_read_b64_tr_b16 a[8:9], v225 offset:28704
  ds_read_b64_tr_b16 a[10:11], v225 offset:32288
  ds_read_b64_tr_b16 a[12:13], v225 offset:43040
  ds_read_b64_tr_b16 a[14:15], v225 offset:46624
  ds_read_b64_tr_b16 a[16:17], v225 offset:28736
  ds_read_b64_tr_b16 a[18:19], v225 offset:32320
  ds_read_b64_tr_b16 a[20:21], v225 offset:43072
  ds_read_b64_tr_b16 a[22:23], v225 offset:46656
  ds_read_b64_tr_b16 a[24:25], v225 offset:28768
  ds_read_b64_tr_b16 a[26:27], v225 offset:32352
  ds_read_b64_tr_b16 a[28:29], v225 offset:43104
  ds_read_b64_tr_b16 a[30:31], v225 offset:46688
  ds_read_b64_tr_b16 a[32:33], v225 offset:28800
  ds_read_b64_tr_b16 a[34:35], v225 offset:32384
  ds_read_b64_tr_b16 a[36:37], v225 offset:43136
  ds_read_b64_tr_b16 a[38:39], v225 offset:46720
  ds_read_b64_tr_b16 a[40:41], v225 offset:28832
  ds_read_b64_tr_b16 a[42:43], v225 offset:32416
  ds_read_b64_tr_b16 a[44:45], v225 offset:43168
  ds_read_b64_tr_b16 a[46:47], v225 offset:46752
  ds_read_b64_tr_b16 a[48:49], v225 offset:28864
  ds_read_b64_tr_b16 a[50:51], v225 offset:32448
  ds_read_b64_tr_b16 a[52:53], v225 offset:43200
  ds_read_b64_tr_b16 a[54:55], v225 offset:46784
  s_waitcnt vmcnt(4) lgkmcnt(0)
  v_mfma_f32_16x16x32_bf16 v[0:3], a[0:3], a[112:115], 0
  ds_read_b64_tr_b16 a[56:57], v225 offset:35840
  v_mfma_f32_16x16x32_bf16 v[4:7], a[0:3], a[116:119], 0
  s_add_u32 s63, s21, 1
  v_mfma_f32_16x16x32_bf16 v[8:11], a[0:3], a[120:123], 0
  ds_read_b64_tr_b16 a[58:59], v225 offset:39424
  v_mfma_f32_16x16x32_bf16 v[12:15], a[0:3], a[124:127], 0
  ds_read_b64_tr_b16 a[60:61], v225 offset:50176
  v_mfma_f32_16x16x32_bf16 v[28:31], a[4:7], a[124:127], 0
  s_and_b32 s63, s63, 3
  v_mfma_f32_16x16x32_bf16 v[24:27], a[4:7], a[120:123], 0
  ds_read_b64_tr_b16 a[62:63], v225 offset:53760
  v_mfma_f32_16x16x32_bf16 v[20:23], a[4:7], a[116:119], 0
  s_mul_i32 s63, s63, 2048
  v_mfma_f32_16x16x32_bf16 v[16:19], a[4:7], a[112:115], 0
  ds_read_b64_tr_b16 a[64:65], v225 offset:35872
  v_mfma_f32_16x16x32_bf16 v[32:35], a[8:11], a[112:115], 0
  ds_read_b64_tr_b16 a[66:67], v225 offset:39456
  v_mfma_f32_16x16x32_bf16 v[36:39], a[8:11], a[116:119], 0
  buffer_load_dwordx4 a[144:147], v233, s[36:39], s63 offen offset:0 sc1
  v_mfma_f32_16x16x32_bf16 v[40:43], a[8:11], a[120:123], 0
  ds_read_b64_tr_b16 a[68:69], v225 offset:50208
  v_mfma_f32_16x16x32_bf16 v[44:47], a[8:11], a[124:127], 0
  s_add_u32 s69, s21, 2
  v_mfma_f32_16x16x32_bf16 v[60:63], a[12:15], a[124:127], 0
  ds_read_b64_tr_b16 a[70:71], v225 offset:53792
  v_mfma_f32_16x16x32_bf16 v[56:59], a[12:15], a[120:123], 0
  ds_read_b64_tr_b16 a[72:73], v225 offset:35904
  v_mfma_f32_16x16x32_bf16 v[52:55], a[12:15], a[116:119], 0
  s_and_b32 s69, s69, 3
  v_mfma_f32_16x16x32_bf16 v[48:51], a[12:15], a[112:115], 0
  ds_read_b64_tr_b16 a[74:75], v225 offset:39488
  v_mfma_f32_16x16x32_bf16 v[64:67], a[16:19], a[112:115], 0
  s_mul_i32 s69, s69, 458752
  v_mfma_f32_16x16x32_bf16 v[68:71], a[16:19], a[116:119], 0
  ds_read_b64_tr_b16 a[76:77], v225 offset:50240
  v_mfma_f32_16x16x32_bf16 v[72:75], a[16:19], a[120:123], 0
  ds_read_b64_tr_b16 a[78:79], v225 offset:53824
  v_mfma_f32_16x16x32_bf16 v[76:79], a[16:19], a[124:127], 0
  s_add_u32 m0, s68, 28672
  v_mfma_f32_16x16x32_bf16 v[92:95], a[20:23], a[124:127], 0
  ds_read_b64_tr_b16 a[80:81], v225 offset:35936
  v_mfma_f32_16x16x32_bf16 v[88:91], a[20:23], a[120:123], 0
  buffer_load_dwordx4 v226, s[64:67], s69 offen lds
  v_mfma_f32_16x16x32_bf16 v[84:87], a[20:23], a[116:119], 0
  ds_read_b64_tr_b16 a[82:83], v225 offset:39520
  v_mfma_f32_16x16x32_bf16 v[80:83], a[20:23], a[112:115], 0
  v_mfma_f32_16x16x32_bf16 v[96:99], a[24:27], a[112:115], 0
  ds_read_b64_tr_b16 a[84:85], v225 offset:50272
  v_mfma_f32_16x16x32_bf16 v[100:103], a[24:27], a[116:119], 0
  buffer_load_dwordx4 a[148:151], v234, s[36:39], s63 offen offset:0 sc1
  v_mfma_f32_16x16x32_bf16 v[104:107], a[24:27], a[120:123], 0
  ds_read_b64_tr_b16 a[86:87], v225 offset:53856
  v_mfma_f32_16x16x32_bf16 v[108:111], a[24:27], a[124:127], 0
  v_mfma_f32_16x16x32_bf16 v[124:127], a[28:31], a[124:127], 0
  ds_read_b64_tr_b16 a[88:89], v225 offset:35968
  v_mfma_f32_16x16x32_bf16 v[120:123], a[28:31], a[120:123], 0
  ds_read_b64_tr_b16 a[90:91], v225 offset:39552
  v_mfma_f32_16x16x32_bf16 v[116:119], a[28:31], a[116:119], 0
  buffer_load_dwordx4 v227, s[64:67], s69 offen offset:1024 lds
  v_mfma_f32_16x16x32_bf16 v[112:115], a[28:31], a[112:115], 0
  ds_read_b64_tr_b16 a[92:93], v225 offset:50304
  v_mfma_f32_16x16x32_bf16 v[128:131], a[32:35], a[112:115], 0
  buffer_load_dwordx4 a[152:155], v235, s[36:39], s63 offen offset:0 sc1
  v_mfma_f32_16x16x32_bf16 v[132:135], a[32:35], a[116:119], 0
  ds_read_b64_tr_b16 a[94:95], v225 offset:53888
  v_mfma_f32_16x16x32_bf16 v[136:139], a[32:35], a[120:123], 0
  ds_read_b64_tr_b16 a[96:97], v225 offset:36000
  v_mfma_f32_16x16x32_bf16 v[140:143], a[32:35], a[124:127], 0
  v_mfma_f32_16x16x32_bf16 v[156:159], a[36:39], a[124:127], 0
  ds_read_b64_tr_b16 a[98:99], v225 offset:39584
  v_mfma_f32_16x16x32_bf16 v[152:155], a[36:39], a[120:123], 0
  buffer_load_dwordx4 v228, s[64:67], s69 offen offset:2048 lds
  v_mfma_f32_16x16x32_bf16 v[148:151], a[36:39], a[116:119], 0
  ds_read_b64_tr_b16 a[100:101], v225 offset:50336
  v_mfma_f32_16x16x32_bf16 v[144:147], a[36:39], a[112:115], 0
  ds_read_b64_tr_b16 a[102:103], v225 offset:53920
  v_mfma_f32_16x16x32_bf16 v[160:163], a[40:43], a[112:115], 0
  buffer_load_dwordx4 a[156:159], v236, s[36:39], s63 offen offset:0 sc1
  v_mfma_f32_16x16x32_bf16 v[164:167], a[40:43], a[116:119], 0
  ds_read_b64_tr_b16 a[104:105], v225 offset:36032
  v_mfma_f32_16x16x32_bf16 v[168:171], a[40:43], a[120:123], 0
  v_mfma_f32_16x16x32_bf16 v[172:175], a[40:43], a[124:127], 0
  ds_read_b64_tr_b16 a[106:107], v225 offset:39616
  v_mfma_f32_16x16x32_bf16 v[188:191], a[44:47], a[124:127], 0
  buffer_load_dwordx4 v229, s[64:67], s69 offen offset:3072 lds
  v_mfma_f32_16x16x32_bf16 v[184:187], a[44:47], a[120:123], 0
  ds_read_b64_tr_b16 a[108:109], v225 offset:50368
  v_mfma_f32_16x16x32_bf16 v[180:183], a[44:47], a[116:119], 0
  ds_read_b64_tr_b16 a[110:111], v225 offset:53952
  v_mfma_f32_16x16x32_bf16 v[176:179], a[44:47], a[112:115], 0
  s_add_u32 m0, s68, 32768
  v_mfma_f32_16x16x32_bf16 v[192:195], a[48:51], a[112:115], 0
  v_mfma_f32_16x16x32_bf16 v[196:199], a[48:51], a[116:119], 0
  buffer_load_dwordx4 v230, s[64:67], s69 offen lds
  v_mfma_f32_16x16x32_bf16 v[200:203], a[48:51], a[120:123], 0
  v_mfma_f32_16x16x32_bf16 v[204:207], a[48:51], a[124:127], 0
  v_mfma_f32_16x16x32_bf16 v[220:223], a[52:55], a[124:127], 0
  v_mfma_f32_16x16x32_bf16 v[216:219], a[52:55], a[120:123], 0
  v_mfma_f32_16x16x32_bf16 v[212:215], a[52:55], a[116:119], 0
  buffer_load_dwordx4 v231, s[64:67], s69 offen offset:1024 lds
  v_mfma_f32_16x16x32_bf16 v[208:211], a[52:55], a[112:115], 0
  s_waitcnt vmcnt(10) lgkmcnt(0)
  v_mfma_f32_16x16x32_bf16 v[0:3], a[56:59], a[128:131], v[0:3]
  s_waitcnt vmcnt(18)
  s_barrier
  v_mfma_f32_16x16x32_bf16 v[4:7], a[56:59], a[132:135], v[4:7]
  ds_read_b64_tr_b16 a[0:1], v225 offset:0
  v_mfma_f32_16x16x32_bf16 v[8:11], a[56:59], a[136:139], v[8:11]
  buffer_load_dwordx4 a[160:163], v233, s[36:39], s63 offen offset:1024 sc1
  v_mfma_f32_16x16x32_bf16 v[12:15], a[56:59], a[140:143], v[12:15]
  ds_read_b64_tr_b16 a[2:3], v225 offset:3584
  v_mfma_f32_16x16x32_bf16 v[28:31], a[60:63], a[140:143], v[28:31]
  ds_read_b64_tr_b16 a[4:5], v225 offset:14336
  v_mfma_f32_16x16x32_bf16 v[24:27], a[60:63], a[136:139], v[24:27]
  v_mfma_f32_16x16x32_bf16 v[20:23], a[60:63], a[132:135], v[20:23]
  ds_read_b64_tr_b16 a[6:7], v225 offset:17920
  v_mfma_f32_16x16x32_bf16 v[16:19], a[60:63], a[128:131], v[16:19]
  ds_read_b64_tr_b16 a[8:9], v225 offset:32
  v_mfma_f32_16x16x32_bf16 v[32:35], a[64:67], a[128:131], v[32:35]
  buffer_load_dwordx4 v232, s[64:67], s69 offen offset:2048 lds
  v_mfma_f32_16x16x32_bf16 v[36:39], a[64:67], a[132:135], v[36:39]
  ds_read_b64_tr_b16 a[10:11], v225 offset:3616
  v_mfma_f32_16x16x32_bf16 v[40:43], a[64:67], a[136:139], v[40:43]
  v_mfma_f32_16x16x32_bf16 v[44:47], a[64:67], a[140:143], v[44:47]
  ds_read_b64_tr_b16 a[12:13], v225 offset:14368
  v_mfma_f32_16x16x32_bf16 v[60:63], a[68:71], a[140:143], v[60:63]
  buffer_load_dwordx4 a[164:167], v234, s[36:39], s63 offen offset:1024 sc1
  v_mfma_f32_16x16x32_bf16 v[56:59], a[68:71], a[136:139], v[56:59]
  ds_read_b64_tr_b16 a[14:15], v225 offset:17952
  v_mfma_f32_16x16x32_bf16 v[52:55], a[68:71], a[132:135], v[52:55]
  ds_read_b64_tr_b16 a[16:17], v225 offset:64
  v_mfma_f32_16x16x32_bf16 v[48:51], a[68:71], a[128:131], v[48:51]
  s_add_u32 s70, s21, 3
  v_mfma_f32_16x16x32_bf16 v[64:67], a[72:75], a[128:131], v[64:67]
  ds_read_b64_tr_b16 a[18:19], v225 offset:3648
  v_mfma_f32_16x16x32_bf16 v[68:71], a[72:75], a[132:135], v[68:71]
  ds_read_b64_tr_b16 a[20:21], v225 offset:14400
  v_mfma_f32_16x16x32_bf16 v[72:75], a[72:75], a[136:139], v[72:75]
  s_and_b32 s70, s70, 3
  v_mfma_f32_16x16x32_bf16 v[76:79], a[72:75], a[140:143], v[76:79]
  ds_read_b64_tr_b16 a[22:23], v225 offset:17984
  v_mfma_f32_16x16x32_bf16 v[92:95], a[76:79], a[140:143], v[92:95]
  s_mul_i32 s70, s70, 458752
  v_mfma_f32_16x16x32_bf16 v[88:91], a[76:79], a[136:139], v[88:91]
  ds_read_b64_tr_b16 a[24:25], v225 offset:96
  v_mfma_f32_16x16x32_bf16 v[84:87], a[76:79], a[132:135], v[84:87]
  ds_read_b64_tr_b16 a[26:27], v225 offset:3680
  v_mfma_f32_16x16x32_bf16 v[80:83], a[76:79], a[128:131], v[80:83]
  s_add_u32 m0, s68, 0
  v_mfma_f32_16x16x32_bf16 v[96:99], a[80:83], a[128:131], v[96:99]
  ds_read_b64_tr_b16 a[28:29], v225 offset:14432
  v_mfma_f32_16x16x32_bf16 v[100:103], a[80:83], a[132:135], v[100:103]
  v_mfma_f32_16x16x32_bf16 v[104:107], a[80:83], a[136:139], v[104:107]
  ds_read_b64_tr_b16 a[30:31], v225 offset:18016
  v_mfma_f32_16x16x32_bf16 v[108:111], a[80:83], a[140:143], v[108:111]
  buffer_load_dwordx4 v226, s[64:67], s70 offen lds
  v_mfma_f32_16x16x32_bf16 v[124:127], a[84:87], a[140:143], v[124:127]
  ds_read_b64_tr_b16 a[32:33], v225 offset:128
  v_mfma_f32_16x16x32_bf16 v[120:123], a[84:87], a[136:139], v[120:123]
  ds_read_b64_tr_b16 a[34:35], v225 offset:3712
  v_mfma_f32_16x16x32_bf16 v[116:119], a[84:87], a[132:135], v[116:119]
  buffer_load_dwordx4 a[168:171], v235, s[36:39], s63 offen offset:1024 sc1
  v_mfma_f32_16x16x32_bf16 v[112:115], a[84:87], a[128:131], v[112:115]
  ds_read_b64_tr_b16 a[36:37], v225 offset:14464
  v_mfma_f32_16x16x32_bf16 v[128:131], a[88:91], a[128:131], v[128:131]
  ds_read_b64_tr_b16 a[38:39], v225 offset:18048
  v_mfma_f32_16x16x32_bf16 v[132:135], a[88:91], a[132:135], v[132:135]
  buffer_load_dwordx4 a[172:175], v236, s[36:39], s63 offen offset:1024 sc1
  v_mfma_f32_16x16x32_bf16 v[136:139], a[88:91], a[136:139], v[136:139]
  ds_read_b64_tr_b16 a[40:41], v225 offset:160
  v_mfma_f32_16x16x32_bf16 v[140:143], a[88:91], a[140:143], v[140:143]
  v_mfma_f32_16x16x32_bf16 v[156:159], a[92:95], a[140:143], v[156:159]
  s_add_u32 s62, s21, 2
  v_mfma_f32_16x16x32_bf16 v[152:155], a[92:95], a[136:139], v[152:155]
  ds_read_b64_tr_b16 a[42:43], v225 offset:3744
  v_mfma_f32_16x16x32_bf16 v[148:151], a[92:95], a[132:135], v[148:151]
  ds_read_b64_tr_b16 a[44:45], v225 offset:14496
  v_mfma_f32_16x16x32_bf16 v[144:147], a[92:95], a[128:131], v[144:147]
  s_and_b32 s62, s62, 3
  v_mfma_f32_16x16x32_bf16 v[160:163], a[96:99], a[128:131], v[160:163]
  ds_read_b64_tr_b16 a[46:47], v225 offset:18080
  v_mfma_f32_16x16x32_bf16 v[164:167], a[96:99], a[132:135], v[164:167]
  ds_read_b64_tr_b16 a[48:49], v225 offset:192
  v_mfma_f32_16x16x32_bf16 v[168:171], a[96:99], a[136:139], v[168:171]
  s_mul_i32 s62, s62, 2048
  v_mfma_f32_16x16x32_bf16 v[172:175], a[96:99], a[140:143], v[172:175]
  ds_read_b64_tr_b16 a[50:51], v225 offset:3776
  v_mfma_f32_16x16x32_bf16 v[188:191], a[100:103], a[140:143], v[188:191]
  ds_read_b64_tr_b16 a[52:53], v225 offset:14528
  v_mfma_f32_16x16x32_bf16 v[184:187], a[100:103], a[136:139], v[184:187]
  buffer_load_dwordx4 a[176:179], v233, s[36:39], s62 offen offset:0 sc1
  v_mfma_f32_16x16x32_bf16 v[180:183], a[100:103], a[132:135], v[180:183]
  ds_read_b64_tr_b16 a[54:55], v225 offset:18112
  v_mfma_f32_16x16x32_bf16 v[176:179], a[100:103], a[128:131], v[176:179]
  v_mfma_f32_16x16x32_bf16 v[192:195], a[104:107], a[128:131], v[192:195]
  buffer_load_dwordx4 a[180:183], v234, s[36:39], s62 offen offset:0 sc1
  v_mfma_f32_16x16x32_bf16 v[196:199], a[104:107], a[132:135], v[196:199]
  v_mfma_f32_16x16x32_bf16 v[200:203], a[104:107], a[136:139], v[200:203]
  v_mfma_f32_16x16x32_bf16 v[204:207], a[104:107], a[140:143], v[204:207]
  buffer_load_dwordx4 a[184:187], v235, s[36:39], s62 offen offset:0 sc1
  v_mfma_f32_16x16x32_bf16 v[220:223], a[108:111], a[140:143], v[220:223]
  v_mfma_f32_16x16x32_bf16 v[216:219], a[108:111], a[136:139], v[216:219]
  v_mfma_f32_16x16x32_bf16 v[212:215], a[108:111], a[132:135], v[212:215]
  buffer_load_dwordx4 a[188:191], v236, s[36:39], s62 offen offset:0 sc1
  v_mfma_f32_16x16x32_bf16 v[208:211], a[108:111], a[128:131], v[208:211]
  s_waitcnt vmcnt(13) lgkmcnt(0)
  v_mfma_f32_16x16x32_bf16 v[0:3], a[0:3], a[144:147], v[0:3]
  ds_read_b64_tr_b16 a[56:57], v225 offset:7168
  v_mfma_f32_16x16x32_bf16 v[4:7], a[0:3], a[148:151], v[4:7]
  buffer_load_dword v249, v248, s[56:59], s85 offen sc1
  v_mfma_f32_16x16x32_bf16 v[8:11], a[0:3], a[152:155], v[8:11]
  ds_read_b64_tr_b16 a[58:59], v225 offset:10752
  v_mfma_f32_16x16x32_bf16 v[12:15], a[0:3], a[156:159], v[12:15]
  ds_read_b64_tr_b16 a[60:61], v225 offset:21504
  v_mfma_f32_16x16x32_bf16 v[28:31], a[4:7], a[156:159], v[28:31]
  buffer_load_dwordx4 a[192:195], v233, s[36:39], s62 offen offset:1024 sc1
  v_mfma_f32_16x16x32_bf16 v[24:27], a[4:7], a[152:155], v[24:27]
  ds_read_b64_tr_b16 a[62:63], v225 offset:25088
  v_mfma_f32_16x16x32_bf16 v[20:23], a[4:7], a[148:151], v[20:23]
  ds_read_b64_tr_b16 a[64:65], v225 offset:7200
  v_mfma_f32_16x16x32_bf16 v[16:19], a[4:7], a[144:147], v[16:19]
  v_mfma_f32_16x16x32_bf16 v[32:35], a[8:11], a[144:147], v[32:35]
  v_mfma_f32_16x16x32_bf16 v[36:39], a[8:11], a[148:151], v[36:39]
  ds_read_b64_tr_b16 a[66:67], v225 offset:10784
  v_mfma_f32_16x16x32_bf16 v[40:43], a[8:11], a[152:155], v[40:43]
  ds_read_b64_tr_b16 a[68:69], v225 offset:21536
  v_mfma_f32_16x16x32_bf16 v[44:47], a[8:11], a[156:159], v[44:47]
  buffer_load_dwordx4 v227, s[64:67], s70 offen offset:1024 lds
  v_mfma_f32_16x16x32_bf16 v[60:63], a[12:15], a[156:159], v[60:63]
  ds_read_b64_tr_b16 a[70:71], v225 offset:25120
  v_mfma_f32_16x16x32_bf16 v[56:59], a[12:15], a[152:155], v[56:59]
  ds_read_b64_tr_b16 a[72:73], v225 offset:7232
  v_mfma_f32_16x16x32_bf16 v[52:55], a[12:15], a[148:151], v[52:55]
  buffer_load_dwordx4 a[196:199], v234, s[36:39], s62 offen offset:1024 sc1
  v_mfma_f32_16x16x32_bf16 v[48:51], a[12:15], a[144:147], v[48:51]
  ds_read_b64_tr_b16 a[74:75], v225 offset:10816
  v_mfma_f32_16x16x32_bf16 v[64:67], a[16:19], a[144:147], v[64:67]
  v_mfma_f32_16x16x32_bf16 v[68:71], a[16:19], a[148:151], v[68:71]
  ds_read_b64_tr_b16 a[76:77], v225 offset:21568
  v_mfma_f32_16x16x32_bf16 v[72:75], a[16:19], a[152:155], v[72:75]
  v_mfma_f32_16x16x32_bf16 v[76:79], a[16:19], a[156:159], v[76:79]
  ds_read_b64_tr_b16 a[78:79], v225 offset:25152
  v_mfma_f32_16x16x32_bf16 v[92:95], a[20:23], a[156:159], v[92:95]
  ds_read_b64_tr_b16 a[80:81], v225 offset:7264
  v_mfma_f32_16x16x32_bf16 v[88:91], a[20:23], a[152:155], v[88:91]
  buffer_load_dwordx4 v228, s[64:67], s70 offen offset:2048 lds
  v_mfma_f32_16x16x32_bf16 v[84:87], a[20:23], a[148:151], v[84:87]
  ds_read_b64_tr_b16 a[82:83], v225 offset:10848
  v_mfma_f32_16x16x32_bf16 v[80:83], a[20:23], a[144:147], v[80:83]
  v_mfma_f32_16x16x32_bf16 v[96:99], a[24:27], a[144:147], v[96:99]
  ds_read_b64_tr_b16 a[84:85], v225 offset:21600
  v_mfma_f32_16x16x32_bf16 v[100:103], a[24:27], a[148:151], v[100:103]
  buffer_load_dwordx4 a[200:203], v235, s[36:39], s62 offen offset:1024 sc1
  v_mfma_f32_16x16x32_bf16 v[104:107], a[24:27], a[152:155], v[104:107]
  ds_read_b64_tr_b16 a[86:87], v225 offset:25184
  v_mfma_f32_16x16x32_bf16 v[108:111], a[24:27], a[156:159], v[108:111]
  ds_read_b64_tr_b16 a[88:89], v225 offset:7296
  v_mfma_f32_16x16x32_bf16 v[124:127], a[28:31], a[156:159], v[124:127]
  v_mfma_f32_16x16x32_bf16 v[120:123], a[28:31], a[152:155], v[120:123]
  ds_read_b64_tr_b16 a[90:91], v225 offset:10880
  v_mfma_f32_16x16x32_bf16 v[116:119], a[28:31], a[148:151], v[116:119]
  ds_read_b64_tr_b16 a[92:93], v225 offset:21632
  v_mfma_f32_16x16x32_bf16 v[112:115], a[28:31], a[144:147], v[112:115]
  buffer_load_dwordx4 v229, s[64:67], s70 offen offset:3072 lds
  v_mfma_f32_16x16x32_bf16 v[128:131], a[32:35], a[144:147], v[128:131]
  ds_read_b64_tr_b16 a[94:95], v225 offset:25216
  v_mfma_f32_16x16x32_bf16 v[132:135], a[32:35], a[148:151], v[132:135]
  v_mfma_f32_16x16x32_bf16 v[136:139], a[32:35], a[152:155], v[136:139]
  ds_read_b64_tr_b16 a[96:97], v225 offset:7328
  v_mfma_f32_16x16x32_bf16 v[140:143], a[32:35], a[156:159], v[140:143]
  buffer_load_dwordx4 a[204:207], v236, s[36:39], s62 offen offset:1024 sc1
  v_mfma_f32_16x16x32_bf16 v[156:159], a[36:39], a[156:159], v[156:159]
  ds_read_b64_tr_b16 a[98:99], v225 offset:10912
  v_mfma_f32_16x16x32_bf16 v[152:155], a[36:39], a[152:155], v[152:155]
  ds_read_b64_tr_b16 a[100:101], v225 offset:21664
  v_mfma_f32_16x16x32_bf16 v[148:151], a[36:39], a[148:151], v[148:151]
  s_add_u32 m0, s68, 4096
  v_mfma_f32_16x16x32_bf16 v[144:147], a[36:39], a[144:147], v[144:147]
  ds_read_b64_tr_b16 a[102:103], v225 offset:25248
  v_mfma_f32_16x16x32_bf16 v[160:163], a[40:43], a[144:147], v[160:163]
  v_mfma_f32_16x16x32_bf16 v[164:167], a[40:43], a[148:151], v[164:167]
  ds_read_b64_tr_b16 a[104:105], v225 offset:7360
  v_mfma_f32_16x16x32_bf16 v[168:171], a[40:43], a[152:155], v[168:171]
  buffer_load_dwordx4 v230, s[64:67], s70 offen lds
  v_mfma_f32_16x16x32_bf16 v[172:175], a[40:43], a[156:159], v[172:175]
  ds_read_b64_tr_b16 a[106:107], v225 offset:10944
  v_mfma_f32_16x16x32_bf16 v[188:191], a[44:47], a[156:159], v[188:191]
  v_mfma_f32_16x16x32_bf16 v[184:187], a[44:47], a[152:155], v[184:187]
  ds_read_b64_tr_b16 a[108:109], v225 offset:21696
  v_mfma_f32_16x16x32_bf16 v[180:183], a[44:47], a[148:151], v[180:183]
  ds_read_b64_tr_b16 a[110:111], v225 offset:25280
  v_mfma_f32_16x16x32_bf16 v[176:179], a[44:47], a[144:147], v[176:179]
  buffer_load_dwordx4 v231, s[64:67], s70 offen offset:1024 lds
  v_mfma_f32_16x16x32_bf16 v[192:195], a[48:51], a[144:147], v[192:195]
  v_mfma_f32_16x16x32_bf16 v[196:199], a[48:51], a[148:151], v[196:199]
  v_mfma_f32_16x16x32_bf16 v[200:203], a[48:51], a[152:155], v[200:203]
  v_mfma_f32_16x16x32_bf16 v[204:207], a[48:51], a[156:159], v[204:207]
  v_mfma_f32_16x16x32_bf16 v[220:223], a[52:55], a[156:159], v[220:223]
  v_mfma_f32_16x16x32_bf16 v[216:219], a[52:55], a[152:155], v[216:219]
  v_mfma_f32_16x16x32_bf16 v[212:215], a[52:55], a[148:151], v[212:215]
  buffer_load_dwordx4 v232, s[64:67], s70 offen offset:2048 lds
  v_mfma_f32_16x16x32_bf16 v[208:211], a[52:55], a[144:147], v[208:211]
  s_waitcnt vmcnt(15) lgkmcnt(0)
  v_mfma_f32_16x16x32_bf16 v[0:3], a[56:59], a[160:163], v[0:3]
  s_waitcnt vmcnt(19)
  s_barrier
  v_mfma_f32_16x16x32_bf16 v[4:7], a[56:59], a[164:167], v[4:7]
  ds_read_b64_tr_b16 a[0:1], v224 offset:28672
  v_mfma_f32_16x16x32_bf16 v[8:11], a[56:59], a[168:171], v[8:11]
  s_waitcnt vmcnt(10)
  v_mfma_f32_16x16x32_bf16 v[12:15], a[56:59], a[172:175], v[12:15]
  ds_read_b64_tr_b16 a[2:3], v224 offset:32256
  v_mfma_f32_16x16x32_bf16 v[28:31], a[60:63], a[172:175], v[28:31]
  v_cmp_eq_u32 vcc, 0, v249
  s_cmp_eq_u64 vcc, 0
  s_cbranch_scc1 L_gok_38
  s_mov_b32 s96, 0
L_poll_39:
  buffer_load_dword v249, v248, s[56:59], s85 offen sc1
  s_waitcnt vmcnt(0)
  v_cmp_eq_u32 vcc, 0, v249
  s_add_u32 s96, s96, 1
  s_cmp_eq_u64 vcc, 0
  s_cbranch_scc1 L_ok_40
  s_sleep 2
  s_cmp_lt_u32 s96, 0x200000
  s_cbranch_scc1 L_poll_39
L_ok_40:
L_gok_38:
  v_mfma_f32_16x16x32_bf16 v[24:27], a[60:63], a[168:171], v[24:27]
  ds_read_b64_tr_b16 a[4:5], v224 offset:43008
  v_mfma_f32_16x16x32_bf16 v[20:23], a[60:63], a[164:167], v[20:23]
  ds_read_b64_tr_b16 a[6:7], v224 offset:46592
  v_mfma_f32_16x16x32_bf16 v[16:19], a[60:63], a[160:163], v[16:19]
  s_add_u32 s63, s21, 3
  v_mfma_f32_16x16x32_bf16 v[32:35], a[64:67], a[160:163], v[32:35]
  ds_read_b64_tr_b16 a[8:9], v224 offset:28704
  v_mfma_f32_16x16x32_bf16 v[36:39], a[64:67], a[164:167], v[36:39]
  s_and_b32 s63, s63, 3
  v_mfma_f32_16x16x32_bf16 v[40:43], a[64:67], a[168:171], v[40:43]
  ds_read_b64_tr_b16 a[10:11], v224 offset:32288
  v_mfma_f32_16x16x32_bf16 v[44:47], a[64:67], a[172:175], v[44:47]
  s_mul_i32 s63, s63, 2048
  v_mfma_f32_16x16x32_bf16 v[60:63], a[68:71], a[172:175], v[60:63]
  ds_read_b64_tr_b16 a[12:13], v224 offset:43040
  v_mfma_f32_16x16x32_bf16 v[56:59], a[68:71], a[168:171], v[56:59]
  ds_read_b64_tr_b16 a[14:15], v224 offset:46624
  v_mfma_f32_16x16x32_bf16 v[52:55], a[68:71], a[164:167], v[52:55]
  buffer_load_dwordx4 a[208:211], v233, s[36:39], s63 offen offset:0 sc1
  v_mfma_f32_16x16x32_bf16 v[48:51], a[68:71], a[160:163], v[48:51]
  ds_read_b64_tr_b16 a[16:17], v224 offset:28736
  v_mfma_f32_16x16x32_bf16 v[64:67], a[72:75], a[160:163], v[64:67]
  s_add_u32 s69, s21, 0
  v_mfma_f32_16x16x32_bf16 v[68:71], a[72:75], a[164:167], v[68:71]
  ds_read_b64_tr_b16 a[18:19], v224 offset:32320
  v_mfma_f32_16x16x32_bf16 v[72:75], a[72:75], a[168:171], v[72:75]
  s_and_b32 s69, s69, 3
  v_mfma_f32_16x16x32_bf16 v[76:79], a[72:75], a[172:175], v[76:79]
  ds_read_b64_tr_b16 a[20:21], v224 offset:43072
  v_mfma_f32_16x16x32_bf16 v[92:95], a[76:79], a[172:175], v[92:95]
  ds_read_b64_tr_b16 a[22:23], v224 offset:46656
  v_mfma_f32_16x16x32_bf16 v[88:91], a[76:79], a[168:171], v[88:91]
  s_add_u32 s69, s69, 4
  v_mfma_f32_16x16x32_bf16 v[84:87], a[76:79], a[164:167], v[84:87]
  ds_read_b64_tr_b16 a[24:25], v224 offset:28768
  v_mfma_f32_16x16x32_bf16 v[80:83], a[76:79], a[160:163], v[80:83]
  s_mul_i32 s69, s69, 458752
  v_mfma_f32_16x16x32_bf16 v[96:99], a[80:83], a[160:163], v[96:99]
  ds_read_b64_tr_b16 a[26:27], v224 offset:32352
  v_mfma_f32_16x16x32_bf16 v[100:103], a[80:83], a[164:167], v[100:103]
  s_add_u32 m0, s68, 86016
  v_mfma_f32_16x16x32_bf16 v[104:107], a[80:83], a[168:171], v[104:107]
  ds_read_b64_tr_b16 a[28:29], v224 offset:43104
  v_mfma_f32_16x16x32_bf16 v[108:111], a[80:83], a[172:175], v[108:111]
  ds_read_b64_tr_b16 a[30:31], v224 offset:46688
  v_mfma_f32_16x16x32_bf16 v[124:127], a[84:87], a[172:175], v[124:127]
  buffer_load_dwordx4 v226, s[64:67], s69 offen lds
  v_mfma_f32_16x16x32_bf16 v[120:123], a[84:87], a[168:171], v[120:123]
  ds_read_b64_tr_b16 a[32:33], v224 offset:28800
  v_mfma_f32_16x16x32_bf16 v[116:119], a[84:87], a[164:167], v[116:119]
  buffer_load_dwordx4 a[212:215], v234, s[36:39], s63 offen offset:0 sc1
  v_mfma_f32_16x16x32_bf16 v[112:115], a[84:87], a[160:163], v[112:115]
  ds_read_b64_tr_b16 a[34:35], v224 offset:32384
  v_mfma_f32_16x16x32_bf16 v[128:131], a[88:91], a[160:163], v[128:131]
  v_mfma_f32_16x16x32_bf16 v[132:135], a[88:91], a[164:167], v[132:135]
  ds_read_b64_tr_b16 a[36:37], v224 offset:43136
  v_mfma_f32_16x16x32_bf16 v[136:139], a[88:91], a[168:171], v[136:139]
  ds_read_b64_tr_b16 a[38:39], v224 offset:46720
  v_mfma_f32_16x16x32_bf16 v[140:143], a[88:91], a[172:175], v[140:143]
  buffer_load_dwordx4 v227, s[64:67], s69 offen offset:1024 lds
  v_mfma_f32_16x16x32_bf16 v[156:159], a[92:95], a[172:175], v[156:159]
  ds_read_b64_tr_b16 a[40:41], v224 offset:28832
  v_mfma_f32_16x16x32_bf16 v[152:155], a[92:95], a[168:171], v[152:155]
  buffer_load_dwordx4 a[216:219], v235, s[36:39], s63 offen offset:0 sc1
  v_mfma_f32_16x16x32_bf16 v[148:151], a[92:95], a[164:167], v[148:151]
  ds_read_b64_tr_b16 a[42:43], v224 offset:32416
  v_mfma_f32_16x16x32_bf16 v[144:147], a[92:95], a[160:163], v[144:147]
  v_mfma_f32_16x16x32_bf16 v[160:163], a[96:99], a[160:163], v[160:163]
  ds_read_b64_tr_b16 a[44:45], v224 offset:43168
  v_mfma_f32_16x16x32_bf16 v[164:167], a[96:99], a[164:167], v[164:167]
  buffer_load_dwordx4 v228, s[64:67], s69 offen offset:2048 lds
  v_mfma_f32_16x16x32_bf16 v[168:171], a[96:99], a[168:171], v[168:171]
  ds_read_b64_tr_b16 a[46:47], v224 offset:46752
  v_mfma_f32_16x16x32_bf16 v[172:175], a[96:99], a[172:175], v[172:175]
  ds_read_b64_tr_b16 a[48:49], v224 offset:28864
  v_mfma_f32_16x16x32_bf16 v[188:191], a[100:103], a[172:175], v[188:191]
  buffer_load_dwordx4 a[220:223], v236, s[36:39], s63 offen offset:0 sc1
  v_mfma_f32_16x16x32_bf16 v[184:187], a[100:103], a[168:171], v[184:187]
  ds_read_b64_tr_b16 a[50:51], v224 offset:32448
  v_mfma_f32_16x16x32_bf16 v[180:183], a[100:103], a[164:167], v[180:183]
  v_mfma_f32_16x16x32_bf16 v[176:179], a[100:103], a[160:163], v[176:179]
  ds_read_b64_tr_b16 a[52:53], v224 offset:43200
  v_mfma_f32_16x16x32_bf16 v[192:195], a[104:107], a[160:163], v[192:195]
  buffer_load_dwordx4 v229, s[64:67], s69 offen offset:3072 lds
  v_mfma_f32_16x16x32_bf16 v[196:199], a[104:107], a[164:167], v[196:199]
  ds_read_b64_tr_b16 a[54:55], v224 offset:46784
  v_mfma_f32_16x16x32_bf16 v[200:203], a[104:107], a[168:171], v[200:203]
  s_add_u32 m0, s68, 90112
  v_mfma_f32_16x16x32_bf16 v[204:207], a[104:107], a[172:175], v[204:207]
  buffer_load_dwordx4 v230, s[64:67], s69 offen lds
  v_mfma_f32_16x16x32_bf16 v[220:223], a[108:111], a[172:175], v[220:223]
  v_mfma_f32_16x16x32_bf16 v[216:219], a[108:111], a[168:171], v[216:219]
  v_mfma_f32_16x16x32_bf16 v[212:215], a[108:111], a[164:167], v[212:215]
  buffer_load_dwordx4 v231, s[64:67], s69 offen offset:1024 lds
  v_mfma_f32_16x16x32_bf16 v[208:211], a[108:111], a[160:163], v[208:211]
  s_waitcnt vmcnt(21) lgkmcnt(0)
  v_mfma_f32_16x16x32_bf16 v[0:3], a[0:3], a[176:179], v[0:3]
  ds_read_b64_tr_b16 a[56:57], v224 offset:35840
  v_mfma_f32_16x16x32_bf16 v[4:7], a[0:3], a[180:183], v[4:7]
  buffer_load_dwordx4 a[224:227], v233, s[36:39], s63 offen offset:1024 sc1
  v_mfma_f32_16x16x32_bf16 v[8:11], a[0:3], a[184:187], v[8:11]
  ds_read_b64_tr_b16 a[58:59], v224 offset:39424
  v_mfma_f32_16x16x32_bf16 v[12:15], a[0:3], a[188:191], v[12:15]
  ds_read_b64_tr_b16 a[60:61], v224 offset:50176
  v_mfma_f32_16x16x32_bf16 v[28:31], a[4:7], a[188:191], v[28:31]
  v_mfma_f32_16x16x32_bf16 v[24:27], a[4:7], a[184:187], v[24:27]
  ds_read_b64_tr_b16 a[62:63], v224 offset:53760
  v_mfma_f32_16x16x32_bf16 v[20:23], a[4:7], a[180:183], v[20:23]
  ds_read_b64_tr_b16 a[64:65], v224 offset:35872
  v_mfma_f32_16x16x32_bf16 v[16:19], a[4:7], a[176:179], v[16:19]
  buffer_load_dwordx4 v232, s[64:67], s69 offen offset:2048 lds
  v_mfma_f32_16x16x32_bf16 v[32:35], a[8:11], a[176:179], v[32:35]
  ds_read_b64_tr_b16 a[66:67], v224 offset:39456
  v_mfma_f32_16x16x32_bf16 v[36:39], a[8:11], a[180:183], v[36:39]
  buffer_load_dwordx4 a[228:231], v234, s[36:39], s63 offen offset:1024 sc1
  v_mfma_f32_16x16x32_bf16 v[40:43], a[8:11], a[184:187], v[40:43]
  ds_read_b64_tr_b16 a[68:69], v224 offset:50208
  v_mfma_f32_16x16x32_bf16 v[44:47], a[8:11], a[188:191], v[44:47]
  v_mfma_f32_16x16x32_bf16 v[60:63], a[12:15], a[188:191], v[60:63]
  ds_read_b64_tr_b16 a[70:71], v224 offset:53792
  v_mfma_f32_16x16x32_bf16 v[56:59], a[12:15], a[184:187], v[56:59]
  s_add_u32 s70, s21, 1
  v_mfma_f32_16x16x32_bf16 v[52:55], a[12:15], a[180:183], v[52:55]
  ds_read_b64_tr_b16 a[72:73], v224 offset:35904
  v_mfma_f32_16x16x32_bf16 v[48:51], a[12:15], a[176:179], v[48:51]
  s_and_b32 s70, s70, 3
  v_mfma_f32_16x16x32_bf16 v[64:67], a[16:19], a[176:179], v[64:67]
  ds_read_b64_tr_b16 a[74:75], v224 offset:39488
  v_mfma_f32_16x16x32_bf16 v[68:71], a[16:19], a[180:183], v[68:71]
  ds_read_b64_tr_b16 a[76:77], v224 offset:50240
  v_mfma_f32_16x16x32_bf16 v[72:75], a[16:19], a[184:187], v[72:75]
  s_add_u32 s70, s70, 4
  v_mfma_f32_16x16x32_bf16 v[76:79], a[16:19], a[188:191], v[76:79]
  ds_read_b64_tr_b16 a[78:79], v224 offset:53824
  v_mfma_f32_16x16x32_bf16 v[92:95], a[20:23], a[188:191], v[92:95]
  ds_read_b64_tr_b16 a[80:81], v224 offset:35936
  v_mfma_f32_16x16x32_bf16 v[88:91], a[20:23], a[184:187], v[88:91]
  s_mul_i32 s70, s70, 458752
  v_mfma_f32_16x16x32_bf16 v[84:87], a[20:23], a[180:183], v[84:87]
  ds_read_b64_tr_b16 a[82:83], v224 offset:39520
  v_mfma_f32_16x16x32_bf16 v[80:83], a[20:23], a[176:179], v[80:83]
  s_add_u32 m0, s68, 57344
  v_mfma_f32_16x16x32_bf16 v[96:99], a[24:27], a[176:179], v[96:99]
  ds_read_b64_tr_b16 a[84:85], v224 offset:50272
  v_mfma_f32_16x16x32_bf16 v[100:103], a[24:27], a[180:183], v[100:103]
  ds_read_b64_tr_b16 a[86:87], v224 offset:53856
  v_mfma_f32_16x16x32_bf16 v[104:107], a[24:27], a[184:187], v[104:107]
  buffer_load_dwordx4 v226, s[64:67], s70 offen lds
  v_mfma_f32_16x16x32_bf16 v[108:111], a[24:27], a[188:191], v[108:111]
  ds_read_b64_tr_b16 a[88:89], v224 offset:35968
  v_mfma_f32_16x16x32_bf16 v[124:127], a[28:31], a[188:191], v[124:127]
  v_mfma_f32_16x16x32_bf16 v[120:123], a[28:31], a[184:187], v[120:123]
  ds_read_b64_tr_b16 a[90:91], v224 offset:39552
  v_mfma_f32_16x16x32_bf16 v[116:119], a[28:31], a[180:183], v[116:119]
  buffer_load_dwordx4 a[232:235], v235, s[36:39], s63 offen offset:1024 sc1
  v_mfma_f32_16x16x32_bf16 v[112:115], a[28:31], a[176:179], v[112:115]
  ds_read_b64_tr_b16 a[92:93], v224 offset:50304
  v_mfma_f32_16x16x32_bf16 v[128:131], a[32:35], a[176:179], v[128:131]
  buffer_load_dwordx4 a[236:239], v236, s[36:39], s63 offen offset:1024 sc1
  v_mfma_f32_16x16x32_bf16 v[132:135], a[32:35], a[180:183], v[132:135]
  ds_read_b64_tr_b16 a[94:95], v224 offset:53888
  v_mfma_f32_16x16x32_bf16 v[136:139], a[32:35], a[184:187], v[136:139]
  ds_read_b64_tr_b16 a[96:97], v224 offset:36000
  v_mfma_f32_16x16x32_bf16 v[140:143], a[32:35], a[188:191], v[140:143]
  s_add_u32 s62, s21, 0
  v_mfma_f32_16x16x32_bf16 v[156:159], a[36:39], a[188:191], v[156:159]
  ds_read_b64_tr_b16 a[98:99], v224 offset:39584
  v_mfma_f32_16x16x32_bf16 v[152:155], a[36:39], a[184:187], v[152:155]
  ds_read_b64_tr_b16 a[100:101], v224 offset:50336
  v_mfma_f32_16x16x32_bf16 v[148:151], a[36:39], a[180:183], v[148:151]
  s_and_b32 s62, s62, 3
  v_mfma_f32_16x16x32_bf16 v[144:147], a[36:39], a[176:179], v[144:147]
  ds_read_b64_tr_b16 a[102:103], v224 offset:53920
  v_mfma_f32_16x16x32_bf16 v[160:163], a[40:43], a[176:179], v[160:163]
  s_add_u32 s62, s62, 4
  v_mfma_f32_16x16x32_bf16 v[164:167], a[40:43], a[180:183], v[164:167]
  ds_read_b64_tr_b16 a[104:105], v224 offset:36032
  v_mfma_f32_16x16x32_bf16 v[168:171], a[40:43], a[184:187], v[168:171]
  ds_read_b64_tr_b16 a[106:107], v224 offset:39616
  v_mfma_f32_16x16x32_bf16 v[172:175], a[40:43], a[188:191], v[172:175]
  s_mul_i32 s62, s62, 2048
  v_mfma_f32_16x16x32_bf16 v[188:191], a[44:47], a[188:191], v[188:191]
  ds_read_b64_tr_b16 a[108:109], v224 offset:50368
  v_mfma_f32_16x16x32_bf16 v[184:187], a[44:47], a[184:187], v[184:187]
  v_mfma_f32_16x16x32_bf16 v[180:183], a[44:47], a[180:183], v[180:183]
  buffer_load_dwordx4 a[112:115], v233, s[36:39], s62 offen offset:0 sc1
  v_mfma_f32_16x16x32_bf16 v[176:179], a[44:47], a[176:179], v[176:179]
  ds_read_b64_tr_b16 a[110:111], v224 offset:53952
  v_mfma_f32_16x16x32_bf16 v[192:195], a[48:51], a[176:179], v[192:195]
  v_mfma_f32_16x16x32_bf16 v[196:199], a[48:51], a[180:183], v[196:199]
  buffer_load_dwordx4 a[116:119], v234, s[36:39], s62 offen offset:0 sc1
  v_mfma_f32_16x16x32_bf16 v[200:203], a[48:51], a[184:187], v[200:203]
  v_mfma_f32_16x16x32_bf16 v[204:207], a[48:51], a[188:191], v[204:207]
  buffer_load_dwordx4 a[120:123], v235, s[36:39], s62 offen offset:0 sc1
  v_mfma_f32_16x16x32_bf16 v[220:223], a[52:55], a[188:191], v[220:223]
  v_mfma_f32_16x16x32_bf16 v[216:219], a[52:55], a[184:187], v[216:219]
  v_mfma_f32_16x16x32_bf16 v[212:215], a[52:55], a[180:183], v[212:215]
  buffer_load_dwordx4 a[124:127], v236, s[36:39], s62 offen offset:0 sc1
  v_mfma_f32_16x16x32_bf16 v[208:211], a[52:55], a[176:179], v[208:211]
  s_waitcnt vmcnt(23) lgkmcnt(0)
  v_mfma_f32_16x16x32_bf16 v[0:3], a[56:59], a[192:195], v[0:3]
  s_waitcnt vmcnt(20)
  s_barrier
  v_mfma_f32_16x16x32_bf16 v[4:7], a[56:59], a[196:199], v[4:7]
  ds_read_b64_tr_b16 a[0:1], v224 offset:0
  v_mfma_f32_16x16x32_bf16 v[8:11], a[56:59], a[200:203], v[8:11]
  ds_read_b64_tr_b16 a[2:3], v224 offset:3584
  v_mfma_f32_16x16x32_bf16 v[12:15], a[56:59], a[204:207], v[12:15]
  buffer_load_dwordx4 a[128:131], v233, s[36:39], s62 offen offset:1024 sc1
  v_mfma_f32_16x16x32_bf16 v[28:31], a[60:63], a[204:207], v[28:31]
  ds_read_b64_tr_b16 a[4:5], v224 offset:14336
  v_mfma_f32_16x16x32_bf16 v[24:27], a[60:63], a[200:203], v[24:27]
  v_mfma_f32_16x16x32_bf16 v[20:23], a[60:63], a[196:199], v[20:23]
  ds_read_b64_tr_b16 a[6:7], v224 offset:17920
  v_mfma_f32_16x16x32_bf16 v[16:19], a[60:63], a[192:195], v[16:19]
  v_mfma_f32_16x16x32_bf16 v[32:35], a[64:67], a[192:195], v[32:35]
  ds_read_b64_tr_b16 a[8:9], v224 offset:32
  v_mfma_f32_16x16x32_bf16 v[36:39], a[64:67], a[196:199], v[36:39]
  ds_read_b64_tr_b16 a[10:11], v224 offset:3616
  v_mfma_f32_16x16x32_bf16 v[40:43], a[64:67], a[200:203], v[40:43]
  buffer_load_dwordx4 v227, s[64:67], s70 offen offset:1024 lds
  v_mfma_f32_16x16x32_bf16 v[44:47], a[64:67], a[204:207], v[44:47]
  ds_read_b64_tr_b16 a[12:13], v224 offset:14368
  v_mfma_f32_16x16x32_bf16 v[60:63], a[68:71], a[204:207], v[60:63]
  ds_read_b64_tr_b16 a[14:15], v224 offset:17952
  v_mfma_f32_16x16x32_bf16 v[56:59], a[68:71], a[200:203], v[56:59]
  buffer_load_dwordx4 a[132:135], v234, s[36:39], s62 offen offset:1024 sc1
  v_mfma_f32_16x16x32_bf16 v[52:55], a[68:71], a[196:199], v[52:55]
  ds_read_b64_tr_b16 a[16:17], v224 offset:64
  v_mfma_f32_16x16x32_bf16 v[48:51], a[68:71], a[192:195], v[48:51]
  v_mfma_f32_16x16x32_bf16 v[64:67], a[72:75], a[192:195], v[64:67]
  ds_read_b64_tr_b16 a[18:19], v224 offset:3648
  v_mfma_f32_16x16x32_bf16 v[68:71], a[72:75], a[196:199], v[68:71]
  v_mfma_f32_16x16x32_bf16 v[72:75], a[72:75], a[200:203], v[72:75]
  ds_read_b64_tr_b16 a[20:21], v224 offset:14400
  v_mfma_f32_16x16x32_bf16 v[76:79], a[72:75], a[204:207], v[76:79]
  ds_read_b64_tr_b16 a[22:23], v224 offset:17984
  v_mfma_f32_16x16x32_bf16 v[92:95], a[76:79], a[204:207], v[92:95]
  buffer_load_dwordx4 v228, s[64:67], s70 offen offset:2048 lds
  v_mfma_f32_16x16x32_bf16 v[88:91], a[76:79], a[200:203], v[88:91]
  ds_read_b64_tr_b16 a[24:25], v224 offset:96
  v_mfma_f32_16x16x32_bf16 v[84:87], a[76:79], a[196:199], v[84:87]
  ds_read_b64_tr_b16 a[26:27], v224 offset:3680
  v_mfma_f32_16x16x32_bf16 v[80:83], a[76:79], a[192:195], v[80:83]
  buffer_load_dwordx4 a[136:139], v235, s[36:39], s62 offen offset:1024 sc1
  v_mfma_f32_16x16x32_bf16 v[96:99], a[80:83], a[192:195], v[96:99]
  ds_read_b64_tr_b16 a[28:29], v224 offset:14432
  v_mfma_f32_16x16x32_bf16 v[100:103], a[80:83], a[196:199], v[100:103]
  v_mfma_f32_16x16x32_bf16 v[104:107], a[80:83], a[200:203], v[104:107]
  ds_read_b64_tr_b16 a[30:31], v224 offset:18016
  v_mfma_f32_16x16x32_bf16 v[108:111], a[80:83], a[204:207], v[108:111]
  v_mfma_f32_16x16x32_bf16 v[124:127], a[84:87], a[204:207], v[124:127]
  ds_read_b64_tr_b16 a[32:33], v224 offset:128
  v_mfma_f32_16x16x32_bf16 v[120:123], a[84:87], a[200:203], v[120:123]
  ds_read_b64_tr_b16 a[34:35], v224 offset:3712
  v_mfma_f32_16x16x32_bf16 v[116:119], a[84:87], a[196:199], v[116:119]
  buffer_load_dwordx4 v229, s[64:67], s70 offen offset:3072 lds
  v_mfma_f32_16x16x32_bf16 v[112:115], a[84:87], a[192:195], v[112:115]
  ds_read_b64_tr_b16 a[36:37], v224 offset:14464
  v_mfma_f32_16x16x32_bf16 v[128:131], a[88:91], a[192:195], v[128:131]
  ds_read_b64_tr_b16 a[38:39], v224 offset:18048
  v_mfma_f32_16x16x32_bf16 v[132:135], a[88:91], a[196:199], v[132:135]
  buffer_load_dwordx4 a[140:143], v236, s[36:39], s62 offen offset:1024 sc1
  v_mfma_f32_16x16x32_bf16 v[136:139], a[88:91], a[200:203], v[136:139]
  ds_read_b64_tr_b16 a[40:41], v224 offset:160
  v_mfma_f32_16x16x32_bf16 v[140:143], a[88:91], a[204:207], v[140:143]
  v_mfma_f32_16x16x32_bf16 v[156:159], a[92:95], a[204:207], v[156:159]
  ds_read_b64_tr_b16 a[42:43], v224 offset:3744
  v_mfma_f32_16x16x32_bf16 v[152:155], a[92:95], a[200:203], v[152:155]
  s_add_u32 m0, s68, 61440
  v_mfma_f32_16x16x32_bf16 v[148:151], a[92:95], a[196:199], v[148:151]
  ds_read_b64_tr_b16 a[44:45], v224 offset:14496
  v_mfma_f32_16x16x32_bf16 v[144:147], a[92:95], a[192:195], v[144:147]
  ds_read_b64_tr_b16 a[46:47], v224 offset:18080
  v_mfma_f32_16x16x32_bf16 v[160:163], a[96:99], a[192:195], v[160:163]
  buffer_load_dwordx4 v230, s[64:67], s70 offen lds
  v_mfma_f32_16x16x32_bf16 v[164:167], a[96:99], a[196:199], v[164:167]
  ds_read_b64_tr_b16 a[48:49], v224 offset:192
  v_mfma_f32_16x16x32_bf16 v[168:171], a[96:99], a[200:203], v[168:171]
  ds_read_b64_tr_b16 a[50:51], v224 offset:3776
  v_mfma_f32_16x16x32_bf16 v[172:175], a[96:99], a[204:207], v[172:175]
  v_mfma_f32_16x16x32_bf16 v[188:191], a[100:103], a[204:207], v[188:191]
  ds_read_b64_tr_b16 a[52:53], v224 offset:14528
  v_mfma_f32_16x16x32_bf16 v[184:187], a[100:103], a[200:203], v[184:187]
  v_mfma_f32_16x16x32_bf16 v[180:183], a[100:103], a[196:199], v[180:183]
  ds_read_b64_tr_b16 a[54:55], v224 offset:18112
  v_mfma_f32_16x16x32_bf16 v[176:179], a[100:103], a[192:195], v[176:179]
  buffer_load_dwordx4 v231, s[64:67], s70 offen offset:1024 lds
  v_mfma_f32_16x16x32_bf16 v[192:195], a[104:107], a[192:195], v[192:195]
  v_mfma_f32_16x16x32_bf16 v[196:199], a[104:107], a[196:199], v[196:199]
  v_mfma_f32_16x16x32_bf16 v[200:203], a[104:107], a[200:203], v[200:203]
  v_mfma_f32_16x16x32_bf16 v[204:207], a[104:107], a[204:207], v[204:207]
  v_mfma_f32_16x16x32_bf16 v[220:223], a[108:111], a[204:207], v[220:223]
  v_mfma_f32_16x16x32_bf16 v[216:219], a[108:111], a[200:203], v[216:219]
  v_mfma_f32_16x16x32_bf16 v[212:215], a[108:111], a[196:199], v[212:215]
  buffer_load_dwordx4 v232, s[64:67], s70 offen offset:2048 lds
  v_mfma_f32_16x16x32_bf16 v[208:211], a[108:111], a[192:195], v[208:211]
  s_waitcnt vmcnt(23) lgkmcnt(0)
  v_mfma_f32_16x16x32_bf16 v[0:3], a[0:3], a[208:211], v[0:3]
  ds_read_b64_tr_b16 a[56:57], v224 offset:7168
  v_mfma_f32_16x16x32_bf16 v[4:7], a[0:3], a[212:215], v[4:7]
  s_add_u32 s63, s21, 1
  v_mfma_f32_16x16x32_bf16 v[8:11], a[0:3], a[216:219], v[8:11]
  ds_read_b64_tr_b16 a[58:59], v224 offset:10752
  v_mfma_f32_16x16x32_bf16 v[12:15], a[0:3], a[220:223], v[12:15]
  s_and_b32 s63, s63, 3
  v_mfma_f32_16x16x32_bf16 v[28:31], a[4:7], a[220:223], v[28:31]
  ds_read_b64_tr_b16 a[60:61], v224 offset:21504
  v_mfma_f32_16x16x32_bf16 v[24:27], a[4:7], a[216:219], v[24:27]
  ds_read_b64_tr_b16 a[62:63], v224 offset:25088
  v_mfma_f32_16x16x32_bf16 v[20:23], a[4:7], a[212:215], v[20:23]
  s_add_u32 s63, s63, 4
  v_mfma_f32_16x16x32_bf16 v[16:19], a[4:7], a[208:211], v[16:19]
  ds_read_b64_tr_b16 a[64:65], v224 offset:7200
  v_mfma_f32_16x16x32_bf16 v[32:35], a[8:11], a[208:211], v[32:35]
  s_mul_i32 s63, s63, 2048
  v_mfma_f32_16x16x32_bf16 v[36:39], a[8:11], a[212:215], v[36:39]
  ds_read_b64_tr_b16 a[66:67], v224 offset:10784
  v_mfma_f32_16x16x32_bf16 v[40:43], a[8:11], a[216:219], v[40:43]
  buffer_load_dwordx4 a[144:147], v233, s[36:39], s63 offen offset:0 sc1
  v_mfma_f32_16x16x32_bf16 v[44:47], a[8:11], a[220:223], v[44:47]
  ds_read_b64_tr_b16 a[68:69], v224 offset:21536
  v_mfma_f32_16x16x32_bf16 v[60:63], a[12:15], a[220:223], v[60:63]
  s_add_u32 s69, s21, 2
  v_mfma_f32_16x16x32_bf16 v[56:59], a[12:15], a[216:219], v[56:59]
  ds_read_b64_tr_b16 a[70:71], v224 offset:25120
  v_mfma_f32_16x16x32_bf16 v[52:55], a[12:15], a[212:215], v[52:55]
  ds_read_b64_tr_b16 a[72:73], v224 offset:7232
  v_mfma_f32_16x16x32_bf16 v[48:51], a[12:15], a[208:211], v[48:51]
  s_and_b32 s69, s69, 3
  v_mfma_f32_16x16x32_bf16 v[64:67], a[16:19], a[208:211], v[64:67]
  ds_read_b64_tr_b16 a[74:75], v224 offset:10816
  v_mfma_f32_16x16x32_bf16 v[68:71], a[16:19], a[212:215], v[68:71]
  s_add_u32 s69, s69, 4
  v_mfma_f32_16x16x32_bf16 v[72:75], a[16:19], a[216:219], v[72:75]
  ds_read_b64_tr_b16 a[76:77], v224 offset:21568
  v_mfma_f32_16x16x32_bf16 v[76:79], a[16:19], a[220:223], v[76:79]
  s_mul_i32 s69, s69, 458752
  v_mfma_f32_16x16x32_bf16 v[92:95], a[20:23], a[220:223], v[92:95]
  ds_read_b64_tr_b16 a[78:79], v224 offset:25152
  v_mfma_f32_16x16x32_bf16 v[88:91], a[20:23], a[216:219], v[88:91]
  s_add_u32 m0, s68, 28672
  v_mfma_f32_16x16x32_bf16 v[84:87], a[20:23], a[212:215], v[84:87]
  ds_read_b64_tr_b16 a[80:81], v224 offset:7264
  v_mfma_f32_16x16x32_bf16 v[80:83], a[20:23], a[208:211], v[80:83]
  ds_read_b64_tr_b16 a[82:83], v224 offset:10848
  v_mfma_f32_16x16x32_bf16 v[96:99], a[24:27], a[208:211], v[96:99]
  buffer_load_dwordx4 v226, s[64:67], s69 offen lds
  v_mfma_f32_16x16x32_bf16 v[100:103], a[24:27], a[212:215], v[100:103]
  ds_read_b64_tr_b16 a[84:85], v224 offset:21600
  v_mfma_f32_16x16x32_bf16 v[104:107], a[24:27], a[216:219], v[104:107]
  buffer_load_dwordx4 a[148:151], v234, s[36:39], s63 offen offset:0 sc1
  v_mfma_f32_16x16x32_bf16 v[108:111], a[24:27], a[220:223], v[108:111]
  ds_read_b64_tr_b16 a[86:87], v224 offset:25184
  v_mfma_f32_16x16x32_bf16 v[124:127], a[28:31], a[220:223], v[124:127]
  v_mfma_f32_16x16x32_bf16 v[120:123], a[28:31], a[216:219], v[120:123]
  ds_read_b64_tr_b16 a[88:89], v224 offset:7296
  v_mfma_f32_16x16x32_bf16 v[116:119], a[28:31], a[212:215], v[116:119]
  buffer_load_dwordx4 v227, s[64:67], s69 offen offset:1024 lds
  v_mfma_f32_16x16x32_bf16 v[112:115], a[28:31], a[208:211], v[112:115]
  ds_read_b64_tr_b16 a[90:91], v224 offset:10880
  v_mfma_f32_16x16x32_bf16 v[128:131], a[32:35], a[208:211], v[128:131]
  ds_read_b64_tr_b16 a[92:93], v224 offset:21632
  v_mfma_f32_16x16x32_bf16 v[132:135], a[32:35], a[212:215], v[132:135]
  buffer_load_dwordx4 a[152:155], v235, s[36:39], s63 offen offset:0 sc1
  v_mfma_f32_16x16x32_bf16 v[136:139], a[32:35], a[216:219], v[136:139]
  ds_read_b64_tr_b16 a[94:95], v224 offset:25216
  v_mfma_f32_16x16x32_bf16 v[140:143], a[32:35], a[220:223], v[140:143]
  v_mfma_f32_16x16x32_bf16 v[156:159], a[36:39], a[220:223], v[156:159]
  ds_read_b64_tr_b16 a[96:97], v224 offset:7328
  v_mfma_f32_16x16x32_bf16 v[152:155], a[36:39], a[216:219], v[152:155]
  buffer_load_dwordx4 v228, s[64:67], s69 offen offset:2048 lds
  v_mfma_f32_16x16x32_bf16 v[148:151], a[36:39], a[212:215], v[148:151]
  ds_read_b64_tr_b16 a[98:99], v224 offset:10912
  v_mfma_f32_16x16x32_bf16 v[144:147], a[36:39], a[208:211], v[144:147]
  buffer_load_dwordx4 a[156:159], v236, s[36:39], s63 offen offset:0 sc1
  v_mfma_f32_16x16x32_bf16 v[160:163], a[40:43], a[208:211], v[160:163]
  ds_read_b64_tr_b16 a[100:101], v224 offset:21664
  v_mfma_f32_16x16x32_bf16 v[164:167], a[40:43], a[212:215], v[164:167]
  ds_read_b64_tr_b16 a[102:103], v224 offset:25248
  v_mfma_f32_16x16x32_bf16 v[168:171], a[40:43], a[216:219], v[168:171]
  v_mfma_f32_16x16x32_bf16 v[172:175], a[40:43], a[220:223], v[172:175]
  ds_read_b64_tr_b16 a[104:105], v224 offset:7360
  v_mfma_f32_16x16x32_bf16 v[188:191], a[44:47], a[220:223], v[188:191]
  buffer_load_dwordx4 v229, s[64:67], s69 offen offset:3072 lds
  v_mfma_f32_16x16x32_bf16 v[184:187], a[44:47], a[216:219], v[184:187]
  ds_read_b64_tr_b16 a[106:107], v224 offset:10944
  v_mfma_f32_16x16x32_bf16 v[180:183], a[44:47], a[212:215], v[180:183]
  s_lshl_b32 s80, s31, 2
  v_mfma_f32_16x16x32_bf16 v[176:179], a[44:47], a[208:211], v[176:179]
  ds_read_b64_tr_b16 a[108:109], v224 offset:21696
  v_mfma_f32_16x16x32_bf16 v[192:195], a[48:51], a[208:211], v[192:195]
  ds_read_b64_tr_b16 a[110:111], v224 offset:25280
  v_mfma_f32_16x16x32_bf16 v[196:199], a[48:51], a[212:215], v[196:199]
  s_add_u32 s80, s80, s3
  v_mfma_f32_16x16x32_bf16 v[200:203], a[48:51], a[216:219], v[200:203]
  s_lshl_b32 s80, s80, 10
  v_mfma_f32_16x16x32_bf16 v[204:207], a[48:51], a[220:223], v[204:207]
  v_add_u32 v254, s80, v238
  v_mfma_f32_16x16x32_bf16 v[220:223], a[52:55], a[220:223], v[220:223]
  v_min_u32 v254, adaLN_cond__linear_kernel_hedgehog__glu_gated_swiglu__prompt_kernel_end-adaLN_cond__linear_kernel_hedgehog__glu_gated_swiglu__prompt_kernel-4, v254
  v_mfma_f32_16x16x32_bf16 v[216:219], a[52:55], a[216:219], v[216:219]
  v_mfma_f32_16x16x32_bf16 v[212:215], a[52:55], a[212:215], v[212:215]
  global_load_dword v240, v254, s[100:101]
  v_mfma_f32_16x16x32_bf16 v[208:211], a[52:55], a[208:211], v[208:211]
  s_waitcnt vmcnt(23) lgkmcnt(0)
  v_mfma_f32_16x16x32_bf16 v[0:3], a[56:59], a[224:227], v[0:3]
  s_waitcnt vmcnt(27)
  s_barrier
  v_mfma_f32_16x16x32_bf16 v[4:7], a[56:59], a[228:231], v[4:7]
  ds_read_b64_tr_b16 a[0:1], v225 offset:28672
  v_mfma_f32_16x16x32_bf16 v[8:11], a[56:59], a[232:235], v[8:11]
  ds_read_b64_tr_b16 a[2:3], v225 offset:32256
  v_mfma_f32_16x16x32_bf16 v[12:15], a[56:59], a[236:239], v[12:15]
  buffer_load_dwordx4 a[160:163], v233, s[36:39], s63 offen offset:1024 sc1
  v_mfma_f32_16x16x32_bf16 v[28:31], a[60:63], a[236:239], v[28:31]
  ds_read_b64_tr_b16 a[4:5], v225 offset:43008
  v_mfma_f32_16x16x32_bf16 v[24:27], a[60:63], a[232:235], v[24:27]
  v_mfma_f32_16x16x32_bf16 v[20:23], a[60:63], a[228:231], v[20:23]
  ds_read_b64_tr_b16 a[6:7], v225 offset:46592
  v_mfma_f32_16x16x32_bf16 v[16:19], a[60:63], a[224:227], v[16:19]
  s_add_u32 m0, s68, 32768
  v_mfma_f32_16x16x32_bf16 v[32:35], a[64:67], a[224:227], v[32:35]
  ds_read_b64_tr_b16 a[8:9], v225 offset:28704
  v_mfma_f32_16x16x32_bf16 v[36:39], a[64:67], a[228:231], v[36:39]
  ds_read_b64_tr_b16 a[10:11], v225 offset:32288
  v_mfma_f32_16x16x32_bf16 v[40:43], a[64:67], a[232:235], v[40:43]
  buffer_load_dwordx4 v230, s[64:67], s69 offen lds
  v_mfma_f32_16x16x32_bf16 v[44:47], a[64:67], a[236:239], v[44:47]
  ds_read_b64_tr_b16 a[12:13], v225 offset:43040
  v_mfma_f32_16x16x32_bf16 v[60:63], a[68:71], a[236:239], v[60:63]
  ds_read_b64_tr_b16 a[14:15], v225 offset:46624
  v_mfma_f32_16x16x32_bf16 v[56:59], a[68:71], a[232:235], v[56:59]
  buffer_load_dwordx4 a[164:167], v234, s[36:39], s63 offen offset:1024 sc1
  v_mfma_f32_16x16x32_bf16 v[52:55], a[68:71], a[228:231], v[52:55]
  ds_read_b64_tr_b16 a[16:17], v225 offset:28736
  v_mfma_f32_16x16x32_bf16 v[48:51], a[68:71], a[224:227], v[48:51]
  v_mfma_f32_16x16x32_bf16 v[64:67], a[72:75], a[224:227], v[64:67]
  ds_read_b64_tr_b16 a[18:19], v225 offset:32320
  v_mfma_f32_16x16x32_bf16 v[68:71], a[72:75], a[228:231], v[68:71]
  v_mfma_f32_16x16x32_bf16 v[72:75], a[72:75], a[232:235], v[72:75]
  ds_read_b64_tr_b16 a[20:21], v225 offset:43072
  v_mfma_f32_16x16x32_bf16 v[76:79], a[72:75], a[236:239], v[76:79]
  ds_read_b64_tr_b16 a[22:23], v225 offset:46656
  v_mfma_f32_16x16x32_bf16 v[92:95], a[76:79], a[236:239], v[92:95]
  buffer_load_dwordx4 v231, s[64:67], s69 offen offset:1024 lds
  v_mfma_f32_16x16x32_bf16 v[88:91], a[76:79], a[232:235], v[88:91]
  ds_read_b64_tr_b16 a[24:25], v225 offset:28768
  v_mfma_f32_16x16x32_bf16 v[84:87], a[76:79], a[228:231], v[84:87]
  ds_read_b64_tr_b16 a[26:27], v225 offset:32352
  v_mfma_f32_16x16x32_bf16 v[80:83], a[76:79], a[224:227], v[80:83]
  buffer_load_dwordx4 a[168:171], v235, s[36:39], s63 offen offset:1024 sc1
  v_mfma_f32_16x16x32_bf16 v[96:99], a[80:83], a[224:227], v[96:99]
  ds_read_b64_tr_b16 a[28:29], v225 offset:43104
  v_mfma_f32_16x16x32_bf16 v[100:103], a[80:83], a[228:231], v[100:103]
  v_mfma_f32_16x16x32_bf16 v[104:107], a[80:83], a[232:235], v[104:107]
  ds_read_b64_tr_b16 a[30:31], v225 offset:46688
  v_mfma_f32_16x16x32_bf16 v[108:111], a[80:83], a[236:239], v[108:111]
  v_mfma_f32_16x16x32_bf16 v[124:127], a[84:87], a[236:239], v[124:127]
  ds_read_b64_tr_b16 a[32:33], v225 offset:28800
  v_mfma_f32_16x16x32_bf16 v[120:123], a[84:87], a[232:235], v[120:123]
  ds_read_b64_tr_b16 a[34:35], v225 offset:32384
  v_mfma_f32_16x16x32_bf16 v[116:119], a[84:87], a[228:231], v[116:119]
  buffer_load_dwordx4 v232, s[64:67], s69 offen offset:2048 lds
  v_mfma_f32_16x16x32_bf16 v[112:115], a[84:87], a[224:227], v[112:115]
  ds_read_b64_tr_b16 a[36:37], v225 offset:43136
  v_mfma_f32_16x16x32_bf16 v[128:131], a[88:91], a[224:227], v[128:131]
  ds_read_b64_tr_b16 a[38:39], v225 offset:46720
  v_mfma_f32_16x16x32_bf16 v[132:135], a[88:91], a[228:231], v[132:135]
  buffer_load_dwordx4 a[172:175], v236, s[36:39], s63 offen offset:1024 sc1
  v_mfma_f32_16x16x32_bf16 v[136:139], a[88:91], a[232:235], v[136:139]
  ds_read_b64_tr_b16 a[40:41], v225 offset:28832
  v_mfma_f32_16x16x32_bf16 v[140:143], a[88:91], a[236:239], v[140:143]
  v_mfma_f32_16x16x32_bf16 v[156:159], a[92:95], a[236:239], v[156:159]
  ds_read_b64_tr_b16 a[42:43], v225 offset:32416
  v_mfma_f32_16x16x32_bf16 v[152:155], a[92:95], a[232:235], v[152:155]
  s_add_u32 s70, s21, 3
  v_mfma_f32_16x16x32_bf16 v[148:151], a[92:95], a[228:231], v[148:151]
  ds_read_b64_tr_b16 a[44:45], v225 offset:43168
  v_mfma_f32_16x16x32_bf16 v[144:147], a[92:95], a[224:227], v[144:147]
  ds_read_b64_tr_b16 a[46:47], v225 offset:46752
  v_mfma_f32_16x16x32_bf16 v[160:163], a[96:99], a[224:227], v[160:163]
  s_and_b32 s70, s70, 3
  v_mfma_f32_16x16x32_bf16 v[164:167], a[96:99], a[228:231], v[164:167]
  ds_read_b64_tr_b16 a[48:49], v225 offset:28864
  v_mfma_f32_16x16x32_bf16 v[168:171], a[96:99], a[232:235], v[168:171]
  ds_read_b64_tr_b16 a[50:51], v225 offset:32448
  v_mfma_f32_16x16x32_bf16 v[172:175], a[96:99], a[236:239], v[172:175]
  s_add_u32 s70, s70, 4
  v_mfma_f32_16x16x32_bf16 v[188:191], a[100:103], a[236:239], v[188:191]
  ds_read_b64_tr_b16 a[52:53], v225 offset:43200
  v_mfma_f32_16x16x32_bf16 v[184:187], a[100:103], a[232:235], v[184:187]
  v_mfma_f32_16x16x32_bf16 v[180:183], a[100:103], a[228:231], v[180:183]
  ds_read_b64_tr_b16 a[54:55], v225 offset:46784
  v_mfma_f32_16x16x32_bf16 v[176:179], a[100:103], a[224:227], v[176:179]
  s_mul_i32 s70, s70, 458752
  v_mfma_f32_16x16x32_bf16 v[192:195], a[104:107], a[224:227], v[192:195]
  v_mfma_f32_16x16x32_bf16 v[196:199], a[104:107], a[228:231], v[196:199]
  v_mfma_f32_16x16x32_bf16 v[200:203], a[104:107], a[232:235], v[200:203]
  s_add_u32 m0, s68, 0
  v_mfma_f32_16x16x32_bf16 v[204:207], a[104:107], a[236:239], v[204:207]
  v_mfma_f32_16x16x32_bf16 v[220:223], a[108:111], a[236:239], v[220:223]
  v_mfma_f32_16x16x32_bf16 v[216:219], a[108:111], a[232:235], v[216:219]
  v_mfma_f32_16x16x32_bf16 v[212:215], a[108:111], a[228:231], v[212:215]
  buffer_load_dwordx4 v226, s[64:67], s70 offen lds
  v_mfma_f32_16x16x32_bf16 v[208:211], a[108:111], a[224:227], v[208:211]
  s_waitcnt vmcnt(27) lgkmcnt(0)
  v_mfma_f32_16x16x32_bf16 v[0:3], a[0:3], a[112:115], v[0:3]
  ds_read_b64_tr_b16 a[56:57], v225 offset:35840
  v_mfma_f32_16x16x32_bf16 v[4:7], a[0:3], a[116:119], v[4:7]
  ds_read_b64_tr_b16 a[58:59], v225 offset:39424
  v_mfma_f32_16x16x32_bf16 v[8:11], a[0:3], a[120:123], v[8:11]
  s_add_u32 s62, s21, 2
  v_mfma_f32_16x16x32_bf16 v[12:15], a[0:3], a[124:127], v[12:15]
  ds_read_b64_tr_b16 a[60:61], v225 offset:50176
  v_mfma_f32_16x16x32_bf16 v[28:31], a[4:7], a[124:127], v[28:31]
  v_mfma_f32_16x16x32_bf16 v[24:27], a[4:7], a[120:123], v[24:27]
  ds_read_b64_tr_b16 a[62:63], v225 offset:53760
  v_mfma_f32_16x16x32_bf16 v[20:23], a[4:7], a[116:119], v[20:23]
  s_and_b32 s62, s62, 3
  v_mfma_f32_16x16x32_bf16 v[16:19], a[4:7], a[112:115], v[16:19]
  ds_read_b64_tr_b16 a[64:65], v225 offset:35872
  v_mfma_f32_16x16x32_bf16 v[32:35], a[8:11], a[112:115], v[32:35]
  ds_read_b64_tr_b16 a[66:67], v225 offset:39456
  v_mfma_f32_16x16x32_bf16 v[36:39], a[8:11], a[116:119], v[36:39]
  s_add_u32 s62, s62, 4
  v_mfma_f32_16x16x32_bf16 v[40:43], a[8:11], a[120:123], v[40:43]
  ds_read_b64_tr_b16 a[68:69], v225 offset:50208
  v_mfma_f32_16x16x32_bf16 v[44:47], a[8:11], a[124:127], v[44:47]
  v_mfma_f32_16x16x32_bf16 v[60:63], a[12:15], a[124:127], v[60:63]
  ds_read_b64_tr_b16 a[70:71], v225 offset:53792
  v_mfma_f32_16x16x32_bf16 v[56:59], a[12:15], a[120:123], v[56:59]
  s_mul_i32 s62, s62, 2048
  v_mfma_f32_16x16x32_bf16 v[52:55], a[12:15], a[116:119], v[52:55]
  ds_read_b64_tr_b16 a[72:73], v225 offset:35904
  v_mfma_f32_16x16x32_bf16 v[48:51], a[12:15], a[112:115], v[48:51]
  ds_read_b64_tr_b16 a[74:75], v225 offset:39488
  v_mfma_f32_16x16x32_bf16 v[64:67], a[16:19], a[112:115], v[64:67]
  buffer_load_dwordx4 a[176:179], v233, s[36:39], s62 offen offset:0 sc1
  v_mfma_f32_16x16x32_bf16 v[68:71], a[16:19], a[116:119], v[68:71]
  ds_read_b64_tr_b16 a[76:77], v225 offset:50240
  v_mfma_f32_16x16x32_bf16 v[72:75], a[16:19], a[120:123], v[72:75]
  ds_read_b64_tr_b16 a[78:79], v225 offset:53824
  v_mfma_f32_16x16x32_bf16 v[76:79], a[16:19], a[124:127], v[76:79]
  v_mfma_f32_16x16x32_bf16 v[92:95], a[20:23], a[124:127], v[92:95]
  ds_read_b64_tr_b16 a[80:81], v225 offset:35936
  v_mfma_f32_16x16x32_bf16 v[88:91], a[20:23], a[120:123], v[88:91]
  v_mfma_f32_16x16x32_bf16 v[84:87], a[20:23], a[116:119], v[84:87]
  ds_read_b64_tr_b16 a[82:83], v225 offset:39520
  v_mfma_f32_16x16x32_bf16 v[80:83], a[20:23], a[112:115], v[80:83]
  buffer_load_dwordx4 v227, s[64:67], s70 offen offset:1024 lds
  v_mfma_f32_16x16x32_bf16 v[96:99], a[24:27], a[112:115], v[96:99]
  ds_read_b64_tr_b16 a[84:85], v225 offset:50272
  v_mfma_f32_16x16x32_bf16 v[100:103], a[24:27], a[116:119], v[100:103]
  ds_read_b64_tr_b16 a[86:87], v225 offset:53856
  v_mfma_f32_16x16x32_bf16 v[104:107], a[24:27], a[120:123], v[104:107]
  buffer_load_dwordx4 a[180:183], v234, s[36:39], s62 offen offset:0 sc1
  v_mfma_f32_16x16x32_bf16 v[108:111], a[24:27], a[124:127], v[108:111]
  ds_read_b64_tr_b16 a[88:89], v225 offset:35968
  v_mfma_f32_16x16x32_bf16 v[124:127], a[28:31], a[124:127], v[124:127]
  v_mfma_f32_16x16x32_bf16 v[120:123], a[28:31], a[120:123], v[120:123]
  ds_read_b64_tr_b16 a[90:91], v225 offset:39552
  v_mfma_f32_16x16x32_bf16 v[116:119], a[28:31], a[116:119], v[116:119]
  v_mfma_f32_16x16x32_bf16 v[112:115], a[28:31], a[112:115], v[112:115]
  ds_read_b64_tr_b16 a[92:93], v225 offset:50304
  v_mfma_f32_16x16x32_bf16 v[128:131], a[32:35], a[112:115], v[128:131]
  ds_read_b64_tr_b16 a[94:95], v225 offset:53888
  v_mfma_f32_16x16x32_bf16 v[132:135], a[32:35], a[116:119], v[132:135]
  buffer_load_dwordx4 v228, s[64:67], s70 offen offset:2048 lds
  v_mfma_f32_16x16x32_bf16 v[136:139], a[32:35], a[120:123], v[136:139]
  ds_read_b64_tr_b16 a[96:97], v225 offset:36000
  v_mfma_f32_16x16x32_bf16 v[140:143], a[32:35], a[124:127], v[140:143]
  v_mfma_f32_16x16x32_bf16 v[156:159], a[36:39], a[124:127], v[156:159]
  ds_read_b64_tr_b16 a[98:99], v225 offset:39584
  v_mfma_f32_16x16x32_bf16 v[152:155], a[36:39], a[120:123], v[152:155]
  buffer_load_dwordx4 a[184:187], v235, s[36:39], s62 offen offset:0 sc1
  v_mfma_f32_16x16x32_bf16 v[148:151], a[36:39], a[116:119], v[148:151]
  ds_read_b64_tr_b16 a[100:101], v225 offset:50336
  v_mfma_f32_16x16x32_bf16 v[144:147], a[36:39], a[112:115], v[144:147]
  ds_read_b64_tr_b16 a[102:103], v225 offset:53920
  v_mfma_f32_16x16x32_bf16 v[160:163], a[40:43], a[112:115], v[160:163]
  v_mfma_f32_16x16x32_bf16 v[164:167], a[40:43], a[116:119], v[164:167]
  ds_read_b64_tr_b16 a[104:105], v225 offset:36032
  v_mfma_f32_16x16x32_bf16 v[168:171], a[40:43], a[120:123], v[168:171]
  ds_read_b64_tr_b16 a[106:107], v225 offset:39616
  v_mfma_f32_16x16x32_bf16 v[172:175], a[40:43], a[124:127], v[172:175]
  buffer_load_dwordx4 v229, s[64:67], s70 offen offset:3072 lds
  v_mfma_f32_16x16x32_bf16 v[188:191], a[44:47], a[124:127], v[188:191]
  ds_read_b64_tr_b16 a[108:109], v225 offset:50368
  v_mfma_f32_16x16x32_bf16 v[184:187], a[44:47], a[120:123], v[184:187]
  v_mfma_f32_16x16x32_bf16 v[180:183], a[44:47], a[116:119], v[180:183]
  ds_read_b64_tr_b16 a[110:111], v225 offset:53952
  v_mfma_f32_16x16x32_bf16 v[176:179], a[44:47], a[112:115], v[176:179]
  buffer_load_dwordx4 a[188:191], v236, s[36:39], s62 offen offset:0 sc1
  v_mfma_f32_16x16x32_bf16 v[192:195], a[48:51], a[112:115], v[192:195]
  v_mfma_f32_16x16x32_bf16 v[196:199], a[48:51], a[116:119], v[196:199]
  v_mfma_f32_16x16x32_bf16 v[200:203], a[48:51], a[120:123], v[200:203]
  s_add_u32 m0, s68, 4096
  v_mfma_f32_16x16x32_bf16 v[204:207], a[48:51], a[124:127], v[204:207]
  v_mfma_f32_16x16x32_bf16 v[220:223], a[52:55], a[124:127], v[220:223]
  v_mfma_f32_16x16x32_bf16 v[216:219], a[52:55], a[120:123], v[216:219]
  v_mfma_f32_16x16x32_bf16 v[212:215], a[52:55], a[116:119], v[212:215]
  buffer_load_dwordx4 v230, s[64:67], s70 offen lds
  v_mfma_f32_16x16x32_bf16 v[208:211], a[52:55], a[112:115], v[208:211]
  s_waitcnt vmcnt(28) lgkmcnt(0)
  v_mfma_f32_16x16x32_bf16 v[0:3], a[56:59], a[128:131], v[0:3]
  s_waitcnt vmcnt(25)
  s_barrier
  v_mfma_f32_16x16x32_bf16 v[4:7], a[56:59], a[132:135], v[4:7]
  ds_read_b64_tr_b16 a[0:1], v225 offset:0
  v_mfma_f32_16x16x32_bf16 v[8:11], a[56:59], a[136:139], v[8:11]
  ds_read_b64_tr_b16 a[2:3], v225 offset:3584
  v_mfma_f32_16x16x32_bf16 v[12:15], a[56:59], a[140:143], v[12:15]
  buffer_load_dwordx4 a[192:195], v233, s[36:39], s62 offen offset:1024 sc1
  v_mfma_f32_16x16x32_bf16 v[28:31], a[60:63], a[140:143], v[28:31]
  ds_read_b64_tr_b16 a[4:5], v225 offset:14336
  v_mfma_f32_16x16x32_bf16 v[24:27], a[60:63], a[136:139], v[24:27]
  v_mfma_f32_16x16x32_bf16 v[20:23], a[60:63], a[132:135], v[20:23]
  ds_read_b64_tr_b16 a[6:7], v225 offset:17920
  v_mfma_f32_16x16x32_bf16 v[16:19], a[60:63], a[128:131], v[16:19]
  v_mfma_f32_16x16x32_bf16 v[32:35], a[64:67], a[128:131], v[32:35]
  ds_read_b64_tr_b16 a[8:9], v225 offset:32
  v_mfma_f32_16x16x32_bf16 v[36:39], a[64:67], a[132:135], v[36:39]
  ds_read_b64_tr_b16 a[10:11], v225 offset:3616
  v_mfma_f32_16x16x32_bf16 v[40:43], a[64:67], a[136:139], v[40:43]
  buffer_load_dwordx4 v231, s[64:67], s70 offen offset:1024 lds
  v_mfma_f32_16x16x32_bf16 v[44:47], a[64:67], a[140:143], v[44:47]
  ds_read_b64_tr_b16 a[12:13], v225 offset:14368
  v_mfma_f32_16x16x32_bf16 v[60:63], a[68:71], a[140:143], v[60:63]
  ds_read_b64_tr_b16 a[14:15], v225 offset:17952
  v_mfma_f32_16x16x32_bf16 v[56:59], a[68:71], a[136:139], v[56:59]
  buffer_load_dwordx4 a[196:199], v234, s[36:39], s62 offen offset:1024 sc1
  v_mfma_f32_16x16x32_bf16 v[52:55], a[68:71], a[132:135], v[52:55]
  ds_read_b64_tr_b16 a[16:17], v225 offset:64
  v_mfma_f32_16x16x32_bf16 v[48:51], a[68:71], a[128:131], v[48:51]
  v_mfma_f32_16x16x32_bf16 v[64:67], a[72:75], a[128:131], v[64:67]
  ds_read_b64_tr_b16 a[18:19], v225 offset:3648
  v_mfma_f32_16x16x32_bf16 v[68:71], a[72:75], a[132:135], v[68:71]
  v_mfma_f32_16x16x32_bf16 v[72:75], a[72:75], a[136:139], v[72:75]
  ds_read_b64_tr_b16 a[20:21], v225 offset:14400
  v_mfma_f32_16x16x32_bf16 v[76:79], a[72:75], a[140:143], v[76:79]
  ds_read_b64_tr_b16 a[22:23], v225 offset:17984
  v_mfma_f32_16x16x32_bf16 v[92:95], a[76:79], a[140:143], v[92:95]
  buffer_load_dwordx4 v232, s[64:67], s70 offen offset:2048 lds
  v_mfma_f32_16x16x32_bf16 v[88:91], a[76:79], a[136:139], v[88:91]
  ds_read_b64_tr_b16 a[24:25], v225 offset:96
  v_mfma_f32_16x16x32_bf16 v[84:87], a[76:79], a[132:135], v[84:87]
  ds_read_b64_tr_b16 a[26:27], v225 offset:3680
  v_mfma_f32_16x16x32_bf16 v[80:83], a[76:79], a[128:131], v[80:83]
  buffer_load_dwordx4 a[200:203], v235, s[36:39], s62 offen offset:1024 sc1
  v_mfma_f32_16x16x32_bf16 v[96:99], a[80:83], a[128:131], v[96:99]
  ds_read_b64_tr_b16 a[28:29], v225 offset:14432
  v_mfma_f32_16x16x32_bf16 v[100:103], a[80:83], a[132:135], v[100:103]
  v_mfma_f32_16x16x32_bf16 v[104:107], a[80:83], a[136:139], v[104:107]
  ds_read_b64_tr_b16 a[30:31], v225 offset:18016
  v_mfma_f32_16x16x32_bf16 v[108:111], a[80:83], a[140:143], v[108:111]
  s_add_u32 s69, s20, 0
  v_mfma_f32_16x16x32_bf16 v[124:127], a[84:87], a[140:143], v[124:127]
  ds_read_b64_tr_b16 a[32:33], v225 offset:128
  v_mfma_f32_16x16x32_bf16 v[120:123], a[84:87], a[136:139], v[120:123]
  ds_read_b64_tr_b16 a[34:35], v225 offset:3712
  v_mfma_f32_16x16x32_bf16 v[116:119], a[84:87], a[132:135], v[116:119]
  s_and_b32 s69, s69, 7
  v_mfma_f32_16x16x32_bf16 v[112:115], a[84:87], a[128:131], v[112:115]
  ds_read_b64_tr_b16 a[36:37], v225 offset:14464
  v_mfma_f32_16x16x32_bf16 v[128:131], a[88:91], a[128:131], v[128:131]
  ds_read_b64_tr_b16 a[38:39], v225 offset:18048
  v_mfma_f32_16x16x32_bf16 v[132:135], a[88:91], a[132:135], v[132:135]
  s_add_u32 s69, s69, 8
  v_mfma_f32_16x16x32_bf16 v[136:139], a[88:91], a[136:139], v[136:139]
  ds_read_b64_tr_b16 a[40:41], v225 offset:160
  v_mfma_f32_16x16x32_bf16 v[140:143], a[88:91], a[140:143], v[140:143]
  v_mfma_f32_16x16x32_bf16 v[156:159], a[92:95], a[140:143], v[156:159]
  ds_read_b64_tr_b16 a[42:43], v225 offset:3744
  v_mfma_f32_16x16x32_bf16 v[152:155], a[92:95], a[136:139], v[152:155]
  s_mul_i32 s69, s69, 458752
  v_mfma_f32_16x16x32_bf16 v[148:151], a[92:95], a[132:135], v[148:151]
  ds_read_b64_tr_b16 a[44:45], v225 offset:14496
  v_mfma_f32_16x16x32_bf16 v[144:147], a[92:95], a[128:131], v[144:147]
  ds_read_b64_tr_b16 a[46:47], v225 offset:18080
  v_mfma_f32_16x16x32_bf16 v[160:163], a[96:99], a[128:131], v[160:163]
  s_add_u32 m0, s68, 86016
  v_mfma_f32_16x16x32_bf16 v[164:167], a[96:99], a[132:135], v[164:167]
  ds_read_b64_tr_b16 a[48:49], v225 offset:192
  v_mfma_f32_16x16x32_bf16 v[168:171], a[96:99], a[136:139], v[168:171]
  ds_read_b64_tr_b16 a[50:51], v225 offset:3776
  v_mfma_f32_16x16x32_bf16 v[172:175], a[96:99], a[140:143], v[172:175]
  buffer_load_dwordx4 v226, s[64:67], s69 offen lds
  v_mfma_f32_16x16x32_bf16 v[188:191], a[100:103], a[140:143], v[188:191]
  ds_read_b64_tr_b16 a[52:53], v225 offset:14528
  v_mfma_f32_16x16x32_bf16 v[184:187], a[100:103], a[136:139], v[184:187]
  v_mfma_f32_16x16x32_bf16 v[180:183], a[100:103], a[132:135], v[180:183]
  ds_read_b64_tr_b16 a[54:55], v225 offset:18112
  v_mfma_f32_16x16x32_bf16 v[176:179], a[100:103], a[128:131], v[176:179]
  buffer_load_dwordx4 a[204:207], v236, s[36:39], s62 offen offset:1024 sc1
  v_mfma_f32_16x16x32_bf16 v[192:195], a[104:107], a[128:131], v[192:195]
  v_mfma_f32_16x16x32_bf16 v[196:199], a[104:107], a[132:135], v[196:199]
  v_mfma_f32_16x16x32_bf16 v[200:203], a[104:107], a[136:139], v[200:203]
  v_mfma_f32_16x16x32_bf16 v[204:207], a[104:107], a[140:143], v[204:207]
  v_mfma_f32_16x16x32_bf16 v[220:223], a[108:111], a[140:143], v[220:223]
  v_mfma_f32_16x16x32_bf16 v[216:219], a[108:111], a[136:139], v[216:219]
  v_mfma_f32_16x16x32_bf16 v[212:215], a[108:111], a[132:135], v[212:215]
  buffer_load_dwordx4 v227, s[64:67], s69 offen offset:1024 lds
  v_mfma_f32_16x16x32_bf16 v[208:211], a[108:111], a[128:131], v[208:211]
  s_waitcnt vmcnt(26) lgkmcnt(0)
  v_mfma_f32_16x16x32_bf16 v[0:3], a[0:3], a[144:147], v[0:3]
  ds_read_b64_tr_b16 a[56:57], v225 offset:7168
  v_mfma_f32_16x16x32_bf16 v[4:7], a[0:3], a[148:151], v[4:7]
  ds_read_b64_tr_b16 a[58:59], v225 offset:10752
  v_mfma_f32_16x16x32_bf16 v[8:11], a[0:3], a[152:155], v[8:11]
  s_add_u32 s63, s21, 3
  v_mfma_f32_16x16x32_bf16 v[12:15], a[0:3], a[156:159], v[12:15]
  ds_read_b64_tr_b16 a[60:61], v225 offset:21504
  v_mfma_f32_16x16x32_bf16 v[28:31], a[4:7], a[156:159], v[28:31]
  v_mfma_f32_16x16x32_bf16 v[24:27], a[4:7], a[152:155], v[24:27]
  ds_read_b64_tr_b16 a[62:63], v225 offset:25088
  v_mfma_f32_16x16x32_bf16 v[20:23], a[4:7], a[148:151], v[20:23]
  s_and_b32 s63, s63, 3
  v_mfma_f32_16x16x32_bf16 v[16:19], a[4:7], a[144:147], v[16:19]
  ds_read_b64_tr_b16 a[64:65], v225 offset:7200
  v_mfma_f32_16x16x32_bf16 v[32:35], a[8:11], a[144:147], v[32:35]
  ds_read_b64_tr_b16 a[66:67], v225 offset:10784
  v_mfma_f32_16x16x32_bf16 v[36:39], a[8:11], a[148:151], v[36:39]
  s_add_u32 s63, s63, 4
  v_mfma_f32_16x16x32_bf16 v[40:43], a[8:11], a[152:155], v[40:43]
  ds_read_b64_tr_b16 a[68:69], v225 offset:21536
  v_mfma_f32_16x16x32_bf16 v[44:47], a[8:11], a[156:159], v[44:47]
  v_mfma_f32_16x16x32_bf16 v[60:63], a[12:15], a[156:159], v[60:63]
  ds_read_b64_tr_b16 a[70:71], v225 offset:25120
  v_mfma_f32_16x16x32_bf16 v[56:59], a[12:15], a[152:155], v[56:59]
  s_mul_i32 s63, s63, 2048
  v_mfma_f32_16x16x32_bf16 v[52:55], a[12:15], a[148:151], v[52:55]
  ds_read_b64_tr_b16 a[72:73], v225 offset:7232
  v_mfma_f32_16x16x32_bf16 v[48:51], a[12:15], a[144:147], v[48:51]
  ds_read_b64_tr_b16 a[74:75], v225 offset:10816
  v_mfma_f32_16x16x32_bf16 v[64:67], a[16:19], a[144:147], v[64:67]
  buffer_load_dwordx4 a[208:211], v233, s[36:39], s63 offen offset:0 sc1
  v_mfma_f32_16x16x32_bf16 v[68:71], a[16:19], a[148:151], v[68:71]
  ds_read_b64_tr_b16 a[76:77], v225 offset:21568
  v_mfma_f32_16x16x32_bf16 v[72:75], a[16:19], a[152:155], v[72:75]
  ds_read_b64_tr_b16 a[78:79], v225 offset:25152
  v_mfma_f32_16x16x32_bf16 v[76:79], a[16:19], a[156:159], v[76:79]
  v_mfma_f32_16x16x32_bf16 v[92:95], a[20:23], a[156:159], v[92:95]
  ds_read_b64_tr_b16 a[80:81], v225 offset:7264
  v_mfma_f32_16x16x32_bf16 v[88:91], a[20:23], a[152:155], v[88:91]
  v_mfma_f32_16x16x32_bf16 v[84:87], a[20:23], a[148:151], v[84:87]
  ds_read_b64_tr_b16 a[82:83], v225 offset:10848
  v_mfma_f32_16x16x32_bf16 v[80:83], a[20:23], a[144:147], v[80:83]
  buffer_load_dwordx4 v228, s[64:67], s69 offen offset:2048 lds
  v_mfma_f32_16x16x32_bf16 v[96:99], a[24:27], a[144:147], v[96:99]
  ds_read_b64_tr_b16 a[84:85], v225 offset:21600
  v_mfma_f32_16x16x32_bf16 v[100:103], a[24:27], a[148:151], v[100:103]
  ds_read_b64_tr_b16 a[86:87], v225 offset:25184
  v_mfma_f32_16x16x32_bf16 v[104:107], a[24:27], a[152:155], v[104:107]
  buffer_load_dwordx4 a[212:215], v234, s[36:39], s63 offen offset:0 sc1
  v_mfma_f32_16x16x32_bf16 v[108:111], a[24:27], a[156:159], v[108:111]
  ds_read_b64_tr_b16 a[88:89], v225 offset:7296
  v_mfma_f32_16x16x32_bf16 v[124:127], a[28:31], a[156:159], v[124:127]
  v_mfma_f32_16x16x32_bf16 v[120:123], a[28:31], a[152:155], v[120:123]
  ds_read_b64_tr_b16 a[90:91], v225 offset:10880
  v_mfma_f32_16x16x32_bf16 v[116:119], a[28:31], a[148:151], v[116:119]
  v_mfma_f32_16x16x32_bf16 v[112:115], a[28:31], a[144:147], v[112:115]
  ds_read_b64_tr_b16 a[92:93], v225 offset:21632
  v_mfma_f32_16x16x32_bf16 v[128:131], a[32:35], a[144:147], v[128:131]
  ds_read_b64_tr_b16 a[94:95], v225 offset:25216
  v_mfma_f32_16x16x32_bf16 v[132:135], a[32:35], a[148:151], v[132:135]
  buffer_load_dwordx4 v229, s[64:67], s69 offen offset:3072 lds
  v_mfma_f32_16x16x32_bf16 v[136:139], a[32:35], a[152:155], v[136:139]
  ds_read_b64_tr_b16 a[96:97], v225 offset:7328
  v_mfma_f32_16x16x32_bf16 v[140:143], a[32:35], a[156:159], v[140:143]
  v_mfma_f32_16x16x32_bf16 v[156:159], a[36:39], a[156:159], v[156:159]
  ds_read_b64_tr_b16 a[98:99], v225 offset:10912
  v_mfma_f32_16x16x32_bf16 v[152:155], a[36:39], a[152:155], v[152:155]
  buffer_load_dwordx4 a[216:219], v235, s[36:39], s63 offen offset:0 sc1
  v_mfma_f32_16x16x32_bf16 v[148:151], a[36:39], a[148:151], v[148:151]
  ds_read_b64_tr_b16 a[100:101], v225 offset:21664
  v_mfma_f32_16x16x32_bf16 v[144:147], a[36:39], a[144:147], v[144:147]
  ds_read_b64_tr_b16 a[102:103], v225 offset:25248
  v_mfma_f32_16x16x32_bf16 v[160:163], a[40:43], a[144:147], v[160:163]
  s_add_u32 m0, s68, 90112
  v_mfma_f32_16x16x32_bf16 v[164:167], a[40:43], a[148:151], v[164:167]
  ds_read_b64_tr_b16 a[104:105], v225 offset:7360
  v_mfma_f32_16x16x32_bf16 v[168:171], a[40:43], a[152:155], v[168:171]
  ds_read_b64_tr_b16 a[106:107], v225 offset:10944
  v_mfma_f32_16x16x32_bf16 v[172:175], a[40:43], a[156:159], v[172:175]
  buffer_load_dwordx4 v230, s[64:67], s69 offen lds
  v_mfma_f32_16x16x32_bf16 v[188:191], a[44:47], a[156:159], v[188:191]
  ds_read_b64_tr_b16 a[108:109], v225 offset:21696
  v_mfma_f32_16x16x32_bf16 v[184:187], a[44:47], a[152:155], v[184:187]
  v_mfma_f32_16x16x32_bf16 v[180:183], a[44:47], a[148:151], v[180:183]
  ds_read_b64_tr_b16 a[110:111], v225 offset:25280
  v_mfma_f32_16x16x32_bf16 v[176:179], a[44:47], a[144:147], v[176:179]
  buffer_load_dwordx4 a[220:223], v236, s[36:39], s63 offen offset:0 sc1
  v_mfma_f32_16x16x32_bf16 v[192:195], a[48:51], a[144:147], v[192:195]
  v_mfma_f32_16x16x32_bf16 v[196:199], a[48:51], a[148:151], v[196:199]
  v_mfma_f32_16x16x32_bf16 v[200:203], a[48:51], a[152:155], v[200:203]
  v_mfma_f32_16x16x32_bf16 v[204:207], a[48:51], a[156:159], v[204:207]
  v_mfma_f32_16x16x32_bf16 v[220:223], a[52:55], a[156:159], v[220:223]
  v_mfma_f32_16x16x32_bf16 v[216:219], a[52:55], a[152:155], v[216:219]
  v_mfma_f32_16x16x32_bf16 v[212:215], a[52:55], a[148:151], v[212:215]
  buffer_load_dwordx4 v231, s[64:67], s69 offen offset:1024 lds
  v_mfma_f32_16x16x32_bf16 v[208:211], a[52:55], a[144:147], v[208:211]
  s_waitcnt vmcnt(25) lgkmcnt(0)
  v_mfma_f32_16x16x32_bf16 v[0:3], a[56:59], a[160:163], v[0:3]
  s_waitcnt vmcnt(26)
  s_barrier
  v_mfma_f32_16x16x32_bf16 v[4:7], a[56:59], a[164:167], v[4:7]
  ds_read_b64_tr_b16 a[0:1], v224 offset:28672
  v_mfma_f32_16x16x32_bf16 v[8:11], a[56:59], a[168:171], v[8:11]
  ds_read_b64_tr_b16 a[2:3], v224 offset:32256
  v_mfma_f32_16x16x32_bf16 v[12:15], a[56:59], a[172:175], v[12:15]
  buffer_load_dwordx4 a[224:227], v233, s[36:39], s63 offen offset:1024 sc1
  v_mfma_f32_16x16x32_bf16 v[28:31], a[60:63], a[172:175], v[28:31]
  ds_read_b64_tr_b16 a[4:5], v224 offset:43008
  v_mfma_f32_16x16x32_bf16 v[24:27], a[60:63], a[168:171], v[24:27]
  v_mfma_f32_16x16x32_bf16 v[20:23], a[60:63], a[164:167], v[20:23]
  ds_read_b64_tr_b16 a[6:7], v224 offset:46592
  v_mfma_f32_16x16x32_bf16 v[16:19], a[60:63], a[160:163], v[16:19]
  v_mfma_f32_16x16x32_bf16 v[32:35], a[64:67], a[160:163], v[32:35]
  ds_read_b64_tr_b16 a[8:9], v224 offset:28704
  v_mfma_f32_16x16x32_bf16 v[36:39], a[64:67], a[164:167], v[36:39]
  ds_read_b64_tr_b16 a[10:11], v224 offset:32288
  v_mfma_f32_16x16x32_bf16 v[40:43], a[64:67], a[168:171], v[40:43]
  buffer_load_dwordx4 v232, s[64:67], s69 offen offset:2048 lds
  v_mfma_f32_16x16x32_bf16 v[44:47], a[64:67], a[172:175], v[44:47]
  ds_read_b64_tr_b16 a[12:13], v224 offset:43040
  v_mfma_f32_16x16x32_bf16 v[60:63], a[68:71], a[172:175], v[60:63]
  ds_read_b64_tr_b16 a[14:15], v224 offset:46624
  v_mfma_f32_16x16x32_bf16 v[56:59], a[68:71], a[168:171], v[56:59]
  buffer_load_dwordx4 a[228:231], v234, s[36:39], s63 offen offset:1024 sc1
  v_mfma_f32_16x16x32_bf16 v[52:55], a[68:71], a[164:167], v[52:55]
  ds_read_b64_tr_b16 a[16:17], v224 offset:28736
  v_mfma_f32_16x16x32_bf16 v[48:51], a[68:71], a[160:163], v[48:51]
  v_mfma_f32_16x16x32_bf16 v[64:67], a[72:75], a[160:163], v[64:67]
  ds_read_b64_tr_b16 a[18:19], v224 offset:32320
  v_mfma_f32_16x16x32_bf16 v[68:71], a[72:75], a[164:167], v[68:71]
  s_add_u32 s70, s20, 1
  v_mfma_f32_16x16x32_bf16 v[72:75], a[72:75], a[168:171], v[72:75]
  ds_read_b64_tr_b16 a[20:21], v224 offset:43072
  v_mfma_f32_16x16x32_bf16 v[76:79], a[72:75], a[172:175], v[76:79]
  ds_read_b64_tr_b16 a[22:23], v224 offset:46656
  v_mfma_f32_16x16x32_bf16 v[92:95], a[76:79], a[172:175], v[92:95]
  s_and_b32 s70, s70, 7
  v_mfma_f32_16x16x32_bf16 v[88:91], a[76:79], a[168:171], v[88:91]
  ds_read_b64_tr_b16 a[24:25], v224 offset:28768
  v_mfma_f32_16x16x32_bf16 v[84:87], a[76:79], a[164:167], v[84:87]
  ds_read_b64_tr_b16 a[26:27], v224 offset:32352
  v_mfma_f32_16x16x32_bf16 v[80:83], a[76:79], a[160:163], v[80:83]
  s_add_u32 s70, s70, 8
  v_mfma_f32_16x16x32_bf16 v[96:99], a[80:83], a[160:163], v[96:99]
  ds_read_b64_tr_b16 a[28:29], v224 offset:43104
  v_mfma_f32_16x16x32_bf16 v[100:103], a[80:83], a[164:167], v[100:103]
  v_mfma_f32_16x16x32_bf16 v[104:107], a[80:83], a[168:171], v[104:107]
  ds_read_b64_tr_b16 a[30:31], v224 offset:46688
  v_mfma_f32_16x16x32_bf16 v[108:111], a[80:83], a[172:175], v[108:111]
  s_mul_i32 s70, s70, 458752
  v_mfma_f32_16x16x32_bf16 v[124:127], a[84:87], a[172:175], v[124:127]
  ds_read_b64_tr_b16 a[32:33], v224 offset:28800
  v_mfma_f32_16x16x32_bf16 v[120:123], a[84:87], a[168:171], v[120:123]
  ds_read_b64_tr_b16 a[34:35], v224 offset:32384
  v_mfma_f32_16x16x32_bf16 v[116:119], a[84:87], a[164:167], v[116:119]
  s_add_u32 m0, s68, 57344
  v_mfma_f32_16x16x32_bf16 v[112:115], a[84:87], a[160:163], v[112:115]
  ds_read_b64_tr_b16 a[36:37], v224 offset:43136
  v_mfma_f32_16x16x32_bf16 v[128:131], a[88:91], a[160:163], v[128:131]
  ds_read_b64_tr_b16 a[38:39], v224 offset:46720
  v_mfma_f32_16x16x32_bf16 v[132:135], a[88:91], a[164:167], v[132:135]
  buffer_load_dwordx4 v226, s[64:67], s70 offen lds
  v_mfma_f32_16x16x32_bf16 v[136:139], a[88:91], a[168:171], v[136:139]
  ds_read_b64_tr_b16 a[40:41], v224 offset:28832
  v_mfma_f32_16x16x32_bf16 v[140:143], a[88:91], a[172:175], v[140:143]
  v_mfma_f32_16x16x32_bf16 v[156:159], a[92:95], a[172:175], v[156:159]
  ds_read_b64_tr_b16 a[42:43], v224 offset:32416
  v_mfma_f32_16x16x32_bf16 v[152:155], a[92:95], a[168:171], v[152:155]
  buffer_load_dwordx4 a[232:235], v235, s[36:39], s63 offen offset:1024 sc1
  v_mfma_f32_16x16x32_bf16 v[148:151], a[92:95], a[164:167], v[148:151]
  ds_read_b64_tr_b16 a[44:45], v224 offset:43168
  v_mfma_f32_16x16x32_bf16 v[144:147], a[92:95], a[160:163], v[144:147]
  ds_read_b64_tr_b16 a[46:47], v224 offset:46752
  v_mfma_f32_16x16x32_bf16 v[160:163], a[96:99], a[160:163], v[160:163]
  v_mfma_f32_16x16x32_bf16 v[164:167], a[96:99], a[164:167], v[164:167]
  ds_read_b64_tr_b16 a[48:49], v224 offset:28864
  v_mfma_f32_16x16x32_bf16 v[168:171], a[96:99], a[168:171], v[168:171]
  ds_read_b64_tr_b16 a[50:51], v224 offset:32448
  v_mfma_f32_16x16x32_bf16 v[172:175], a[96:99], a[172:175], v[172:175]
  buffer_load_dwordx4 v227, s[64:67], s70 offen offset:1024 lds
  v_mfma_f32_16x16x32_bf16 v[188:191], a[100:103], a[172:175], v[188:191]
  ds_read_b64_tr_b16 a[52:53], v224 offset:43200
  v_mfma_f32_16x16x32_bf16 v[184:187], a[100:103], a[168:171], v[184:187]
  v_mfma_f32_16x16x32_bf16 v[180:183], a[100:103], a[164:167], v[180:183]
  ds_read_b64_tr_b16 a[54:55], v224 offset:46784
  v_mfma_f32_16x16x32_bf16 v[176:179], a[100:103], a[160:163], v[176:179]
  buffer_load_dwordx4 a[236:239], v236, s[36:39], s63 offen offset:1024 sc1
  v_mfma_f32_16x16x32_bf16 v[192:195], a[104:107], a[160:163], v[192:195]
  v_mfma_f32_16x16x32_bf16 v[196:199], a[104:107], a[164:167], v[196:199]
  v_mfma_f32_16x16x32_bf16 v[200:203], a[104:107], a[168:171], v[200:203]
  v_mfma_f32_16x16x32_bf16 v[204:207], a[104:107], a[172:175], v[204:207]
  v_mfma_f32_16x16x32_bf16 v[220:223], a[108:111], a[172:175], v[220:223]
  v_mfma_f32_16x16x32_bf16 v[216:219], a[108:111], a[168:171], v[216:219]
  v_mfma_f32_16x16x32_bf16 v[212:215], a[108:111], a[164:167], v[212:215]
  buffer_load_dwordx4 v228, s[64:67], s70 offen offset:2048 lds
  v_mfma_f32_16x16x32_bf16 v[208:211], a[108:111], a[160:163], v[208:211]
  s_waitcnt vmcnt(25) lgkmcnt(0)
  v_mfma_f32_16x16x32_bf16 v[0:3], a[0:3], a[176:179], v[0:3]
  ds_read_b64_tr_b16 a[56:57], v224 offset:35840
  v_mfma_f32_16x16x32_bf16 v[4:7], a[0:3], a[180:183], v[4:7]
  ds_read_b64_tr_b16 a[58:59], v224 offset:39424
  v_mfma_f32_16x16x32_bf16 v[8:11], a[0:3], a[184:187], v[8:11]
  s_add_u32 s62, s20, 0
  v_mfma_f32_16x16x32_bf16 v[12:15], a[0:3], a[188:191], v[12:15]
  ds_read_b64_tr_b16 a[60:61], v224 offset:50176
  v_mfma_f32_16x16x32_bf16 v[28:31], a[4:7], a[188:191], v[28:31]
  v_mfma_f32_16x16x32_bf16 v[24:27], a[4:7], a[184:187], v[24:27]
  ds_read_b64_tr_b16 a[62:63], v224 offset:53760
  v_mfma_f32_16x16x32_bf16 v[20:23], a[4:7], a[180:183], v[20:23]
  s_and_b32 s62, s62, 7
  v_mfma_f32_16x16x32_bf16 v[16:19], a[4:7], a[176:179], v[16:19]
  ds_read_b64_tr_b16 a[64:65], v224 offset:35872
  v_mfma_f32_16x16x32_bf16 v[32:35], a[8:11], a[176:179], v[32:35]
  ds_read_b64_tr_b16 a[66:67], v224 offset:39456
  v_mfma_f32_16x16x32_bf16 v[36:39], a[8:11], a[180:183], v[36:39]
  s_add_u32 s62, s62, 8
  v_mfma_f32_16x16x32_bf16 v[40:43], a[8:11], a[184:187], v[40:43]
  ds_read_b64_tr_b16 a[68:69], v224 offset:50208
  v_mfma_f32_16x16x32_bf16 v[44:47], a[8:11], a[188:191], v[44:47]
  v_mfma_f32_16x16x32_bf16 v[60:63], a[12:15], a[188:191], v[60:63]
  ds_read_b64_tr_b16 a[70:71], v224 offset:53792
  v_mfma_f32_16x16x32_bf16 v[56:59], a[12:15], a[184:187], v[56:59]
  s_mul_i32 s62, s62, 2048
  v_mfma_f32_16x16x32_bf16 v[52:55], a[12:15], a[180:183], v[52:55]
  ds_read_b64_tr_b16 a[72:73], v224 offset:35904
  v_mfma_f32_16x16x32_bf16 v[48:51], a[12:15], a[176:179], v[48:51]
  ds_read_b64_tr_b16 a[74:75], v224 offset:39488
  v_mfma_f32_16x16x32_bf16 v[64:67], a[16:19], a[176:179], v[64:67]
  buffer_load_dwordx4 a[112:115], v233, s[36:39], s62 offen offset:0 sc1
  v_mfma_f32_16x16x32_bf16 v[68:71], a[16:19], a[180:183], v[68:71]
  ds_read_b64_tr_b16 a[76:77], v224 offset:50240
  v_mfma_f32_16x16x32_bf16 v[72:75], a[16:19], a[184:187], v[72:75]
  ds_read_b64_tr_b16 a[78:79], v224 offset:53824
  v_mfma_f32_16x16x32_bf16 v[76:79], a[16:19], a[188:191], v[76:79]
  v_mfma_f32_16x16x32_bf16 v[92:95], a[20:23], a[188:191], v[92:95]
  ds_read_b64_tr_b16 a[80:81], v224 offset:35936
  v_mfma_f32_16x16x32_bf16 v[88:91], a[20:23], a[184:187], v[88:91]
  v_mfma_f32_16x16x32_bf16 v[84:87], a[20:23], a[180:183], v[84:87]
  ds_read_b64_tr_b16 a[82:83], v224 offset:39520
  v_mfma_f32_16x16x32_bf16 v[80:83], a[20:23], a[176:179], v[80:83]
  buffer_load_dwordx4 v229, s[64:67], s70 offen offset:3072 lds
  v_mfma_f32_16x16x32_bf16 v[96:99], a[24:27], a[176:179], v[96:99]
  ds_read_b64_tr_b16 a[84:85], v224 offset:50272
  v_mfma_f32_16x16x32_bf16 v[100:103], a[24:27], a[180:183], v[100:103]
  ds_read_b64_tr_b16 a[86:87], v224 offset:53856
  v_mfma_f32_16x16x32_bf16 v[104:107], a[24:27], a[184:187], v[104:107]
  buffer_load_dwordx4 a[116:119], v234, s[36:39], s62 offen offset:0 sc1
  v_mfma_f32_16x16x32_bf16 v[108:111], a[24:27], a[188:191], v[108:111]
  ds_read_b64_tr_b16 a[88:89], v224 offset:35968
  v_mfma_f32_16x16x32_bf16 v[124:127], a[28:31], a[188:191], v[124:127]
  v_mfma_f32_16x16x32_bf16 v[120:123], a[28:31], a[184:187], v[120:123]
  ds_read_b64_tr_b16 a[90:91], v224 offset:39552
  v_mfma_f32_16x16x32_bf16 v[116:119], a[28:31], a[180:183], v[116:119]
  s_add_u32 m0, s68, 61440
  v_mfma_f32_16x16x32_bf16 v[112:115], a[28:31], a[176:179], v[112:115]
  ds_read_b64_tr_b16 a[92:93], v224 offset:50304
  v_mfma_f32_16x16x32_bf16 v[128:131], a[32:35], a[176:179], v[128:131]
  ds_read_b64_tr_b16 a[94:95], v224 offset:53888
  v_mfma_f32_16x16x32_bf16 v[132:135], a[32:35], a[180:183], v[132:135]
  buffer_load_dwordx4 v230, s[64:67], s70 offen lds
  v_mfma_f32_16x16x32_bf16 v[136:139], a[32:35], a[184:187], v[136:139]
  ds_read_b64_tr_b16 a[96:97], v224 offset:36000
  v_mfma_f32_16x16x32_bf16 v[140:143], a[32:35], a[188:191], v[140:143]
  v_mfma_f32_16x16x32_bf16 v[156:159], a[36:39], a[188:191], v[156:159]
  ds_read_b64_tr_b16 a[98:99], v224 offset:39584
  v_mfma_f32_16x16x32_bf16 v[152:155], a[36:39], a[184:187], v[152:155]
  buffer_load_dwordx4 a[120:123], v235, s[36:39], s62 offen offset:0 sc1
  v_mfma_f32_16x16x32_bf16 v[148:151], a[36:39], a[180:183], v[148:151]
  ds_read_b64_tr_b16 a[100:101], v224 offset:50336
  v_mfma_f32_16x16x32_bf16 v[144:147], a[36:39], a[176:179], v[144:147]
  ds_read_b64_tr_b16 a[102:103], v224 offset:53920
  v_mfma_f32_16x16x32_bf16 v[160:163], a[40:43], a[176:179], v[160:163]
  v_mfma_f32_16x16x32_bf16 v[164:167], a[40:43], a[180:183], v[164:167]
  ds_read_b64_tr_b16 a[104:105], v224 offset:36032
  v_mfma_f32_16x16x32_bf16 v[168:171], a[40:43], a[184:187], v[168:171]
  ds_read_b64_tr_b16 a[106:107], v224 offset:39616
  v_mfma_f32_16x16x32_bf16 v[172:175], a[40:43], a[188:191], v[172:175]
  buffer_load_dwordx4 v231, s[64:67], s70 offen offset:1024 lds
  v_mfma_f32_16x16x32_bf16 v[188:191], a[44:47], a[188:191], v[188:191]
  ds_read_b64_tr_b16 a[108:109], v224 offset:50368
  v_mfma_f32_16x16x32_bf16 v[184:187], a[44:47], a[184:187], v[184:187]
  v_mfma_f32_16x16x32_bf16 v[180:183], a[44:47], a[180:183], v[180:183]
  ds_read_b64_tr_b16 a[110:111], v224 offset:53952
  v_mfma_f32_16x16x32_bf16 v[176:179], a[44:47], a[176:179], v[176:179]
  buffer_load_dwordx4 a[124:127], v236, s[36:39], s62 offen offset:0 sc1
  v_mfma_f32_16x16x32_bf16 v[192:195], a[48:51], a[176:179], v[192:195]
  v_mfma_f32_16x16x32_bf16 v[196:199], a[48:51], a[180:183], v[196:199]
  v_mfma_f32_16x16x32_bf16 v[200:203], a[48:51], a[184:187], v[200:203]
  v_mfma_f32_16x16x32_bf16 v[204:207], a[48:51], a[188:191], v[204:207]
  v_mfma_f32_16x16x32_bf16 v[220:223], a[52:55], a[188:191], v[220:223]
  v_mfma_f32_16x16x32_bf16 v[216:219], a[52:55], a[184:187], v[216:219]
  v_mfma_f32_16x16x32_bf16 v[212:215], a[52:55], a[180:183], v[212:215]
  buffer_load_dwordx4 v232, s[64:67], s70 offen offset:2048 lds
  v_mfma_f32_16x16x32_bf16 v[208:211], a[52:55], a[176:179], v[208:211]
  s_waitcnt vmcnt(25) lgkmcnt(0)
  v_mfma_f32_16x16x32_bf16 v[0:3], a[56:59], a[192:195], v[0:3]
  s_waitcnt vmcnt(28)
  s_barrier
  v_mfma_f32_16x16x32_bf16 v[4:7], a[56:59], a[196:199], v[4:7]
  ds_read_b64_tr_b16 a[0:1], v224 offset:0
  v_mfma_f32_16x16x32_bf16 v[8:11], a[56:59], a[200:203], v[8:11]
  ds_read_b64_tr_b16 a[2:3], v224 offset:3584
  v_mfma_f32_16x16x32_bf16 v[12:15], a[56:59], a[204:207], v[12:15]
  buffer_load_dwordx4 a[128:131], v233, s[36:39], s62 offen offset:1024 sc1
  v_mfma_f32_16x16x32_bf16 v[28:31], a[60:63], a[204:207], v[28:31]
  ds_read_b64_tr_b16 a[4:5], v224 offset:14336
  v_mfma_f32_16x16x32_bf16 v[24:27], a[60:63], a[200:203], v[24:27]
  v_mfma_f32_16x16x32_bf16 v[20:23], a[60:63], a[196:199], v[20:23]
  ds_read_b64_tr_b16 a[6:7], v224 offset:17920
  v_mfma_f32_16x16x32_bf16 v[16:19], a[60:63], a[192:195], v[16:19]
  s_add_u32 s69, s20, 2
  v_mfma_f32_16x16x32_bf16 v[32:35], a[64:67], a[192:195], v[32:35]
  ds_read_b64_tr_b16 a[8:9], v224 offset:32
  v_mfma_f32_16x16x32_bf16 v[36:39], a[64:67], a[196:199], v[36:39]
  ds_read_b64_tr_b16 a[10:11], v224 offset:3616
  v_mfma_f32_16x16x32_bf16 v[40:43], a[64:67], a[200:203], v[40:43]
  s_and_b32 s69, s69, 7
  v_mfma_f32_16x16x32_bf16 v[44:47], a[64:67], a[204:207], v[44:47]
  ds_read_b64_tr_b16 a[12:13], v224 offset:14368
  v_mfma_f32_16x16x32_bf16 v[60:63], a[68:71], a[204:207], v[60:63]
  ds_read_b64_tr_b16 a[14:15], v224 offset:17952
  v_mfma_f32_16x16x32_bf16 v[56:59], a[68:71], a[200:203], v[56:59]
  s_add_u32 s69, s69, 8
  v_mfma_f32_16x16x32_bf16 v[52:55], a[68:71], a[196:199], v[52:55]
  ds_read_b64_tr_b16 a[16:17], v224 offset:64
  v_mfma_f32_16x16x32_bf16 v[48:51], a[68:71], a[192:195], v[48:51]
  v_mfma_f32_16x16x32_bf16 v[64:67], a[72:75], a[192:195], v[64:67]
  ds_read_b64_tr_b16 a[18:19], v224 offset:3648
  v_mfma_f32_16x16x32_bf16 v[68:71], a[72:75], a[196:199], v[68:71]
  s_mul_i32 s69, s69, 458752
  v_mfma_f32_16x16x32_bf16 v[72:75], a[72:75], a[200:203], v[72:75]
  ds_read_b64_tr_b16 a[20:21], v224 offset:14400
  v_mfma_f32_16x16x32_bf16 v[76:79], a[72:75], a[204:207], v[76:79]
  ds_read_b64_tr_b16 a[22:23], v224 offset:17984
  v_mfma_f32_16x16x32_bf16 v[92:95], a[76:79], a[204:207], v[92:95]
  s_add_u32 m0, s68, 28672
  v_mfma_f32_16x16x32_bf16 v[88:91], a[76:79], a[200:203], v[88:91]
  ds_read_b64_tr_b16 a[24:25], v224 offset:96
  v_mfma_f32_16x16x32_bf16 v[84:87], a[76:79], a[196:199], v[84:87]
  ds_read_b64_tr_b16 a[26:27], v224 offset:3680
  v_mfma_f32_16x16x32_bf16 v[80:83], a[76:79], a[192:195], v[80:83]
  buffer_load_dwordx4 v226, s[64:67], s69 offen lds
  v_mfma_f32_16x16x32_bf16 v[96:99], a[80:83], a[192:195], v[96:99]
  ds_read_b64_tr_b16 a[28:29], v224 offset:14432
  v_mfma_f32_16x16x32_bf16 v[100:103], a[80:83], a[196:199], v[100:103]
  v_mfma_f32_16x16x32_bf16 v[104:107], a[80:83], a[200:203], v[104:107]
  ds_read_b64_tr_b16 a[30:31], v224 offset:18016
  v_mfma_f32_16x16x32_bf16 v[108:111], a[80:83], a[204:207], v[108:111]
  buffer_load_dwordx4 a[132:135], v234, s[36:39], s62 offen offset:1024 sc1
  v_mfma_f32_16x16x32_bf16 v[124:127], a[84:87], a[204:207], v[124:127]
  ds_read_b64_tr_b16 a[32:33], v224 offset:128
  v_mfma_f32_16x16x32_bf16 v[120:123], a[84:87], a[200:203], v[120:123]
  ds_read_b64_tr_b16 a[34:35], v224 offset:3712
  v_mfma_f32_16x16x32_bf16 v[116:119], a[84:87], a[196:199], v[116:119]
  v_mfma_f32_16x16x32_bf16 v[112:115], a[84:87], a[192:195], v[112:115]
  ds_read_b64_tr_b16 a[36:37], v224 offset:14464
  v_mfma_f32_16x16x32_bf16 v[128:131], a[88:91], a[192:195], v[128:131]
  ds_read_b64_tr_b16 a[38:39], v224 offset:18048
  v_mfma_f32_16x16x32_bf16 v[132:135], a[88:91], a[196:199], v[132:135]
  buffer_load_dwordx4 v227, s[64:67], s69 offen offset:1024 lds
  v_mfma_f32_16x16x32_bf16 v[136:139], a[88:91], a[200:203], v[136:139]
  ds_read_b64_tr_b16 a[40:41], v224 offset:160
  v_mfma_f32_16x16x32_bf16 v[140:143], a[88:91], a[204:207], v[140:143]
  v_mfma_f32_16x16x32_bf16 v[156:159], a[92:95], a[204:207], v[156:159]
  ds_read_b64_tr_b16 a[42:43], v224 offset:3744
  v_mfma_f32_16x16x32_bf16 v[152:155], a[92:95], a[200:203], v[152:155]
  buffer_load_dwordx4 a[136:139], v235, s[36:39], s62 offen offset:1024 sc1
  v_mfma_f32_16x16x32_bf16 v[148:151], a[92:95], a[196:199], v[148:151]
  ds_read_b64_tr_b16 a[44:45], v224 offset:14496
  v_mfma_f32_16x16x32_bf16 v[144:147], a[92:95], a[192:195], v[144:147]
  ds_read_b64_tr_b16 a[46:47], v224 offset:18080
  v_mfma_f32_16x16x32_bf16 v[160:163], a[96:99], a[192:195], v[160:163]
  v_mfma_f32_16x16x32_bf16 v[164:167], a[96:99], a[196:199], v[164:167]
  ds_read_b64_tr_b16 a[48:49], v224 offset:192
  v_mfma_f32_16x16x32_bf16 v[168:171], a[96:99], a[200:203], v[168:171]
  ds_read_b64_tr_b16 a[50:51], v224 offset:3776
  v_mfma_f32_16x16x32_bf16 v[172:175], a[96:99], a[204:207], v[172:175]
  buffer_load_dwordx4 v228, s[64:67], s69 offen offset:2048 lds
  v_mfma_f32_16x16x32_bf16 v[188:191], a[100:103], a[204:207], v[188:191]
  ds_read_b64_tr_b16 a[52:53], v224 offset:14528
  v_mfma_f32_16x16x32_bf16 v[184:187], a[100:103], a[200:203], v[184:187]
  v_mfma_f32_16x16x32_bf16 v[180:183], a[100:103], a[196:199], v[180:183]
  ds_read_b64_tr_b16 a[54:55], v224 offset:18112
  v_mfma_f32_16x16x32_bf16 v[176:179], a[100:103], a[192:195], v[176:179]
  buffer_load_dwordx4 a[140:143], v236, s[36:39], s62 offen offset:1024 sc1
  v_mfma_f32_16x16x32_bf16 v[192:195], a[104:107], a[192:195], v[192:195]
  v_mfma_f32_16x16x32_bf16 v[196:199], a[104:107], a[196:199], v[196:199]
  v_mfma_f32_16x16x32_bf16 v[200:203], a[104:107], a[200:203], v[200:203]
  v_mfma_f32_16x16x32_bf16 v[204:207], a[104:107], a[204:207], v[204:207]
  v_mfma_f32_16x16x32_bf16 v[220:223], a[108:111], a[204:207], v[220:223]
  v_mfma_f32_16x16x32_bf16 v[216:219], a[108:111], a[200:203], v[216:219]
  v_mfma_f32_16x16x32_bf16 v[212:215], a[108:111], a[196:199], v[212:215]
  buffer_load_dwordx4 v229, s[64:67], s69 offen offset:3072 lds
  v_mfma_f32_16x16x32_bf16 v[208:211], a[108:111], a[192:195], v[208:211]
  s_waitcnt vmcnt(25) lgkmcnt(0)
  v_mfma_f32_16x16x32_bf16 v[0:3], a[0:3], a[208:211], v[0:3]
  ds_read_b64_tr_b16 a[56:57], v224 offset:7168
  v_mfma_f32_16x16x32_bf16 v[4:7], a[0:3], a[212:215], v[4:7]
  ds_read_b64_tr_b16 a[58:59], v224 offset:10752
  v_mfma_f32_16x16x32_bf16 v[8:11], a[0:3], a[216:219], v[8:11]
  s_add_u32 s63, s20, 1
  v_mfma_f32_16x16x32_bf16 v[12:15], a[0:3], a[220:223], v[12:15]
  ds_read_b64_tr_b16 a[60:61], v224 offset:21504
  v_mfma_f32_16x16x32_bf16 v[28:31], a[4:7], a[220:223], v[28:31]
  v_mfma_f32_16x16x32_bf16 v[24:27], a[4:7], a[216:219], v[24:27]
  ds_read_b64_tr_b16 a[62:63], v224 offset:25088
  v_mfma_f32_16x16x32_bf16 v[20:23], a[4:7], a[212:215], v[20:23]
  s_and_b32 s63, s63, 7
  v_mfma_f32_16x16x32_bf16 v[16:19], a[4:7], a[208:211], v[16:19]
  ds_read_b64_tr_b16 a[64:65], v224 offset:7200
  v_mfma_f32_16x16x32_bf16 v[32:35], a[8:11], a[208:211], v[32:35]
  ds_read_b64_tr_b16 a[66:67], v224 offset:10784
  v_mfma_f32_16x16x32_bf16 v[36:39], a[8:11], a[212:215], v[36:39]
  v_mfma_f32_16x16x32_bf16 v[40:43], a[8:11], a[216:219], v[40:43]
  s_add_u32 s63, s63, 8
  v_mfma_f32_16x16x32_bf16 v[44:47], a[8:11], a[220:223], v[44:47]
  ds_read_b64_tr_b16 a[68:69], v224 offset:21536
  v_mfma_f32_16x16x32_bf16 v[60:63], a[12:15], a[220:223], v[60:63]
  ds_read_b64_tr_b16 a[70:71], v224 offset:25120
  v_mfma_f32_16x16x32_bf16 v[56:59], a[12:15], a[216:219], v[56:59]
  ds_read_b64_tr_b16 a[72:73], v224 offset:7232
  v_mfma_f32_16x16x32_bf16 v[52:55], a[12:15], a[212:215], v[52:55]
  s_mul_i32 s63, s63, 2048
  v_mfma_f32_16x16x32_bf16 v[48:51], a[12:15], a[208:211], v[48:51]
  ds_read_b64_tr_b16 a[74:75], v224 offset:10816
  v_mfma_f32_16x16x32_bf16 v[64:67], a[16:19], a[208:211], v[64:67]
  v_mfma_f32_16x16x32_bf16 v[68:71], a[16:19], a[212:215], v[68:71]
  ds_read_b64_tr_b16 a[76:77], v224 offset:21568
  v_mfma_f32_16x16x32_bf16 v[72:75], a[16:19], a[216:219], v[72:75]
  buffer_load_dwordx4 a[144:147], v233, s[36:39], s63 offen offset:0 sc1
  v_mfma_f32_16x16x32_bf16 v[76:79], a[16:19], a[220:223], v[76:79]
  ds_read_b64_tr_b16 a[78:79], v224 offset:25152
  v_mfma_f32_16x16x32_bf16 v[92:95], a[20:23], a[220:223], v[92:95]
  ds_read_b64_tr_b16 a[80:81], v224 offset:7264
  v_mfma_f32_16x16x32_bf16 v[88:91], a[20:23], a[216:219], v[88:91]
  v_mfma_f32_16x16x32_bf16 v[84:87], a[20:23], a[212:215], v[84:87]
  s_add_u32 m0, s68, 32768
  v_mfma_f32_16x16x32_bf16 v[80:83], a[20:23], a[208:211], v[80:83]
  ds_read_b64_tr_b16 a[82:83], v224 offset:10848
  v_mfma_f32_16x16x32_bf16 v[96:99], a[24:27], a[208:211], v[96:99]
  ds_read_b64_tr_b16 a[84:85], v224 offset:21600
  v_mfma_f32_16x16x32_bf16 v[100:103], a[24:27], a[212:215], v[100:103]
  ds_read_b64_tr_b16 a[86:87], v224 offset:25184
  v_mfma_f32_16x16x32_bf16 v[104:107], a[24:27], a[216:219], v[104:107]
  buffer_load_dwordx4 v230, s[64:67], s69 offen lds
  v_mfma_f32_16x16x32_bf16 v[108:111], a[24:27], a[220:223], v[108:111]
  ds_read_b64_tr_b16 a[88:89], v224 offset:7296
  v_mfma_f32_16x16x32_bf16 v[124:127], a[28:31], a[220:223], v[124:127]
  v_mfma_f32_16x16x32_bf16 v[120:123], a[28:31], a[216:219], v[120:123]
  ds_read_b64_tr_b16 a[90:91], v224 offset:10880
  v_mfma_f32_16x16x32_bf16 v[116:119], a[28:31], a[212:215], v[116:119]
  buffer_load_dwordx4 a[148:151], v234, s[36:39], s63 offen offset:0 sc1
  v_mfma_f32_16x16x32_bf16 v[112:115], a[28:31], a[208:211], v[112:115]
  ds_read_b64_tr_b16 a[92:93], v224 offset:21632
  v_mfma_f32_16x16x32_bf16 v[128:131], a[32:35], a[208:211], v[128:131]
  ds_read_b64_tr_b16 a[94:95], v224 offset:25216
  v_mfma_f32_16x16x32_bf16 v[132:135], a[32:35], a[212:215], v[132:135]
  v_mfma_f32_16x16x32_bf16 v[136:139], a[32:35], a[216:219], v[136:139]
  v_mfma_f32_16x16x32_bf16 v[140:143], a[32:35], a[220:223], v[140:143]
  ds_read_b64_tr_b16 a[96:97], v224 offset:7328
  v_mfma_f32_16x16x32_bf16 v[156:159], a[36:39], a[220:223], v[156:159]
  ds_read_b64_tr_b16 a[98:99], v224 offset:10912
  v_mfma_f32_16x16x32_bf16 v[152:155], a[36:39], a[216:219], v[152:155]
  ds_read_b64_tr_b16 a[100:101], v224 offset:21664
  v_mfma_f32_16x16x32_bf16 v[148:151], a[36:39], a[212:215], v[148:151]
  buffer_load_dwordx4 v231, s[64:67], s69 offen offset:1024 lds
  v_mfma_f32_16x16x32_bf16 v[144:147], a[36:39], a[208:211], v[144:147]
  ds_read_b64_tr_b16 a[102:103], v224 offset:25248
  v_mfma_f32_16x16x32_bf16 v[160:163], a[40:43], a[208:211], v[160:163]
  v_mfma_f32_16x16x32_bf16 v[164:167], a[40:43], a[212:215], v[164:167]
  ds_read_b64_tr_b16 a[104:105], v224 offset:7360
  v_mfma_f32_16x16x32_bf16 v[168:171], a[40:43], a[216:219], v[168:171]
  buffer_load_dwordx4 a[152:155], v235, s[36:39], s63 offen offset:0 sc1
  v_mfma_f32_16x16x32_bf16 v[172:175], a[40:43], a[220:223], v[172:175]
  ds_read_b64_tr_b16 a[106:107], v224 offset:10944
  v_mfma_f32_16x16x32_bf16 v[188:191], a[44:47], a[220:223], v[188:191]
  ds_read_b64_tr_b16 a[108:109], v224 offset:21696
  v_mfma_f32_16x16x32_bf16 v[184:187], a[44:47], a[216:219], v[184:187]
  v_mfma_f32_16x16x32_bf16 v[180:183], a[44:47], a[212:215], v[180:183]
  v_mfma_f32_16x16x32_bf16 v[176:179], a[44:47], a[208:211], v[176:179]
  ds_read_b64_tr_b16 a[110:111], v224 offset:25280
  v_mfma_f32_16x16x32_bf16 v[192:195], a[48:51], a[208:211], v[192:195]
  v_mfma_f32_16x16x32_bf16 v[196:199], a[48:51], a[212:215], v[196:199]
  v_mfma_f32_16x16x32_bf16 v[200:203], a[48:51], a[216:219], v[200:203]
  buffer_load_dwordx4 v232, s[64:67], s69 offen offset:2048 lds
  v_mfma_f32_16x16x32_bf16 v[204:207], a[48:51], a[220:223], v[204:207]
  v_mfma_f32_16x16x32_bf16 v[220:223], a[52:55], a[220:223], v[220:223]
  v_mfma_f32_16x16x32_bf16 v[216:219], a[52:55], a[216:219], v[216:219]
  v_mfma_f32_16x16x32_bf16 v[212:215], a[52:55], a[212:215], v[212:215]
  buffer_load_dwordx4 a[156:159], v236, s[36:39], s63 offen offset:0 sc1
  v_mfma_f32_16x16x32_bf16 v[208:211], a[52:55], a[208:211], v[208:211]
  s_waitcnt vmcnt(24) lgkmcnt(0)
  v_mfma_f32_16x16x32_bf16 v[0:3], a[56:59], a[224:227], v[0:3]
  s_waitcnt vmcnt(29)
  s_barrier
  v_mfma_f32_16x16x32_bf16 v[4:7], a[56:59], a[228:231], v[4:7]
  ds_read_b64_tr_b16 a[0:1], v225 offset:28672
  v_mfma_f32_16x16x32_bf16 v[8:11], a[56:59], a[232:235], v[8:11]
  ds_read_b64_tr_b16 a[2:3], v225 offset:32256
  v_mfma_f32_16x16x32_bf16 v[12:15], a[56:59], a[236:239], v[12:15]
  buffer_load_dwordx4 a[160:163], v233, s[36:39], s63 offen offset:1024 sc1
  v_mfma_f32_16x16x32_bf16 v[28:31], a[60:63], a[236:239], v[28:31]
  ds_read_b64_tr_b16 a[4:5], v225 offset:43008
  v_mfma_f32_16x16x32_bf16 v[24:27], a[60:63], a[232:235], v[24:27]
  v_mfma_f32_16x16x32_bf16 v[20:23], a[60:63], a[228:231], v[20:23]
  ds_read_b64_tr_b16 a[6:7], v225 offset:46592
  v_mfma_f32_16x16x32_bf16 v[16:19], a[60:63], a[224:227], v[16:19]
  s_add_u32 s70, s20, 3
  v_mfma_f32_16x16x32_bf16 v[32:35], a[64:67], a[224:227], v[32:35]
  ds_read_b64_tr_b16 a[8:9], v225 offset:28704
  v_mfma_f32_16x16x32_bf16 v[36:39], a[64:67], a[228:231], v[36:39]
  ds_read_b64_tr_b16 a[10:11], v225 offset:32288
  v_mfma_f32_16x16x32_bf16 v[40:43], a[64:67], a[232:235], v[40:43]
  s_and_b32 s70, s70, 7
  v_mfma_f32_16x16x32_bf16 v[44:47], a[64:67], a[236:239], v[44:47]
  ds_read_b64_tr_b16 a[12:13], v225 offset:43040
  v_mfma_f32_16x16x32_bf16 v[60:63], a[68:71], a[236:239], v[60:63]
  ds_read_b64_tr_b16 a[14:15], v225 offset:46624
  v_mfma_f32_16x16x32_bf16 v[56:59], a[68:71], a[232:235], v[56:59]
  s_add_u32 s70, s70, 8
  v_mfma_f32_16x16x32_bf16 v[52:55], a[68:71], a[228:231], v[52:55]
  ds_read_b64_tr_b16 a[16:17], v225 offset:28736
  v_mfma_f32_16x16x32_bf16 v[48:51], a[68:71], a[224:227], v[48:51]
  v_mfma_f32_16x16x32_bf16 v[64:67], a[72:75], a[224:227], v[64:67]
  ds_read_b64_tr_b16 a[18:19], v225 offset:32320
  v_mfma_f32_16x16x32_bf16 v[68:71], a[72:75], a[228:231], v[68:71]
  s_mul_i32 s70, s70, 458752
  v_mfma_f32_16x16x32_bf16 v[72:75], a[72:75], a[232:235], v[72:75]
  ds_read_b64_tr_b16 a[20:21], v225 offset:43072
  v_mfma_f32_16x16x32_bf16 v[76:79], a[72:75], a[236:239], v[76:79]
  ds_read_b64_tr_b16 a[22:23], v225 offset:46656
  v_mfma_f32_16x16x32_bf16 v[92:95], a[76:79], a[236:239], v[92:95]
  s_add_u32 m0, s68, 0
  v_mfma_f32_16x16x32_bf16 v[88:91], a[76:79], a[232:235], v[88:91]
  ds_read_b64_tr_b16 a[24:25], v225 offset:28768
  v_mfma_f32_16x16x32_bf16 v[84:87], a[76:79], a[228:231], v[84:87]
  ds_read_b64_tr_b16 a[26:27], v225 offset:32352
  v_mfma_f32_16x16x32_bf16 v[80:83], a[76:79], a[224:227], v[80:83]
  buffer_load_dwordx4 v226, s[64:67], s70 offen lds
  v_mfma_f32_16x16x32_bf16 v[96:99], a[80:83], a[224:227], v[96:99]
  ds_read_b64_tr_b16 a[28:29], v225 offset:43104
  v_mfma_f32_16x16x32_bf16 v[100:103], a[80:83], a[228:231], v[100:103]
  v_mfma_f32_16x16x32_bf16 v[104:107], a[80:83], a[232:235], v[104:107]
  ds_read_b64_tr_b16 a[30:31], v225 offset:46688
  v_mfma_f32_16x16x32_bf16 v[108:111], a[80:83], a[236:239], v[108:111]
  buffer_load_dwordx4 a[164:167], v234, s[36:39], s63 offen offset:1024 sc1
  v_mfma_f32_16x16x32_bf16 v[124:127], a[84:87], a[236:239], v[124:127]
  ds_read_b64_tr_b16 a[32:33], v225 offset:28800
  v_mfma_f32_16x16x32_bf16 v[120:123], a[84:87], a[232:235], v[120:123]
  ds_read_b64_tr_b16 a[34:35], v225 offset:32384
  v_mfma_f32_16x16x32_bf16 v[116:119], a[84:87], a[228:231], v[116:119]
  v_mfma_f32_16x16x32_bf16 v[112:115], a[84:87], a[224:227], v[112:115]
  ds_read_b64_tr_b16 a[36:37], v225 offset:43136
  v_mfma_f32_16x16x32_bf16 v[128:131], a[88:91], a[224:227], v[128:131]
  ds_read_b64_tr_b16 a[38:39], v225 offset:46720
  v_mfma_f32_16x16x32_bf16 v[132:135], a[88:91], a[228:231], v[132:135]
  buffer_load_dwordx4 v227, s[64:67], s70 offen offset:1024 lds
  v_mfma_f32_16x16x32_bf16 v[136:139], a[88:91], a[232:235], v[136:139]
  ds_read_b64_tr_b16 a[40:41], v225 offset:28832
  v_mfma_f32_16x16x32_bf16 v[140:143], a[88:91], a[236:239], v[140:143]
  v_mfma_f32_16x16x32_bf16 v[156:159], a[92:95], a[236:239], v[156:159]
  ds_read_b64_tr_b16 a[42:43], v225 offset:32416
  v_mfma_f32_16x16x32_bf16 v[152:155], a[92:95], a[232:235], v[152:155]
  buffer_load_dwordx4 a[168:171], v235, s[36:39], s63 offen offset:1024 sc1
  v_mfma_f32_16x16x32_bf16 v[148:151], a[92:95], a[228:231], v[148:151]
  ds_read_b64_tr_b16 a[44:45], v225 offset:43168
  v_mfma_f32_16x16x32_bf16 v[144:147], a[92:95], a[224:227], v[144:147]
  ds_read_b64_tr_b16 a[46:47], v225 offset:46752
  v_mfma_f32_16x16x32_bf16 v[160:163], a[96:99], a[224:227], v[160:163]
  v_mfma_f32_16x16x32_bf16 v[164:167], a[96:99], a[228:231], v[164:167]
  ds_read_b64_tr_b16 a[48:49], v225 offset:28864
  v_mfma_f32_16x16x32_bf16 v[168:171], a[96:99], a[232:235], v[168:171]
  ds_read_b64_tr_b16 a[50:51], v225 offset:32448
  v_mfma_f32_16x16x32_bf16 v[172:175], a[96:99], a[236:239], v[172:175]
  buffer_load_dwordx4 v228, s[64:67], s70 offen offset:2048 lds
  v_mfma_f32_16x16x32_bf16 v[188:191], a[100:103], a[236:239], v[188:191]
  ds_read_b64_tr_b16 a[52:53], v225 offset:43200
  v_mfma_f32_16x16x32_bf16 v[184:187], a[100:103], a[232:235], v[184:187]
  v_mfma_f32_16x16x32_bf16 v[180:183], a[100:103], a[228:231], v[180:183]
  ds_read_b64_tr_b16 a[54:55], v225 offset:46784
  v_mfma_f32_16x16x32_bf16 v[176:179], a[100:103], a[224:227], v[176:179]
  buffer_load_dwordx4 a[172:175], v236, s[36:39], s63 offen offset:1024 sc1
  v_mfma_f32_16x16x32_bf16 v[192:195], a[104:107], a[224:227], v[192:195]
  v_mfma_f32_16x16x32_bf16 v[196:199], a[104:107], a[228:231], v[196:199]
  v_mfma_f32_16x16x32_bf16 v[200:203], a[104:107], a[232:235], v[200:203]
  v_mfma_f32_16x16x32_bf16 v[204:207], a[104:107], a[236:239], v[204:207]
  v_mfma_f32_16x16x32_bf16 v[220:223], a[108:111], a[236:239], v[220:223]
  v_mfma_f32_16x16x32_bf16 v[216:219], a[108:111], a[232:235], v[216:219]
  v_mfma_f32_16x16x32_bf16 v[212:215], a[108:111], a[228:231], v[212:215]
  buffer_load_dwordx4 v229, s[64:67], s70 offen offset:3072 lds
  v_mfma_f32_16x16x32_bf16 v[208:211], a[108:111], a[224:227], v[208:211]
  s_waitcnt vmcnt(24) lgkmcnt(0)
  v_mfma_f32_16x16x32_bf16 v[0:3], a[0:3], a[112:115], v[0:3]
  ds_read_b64_tr_b16 a[56:57], v225 offset:35840
  v_mfma_f32_16x16x32_bf16 v[4:7], a[0:3], a[116:119], v[4:7]
  ds_read_b64_tr_b16 a[58:59], v225 offset:39424
  v_mfma_f32_16x16x32_bf16 v[8:11], a[0:3], a[120:123], v[8:11]
  s_add_u32 s62, s20, 2
  v_mfma_f32_16x16x32_bf16 v[12:15], a[0:3], a[124:127], v[12:15]
  ds_read_b64_tr_b16 a[60:61], v225 offset:50176
  v_mfma_f32_16x16x32_bf16 v[28:31], a[4:7], a[124:127], v[28:31]
  v_mfma_f32_16x16x32_bf16 v[24:27], a[4:7], a[120:123], v[24:27]
  ds_read_b64_tr_b16 a[62:63], v225 offset:53760
  v_mfma_f32_16x16x32_bf16 v[20:23], a[4:7], a[116:119], v[20:23]
  s_and_b32 s62, s62, 7
  v_mfma_f32_16x16x32_bf16 v[16:19], a[4:7], a[112:115], v[16:19]
  ds_read_b64_tr_b16 a[64:65], v225 offset:35872
  v_mfma_f32_16x16x32_bf16 v[32:35], a[8:11], a[112:115], v[32:35]
  ds_read_b64_tr_b16 a[66:67], v225 offset:39456
  v_mfma_f32_16x16x32_bf16 v[36:39], a[8:11], a[116:119], v[36:39]
  v_mfma_f32_16x16x32_bf16 v[40:43], a[8:11], a[120:123], v[40:43]
  s_add_u32 s62, s62, 8
  v_mfma_f32_16x16x32_bf16 v[44:47], a[8:11], a[124:127], v[44:47]
  ds_read_b64_tr_b16 a[68:69], v225 offset:50208
  v_mfma_f32_16x16x32_bf16 v[60:63], a[12:15], a[124:127], v[60:63]
  ds_read_b64_tr_b16 a[70:71], v225 offset:53792
  v_mfma_f32_16x16x32_bf16 v[56:59], a[12:15], a[120:123], v[56:59]
  ds_read_b64_tr_b16 a[72:73], v225 offset:35904
  v_mfma_f32_16x16x32_bf16 v[52:55], a[12:15], a[116:119], v[52:55]
  s_mul_i32 s62, s62, 2048
  v_mfma_f32_16x16x32_bf16 v[48:51], a[12:15], a[112:115], v[48:51]
  ds_read_b64_tr_b16 a[74:75], v225 offset:39488
  v_mfma_f32_16x16x32_bf16 v[64:67], a[16:19], a[112:115], v[64:67]
  v_mfma_f32_16x16x32_bf16 v[68:71], a[16:19], a[116:119], v[68:71]
  ds_read_b64_tr_b16 a[76:77], v225 offset:50240
  v_mfma_f32_16x16x32_bf16 v[72:75], a[16:19], a[120:123], v[72:75]
  buffer_load_dwordx4 a[176:179], v233, s[36:39], s62 offen offset:0 sc1
  v_mfma_f32_16x16x32_bf16 v[76:79], a[16:19], a[124:127], v[76:79]
  ds_read_b64_tr_b16 a[78:79], v225 offset:53824
  v_mfma_f32_16x16x32_bf16 v[92:95], a[20:23], a[124:127], v[92:95]
  ds_read_b64_tr_b16 a[80:81], v225 offset:35936
  v_mfma_f32_16x16x32_bf16 v[88:91], a[20:23], a[120:123], v[88:91]
  v_mfma_f32_16x16x32_bf16 v[84:87], a[20:23], a[116:119], v[84:87]
  s_add_u32 m0, s68, 4096
  v_mfma_f32_16x16x32_bf16 v[80:83], a[20:23], a[112:115], v[80:83]
  ds_read_b64_tr_b16 a[82:83], v225 offset:39520
  v_mfma_f32_16x16x32_bf16 v[96:99], a[24:27], a[112:115], v[96:99]
  ds_read_b64_tr_b16 a[84:85], v225 offset:50272
  v_mfma_f32_16x16x32_bf16 v[100:103], a[24:27], a[116:119], v[100:103]
  ds_read_b64_tr_b16 a[86:87], v225 offset:53856
  v_mfma_f32_16x16x32_bf16 v[104:107], a[24:27], a[120:123], v[104:107]
  buffer_load_dwordx4 v230, s[64:67], s70 offen lds
  v_mfma_f32_16x16x32_bf16 v[108:111], a[24:27], a[124:127], v[108:111]
  ds_read_b64_tr_b16 a[88:89], v225 offset:35968
  v_mfma_f32_16x16x32_bf16 v[124:127], a[28:31], a[124:127], v[124:127]
  v_mfma_f32_16x16x32_bf16 v[120:123], a[28:31], a[120:123], v[120:123]
  ds_read_b64_tr_b16 a[90:91], v225 offset:39552
  v_mfma_f32_16x16x32_bf16 v[116:119], a[28:31], a[116:119], v[116:119]
  buffer_load_dwordx4 a[180:183], v234, s[36:39], s62 offen offset:0 sc1
  v_mfma_f32_16x16x32_bf16 v[112:115], a[28:31], a[112:115], v[112:115]
  ds_read_b64_tr_b16 a[92:93], v225 offset:50304
  v_mfma_f32_16x16x32_bf16 v[128:131], a[32:35], a[112:115], v[128:131]
  ds_read_b64_tr_b16 a[94:95], v225 offset:53888
  v_mfma_f32_16x16x32_bf16 v[132:135], a[32:35], a[116:119], v[132:135]
  v_mfma_f32_16x16x32_bf16 v[136:139], a[32:35], a[120:123], v[136:139]
  v_mfma_f32_16x16x32_bf16 v[140:143], a[32:35], a[124:127], v[140:143]
  ds_read_b64_tr_b16 a[96:97], v225 offset:36000
  v_mfma_f32_16x16x32_bf16 v[156:159], a[36:39], a[124:127], v[156:159]
  ds_read_b64_tr_b16 a[98:99], v225 offset:39584
  v_mfma_f32_16x16x32_bf16 v[152:155], a[36:39], a[120:123], v[152:155]
  ds_read_b64_tr_b16 a[100:101], v225 offset:50336
  v_mfma_f32_16x16x32_bf16 v[148:151], a[36:39], a[116:119], v[148:151]
  buffer_load_dwordx4 v231, s[64:67], s70 offen offset:1024 lds
  v_mfma_f32_16x16x32_bf16 v[144:147], a[36:39], a[112:115], v[144:147]
  ds_read_b64_tr_b16 a[102:103], v225 offset:53920
  v_mfma_f32_16x16x32_bf16 v[160:163], a[40:43], a[112:115], v[160:163]
  v_mfma_f32_16x16x32_bf16 v[164:167], a[40:43], a[116:119], v[164:167]
  ds_read_b64_tr_b16 a[104:105], v225 offset:36032
  v_mfma_f32_16x16x32_bf16 v[168:171], a[40:43], a[120:123], v[168:171]
  buffer_load_dwordx4 a[184:187], v235, s[36:39], s62 offen offset:0 sc1
  v_mfma_f32_16x16x32_bf16 v[172:175], a[40:43], a[124:127], v[172:175]
  ds_read_b64_tr_b16 a[106:107], v225 offset:39616
  v_mfma_f32_16x16x32_bf16 v[188:191], a[44:47], a[124:127], v[188:191]
  ds_read_b64_tr_b16 a[108:109], v225 offset:50368
  v_mfma_f32_16x16x32_bf16 v[184:187], a[44:47], a[120:123], v[184:187]
  v_mfma_f32_16x16x32_bf16 v[180:183], a[44:47], a[116:119], v[180:183]
  v_mfma_f32_16x16x32_bf16 v[176:179], a[44:47], a[112:115], v[176:179]
  ds_read_b64_tr_b16 a[110:111], v225 offset:53952
  v_mfma_f32_16x16x32_bf16 v[192:195], a[48:51], a[112:115], v[192:195]
  v_mfma_f32_16x16x32_bf16 v[196:199], a[48:51], a[116:119], v[196:199]
  v_mfma_f32_16x16x32_bf16 v[200:203], a[48:51], a[120:123], v[200:203]
  buffer_load_dwordx4 v232, s[64:67], s70 offen offset:2048 lds
  v_mfma_f32_16x16x32_bf16 v[204:207], a[48:51], a[124:127], v[204:207]
  v_mfma_f32_16x16x32_bf16 v[220:223], a[52:55], a[124:127], v[220:223]
  v_mfma_f32_16x16x32_bf16 v[216:219], a[52:55], a[120:123], v[216:219]
  v_mfma_f32_16x16x32_bf16 v[212:215], a[52:55], a[116:119], v[212:215]
  buffer_load_dwordx4 a[188:191], v236, s[36:39], s62 offen offset:0 sc1
  v_mfma_f32_16x16x32_bf16 v[208:211], a[52:55], a[112:115], v[208:211]
  s_waitcnt vmcnt(23) lgkmcnt(0)
  v_mfma_f32_16x16x32_bf16 v[0:3], a[56:59], a[128:131], v[0:3]
  s_waitcnt vmcnt(30)
  s_barrier
  v_mfma_f32_16x16x32_bf16 v[4:7], a[56:59], a[132:135], v[4:7]
  ds_read_b64_tr_b16 a[0:1], v225 offset:0
  v_mfma_f32_16x16x32_bf16 v[8:11], a[56:59], a[136:139], v[8:11]
  ds_read_b64_tr_b16 a[2:3], v225 offset:3584
  v_mfma_f32_16x16x32_bf16 v[12:15], a[56:59], a[140:143], v[12:15]
  buffer_load_dwordx4 a[192:195], v233, s[36:39], s62 offen offset:1024 sc1
  v_mfma_f32_16x16x32_bf16 v[28:31], a[60:63], a[140:143], v[28:31]
  ds_read_b64_tr_b16 a[4:5], v225 offset:14336
  v_mfma_f32_16x16x32_bf16 v[24:27], a[60:63], a[136:139], v[24:27]
  v_mfma_f32_16x16x32_bf16 v[20:23], a[60:63], a[132:135], v[20:23]
  ds_read_b64_tr_b16 a[6:7], v225 offset:17920
  v_mfma_f32_16x16x32_bf16 v[16:19], a[60:63], a[128:131], v[16:19]
  s_add_u32 s69, s20, 4
  v_mfma_f32_16x16x32_bf16 v[32:35], a[64:67], a[128:131], v[32:35]
  ds_read_b64_tr_b16 a[8:9], v225 offset:32
  v_mfma_f32_16x16x32_bf16 v[36:39], a[64:67], a[132:135], v[36:39]
  ds_read_b64_tr_b16 a[10:11], v225 offset:3616
  v_mfma_f32_16x16x32_bf16 v[40:43], a[64:67], a[136:139], v[40:43]
  s_and_b32 s69, s69, 7
  v_mfma_f32_16x16x32_bf16 v[44:47], a[64:67], a[140:143], v[44:47]
  ds_read_b64_tr_b16 a[12:13], v225 offset:14368
  v_mfma_f32_16x16x32_bf16 v[60:63], a[68:71], a[140:143], v[60:63]
  ds_read_b64_tr_b16 a[14:15], v225 offset:17952
  v_mfma_f32_16x16x32_bf16 v[56:59], a[68:71], a[136:139], v[56:59]
  s_add_u32 s69, s69, 8
  v_mfma_f32_16x16x32_bf16 v[52:55], a[68:71], a[132:135], v[52:55]
  ds_read_b64_tr_b16 a[16:17], v225 offset:64
  v_mfma_f32_16x16x32_bf16 v[48:51], a[68:71], a[128:131], v[48:51]
  v_mfma_f32_16x16x32_bf16 v[64:67], a[72:75], a[128:131], v[64:67]
  ds_read_b64_tr_b16 a[18:19], v225 offset:3648
  v_mfma_f32_16x16x32_bf16 v[68:71], a[72:75], a[132:135], v[68:71]
  s_mul_i32 s69, s69, 458752
  v_mfma_f32_16x16x32_bf16 v[72:75], a[72:75], a[136:139], v[72:75]
  ds_read_b64_tr_b16 a[20:21], v225 offset:14400
  v_mfma_f32_16x16x32_bf16 v[76:79], a[72:75], a[140:143], v[76:79]
  ds_read_b64_tr_b16 a[22:23], v225 offset:17984
  v_mfma_f32_16x16x32_bf16 v[92:95], a[76:79], a[140:143], v[92:95]
  s_add_u32 m0, s68, 86016
  v_mfma_f32_16x16x32_bf16 v[88:91], a[76:79], a[136:139], v[88:91]
  ds_read_b64_tr_b16 a[24:25], v225 offset:96
  v_mfma_f32_16x16x32_bf16 v[84:87], a[76:79], a[132:135], v[84:87]
  ds_read_b64_tr_b16 a[26:27], v225 offset:3680
  v_mfma_f32_16x16x32_bf16 v[80:83], a[76:79], a[128:131], v[80:83]
  buffer_load_dwordx4 v226, s[64:67], s69 offen lds
  v_mfma_f32_16x16x32_bf16 v[96:99], a[80:83], a[128:131], v[96:99]
  ds_read_b64_tr_b16 a[28:29], v225 offset:14432
  v_mfma_f32_16x16x32_bf16 v[100:103], a[80:83], a[132:135], v[100:103]
  v_mfma_f32_16x16x32_bf16 v[104:107], a[80:83], a[136:139], v[104:107]
  ds_read_b64_tr_b16 a[30:31], v225 offset:18016
  v_mfma_f32_16x16x32_bf16 v[108:111], a[80:83], a[140:143], v[108:111]
  buffer_load_dwordx4 a[196:199], v234, s[36:39], s62 offen offset:1024 sc1
  v_mfma_f32_16x16x32_bf16 v[124:127], a[84:87], a[140:143], v[124:127]
  ds_read_b64_tr_b16 a[32:33], v225 offset:128
  v_mfma_f32_16x16x32_bf16 v[120:123], a[84:87], a[136:139], v[120:123]
  ds_read_b64_tr_b16 a[34:35], v225 offset:3712
  v_mfma_f32_16x16x32_bf16 v[116:119], a[84:87], a[132:135], v[116:119]
  v_mfma_f32_16x16x32_bf16 v[112:115], a[84:87], a[128:131], v[112:115]
  ds_read_b64_tr_b16 a[36:37], v225 offset:14464
  v_mfma_f32_16x16x32_bf16 v[128:131], a[88:91], a[128:131], v[128:131]
  ds_read_b64_tr_b16 a[38:39], v225 offset:18048
  v_mfma_f32_16x16x32_bf16 v[132:135], a[88:91], a[132:135], v[132:135]
  buffer_load_dwordx4 v227, s[64:67], s69 offen offset:1024 lds
  v_mfma_f32_16x16x32_bf16 v[136:139], a[88:91], a[136:139], v[136:139]
  ds_read_b64_tr_b16 a[40:41], v225 offset:160
  v_mfma_f32_16x16x32_bf16 v[140:143], a[88:91], a[140:143], v[140:143]
  v_mfma_f32_16x16x32_bf16 v[156:159], a[92:95], a[140:143], v[156:159]
  ds_read_b64_tr_b16 a[42:43], v225 offset:3744
  v_mfma_f32_16x16x32_bf16 v[152:155], a[92:95], a[136:139], v[152:155]
  buffer_load_dwordx4 a[200:203], v235, s[36:39], s62 offen offset:1024 sc1
  v_mfma_f32_16x16x32_bf16 v[148:151], a[92:95], a[132:135], v[148:151]
  ds_read_b64_tr_b16 a[44:45], v225 offset:14496
  v_mfma_f32_16x16x32_bf16 v[144:147], a[92:95], a[128:131], v[144:147]
  ds_read_b64_tr_b16 a[46:47], v225 offset:18080
  v_mfma_f32_16x16x32_bf16 v[160:163], a[96:99], a[128:131], v[160:163]
  v_mfma_f32_16x16x32_bf16 v[164:167], a[96:99], a[132:135], v[164:167]
  ds_read_b64_tr_b16 a[48:49], v225 offset:192
  v_mfma_f32_16x16x32_bf16 v[168:171], a[96:99], a[136:139], v[168:171]
  ds_read_b64_tr_b16 a[50:51], v225 offset:3776
  v_mfma_f32_16x16x32_bf16 v[172:175], a[96:99], a[140:143], v[172:175]
  buffer_load_dwordx4 v228, s[64:67], s69 offen offset:2048 lds
  v_mfma_f32_16x16x32_bf16 v[188:191], a[100:103], a[140:143], v[188:191]
  ds_read_b64_tr_b16 a[52:53], v225 offset:14528
  v_mfma_f32_16x16x32_bf16 v[184:187], a[100:103], a[136:139], v[184:187]
  v_mfma_f32_16x16x32_bf16 v[180:183], a[100:103], a[132:135], v[180:183]
  ds_read_b64_tr_b16 a[54:55], v225 offset:18112
  v_mfma_f32_16x16x32_bf16 v[176:179], a[100:103], a[128:131], v[176:179]
  buffer_load_dwordx4 a[204:207], v236, s[36:39], s62 offen offset:1024 sc1
  v_mfma_f32_16x16x32_bf16 v[192:195], a[104:107], a[128:131], v[192:195]
  v_mfma_f32_16x16x32_bf16 v[196:199], a[104:107], a[132:135], v[196:199]
  v_mfma_f32_16x16x32_bf16 v[200:203], a[104:107], a[136:139], v[200:203]
  v_mfma_f32_16x16x32_bf16 v[204:207], a[104:107], a[140:143], v[204:207]
  v_mfma_f32_16x16x32_bf16 v[220:223], a[108:111], a[140:143], v[220:223]
  v_mfma_f32_16x16x32_bf16 v[216:219], a[108:111], a[136:139], v[216:219]
  v_mfma_f32_16x16x32_bf16 v[212:215], a[108:111], a[132:135], v[212:215]
  buffer_load_dwordx4 v229, s[64:67], s69 offen offset:3072 lds
  v_mfma_f32_16x16x32_bf16 v[208:211], a[108:111], a[128:131], v[208:211]
  s_waitcnt vmcnt(23) lgkmcnt(0)
  v_mfma_f32_16x16x32_bf16 v[0:3], a[0:3], a[144:147], v[0:3]
  ds_read_b64_tr_b16 a[56:57], v225 offset:7168
  v_mfma_f32_16x16x32_bf16 v[4:7], a[0:3], a[148:151], v[4:7]
  ds_read_b64_tr_b16 a[58:59], v225 offset:10752
  v_mfma_f32_16x16x32_bf16 v[8:11], a[0:3], a[152:155], v[8:11]
  s_add_u32 s63, s20, 3
  v_mfma_f32_16x16x32_bf16 v[12:15], a[0:3], a[156:159], v[12:15]
  ds_read_b64_tr_b16 a[60:61], v225 offset:21504
  v_mfma_f32_16x16x32_bf16 v[28:31], a[4:7], a[156:159], v[28:31]
  v_mfma_f32_16x16x32_bf16 v[24:27], a[4:7], a[152:155], v[24:27]
  ds_read_b64_tr_b16 a[62:63], v225 offset:25088
  v_mfma_f32_16x16x32_bf16 v[20:23], a[4:7], a[148:151], v[20:23]
  s_and_b32 s63, s63, 7
  v_mfma_f32_16x16x32_bf16 v[16:19], a[4:7], a[144:147], v[16:19]
  ds_read_b64_tr_b16 a[64:65], v225 offset:7200
  v_mfma_f32_16x16x32_bf16 v[32:35], a[8:11], a[144:147], v[32:35]
  ds_read_b64_tr_b16 a[66:67], v225 offset:10784
  v_mfma_f32_16x16x32_bf16 v[36:39], a[8:11], a[148:151], v[36:39]
  v_mfma_f32_16x16x32_bf16 v[40:43], a[8:11], a[152:155], v[40:43]
  s_add_u32 s63, s63, 8
  v_mfma_f32_16x16x32_bf16 v[44:47], a[8:11], a[156:159], v[44:47]
  ds_read_b64_tr_b16 a[68:69], v225 offset:21536
  v_mfma_f32_16x16x32_bf16 v[60:63], a[12:15], a[156:159], v[60:63]
  ds_read_b64_tr_b16 a[70:71], v225 offset:25120
  v_mfma_f32_16x16x32_bf16 v[56:59], a[12:15], a[152:155], v[56:59]
  ds_read_b64_tr_b16 a[72:73], v225 offset:7232
  v_mfma_f32_16x16x32_bf16 v[52:55], a[12:15], a[148:151], v[52:55]
  s_mul_i32 s63, s63, 2048
  v_mfma_f32_16x16x32_bf16 v[48:51], a[12:15], a[144:147], v[48:51]
  ds_read_b64_tr_b16 a[74:75], v225 offset:10816
  v_mfma_f32_16x16x32_bf16 v[64:67], a[16:19], a[144:147], v[64:67]
  v_mfma_f32_16x16x32_bf16 v[68:71], a[16:19], a[148:151], v[68:71]
  ds_read_b64_tr_b16 a[76:77], v225 offset:21568
  v_mfma_f32_16x16x32_bf16 v[72:75], a[16:19], a[152:155], v[72:75]
  buffer_load_dwordx4 a[208:211], v233, s[36:39], s63 offen offset:0 sc1
  v_mfma_f32_16x16x32_bf16 v[76:79], a[16:19], a[156:159], v[76:79]
  ds_read_b64_tr_b16 a[78:79], v225 offset:25152
  v_mfma_f32_16x16x32_bf16 v[92:95], a[20:23], a[156:159], v[92:95]
  ds_read_b64_tr_b16 a[80:81], v225 offset:7264
  v_mfma_f32_16x16x32_bf16 v[88:91], a[20:23], a[152:155], v[88:91]
  v_mfma_f32_16x16x32_bf16 v[84:87], a[20:23], a[148:151], v[84:87]
  s_add_u32 m0, s68, 90112
  v_mfma_f32_16x16x32_bf16 v[80:83], a[20:23], a[144:147], v[80:83]
  ds_read_b64_tr_b16 a[82:83], v225 offset:10848
  v_mfma_f32_16x16x32_bf16 v[96:99], a[24:27], a[144:147], v[96:99]
  ds_read_b64_tr_b16 a[84:85], v225 offset:21600
  v_mfma_f32_16x16x32_bf16 v[100:103], a[24:27], a[148:151], v[100:103]
  ds_read_b64_tr_b16 a[86:87], v225 offset:25184
  v_mfma_f32_16x16x32_bf16 v[104:107], a[24:27], a[152:155], v[104:107]
  buffer_load_dwordx4 v230, s[64:67], s69 offen lds
  v_mfma_f32_16x16x32_bf16 v[108:111], a[24:27], a[156:159], v[108:111]
  ds_read_b64_tr_b16 a[88:89], v225 offset:7296
  v_mfma_f32_16x16x32_bf16 v[124:127], a[28:31], a[156:159], v[124:127]
  v_mfma_f32_16x16x32_bf16 v[120:123], a[28:31], a[152:155], v[120:123]
  ds_read_b64_tr_b16 a[90:91], v225 offset:10880
  v_mfma_f32_16x16x32_bf16 v[116:119], a[28:31], a[148:151], v[116:119]
  buffer_load_dwordx4 a[212:215], v234, s[36:39], s63 offen offset:0 sc1
  v_mfma_f32_16x16x32_bf16 v[112:115], a[28:31], a[144:147], v[112:115]
  ds_read_b64_tr_b16 a[92:93], v225 offset:21632
  v_mfma_f32_16x16x32_bf16 v[128:131], a[32:35], a[144:147], v[128:131]
  ds_read_b64_tr_b16 a[94:95], v225 offset:25216
  v_mfma_f32_16x16x32_bf16 v[132:135], a[32:35], a[148:151], v[132:135]
  v_mfma_f32_16x16x32_bf16 v[136:139], a[32:35], a[152:155], v[136:139]
  v_mfma_f32_16x16x32_bf16 v[140:143], a[32:35], a[156:159], v[140:143]
  ds_read_b64_tr_b16 a[96:97], v225 offset:7328
  v_mfma_f32_16x16x32_bf16 v[156:159], a[36:39], a[156:159], v[156:159]
  ds_read_b64_tr_b16 a[98:99], v225 offset:10912
  v_mfma_f32_16x16x32_bf16 v[152:155], a[36:39], a[152:155], v[152:155]
  ds_read_b64_tr_b16 a[100:101], v225 offset:21664
  v_mfma_f32_16x16x32_bf16 v[148:151], a[36:39], a[148:151], v[148:151]
  buffer_load_dwordx4 v231, s[64:67], s69 offen offset:1024 lds
  v_mfma_f32_16x16x32_bf16 v[144:147], a[36:39], a[144:147], v[144:147]
  ds_read_b64_tr_b16 a[102:103], v225 offset:25248
  v_mfma_f32_16x16x32_bf16 v[160:163], a[40:43], a[144:147], v[160:163]
  v_mfma_f32_16x16x32_bf16 v[164:167], a[40:43], a[148:151], v[164:167]
  ds_read_b64_tr_b16 a[104:105], v225 offset:7360
  v_mfma_f32_16x16x32_bf16 v[168:171], a[40:43], a[152:155], v[168:171]
  buffer_load_dwordx4 a[216:219], v235, s[36:39], s63 offen offset:0 sc1
  v_mfma_f32_16x16x32_bf16 v[172:175], a[40:43], a[156:159], v[172:175]
  ds_read_b64_tr_b16 a[106:107], v225 offset:10944
  v_mfma_f32_16x16x32_bf16 v[188:191], a[44:47], a[156:159], v[188:191]
  ds_read_b64_tr_b16 a[108:109], v225 offset:21696
  v_mfma_f32_16x16x32_bf16 v[184:187], a[44:47], a[152:155], v[184:187]
  v_mfma_f32_16x16x32_bf16 v[180:183], a[44:47], a[148:151], v[180:183]
  v_mfma_f32_16x16x32_bf16 v[176:179], a[44:47], a[144:147], v[176:179]
  ds_read_b64_tr_b16 a[110:111], v225 offset:25280
  v_mfma_f32_16x16x32_bf16 v[192:195], a[48:51], a[144:147], v[192:195]
  v_mfma_f32_16x16x32_bf16 v[196:199], a[48:51], a[148:151], v[196:199]
  v_mfma_f32_16x16x32_bf16 v[200:203], a[48:51], a[152:155], v[200:203]
  buffer_load_dwordx4 v232, s[64:67], s69 offen offset:2048 lds
  v_mfma_f32_16x16x32_bf16 v[204:207], a[48:51], a[156:159], v[204:207]
  v_mfma_f32_16x16x32_bf16 v[220:223], a[52:55], a[156:159], v[220:223]
  v_mfma_f32_16x16x32_bf16 v[216:219], a[52:55], a[152:155], v[216:219]
  v_mfma_f32_16x16x32_bf16 v[212:215], a[52:55], a[148:151], v[212:215]
  buffer_load_dwordx4 a[220:223], v236, s[36:39], s63 offen offset:0 sc1
  v_mfma_f32_16x16x32_bf16 v[208:211], a[52:55], a[144:147], v[208:211]
  s_waitcnt vmcnt(23) lgkmcnt(0)
  v_mfma_f32_16x16x32_bf16 v[0:3], a[56:59], a[160:163], v[0:3]
  s_waitcnt vmcnt(31)
  s_barrier
  v_mfma_f32_16x16x32_bf16 v[4:7], a[56:59], a[164:167], v[4:7]
  ds_read_b64_tr_b16 a[0:1], v224 offset:28672
  buffer_load_dwordx4 a[224:227], v233, s[36:39], s63 offen offset:1024 sc1
  v_mfma_f32_16x16x32_bf16 v[8:11], a[56:59], a[168:171], v[8:11]
  ds_read_b64_tr_b16 a[2:3], v224 offset:32256
  v_mfma_f32_16x16x32_bf16 v[12:15], a[56:59], a[172:175], v[12:15]
  s_add_u32 s70, s20, 5
  v_mfma_f32_16x16x32_bf16 v[28:31], a[60:63], a[172:175], v[28:31]
  ds_read_b64_tr_b16 a[4:5], v224 offset:43008
  s_and_b32 s70, s70, 7
  v_mfma_f32_16x16x32_bf16 v[24:27], a[60:63], a[168:171], v[24:27]
  v_mfma_f32_16x16x32_bf16 v[20:23], a[60:63], a[164:167], v[20:23]
  ds_read_b64_tr_b16 a[6:7], v224 offset:46592
  s_add_u32 s70, s70, 8
  v_mfma_f32_16x16x32_bf16 v[16:19], a[60:63], a[160:163], v[16:19]
  s_mul_i32 s70, s70, 458752
  ds_read_b64_tr_b16 a[8:9], v224 offset:28704
  v_mfma_f32_16x16x32_bf16 v[32:35], a[64:67], a[160:163], v[32:35]
  s_add_u32 m0, s68, 57344
  v_mfma_f32_16x16x32_bf16 v[36:39], a[64:67], a[164:167], v[36:39]
  ds_read_b64_tr_b16 a[10:11], v224 offset:32288
  v_mfma_f32_16x16x32_bf16 v[40:43], a[64:67], a[168:171], v[40:43]
  buffer_load_dwordx4 v226, s[64:67], s70 offen lds
  v_mfma_f32_16x16x32_bf16 v[44:47], a[64:67], a[172:175], v[44:47]
  ds_read_b64_tr_b16 a[12:13], v224 offset:43040
  buffer_load_dwordx4 a[228:231], v234, s[36:39], s63 offen offset:1024 sc1
  v_mfma_f32_16x16x32_bf16 v[60:63], a[68:71], a[172:175], v[60:63]
  ds_read_b64_tr_b16 a[14:15], v224 offset:46624
  v_mfma_f32_16x16x32_bf16 v[56:59], a[68:71], a[168:171], v[56:59]
  v_mfma_f32_16x16x32_bf16 v[52:55], a[68:71], a[164:167], v[52:55]
  ds_read_b64_tr_b16 a[16:17], v224 offset:28736
  buffer_load_dwordx4 v227, s[64:67], s70 offen offset:1024 lds
  v_mfma_f32_16x16x32_bf16 v[48:51], a[68:71], a[160:163], v[48:51]
  v_mfma_f32_16x16x32_bf16 v[64:67], a[72:75], a[160:163], v[64:67]
  ds_read_b64_tr_b16 a[18:19], v224 offset:32320
  buffer_load_dwordx4 a[232:235], v235, s[36:39], s63 offen offset:1024 sc1
  v_mfma_f32_16x16x32_bf16 v[68:71], a[72:75], a[164:167], v[68:71]
  ds_read_b64_tr_b16 a[20:21], v224 offset:43072
  v_mfma_f32_16x16x32_bf16 v[72:75], a[72:75], a[168:171], v[72:75]
  v_mfma_f32_16x16x32_bf16 v[76:79], a[72:75], a[172:175], v[76:79]
  buffer_load_dwordx4 v228, s[64:67], s70 offen offset:2048 lds
  ds_read_b64_tr_b16 a[22:23], v224 offset:46656
  v_mfma_f32_16x16x32_bf16 v[92:95], a[76:79], a[172:175], v[92:95]
  buffer_load_dwordx4 a[236:239], v236, s[36:39], s63 offen offset:1024 sc1
  v_mfma_f32_16x16x32_bf16 v[88:91], a[76:79], a[168:171], v[88:91]
  ds_read_b64_tr_b16 a[24:25], v224 offset:28768
  v_mfma_f32_16x16x32_bf16 v[84:87], a[76:79], a[164:167], v[84:87]
  ds_read_b64_tr_b16 a[26:27], v224 offset:32352
  v_mfma_f32_16x16x32_bf16 v[80:83], a[76:79], a[160:163], v[80:83]
  buffer_load_dwordx4 v229, s[64:67], s70 offen offset:3072 lds
  v_mfma_f32_16x16x32_bf16 v[96:99], a[80:83], a[160:163], v[96:99]
  ds_read_b64_tr_b16 a[28:29], v224 offset:43104
  v_mbcnt_lo_u32_b32 v248, -1, 0
  v_mfma_f32_16x16x32_bf16 v[100:103], a[80:83], a[164:167], v[100:103]
  v_mfma_f32_16x16x32_bf16 v[104:107], a[80:83], a[168:171], v[104:107]
  ds_read_b64_tr_b16 a[30:31], v224 offset:46688
  v_mbcnt_hi_u32_b32 v248, -1, v248
  v_mfma_f32_16x16x32_bf16 v[108:111], a[80:83], a[172:175], v[108:111]
  v_lshlrev_b32 v249, 4, v248
  ds_read_b64_tr_b16 a[32:33], v224 offset:28800
  v_mfma_f32_16x16x32_bf16 v[124:127], a[84:87], a[172:175], v[124:127]
  v_mfma_f32_16x16x32_bf16 v[120:123], a[84:87], a[168:171], v[120:123]
  s_lshr_b32 s80, s3, 1
  ds_read_b64_tr_b16 a[34:35], v224 offset:32384
  v_mfma_f32_16x16x32_bf16 v[116:119], a[84:87], a[164:167], v[116:119]
  s_and_b32 s81, s3, 1
  v_mfma_f32_16x16x32_bf16 v[112:115], a[84:87], a[160:163], v[112:115]
  ds_read_b64_tr_b16 a[36:37], v224 offset:43136
  v_mfma_f32_16x16x32_bf16 v[128:131], a[88:91], a[160:163], v[128:131]
  s_mul_i32 s6, s80, 163840
  ds_read_b64_tr_b16 a[38:39], v224 offset:46720
  v_mfma_f32_16x16x32_bf16 v[132:135], a[88:91], a[164:167], v[132:135]
  s_mul_i32 s7, s80, 393216
  v_mfma_f32_16x16x32_bf16 v[136:139], a[88:91], a[168:171], v[136:139]
  ds_read_b64_tr_b16 a[40:41], v224 offset:28832
  v_mfma_f32_16x16x32_bf16 v[140:143], a[88:91], a[172:175], v[140:143]
  s_lshl_b32 s82, s80, 5
  v_mfma_f32_16x16x32_bf16 v[156:159], a[92:95], a[172:175], v[156:159]
  ds_read_b64_tr_b16 a[42:43], v224 offset:32416
  s_lshl_b32 s83, s81, 1
  v_mfma_f32_16x16x32_bf16 v[152:155], a[92:95], a[168:171], v[152:155]
  s_add_u32 s82, s82, s83
  ds_read_b64_tr_b16 a[44:45], v224 offset:43168
  v_mfma_f32_16x16x32_bf16 v[148:151], a[92:95], a[164:167], v[148:151]
  v_mfma_f32_16x16x32_bf16 v[144:147], a[92:95], a[160:163], v[144:147]
  s_and_b32 s78, s27, 1
  ds_read_b64_tr_b16 a[46:47], v224 offset:46752
  v_mfma_f32_16x16x32_bf16 v[160:163], a[96:99], a[160:163], v[160:163]
  s_mul_i32 s83, s78, 1792
  v_mfma_f32_16x16x32_bf16 v[164:167], a[96:99], a[164:167], v[164:167]
  ds_read_b64_tr_b16 a[48:49], v224 offset:28864
  v_mfma_f32_16x16x32_bf16 v[168:171], a[96:99], a[168:171], v[168:171]
  s_add_u32 s82, s82, s83
  ds_read_b64_tr_b16 a[50:51], v224 offset:32448
  v_mfma_f32_16x16x32_bf16 v[172:175], a[96:99], a[172:175], v[172:175]
  s_lshl_b32 s82, s82, 11
  v_mfma_f32_16x16x32_bf16 v[188:191], a[100:103], a[172:175], v[188:191]
  ds_read_b64_tr_b16 a[52:53], v224 offset:43200
  v_mfma_f32_16x16x32_bf16 v[184:187], a[100:103], a[168:171], v[184:187]
  v_lshrrev_b32 v250, 3, v248
  v_mfma_f32_16x16x32_bf16 v[180:183], a[100:103], a[164:167], v[180:183]
  ds_read_b64_tr_b16 a[54:55], v224 offset:46784
  v_lshlrev_b32 v250, 13, v250
  v_mfma_f32_16x16x32_bf16 v[176:179], a[100:103], a[160:163], v[176:179]
  v_mfma_f32_16x16x32_bf16 v[192:195], a[104:107], a[160:163], v[192:195]
  v_and_b32 v251, 7, v248
  v_mfma_f32_16x16x32_bf16 v[196:199], a[104:107], a[164:167], v[196:199]
  v_lshl_add_u32 v250, v251, 4, v250
  v_mfma_f32_16x16x32_bf16 v[200:203], a[104:107], a[168:171], v[200:203]
  v_add_u32 v250, s82, v250
  v_mfma_f32_16x16x32_bf16 v[204:207], a[104:107], a[172:175], v[204:207]
  v_mfma_f32_16x16x32_bf16 v[220:223], a[108:111], a[172:175], v[220:223]
  s_lshl_b32 s83, s27, 7
  v_mfma_f32_16x16x32_bf16 v[216:219], a[108:111], a[168:171], v[216:219]
  v_add_u32 v245, s83, v250
  v_mfma_f32_16x16x32_bf16 v[212:215], a[108:111], a[164:167], v[212:215]
  v_mfma_f32_16x16x32_bf16 v[208:211], a[108:111], a[160:163], v[208:211]
  v_xor_b32 v244, 128, v245
  s_waitcnt vmcnt(23) lgkmcnt(0)
  v_mfma_f32_16x16x32_bf16 v[0:3], a[0:3], a[176:179], v[0:3]
  ds_read_b64_tr_b16 a[56:57], v224 offset:35840
  s_add_u32 s62, s20, 4
  v_mfma_f32_16x16x32_bf16 v[4:7], a[0:3], a[180:183], v[4:7]
  ds_read_b64_tr_b16 a[58:59], v224 offset:39424
  v_mfma_f32_16x16x32_bf16 v[8:11], a[0:3], a[184:187], v[8:11]
  s_and_b32 s62, s62, 7
  v_mfma_f32_16x16x32_bf16 v[12:15], a[0:3], a[188:191], v[12:15]
  ds_read_b64_tr_b16 a[60:61], v224 offset:50176
  s_add_u32 s62, s62, 8
  v_mfma_f32_16x16x32_bf16 v[28:31], a[4:7], a[188:191], v[28:31]
  v_mfma_f32_16x16x32_bf16 v[24:27], a[4:7], a[184:187], v[24:27]
  ds_read_b64_tr_b16 a[62:63], v224 offset:53760
  s_mul_i32 s62, s62, 2048
  v_mfma_f32_16x16x32_bf16 v[20:23], a[4:7], a[180:183], v[20:23]
  ds_read_b64_tr_b16 a[64:65], v224 offset:35872
  v_mfma_f32_16x16x32_bf16 v[16:19], a[4:7], a[176:179], v[16:19]
  buffer_load_dwordx4 a[112:115], v233, s[36:39], s62 offen offset:0 sc1
  v_mfma_f32_16x16x32_bf16 v[32:35], a[8:11], a[176:179], v[32:35]
  s_add_u32 m0, s68, 61440
  ds_read_b64_tr_b16 a[66:67], v224 offset:39456
  v_mfma_f32_16x16x32_bf16 v[36:39], a[8:11], a[180:183], v[36:39]
  v_mfma_f32_16x16x32_bf16 v[40:43], a[8:11], a[184:187], v[40:43]
  buffer_load_dwordx4 v230, s[64:67], s70 offen lds
  ds_read_b64_tr_b16 a[68:69], v224 offset:50208
  v_mfma_f32_16x16x32_bf16 v[44:47], a[8:11], a[188:191], v[44:47]
  buffer_load_dwordx4 a[116:119], v234, s[36:39], s62 offen offset:0 sc1
  v_mfma_f32_16x16x32_bf16 v[60:63], a[12:15], a[188:191], v[60:63]
  ds_read_b64_tr_b16 a[70:71], v224 offset:53792
  v_mfma_f32_16x16x32_bf16 v[56:59], a[12:15], a[184:187], v[56:59]
  ds_read_b64_tr_b16 a[72:73], v224 offset:35904
  v_mfma_f32_16x16x32_bf16 v[52:55], a[12:15], a[180:183], v[52:55]
  buffer_load_dwordx4 v231, s[64:67], s70 offen offset:1024 lds
  v_mfma_f32_16x16x32_bf16 v[48:51], a[12:15], a[176:179], v[48:51]
  ds_read_b64_tr_b16 a[74:75], v224 offset:39488
  v_mfma_f32_16x16x32_bf16 v[64:67], a[16:19], a[176:179], v[64:67]
  buffer_load_dwordx4 a[120:123], v235, s[36:39], s62 offen offset:0 sc1
  v_mfma_f32_16x16x32_bf16 v[68:71], a[16:19], a[180:183], v[68:71]
  ds_read_b64_tr_b16 a[76:77], v224 offset:50240
  v_mfma_f32_16x16x32_bf16 v[72:75], a[16:19], a[184:187], v[72:75]
  ds_read_b64_tr_b16 a[78:79], v224 offset:53824
  v_mfma_f32_16x16x32_bf16 v[76:79], a[16:19], a[188:191], v[76:79]
  buffer_load_dwordx4 v232, s[64:67], s70 offen offset:2048 lds
  v_mfma_f32_16x16x32_bf16 v[92:95], a[20:23], a[188:191], v[92:95]
  ds_read_b64_tr_b16 a[80:81], v224 offset:35936
  v_mfma_f32_16x16x32_bf16 v[88:91], a[20:23], a[184:187], v[88:91]
  buffer_load_dwordx4 a[124:127], v236, s[36:39], s62 offen offset:0 sc1
  v_mfma_f32_16x16x32_bf16 v[84:87], a[20:23], a[180:183], v[84:87]
  ds_read_b64_tr_b16 a[82:83], v224 offset:39520
  v_bfe_u32 v250, v248, 2, 2
  v_mfma_f32_16x16x32_bf16 v[80:83], a[20:23], a[176:179], v[80:83]
  v_mfma_f32_16x16x32_bf16 v[96:99], a[24:27], a[176:179], v[96:99]
  ds_read_b64_tr_b16 a[84:85], v224 offset:50272
  v_mul_u32_u24 v250, 1056, v250
  v_mfma_f32_16x16x32_bf16 v[100:103], a[24:27], a[180:183], v[100:103]
  v_lshrrev_b32_e64 v251, 4, v248
  ds_read_b64_tr_b16 a[86:87], v224 offset:53856
  v_mfma_f32_16x16x32_bf16 v[104:107], a[24:27], a[184:187], v[104:107]
  v_mfma_f32_16x16x32_bf16 v[108:111], a[24:27], a[188:191], v[108:111]
  v_lshl_add_u32 v250, v251, 7, v250
  ds_read_b64_tr_b16 a[88:89], v224 offset:35968
  v_mfma_f32_16x16x32_bf16 v[124:127], a[28:31], a[188:191], v[124:127]
  v_and_b32_e64 v251, 3, v248
  v_mfma_f32_16x16x32_bf16 v[120:123], a[28:31], a[184:187], v[120:123]
  ds_read_b64_tr_b16 a[90:91], v224 offset:39552
  v_mfma_f32_16x16x32_bf16 v[116:119], a[28:31], a[180:183], v[116:119]
  v_lshl_add_u32 v243, v251, 3, v250
  ds_read_b64_tr_b16 a[92:93], v224 offset:50304
  v_mfma_f32_16x16x32_bf16 v[112:115], a[28:31], a[176:179], v[112:115]
  v_add_u32 v242, 129792, v243
  v_mfma_f32_16x16x32_bf16 v[128:131], a[32:35], a[176:179], v[128:131]
  ds_read_b64_tr_b16 a[94:95], v224 offset:53888
  v_mfma_f32_16x16x32_bf16 v[132:135], a[32:35], a[180:183], v[132:135]
  s_lshl_b32 s82, s26, 3
  v_mfma_f32_16x16x32_bf16 v[136:139], a[32:35], a[184:187], v[136:139]
  ds_read_b64_tr_b16 a[96:97], v224 offset:36000
  v_mfma_f32_16x16x32_bf16 v[140:143], a[32:35], a[188:191], v[140:143]
  s_lshl_b32 s83, s3, 1
  v_mfma_f32_16x16x32_bf16 v[156:159], a[36:39], a[188:191], v[156:159]
  ds_read_b64_tr_b16 a[98:99], v224 offset:39584
  s_add_u32 s82, s82, s83
  v_mfma_f32_16x16x32_bf16 v[152:155], a[36:39], a[184:187], v[152:155]
  ds_read_b64_tr_b16 a[100:101], v224 offset:50336
  v_mfma_f32_16x16x32_bf16 v[148:151], a[36:39], a[180:183], v[148:151]
  s_mul_i32 s82, s82, 114688
  v_mfma_f32_16x16x32_bf16 v[144:147], a[36:39], a[176:179], v[144:147]
  ds_read_b64_tr_b16 a[102:103], v224 offset:53920
  s_mul_i32 s83, s78, 57344
  v_mfma_f32_16x16x32_bf16 v[160:163], a[40:43], a[176:179], v[160:163]
  v_mfma_f32_16x16x32_bf16 v[164:167], a[40:43], a[180:183], v[164:167]
  ds_read_b64_tr_b16 a[104:105], v224 offset:36032
  s_add_u32 s82, s82, s83
  v_mfma_f32_16x16x32_bf16 v[168:171], a[40:43], a[184:187], v[168:171]
  v_add_u32_e64 v246, s82, v249
  ds_read_b64_tr_b16 a[106:107], v224 offset:39616
  v_mfma_f32_16x16x32_bf16 v[172:175], a[40:43], a[188:191], v[172:175]
  v_mfma_f32_16x16x32_bf16 v[188:191], a[44:47], a[188:191], v[188:191]
  v_add_u32 v247, 114688, v246
  ds_read_b64_tr_b16 a[108:109], v224 offset:50368
  v_mfma_f32_16x16x32_bf16 v[184:187], a[44:47], a[184:187], v[184:187]
  s_mul_i32 s76, s80, 4224
  v_mfma_f32_16x16x32_bf16 v[180:183], a[44:47], a[180:183], v[180:183]
  ds_read_b64_tr_b16 a[110:111], v224 offset:53952
  v_mfma_f32_16x16x32_bf16 v[176:179], a[44:47], a[176:179], v[176:179]
  s_mul_i32 s82, s81, 2112
  v_mfma_f32_16x16x32_bf16 v[192:195], a[48:51], a[176:179], v[192:195]
  v_mfma_f32_16x16x32_bf16 v[196:199], a[48:51], a[180:183], v[196:199]
  s_add_u32 s76, s76, s82
  v_mfma_f32_16x16x32_bf16 v[200:203], a[48:51], a[184:187], v[200:203]
  s_mov_b32 s32, s18
  v_mfma_f32_16x16x32_bf16 v[204:207], a[48:51], a[188:191], v[204:207]
  v_mfma_f32_16x16x32_bf16 v[220:223], a[52:55], a[188:191], v[220:223]
  s_mov_b32 s33, s19
  v_mfma_f32_16x16x32_bf16 v[216:219], a[52:55], a[184:187], v[216:219]
  s_mov_b32 s34, 7340032
  v_mfma_f32_16x16x32_bf16 v[212:215], a[52:55], a[180:183], v[212:215]
  v_mfma_f32_16x16x32_bf16 v[208:211], a[52:55], a[176:179], v[208:211]
  s_mov_b32 s35, 0x20000
  s_waitcnt vmcnt(23) lgkmcnt(0)
  v_mfma_f32_16x16x32_bf16 v[0:3], a[56:59], a[192:195], v[0:3]
  s_waitcnt vmcnt(31)
  s_barrier
  v_mfma_f32_16x16x32_bf16 v[4:7], a[56:59], a[196:199], v[4:7]
  ds_read_b64_tr_b16 a[0:1], v224 offset:0
  v_mfma_f32_16x16x32_bf16 v[8:11], a[56:59], a[200:203], v[8:11]
  ds_read_b64_tr_b16 a[2:3], v224 offset:3584
  v_mfma_f32_16x16x32_bf16 v[12:15], a[56:59], a[204:207], v[12:15]
  buffer_load_dwordx4 a[128:131], v233, s[36:39], s62 offen offset:1024 sc1
  v_mfma_f32_16x16x32_bf16 v[28:31], a[60:63], a[204:207], v[28:31]
  ds_read_b64_tr_b16 a[4:5], v224 offset:14336
  v_mfma_f32_16x16x32_bf16 v[24:27], a[60:63], a[200:203], v[24:27]
  v_mfma_f32_16x16x32_bf16 v[20:23], a[60:63], a[196:199], v[20:23]
  ds_read_b64_tr_b16 a[6:7], v224 offset:17920
  v_mfma_f32_16x16x32_bf16 v[16:19], a[60:63], a[192:195], v[16:19]
  s_add_u32 s69, s20, 6
  v_mfma_f32_16x16x32_bf16 v[32:35], a[64:67], a[192:195], v[32:35]
  ds_read_b64_tr_b16 a[8:9], v224 offset:32
  v_mfma_f32_16x16x32_bf16 v[36:39], a[64:67], a[196:199], v[36:39]
  ds_read_b64_tr_b16 a[10:11], v224 offset:3616
  v_mfma_f32_16x16x32_bf16 v[40:43], a[64:67], a[200:203], v[40:43]
  s_and_b32 s69, s69, 7
  v_mfma_f32_16x16x32_bf16 v[44:47], a[64:67], a[204:207], v[44:47]
  ds_read_b64_tr_b16 a[12:13], v224 offset:14368
  v_mfma_f32_16x16x32_bf16 v[60:63], a[68:71], a[204:207], v[60:63]
  ds_read_b64_tr_b16 a[14:15], v224 offset:17952
  v_mfma_f32_16x16x32_bf16 v[56:59], a[68:71], a[200:203], v[56:59]
  s_add_u32 s69, s69, 8
  v_mfma_f32_16x16x32_bf16 v[52:55], a[68:71], a[196:199], v[52:55]
  ds_read_b64_tr_b16 a[16:17], v224 offset:64
  v_mfma_f32_16x16x32_bf16 v[48:51], a[68:71], a[192:195], v[48:51]
  v_mfma_f32_16x16x32_bf16 v[64:67], a[72:75], a[192:195], v[64:67]
  ds_read_b64_tr_b16 a[18:19], v224 offset:3648
  v_mfma_f32_16x16x32_bf16 v[68:71], a[72:75], a[196:199], v[68:71]
  s_mul_i32 s69, s69, 458752
  v_mfma_f32_16x16x32_bf16 v[72:75], a[72:75], a[200:203], v[72:75]
  ds_read_b64_tr_b16 a[20:21], v224 offset:14400
  v_mfma_f32_16x16x32_bf16 v[76:79], a[72:75], a[204:207], v[76:79]
  ds_read_b64_tr_b16 a[22:23], v224 offset:17984
  v_mfma_f32_16x16x32_bf16 v[92:95], a[76:79], a[204:207], v[92:95]
  s_add_u32 m0, s68, 28672
  v_mfma_f32_16x16x32_bf16 v[88:91], a[76:79], a[200:203], v[88:91]
  ds_read_b64_tr_b16 a[24:25], v224 offset:96
  v_mfma_f32_16x16x32_bf16 v[84:87], a[76:79], a[196:199], v[84:87]
  ds_read_b64_tr_b16 a[26:27], v224 offset:3680
  v_mfma_f32_16x16x32_bf16 v[80:83], a[76:79], a[192:195], v[80:83]
  buffer_load_dwordx4 v226, s[64:67], s69 offen lds
  v_mfma_f32_16x16x32_bf16 v[96:99], a[80:83], a[192:195], v[96:99]
  ds_read_b64_tr_b16 a[28:29], v224 offset:14432
  v_mfma_f32_16x16x32_bf16 v[100:103], a[80:83], a[196:199], v[100:103]
  v_mfma_f32_16x16x32_bf16 v[104:107], a[80:83], a[200:203], v[104:107]
  ds_read_b64_tr_b16 a[30:31], v224 offset:18016
  v_mfma_f32_16x16x32_bf16 v[108:111], a[80:83], a[204:207], v[108:111]
  buffer_load_dwordx4 a[132:135], v234, s[36:39], s62 offen offset:1024 sc1
  v_mfma_f32_16x16x32_bf16 v[124:127], a[84:87], a[204:207], v[124:127]
  ds_read_b64_tr_b16 a[32:33], v224 offset:128
  v_mfma_f32_16x16x32_bf16 v[120:123], a[84:87], a[200:203], v[120:123]
  ds_read_b64_tr_b16 a[34:35], v224 offset:3712
  v_mfma_f32_16x16x32_bf16 v[116:119], a[84:87], a[196:199], v[116:119]
  v_mfma_f32_16x16x32_bf16 v[112:115], a[84:87], a[192:195], v[112:115]
  ds_read_b64_tr_b16 a[36:37], v224 offset:14464
  v_mfma_f32_16x16x32_bf16 v[128:131], a[88:91], a[192:195], v[128:131]
  ds_read_b64_tr_b16 a[38:39], v224 offset:18048
  v_mfma_f32_16x16x32_bf16 v[132:135], a[88:91], a[196:199], v[132:135]
  buffer_load_dwordx4 v227, s[64:67], s69 offen offset:1024 lds
  v_mfma_f32_16x16x32_bf16 v[136:139], a[88:91], a[200:203], v[136:139]
  ds_read_b64_tr_b16 a[40:41], v224 offset:160
  v_mfma_f32_16x16x32_bf16 v[140:143], a[88:91], a[204:207], v[140:143]
  v_mfma_f32_16x16x32_bf16 v[156:159], a[92:95], a[204:207], v[156:159]
  ds_read_b64_tr_b16 a[42:43], v224 offset:3744
  v_mfma_f32_16x16x32_bf16 v[152:155], a[92:95], a[200:203], v[152:155]
  buffer_load_dwordx4 a[136:139], v235, s[36:39], s62 offen offset:1024 sc1
  v_mfma_f32_16x16x32_bf16 v[148:151], a[92:95], a[196:199], v[148:151]
  ds_read_b64_tr_b16 a[44:45], v224 offset:14496
  v_mfma_f32_16x16x32_bf16 v[144:147], a[92:95], a[192:195], v[144:147]
  ds_read_b64_tr_b16 a[46:47], v224 offset:18080
  v_mfma_f32_16x16x32_bf16 v[160:163], a[96:99], a[192:195], v[160:163]
  v_mfma_f32_16x16x32_bf16 v[164:167], a[96:99], a[196:199], v[164:167]
  ds_read_b64_tr_b16 a[48:49], v224 offset:192
  v_mfma_f32_16x16x32_bf16 v[168:171], a[96:99], a[200:203], v[168:171]
  ds_read_b64_tr_b16 a[50:51], v224 offset:3776
  v_mfma_f32_16x16x32_bf16 v[172:175], a[96:99], a[204:207], v[172:175]
  buffer_load_dwordx4 v228, s[64:67], s69 offen offset:2048 lds
  v_mfma_f32_16x16x32_bf16 v[188:191], a[100:103], a[204:207], v[188:191]
  ds_read_b64_tr_b16 a[52:53], v224 offset:14528
  v_mfma_f32_16x16x32_bf16 v[184:187], a[100:103], a[200:203], v[184:187]
  v_mfma_f32_16x16x32_bf16 v[180:183], a[100:103], a[196:199], v[180:183]
  ds_read_b64_tr_b16 a[54:55], v224 offset:18112
  v_mfma_f32_16x16x32_bf16 v[176:179], a[100:103], a[192:195], v[176:179]
  buffer_load_dwordx4 a[140:143], v236, s[36:39], s62 offen offset:1024 sc1
  v_mfma_f32_16x16x32_bf16 v[192:195], a[104:107], a[192:195], v[192:195]
  v_mfma_f32_16x16x32_bf16 v[196:199], a[104:107], a[196:199], v[196:199]
  v_mfma_f32_16x16x32_bf16 v[200:203], a[104:107], a[200:203], v[200:203]
  v_mfma_f32_16x16x32_bf16 v[204:207], a[104:107], a[204:207], v[204:207]
  v_mfma_f32_16x16x32_bf16 v[220:223], a[108:111], a[204:207], v[220:223]
  v_mfma_f32_16x16x32_bf16 v[216:219], a[108:111], a[200:203], v[216:219]
  v_mfma_f32_16x16x32_bf16 v[212:215], a[108:111], a[196:199], v[212:215]
  buffer_load_dwordx4 v229, s[64:67], s69 offen offset:3072 lds
  v_mfma_f32_16x16x32_bf16 v[208:211], a[108:111], a[192:195], v[208:211]
  s_waitcnt vmcnt(23) lgkmcnt(0)
  v_mfma_f32_16x16x32_bf16 v[0:3], a[0:3], a[208:211], v[0:3]
  ds_read_b64_tr_b16 a[56:57], v224 offset:7168
  v_mfma_f32_16x16x32_bf16 v[4:7], a[0:3], a[212:215], v[4:7]
  s_add_u32 s63, s20, 5
  v_mfma_f32_16x16x32_bf16 v[8:11], a[0:3], a[216:219], v[8:11]
  ds_read_b64_tr_b16 a[58:59], v224 offset:10752
  v_mfma_f32_16x16x32_bf16 v[12:15], a[0:3], a[220:223], v[12:15]
  ds_read_b64_tr_b16 a[60:61], v224 offset:21504
  v_mfma_f32_16x16x32_bf16 v[28:31], a[4:7], a[220:223], v[28:31]
  s_and_b32 s63, s63, 7
  v_mfma_f32_16x16x32_bf16 v[24:27], a[4:7], a[216:219], v[24:27]
  ds_read_b64_tr_b16 a[62:63], v224 offset:25088
  v_mfma_f32_16x16x32_bf16 v[20:23], a[4:7], a[212:215], v[20:23]
  ds_read_b64_tr_b16 a[64:65], v224 offset:7200
  v_mfma_f32_16x16x32_bf16 v[16:19], a[4:7], a[208:211], v[16:19]
  s_add_u32 s63, s63, 8
  v_mfma_f32_16x16x32_bf16 v[32:35], a[8:11], a[208:211], v[32:35]
  ds_read_b64_tr_b16 a[66:67], v224 offset:10784
  v_mfma_f32_16x16x32_bf16 v[36:39], a[8:11], a[212:215], v[36:39]
  s_mul_i32 s63, s63, 2048
  v_mfma_f32_16x16x32_bf16 v[40:43], a[8:11], a[216:219], v[40:43]
  ds_read_b64_tr_b16 a[68:69], v224 offset:21536
  v_mfma_f32_16x16x32_bf16 v[44:47], a[8:11], a[220:223], v[44:47]
  v_mfma_f32_16x16x32_bf16 v[60:63], a[12:15], a[220:223], v[60:63]
  ds_read_b64_tr_b16 a[70:71], v224 offset:25120
  v_mfma_f32_16x16x32_bf16 v[56:59], a[12:15], a[216:219], v[56:59]
  buffer_load_dwordx4 a[144:147], v233, s[36:39], s63 offen offset:0 sc1
  v_mfma_f32_16x16x32_bf16 v[52:55], a[12:15], a[212:215], v[52:55]
  ds_read_b64_tr_b16 a[72:73], v224 offset:7232
  v_mfma_f32_16x16x32_bf16 v[48:51], a[12:15], a[208:211], v[48:51]
  s_add_u32 m0, s68, 32768
  v_mfma_f32_16x16x32_bf16 v[64:67], a[16:19], a[208:211], v[64:67]
  ds_read_b64_tr_b16 a[74:75], v224 offset:10816
  v_mfma_f32_16x16x32_bf16 v[68:71], a[16:19], a[212:215], v[68:71]
  ds_read_b64_tr_b16 a[76:77], v224 offset:21568
  v_mfma_f32_16x16x32_bf16 v[72:75], a[16:19], a[216:219], v[72:75]
  buffer_load_dwordx4 v230, s[64:67], s69 offen lds
  v_mfma_f32_16x16x32_bf16 v[76:79], a[16:19], a[220:223], v[76:79]
  ds_read_b64_tr_b16 a[78:79], v224 offset:25152
  v_mfma_f32_16x16x32_bf16 v[92:95], a[20:23], a[220:223], v[92:95]
  ds_read_b64_tr_b16 a[80:81], v224 offset:7264
  v_mfma_f32_16x16x32_bf16 v[88:91], a[20:23], a[216:219], v[88:91]
  buffer_load_dwordx4 a[148:151], v234, s[36:39], s63 offen offset:0 sc1
  v_mfma_f32_16x16x32_bf16 v[84:87], a[20:23], a[212:215], v[84:87]
  ds_read_b64_tr_b16 a[82:83], v224 offset:10848
  v_mfma_f32_16x16x32_bf16 v[80:83], a[20:23], a[208:211], v[80:83]
  v_mfma_f32_16x16x32_bf16 v[96:99], a[24:27], a[208:211], v[96:99]
  ds_read_b64_tr_b16 a[84:85], v224 offset:21600
  v_mfma_f32_16x16x32_bf16 v[100:103], a[24:27], a[212:215], v[100:103]
  ds_read_b64_tr_b16 a[86:87], v224 offset:25184
  v_mfma_f32_16x16x32_bf16 v[104:107], a[24:27], a[216:219], v[104:107]
  buffer_load_dwordx4 v231, s[64:67], s69 offen offset:1024 lds
  v_mfma_f32_16x16x32_bf16 v[108:111], a[24:27], a[220:223], v[108:111]
  ds_read_b64_tr_b16 a[88:89], v224 offset:7296
  v_mfma_f32_16x16x32_bf16 v[124:127], a[28:31], a[220:223], v[124:127]
  v_mfma_f32_16x16x32_bf16 v[120:123], a[28:31], a[216:219], v[120:123]
  ds_read_b64_tr_b16 a[90:91], v224 offset:10880
  v_mfma_f32_16x16x32_bf16 v[116:119], a[28:31], a[212:215], v[116:119]
  buffer_load_dwordx4 a[152:155], v235, s[36:39], s63 offen offset:0 sc1
  v_mfma_f32_16x16x32_bf16 v[112:115], a[28:31], a[208:211], v[112:115]
  ds_read_b64_tr_b16 a[92:93], v224 offset:21632
  v_mfma_f32_16x16x32_bf16 v[128:131], a[32:35], a[208:211], v[128:131]
  v_mfma_f32_16x16x32_bf16 v[132:135], a[32:35], a[212:215], v[132:135]
  ds_read_b64_tr_b16 a[94:95], v224 offset:25216
  v_mfma_f32_16x16x32_bf16 v[136:139], a[32:35], a[216:219], v[136:139]
  ds_read_b64_tr_b16 a[96:97], v224 offset:7328
  v_mfma_f32_16x16x32_bf16 v[140:143], a[32:35], a[220:223], v[140:143]
  buffer_load_dwordx4 v232, s[64:67], s69 offen offset:2048 lds
  v_mfma_f32_16x16x32_bf16 v[156:159], a[36:39], a[220:223], v[156:159]
  ds_read_b64_tr_b16 a[98:99], v224 offset:10912
  v_mfma_f32_16x16x32_bf16 v[152:155], a[36:39], a[216:219], v[152:155]
  ds_read_b64_tr_b16 a[100:101], v224 offset:21664
  v_mfma_f32_16x16x32_bf16 v[148:151], a[36:39], a[212:215], v[148:151]
  buffer_load_dwordx4 a[156:159], v236, s[36:39], s63 offen offset:0 sc1
  v_mfma_f32_16x16x32_bf16 v[144:147], a[36:39], a[208:211], v[144:147]
  ds_read_b64_tr_b16 a[102:103], v224 offset:25248
  v_mfma_f32_16x16x32_bf16 v[160:163], a[40:43], a[208:211], v[160:163]
  s_lshl_b32 s80, s31, 2
  v_mfma_f32_16x16x32_bf16 v[164:167], a[40:43], a[212:215], v[164:167]
  ds_read_b64_tr_b16 a[104:105], v224 offset:7360
  v_mfma_f32_16x16x32_bf16 v[168:171], a[40:43], a[216:219], v[168:171]
  ds_read_b64_tr_b16 a[106:107], v224 offset:10944
  v_mfma_f32_16x16x32_bf16 v[172:175], a[40:43], a[220:223], v[172:175]
  s_add_u32 s80, s80, s3
  v_mfma_f32_16x16x32_bf16 v[188:191], a[44:47], a[220:223], v[188:191]
  ds_read_b64_tr_b16 a[108:109], v224 offset:21696
  v_mfma_f32_16x16x32_bf16 v[184:187], a[44:47], a[216:219], v[184:187]
  v_mfma_f32_16x16x32_bf16 v[180:183], a[44:47], a[212:215], v[180:183]
  s_lshl_b32 s80, s80, 10
  v_mfma_f32_16x16x32_bf16 v[176:179], a[44:47], a[208:211], v[176:179]
  ds_read_b64_tr_b16 a[110:111], v224 offset:25280
  v_mfma_f32_16x16x32_bf16 v[192:195], a[48:51], a[208:211], v[192:195]
  v_mfma_f32_16x16x32_bf16 v[196:199], a[48:51], a[212:215], v[196:199]
  v_add_u32 v254, s80, v238
  v_mfma_f32_16x16x32_bf16 v[200:203], a[48:51], a[216:219], v[200:203]
  v_mfma_f32_16x16x32_bf16 v[204:207], a[48:51], a[220:223], v[204:207]
  v_min_u32 v254, adaLN_cond__linear_kernel_hedgehog__glu_gated_swiglu__prompt_kernel_end-adaLN_cond__linear_kernel_hedgehog__glu_gated_swiglu__prompt_kernel-4, v254
  v_mfma_f32_16x16x32_bf16 v[220:223], a[52:55], a[220:223], v[220:223]
  v_mfma_f32_16x16x32_bf16 v[216:219], a[52:55], a[216:219], v[216:219]
  v_mfma_f32_16x16x32_bf16 v[212:215], a[52:55], a[212:215], v[212:215]
  global_load_dword v240, v254, s[100:101]
  v_mfma_f32_16x16x32_bf16 v[208:211], a[52:55], a[208:211], v[208:211]
  s_waitcnt vmcnt(24) lgkmcnt(0)
  v_mfma_f32_16x16x32_bf16 v[0:3], a[56:59], a[224:227], v[0:3]
  s_waitcnt vmcnt(32)
  s_barrier
  v_mfma_f32_16x16x32_bf16 v[4:7], a[56:59], a[228:231], v[4:7]
  ds_read_b64_tr_b16 a[0:1], v225 offset:28672
  v_mfma_f32_16x16x32_bf16 v[8:11], a[56:59], a[232:235], v[8:11]
  ds_read_b64_tr_b16 a[2:3], v225 offset:32256
  v_mfma_f32_16x16x32_bf16 v[12:15], a[56:59], a[236:239], v[12:15]
  buffer_load_dwordx4 a[160:163], v233, s[36:39], s63 offen offset:1024 sc1
  v_mfma_f32_16x16x32_bf16 v[28:31], a[60:63], a[236:239], v[28:31]
  ds_read_b64_tr_b16 a[4:5], v225 offset:43008
  v_mfma_f32_16x16x32_bf16 v[24:27], a[60:63], a[232:235], v[24:27]
  v_mfma_f32_16x16x32_bf16 v[20:23], a[60:63], a[228:231], v[20:23]
  ds_read_b64_tr_b16 a[6:7], v225 offset:46592
  v_mfma_f32_16x16x32_bf16 v[16:19], a[60:63], a[224:227], v[16:19]
  s_add_u32 s70, s20, 7
  v_mfma_f32_16x16x32_bf16 v[32:35], a[64:67], a[224:227], v[32:35]
  ds_read_b64_tr_b16 a[8:9], v225 offset:28704
  v_mfma_f32_16x16x32_bf16 v[36:39], a[64:67], a[228:231], v[36:39]
  ds_read_b64_tr_b16 a[10:11], v225 offset:32288
  v_mfma_f32_16x16x32_bf16 v[40:43], a[64:67], a[232:235], v[40:43]
  s_and_b32 s70, s70, 7
  v_mfma_f32_16x16x32_bf16 v[44:47], a[64:67], a[236:239], v[44:47]
  ds_read_b64_tr_b16 a[12:13], v225 offset:43040
  v_mfma_f32_16x16x32_bf16 v[60:63], a[68:71], a[236:239], v[60:63]
  ds_read_b64_tr_b16 a[14:15], v225 offset:46624
  v_mfma_f32_16x16x32_bf16 v[56:59], a[68:71], a[232:235], v[56:59]
  s_add_u32 s70, s70, 8
  v_mfma_f32_16x16x32_bf16 v[52:55], a[68:71], a[228:231], v[52:55]
  ds_read_b64_tr_b16 a[16:17], v225 offset:28736
  v_mfma_f32_16x16x32_bf16 v[48:51], a[68:71], a[224:227], v[48:51]
  v_mfma_f32_16x16x32_bf16 v[64:67], a[72:75], a[224:227], v[64:67]
  ds_read_b64_tr_b16 a[18:19], v225 offset:32320
  v_mfma_f32_16x16x32_bf16 v[68:71], a[72:75], a[228:231], v[68:71]
  s_mul_i32 s70, s70, 458752
  v_mfma_f32_16x16x32_bf16 v[72:75], a[72:75], a[232:235], v[72:75]
  ds_read_b64_tr_b16 a[20:21], v225 offset:43072
  v_mfma_f32_16x16x32_bf16 v[76:79], a[72:75], a[236:239], v[76:79]
  ds_read_b64_tr_b16 a[22:23], v225 offset:46656
  v_mfma_f32_16x16x32_bf16 v[92:95], a[76:79], a[236:239], v[92:95]
  s_add_u32 m0, s68, 0
  v_mfma_f32_16x16x32_bf16 v[88:91], a[76:79], a[232:235], v[88:91]
  ds_read_b64_tr_b16 a[24:25], v225 offset:28768
  v_mfma_f32_16x16x32_bf16 v[84:87], a[76:79], a[228:231], v[84:87]
  ds_read_b64_tr_b16 a[26:27], v225 offset:32352
  v_mfma_f32_16x16x32_bf16 v[80:83], a[76:79], a[224:227], v[80:83]
  buffer_load_dwordx4 v226, s[64:67], s70 offen lds
  v_mfma_f32_16x16x32_bf16 v[96:99], a[80:83], a[224:227], v[96:99]
  ds_read_b64_tr_b16 a[28:29], v225 offset:43104
  v_mfma_f32_16x16x32_bf16 v[100:103], a[80:83], a[228:231], v[100:103]
  v_mfma_f32_16x16x32_bf16 v[104:107], a[80:83], a[232:235], v[104:107]
  ds_read_b64_tr_b16 a[30:31], v225 offset:46688
  v_mfma_f32_16x16x32_bf16 v[108:111], a[80:83], a[236:239], v[108:111]
  buffer_load_dwordx4 a[164:167], v234, s[36:39], s63 offen offset:1024 sc1
  v_mfma_f32_16x16x32_bf16 v[124:127], a[84:87], a[236:239], v[124:127]
  ds_read_b64_tr_b16 a[32:33], v225 offset:28800
  v_mfma_f32_16x16x32_bf16 v[120:123], a[84:87], a[232:235], v[120:123]
  ds_read_b64_tr_b16 a[34:35], v225 offset:32384
  v_mfma_f32_16x16x32_bf16 v[116:119], a[84:87], a[228:231], v[116:119]
  v_mfma_f32_16x16x32_bf16 v[112:115], a[84:87], a[224:227], v[112:115]
  ds_read_b64_tr_b16 a[36:37], v225 offset:43136
  v_mfma_f32_16x16x32_bf16 v[128:131], a[88:91], a[224:227], v[128:131]
  ds_read_b64_tr_b16 a[38:39], v225 offset:46720
  v_mfma_f32_16x16x32_bf16 v[132:135], a[88:91], a[228:231], v[132:135]
  buffer_load_dwordx4 v227, s[64:67], s70 offen offset:1024 lds
  v_mfma_f32_16x16x32_bf16 v[136:139], a[88:91], a[232:235], v[136:139]
  ds_read_b64_tr_b16 a[40:41], v225 offset:28832
  v_mfma_f32_16x16x32_bf16 v[140:143], a[88:91], a[236:239], v[140:143]
  v_mfma_f32_16x16x32_bf16 v[156:159], a[92:95], a[236:239], v[156:159]
  ds_read_b64_tr_b16 a[42:43], v225 offset:32416
  v_mfma_f32_16x16x32_bf16 v[152:155], a[92:95], a[232:235], v[152:155]
  buffer_load_dwordx4 a[168:171], v235, s[36:39], s63 offen offset:1024 sc1
  v_mfma_f32_16x16x32_bf16 v[148:151], a[92:95], a[228:231], v[148:151]
  ds_read_b64_tr_b16 a[44:45], v225 offset:43168
  v_mfma_f32_16x16x32_bf16 v[144:147], a[92:95], a[224:227], v[144:147]
  ds_read_b64_tr_b16 a[46:47], v225 offset:46752
  v_mfma_f32_16x16x32_bf16 v[160:163], a[96:99], a[224:227], v[160:163]
  v_mfma_f32_16x16x32_bf16 v[164:167], a[96:99], a[228:231], v[164:167]
  ds_read_b64_tr_b16 a[48:49], v225 offset:28864
  v_mfma_f32_16x16x32_bf16 v[168:171], a[96:99], a[232:235], v[168:171]
  ds_read_b64_tr_b16 a[50:51], v225 offset:32448
  v_mfma_f32_16x16x32_bf16 v[172:175], a[96:99], a[236:239], v[172:175]
  buffer_load_dwordx4 v228, s[64:67], s70 offen offset:2048 lds
  v_mfma_f32_16x16x32_bf16 v[188:191], a[100:103], a[236:239], v[188:191]
  ds_read_b64_tr_b16 a[52:53], v225 offset:43200
  v_mfma_f32_16x16x32_bf16 v[184:187], a[100:103], a[232:235], v[184:187]
  v_mfma_f32_16x16x32_bf16 v[180:183], a[100:103], a[228:231], v[180:183]
  ds_read_b64_tr_b16 a[54:55], v225 offset:46784
  v_mfma_f32_16x16x32_bf16 v[176:179], a[100:103], a[224:227], v[176:179]
  buffer_load_dwordx4 a[172:175], v236, s[36:39], s63 offen offset:1024 sc1
  v_mfma_f32_16x16x32_bf16 v[192:195], a[104:107], a[224:227], v[192:195]
  v_mfma_f32_16x16x32_bf16 v[196:199], a[104:107], a[228:231], v[196:199]
  v_mfma_f32_16x16x32_bf16 v[200:203], a[104:107], a[232:235], v[200:203]
  v_mfma_f32_16x16x32_bf16 v[204:207], a[104:107], a[236:239], v[204:207]
  v_mfma_f32_16x16x32_bf16 v[220:223], a[108:111], a[236:239], v[220:223]
  v_mfma_f32_16x16x32_bf16 v[216:219], a[108:111], a[232:235], v[216:219]
  v_mfma_f32_16x16x32_bf16 v[212:215], a[108:111], a[228:231], v[212:215]
  buffer_load_dwordx4 v229, s[64:67], s70 offen offset:3072 lds
  v_mfma_f32_16x16x32_bf16 v[208:211], a[108:111], a[224:227], v[208:211]
  s_waitcnt vmcnt(24) lgkmcnt(0)
  v_mfma_f32_16x16x32_bf16 v[0:3], a[0:3], a[112:115], v[0:3]
  ds_read_b64_tr_b16 a[56:57], v225 offset:35840
  v_mfma_f32_16x16x32_bf16 v[4:7], a[0:3], a[116:119], v[4:7]
  ds_read_b64_tr_b16 a[58:59], v225 offset:39424
  v_mfma_f32_16x16x32_bf16 v[8:11], a[0:3], a[120:123], v[8:11]
  s_add_u32 s62, s20, 6
  v_mfma_f32_16x16x32_bf16 v[12:15], a[0:3], a[124:127], v[12:15]
  ds_read_b64_tr_b16 a[60:61], v225 offset:50176
  v_mfma_f32_16x16x32_bf16 v[28:31], a[4:7], a[124:127], v[28:31]
  v_mfma_f32_16x16x32_bf16 v[24:27], a[4:7], a[120:123], v[24:27]
  ds_read_b64_tr_b16 a[62:63], v225 offset:53760
  v_mfma_f32_16x16x32_bf16 v[20:23], a[4:7], a[116:119], v[20:23]
  s_and_b32 s62, s62, 7
  v_mfma_f32_16x16x32_bf16 v[16:19], a[4:7], a[112:115], v[16:19]
  ds_read_b64_tr_b16 a[64:65], v225 offset:35872
  v_mfma_f32_16x16x32_bf16 v[32:35], a[8:11], a[112:115], v[32:35]
  ds_read_b64_tr_b16 a[66:67], v225 offset:39456
  v_mfma_f32_16x16x32_bf16 v[36:39], a[8:11], a[116:119], v[36:39]
  v_mfma_f32_16x16x32_bf16 v[40:43], a[8:11], a[120:123], v[40:43]
  s_add_u32 s62, s62, 8
  v_mfma_f32_16x16x32_bf16 v[44:47], a[8:11], a[124:127], v[44:47]
  ds_read_b64_tr_b16 a[68:69], v225 offset:50208
  v_mfma_f32_16x16x32_bf16 v[60:63], a[12:15], a[124:127], v[60:63]
  ds_read_b64_tr_b16 a[70:71], v225 offset:53792
  v_mfma_f32_16x16x32_bf16 v[56:59], a[12:15], a[120:123], v[56:59]
  ds_read_b64_tr_b16 a[72:73], v225 offset:35904
  v_mfma_f32_16x16x32_bf16 v[52:55], a[12:15], a[116:119], v[52:55]
  s_mul_i32 s62, s62, 2048
  v_mfma_f32_16x16x32_bf16 v[48:51], a[12:15], a[112:115], v[48:51]
  ds_read_b64_tr_b16 a[74:75], v225 offset:39488
  v_mfma_f32_16x16x32_bf16 v[64:67], a[16:19], a[112:115], v[64:67]
  v_mfma_f32_16x16x32_bf16 v[68:71], a[16:19], a[116:119], v[68:71]
  ds_read_b64_tr_b16 a[76:77], v225 offset:50240
  v_mfma_f32_16x16x32_bf16 v[72:75], a[16:19], a[120:123], v[72:75]
  buffer_load_dwordx4 a[176:179], v233, s[36:39], s62 offen offset:0 sc1
  v_mfma_f32_16x16x32_bf16 v[76:79], a[16:19], a[124:127], v[76:79]
  ds_read_b64_tr_b16 a[78:79], v225 offset:53824
  v_mfma_f32_16x16x32_bf16 v[92:95], a[20:23], a[124:127], v[92:95]
  ds_read_b64_tr_b16 a[80:81], v225 offset:35936
  v_mfma_f32_16x16x32_bf16 v[88:91], a[20:23], a[120:123], v[88:91]
  v_mfma_f32_16x16x32_bf16 v[84:87], a[20:23], a[116:119], v[84:87]
  s_add_u32 m0, s68, 4096
  v_mfma_f32_16x16x32_bf16 v[80:83], a[20:23], a[112:115], v[80:83]
  ds_read_b64_tr_b16 a[82:83], v225 offset:39520
  v_mfma_f32_16x16x32_bf16 v[96:99], a[24:27], a[112:115], v[96:99]
  ds_read_b64_tr_b16 a[84:85], v225 offset:50272
  v_mfma_f32_16x16x32_bf16 v[100:103], a[24:27], a[116:119], v[100:103]
  ds_read_b64_tr_b16 a[86:87], v225 offset:53856
  v_mfma_f32_16x16x32_bf16 v[104:107], a[24:27], a[120:123], v[104:107]
  buffer_load_dwordx4 v230, s[64:67], s70 offen lds
  v_mfma_f32_16x16x32_bf16 v[108:111], a[24:27], a[124:127], v[108:111]
  ds_read_b64_tr_b16 a[88:89], v225 offset:35968
  v_mfma_f32_16x16x32_bf16 v[124:127], a[28:31], a[124:127], v[124:127]
  v_mfma_f32_16x16x32_bf16 v[120:123], a[28:31], a[120:123], v[120:123]
  ds_read_b64_tr_b16 a[90:91], v225 offset:39552
  v_mfma_f32_16x16x32_bf16 v[116:119], a[28:31], a[116:119], v[116:119]
  buffer_load_dwordx4 a[180:183], v234, s[36:39], s62 offen offset:0 sc1
  v_mfma_f32_16x16x32_bf16 v[112:115], a[28:31], a[112:115], v[112:115]
  ds_read_b64_tr_b16 a[92:93], v225 offset:50304
  v_mfma_f32_16x16x32_bf16 v[128:131], a[32:35], a[112:115], v[128:131]
  ds_read_b64_tr_b16 a[94:95], v225 offset:53888
  v_mfma_f32_16x16x32_bf16 v[132:135], a[32:35], a[116:119], v[132:135]
  v_mfma_f32_16x16x32_bf16 v[136:139], a[32:35], a[120:123], v[136:139]
  v_mfma_f32_16x16x32_bf16 v[140:143], a[32:35], a[124:127], v[140:143]
  ds_read_b64_tr_b16 a[96:97], v225 offset:36000
  v_mfma_f32_16x16x32_bf16 v[156:159], a[36:39], a[124:127], v[156:159]
  ds_read_b64_tr_b16 a[98:99], v225 offset:39584
  v_mfma_f32_16x16x32_bf16 v[152:155], a[36:39], a[120:123], v[152:155]
  ds_read_b64_tr_b16 a[100:101], v225 offset:50336
  v_mfma_f32_16x16x32_bf16 v[148:151], a[36:39], a[116:119], v[148:151]
  buffer_load_dwordx4 v231, s[64:67], s70 offen offset:1024 lds
  v_mfma_f32_16x16x32_bf16 v[144:147], a[36:39], a[112:115], v[144:147]
  ds_read_b64_tr_b16 a[102:103], v225 offset:53920
  v_mfma_f32_16x16x32_bf16 v[160:163], a[40:43], a[112:115], v[160:163]
  v_mfma_f32_16x16x32_bf16 v[164:167], a[40:43], a[116:119], v[164:167]
  ds_read_b64_tr_b16 a[104:105], v225 offset:36032
  v_mfma_f32_16x16x32_bf16 v[168:171], a[40:43], a[120:123], v[168:171]
  buffer_load_dwordx4 a[184:187], v235, s[36:39], s62 offen offset:0 sc1
  v_mfma_f32_16x16x32_bf16 v[172:175], a[40:43], a[124:127], v[172:175]
  ds_read_b64_tr_b16 a[106:107], v225 offset:39616
  v_mfma_f32_16x16x32_bf16 v[188:191], a[44:47], a[124:127], v[188:191]
  ds_read_b64_tr_b16 a[108:109], v225 offset:50368
  v_mfma_f32_16x16x32_bf16 v[184:187], a[44:47], a[120:123], v[184:187]
  v_mfma_f32_16x16x32_bf16 v[180:183], a[44:47], a[116:119], v[180:183]
  v_mfma_f32_16x16x32_bf16 v[176:179], a[44:47], a[112:115], v[176:179]
  ds_read_b64_tr_b16 a[110:111], v225 offset:53952
  v_mfma_f32_16x16x32_bf16 v[192:195], a[48:51], a[112:115], v[192:195]
  v_mfma_f32_16x16x32_bf16 v[196:199], a[48:51], a[116:119], v[196:199]
  v_mfma_f32_16x16x32_bf16 v[200:203], a[48:51], a[120:123], v[200:203]
  buffer_load_dwordx4 v232, s[64:67], s70 offen offset:2048 lds
  v_mfma_f32_16x16x32_bf16 v[204:207], a[48:51], a[124:127], v[204:207]
  v_mfma_f32_16x16x32_bf16 v[220:223], a[52:55], a[124:127], v[220:223]
  v_mfma_f32_16x16x32_bf16 v[216:219], a[52:55], a[120:123], v[216:219]
  v_mfma_f32_16x16x32_bf16 v[212:215], a[52:55], a[116:119], v[212:215]
  buffer_load_dwordx4 a[188:191], v236, s[36:39], s62 offen offset:0 sc1
  v_mfma_f32_16x16x32_bf16 v[208:211], a[52:55], a[112:115], v[208:211]
  s_waitcnt vmcnt(24) lgkmcnt(0)
  v_mfma_f32_16x16x32_bf16 v[0:3], a[56:59], a[128:131], v[0:3]
  s_waitcnt vmcnt(32)
  s_barrier
  v_mfma_f32_16x16x32_bf16 v[4:7], a[56:59], a[132:135], v[4:7]
  ds_read_b64_tr_b16 a[0:1], v225 offset:0
  v_mfma_f32_16x16x32_bf16 v[8:11], a[56:59], a[136:139], v[8:11]
  ds_read_b64_tr_b16 a[2:3], v225 offset:3584
  v_mfma_f32_16x16x32_bf16 v[12:15], a[56:59], a[140:143], v[12:15]
  v_mfma_f32_16x16x32_bf16 v[28:31], a[60:63], a[140:143], v[28:31]
  ds_read_b64_tr_b16 a[4:5], v225 offset:14336
  v_mfma_f32_16x16x32_bf16 v[24:27], a[60:63], a[136:139], v[24:27]
  v_mfma_f32_16x16x32_bf16 v[20:23], a[60:63], a[132:135], v[20:23]
  ds_read_b64_tr_b16 a[6:7], v225 offset:17920
  v_mfma_f32_16x16x32_bf16 v[16:19], a[60:63], a[128:131], v[16:19]
  ds_read_b64_tr_b16 a[8:9], v225 offset:32
  v_mfma_f32_16x16x32_bf16 v[32:35], a[64:67], a[128:131], v[32:35]
  buffer_load_dwordx4 a[192:195], v233, s[36:39], s62 offen offset:1024 sc1
  v_mfma_f32_16x16x32_bf16 v[36:39], a[64:67], a[132:135], v[36:39]
  ds_read_b64_tr_b16 a[10:11], v225 offset:3616
  v_mfma_f32_16x16x32_bf16 v[40:43], a[64:67], a[136:139], v[40:43]
  v_mfma_f32_16x16x32_bf16 v[44:47], a[64:67], a[140:143], v[44:47]
  ds_read_b64_tr_b16 a[12:13], v225 offset:14368
  v_mfma_f32_16x16x32_bf16 v[60:63], a[68:71], a[140:143], v[60:63]
  ds_read_b64_tr_b16 a[14:15], v225 offset:17952
  v_mfma_f32_16x16x32_bf16 v[56:59], a[68:71], a[136:139], v[56:59]
  v_mfma_f32_16x16x32_bf16 v[52:55], a[68:71], a[132:135], v[52:55]
  ds_read_b64_tr_b16 a[16:17], v225 offset:64
  v_mfma_f32_16x16x32_bf16 v[48:51], a[68:71], a[128:131], v[48:51]
  v_mfma_f32_16x16x32_bf16 v[64:67], a[72:75], a[128:131], v[64:67]
  ds_read_b64_tr_b16 a[18:19], v225 offset:3648
  v_mfma_f32_16x16x32_bf16 v[68:71], a[72:75], a[132:135], v[68:71]
  ds_read_b64_tr_b16 a[20:21], v225 offset:14400
  v_mfma_f32_16x16x32_bf16 v[72:75], a[72:75], a[136:139], v[72:75]
  v_mfma_f32_16x16x32_bf16 v[76:79], a[72:75], a[140:143], v[76:79]
  ds_read_b64_tr_b16 a[22:23], v225 offset:17984
  v_mfma_f32_16x16x32_bf16 v[92:95], a[76:79], a[140:143], v[92:95]
  v_mfma_f32_16x16x32_bf16 v[88:91], a[76:79], a[136:139], v[88:91]
  ds_read_b64_tr_b16 a[24:25], v225 offset:96
  v_mfma_f32_16x16x32_bf16 v[84:87], a[76:79], a[132:135], v[84:87]
  buffer_load_dwordx4 a[196:199], v234, s[36:39], s62 offen offset:1024 sc1
  v_mfma_f32_16x16x32_bf16 v[80:83], a[76:79], a[128:131], v[80:83]
  ds_read_b64_tr_b16 a[26:27], v225 offset:3680
  v_mfma_f32_16x16x32_bf16 v[96:99], a[80:83], a[128:131], v[96:99]
  ds_read_b64_tr_b16 a[28:29], v225 offset:14432
  v_mfma_f32_16x16x32_bf16 v[100:103], a[80:83], a[132:135], v[100:103]
  v_mfma_f32_16x16x32_bf16 v[104:107], a[80:83], a[136:139], v[104:107]
  ds_read_b64_tr_b16 a[30:31], v225 offset:18016
  v_mfma_f32_16x16x32_bf16 v[108:111], a[80:83], a[140:143], v[108:111]
  ds_read_b64_tr_b16 a[32:33], v225 offset:128
  v_mfma_f32_16x16x32_bf16 v[124:127], a[84:87], a[140:143], v[124:127]
  v_mfma_f32_16x16x32_bf16 v[120:123], a[84:87], a[136:139], v[120:123]
  ds_read_b64_tr_b16 a[34:35], v225 offset:3712
  v_mfma_f32_16x16x32_bf16 v[116:119], a[84:87], a[132:135], v[116:119]
  v_mfma_f32_16x16x32_bf16 v[112:115], a[84:87], a[128:131], v[112:115]
  ds_read_b64_tr_b16 a[36:37], v225 offset:14464
  v_mfma_f32_16x16x32_bf16 v[128:131], a[88:91], a[128:131], v[128:131]
  ds_read_b64_tr_b16 a[38:39], v225 offset:18048
  v_mfma_f32_16x16x32_bf16 v[132:135], a[88:91], a[132:135], v[132:135]
  v_mfma_f32_16x16x32_bf16 v[136:139], a[88:91], a[136:139], v[136:139]
  ds_read_b64_tr_b16 a[40:41], v225 offset:160
  v_mfma_f32_16x16x32_bf16 v[140:143], a[88:91], a[140:143], v[140:143]
  buffer_load_dwordx4 a[200:203], v235, s[36:39], s62 offen offset:1024 sc1
  v_mfma_f32_16x16x32_bf16 v[156:159], a[92:95], a[140:143], v[156:159]
  ds_read_b64_tr_b16 a[42:43], v225 offset:3744
  v_mfma_f32_16x16x32_bf16 v[152:155], a[92:95], a[136:139], v[152:155]
  ds_read_b64_tr_b16 a[44:45], v225 offset:14496
  v_mfma_f32_16x16x32_bf16 v[148:151], a[92:95], a[132:135], v[148:151]
  v_mfma_f32_16x16x32_bf16 v[144:147], a[92:95], a[128:131], v[144:147]
  ds_read_b64_tr_b16 a[46:47], v225 offset:18080
  v_mfma_f32_16x16x32_bf16 v[160:163], a[96:99], a[128:131], v[160:163]
  v_mfma_f32_16x16x32_bf16 v[164:167], a[96:99], a[132:135], v[164:167]
  ds_read_b64_tr_b16 a[48:49], v225 offset:192
  v_mfma_f32_16x16x32_bf16 v[168:171], a[96:99], a[136:139], v[168:171]
  ds_read_b64_tr_b16 a[50:51], v225 offset:3776
  v_mfma_f32_16x16x32_bf16 v[172:175], a[96:99], a[140:143], v[172:175]
  v_mfma_f32_16x16x32_bf16 v[188:191], a[100:103], a[140:143], v[188:191]
  ds_read_b64_tr_b16 a[52:53], v225 offset:14528
  v_mfma_f32_16x16x32_bf16 v[184:187], a[100:103], a[136:139], v[184:187]
  v_mfma_f32_16x16x32_bf16 v[180:183], a[100:103], a[132:135], v[180:183]
  ds_read_b64_tr_b16 a[54:55], v225 offset:18112
  v_mfma_f32_16x16x32_bf16 v[176:179], a[100:103], a[128:131], v[176:179]
  v_mfma_f32_16x16x32_bf16 v[192:195], a[104:107], a[128:131], v[192:195]
  v_mfma_f32_16x16x32_bf16 v[196:199], a[104:107], a[132:135], v[196:199]
  buffer_load_dwordx4 a[204:207], v236, s[36:39], s62 offen offset:1024 sc1
  v_mfma_f32_16x16x32_bf16 v[200:203], a[104:107], a[136:139], v[200:203]
  v_mfma_f32_16x16x32_bf16 v[204:207], a[104:107], a[140:143], v[204:207]
  v_mfma_f32_16x16x32_bf16 v[220:223], a[108:111], a[140:143], v[220:223]
  v_mfma_f32_16x16x32_bf16 v[216:219], a[108:111], a[136:139], v[216:219]
  v_mfma_f32_16x16x32_bf16 v[212:215], a[108:111], a[132:135], v[212:215]
  v_mfma_f32_16x16x32_bf16 v[208:211], a[108:111], a[128:131], v[208:211]
  s_waitcnt vmcnt(20) lgkmcnt(0)
  v_mfma_f32_16x16x32_bf16 v[0:3], a[0:3], a[144:147], v[0:3]
  ds_read_b64_tr_b16 a[56:57], v225 offset:7168
  v_mfma_f32_16x16x32_bf16 v[4:7], a[0:3], a[148:151], v[4:7]
  ds_read_b64_tr_b16 a[58:59], v225 offset:10752
  v_mfma_f32_16x16x32_bf16 v[8:11], a[0:3], a[152:155], v[8:11]
  v_mfma_f32_16x16x32_bf16 v[12:15], a[0:3], a[156:159], v[12:15]
  ds_read_b64_tr_b16 a[60:61], v225 offset:21504
  v_mfma_f32_16x16x32_bf16 v[28:31], a[4:7], a[156:159], v[28:31]
  s_add_u32 s63, s20, 7
  v_mfma_f32_16x16x32_bf16 v[24:27], a[4:7], a[152:155], v[24:27]
  ds_read_b64_tr_b16 a[62:63], v225 offset:25088
  v_mfma_f32_16x16x32_bf16 v[20:23], a[4:7], a[148:151], v[20:23]
  ds_read_b64_tr_b16 a[64:65], v225 offset:7200
  v_mfma_f32_16x16x32_bf16 v[16:19], a[4:7], a[144:147], v[16:19]
  v_mfma_f32_16x16x32_bf16 v[32:35], a[8:11], a[144:147], v[32:35]
  ds_read_b64_tr_b16 a[66:67], v225 offset:10784
  v_mfma_f32_16x16x32_bf16 v[36:39], a[8:11], a[148:151], v[36:39]
  v_mfma_f32_16x16x32_bf16 v[40:43], a[8:11], a[152:155], v[40:43]
  ds_read_b64_tr_b16 a[68:69], v225 offset:21536
  v_mfma_f32_16x16x32_bf16 v[44:47], a[8:11], a[156:159], v[44:47]
  s_and_b32 s63, s63, 7
  v_mfma_f32_16x16x32_bf16 v[60:63], a[12:15], a[156:159], v[60:63]
  ds_read_b64_tr_b16 a[70:71], v225 offset:25120
  v_mfma_f32_16x16x32_bf16 v[56:59], a[12:15], a[152:155], v[56:59]
  ds_read_b64_tr_b16 a[72:73], v225 offset:7232
  v_mfma_f32_16x16x32_bf16 v[52:55], a[12:15], a[148:151], v[52:55]
  v_mfma_f32_16x16x32_bf16 v[48:51], a[12:15], a[144:147], v[48:51]
  ds_read_b64_tr_b16 a[74:75], v225 offset:10816
  v_mfma_f32_16x16x32_bf16 v[64:67], a[16:19], a[144:147], v[64:67]
  v_mfma_f32_16x16x32_bf16 v[68:71], a[16:19], a[148:151], v[68:71]
  ds_read_b64_tr_b16 a[76:77], v225 offset:21568
  v_mfma_f32_16x16x32_bf16 v[72:75], a[16:19], a[152:155], v[72:75]
  s_add_u32 s63, s63, 8
  v_mfma_f32_16x16x32_bf16 v[76:79], a[16:19], a[156:159], v[76:79]
  ds_read_b64_tr_b16 a[78:79], v225 offset:25152
  v_mfma_f32_16x16x32_bf16 v[92:95], a[20:23], a[156:159], v[92:95]
  ds_read_b64_tr_b16 a[80:81], v225 offset:7264
  v_mfma_f32_16x16x32_bf16 v[88:91], a[20:23], a[152:155], v[88:91]
  v_mfma_f32_16x16x32_bf16 v[84:87], a[20:23], a[148:151], v[84:87]
  ds_read_b64_tr_b16 a[82:83], v225 offset:10848
  v_mfma_f32_16x16x32_bf16 v[80:83], a[20:23], a[144:147], v[80:83]
  v_mfma_f32_16x16x32_bf16 v[96:99], a[24:27], a[144:147], v[96:99]
  ds_read_b64_tr_b16 a[84:85], v225 offset:21600
  v_mfma_f32_16x16x32_bf16 v[100:103], a[24:27], a[148:151], v[100:103]
  s_mul_i32 s63, s63, 2048
  v_mfma_f32_16x16x32_bf16 v[104:107], a[24:27], a[152:155], v[104:107]
  ds_read_b64_tr_b16 a[86:87], v225 offset:25184
  v_mfma_f32_16x16x32_bf16 v[108:111], a[24:27], a[156:159], v[108:111]
  ds_read_b64_tr_b16 a[88:89], v225 offset:7296
  v_mfma_f32_16x16x32_bf16 v[124:127], a[28:31], a[156:159], v[124:127]
  v_mfma_f32_16x16x32_bf16 v[120:123], a[28:31], a[152:155], v[120:123]
  ds_read_b64_tr_b16 a[90:91], v225 offset:10880
  v_mfma_f32_16x16x32_bf16 v[116:119], a[28:31], a[148:151], v[116:119]
  ds_read_b64_tr_b16 a[92:93], v225 offset:21632
  v_mfma_f32_16x16x32_bf16 v[112:115], a[28:31], a[144:147], v[112:115]
  buffer_load_dwordx4 a[208:211], v233, s[36:39], s63 offen offset:0 sc1
  v_mfma_f32_16x16x32_bf16 v[128:131], a[32:35], a[144:147], v[128:131]
  ds_read_b64_tr_b16 a[94:95], v225 offset:25216
  v_mfma_f32_16x16x32_bf16 v[132:135], a[32:35], a[148:151], v[132:135]
  v_mfma_f32_16x16x32_bf16 v[136:139], a[32:35], a[152:155], v[136:139]
  ds_read_b64_tr_b16 a[96:97], v225 offset:7328
  v_mfma_f32_16x16x32_bf16 v[140:143], a[32:35], a[156:159], v[140:143]
  v_mfma_f32_16x16x32_bf16 v[156:159], a[36:39], a[156:159], v[156:159]
  ds_read_b64_tr_b16 a[98:99], v225 offset:10912
  v_mfma_f32_16x16x32_bf16 v[152:155], a[36:39], a[152:155], v[152:155]
  ds_read_b64_tr_b16 a[100:101], v225 offset:21664
  v_mfma_f32_16x16x32_bf16 v[148:151], a[36:39], a[148:151], v[148:151]
  buffer_load_dwordx4 a[212:215], v234, s[36:39], s63 offen offset:0 sc1
  v_mfma_f32_16x16x32_bf16 v[144:147], a[36:39], a[144:147], v[144:147]
  ds_read_b64_tr_b16 a[102:103], v225 offset:25248
  v_mfma_f32_16x16x32_bf16 v[160:163], a[40:43], a[144:147], v[160:163]
  v_mfma_f32_16x16x32_bf16 v[164:167], a[40:43], a[148:151], v[164:167]
  ds_read_b64_tr_b16 a[104:105], v225 offset:7360
  v_mfma_f32_16x16x32_bf16 v[168:171], a[40:43], a[152:155], v[168:171]
  ds_read_b64_tr_b16 a[106:107], v225 offset:10944
  v_mfma_f32_16x16x32_bf16 v[172:175], a[40:43], a[156:159], v[172:175]
  v_mfma_f32_16x16x32_bf16 v[188:191], a[44:47], a[156:159], v[188:191]
  ds_read_b64_tr_b16 a[108:109], v225 offset:21696
  v_mfma_f32_16x16x32_bf16 v[184:187], a[44:47], a[152:155], v[184:187]
  buffer_load_dwordx4 a[216:219], v235, s[36:39], s63 offen offset:0 sc1
  v_mfma_f32_16x16x32_bf16 v[180:183], a[44:47], a[148:151], v[180:183]
  ds_read_b64_tr_b16 a[110:111], v225 offset:25280
  v_mfma_f32_16x16x32_bf16 v[176:179], a[44:47], a[144:147], v[176:179]
  v_mfma_f32_16x16x32_bf16 v[192:195], a[48:51], a[144:147], v[192:195]
  v_mfma_f32_16x16x32_bf16 v[196:199], a[48:51], a[148:151], v[196:199]
  v_mfma_f32_16x16x32_bf16 v[200:203], a[48:51], a[152:155], v[200:203]
  v_mfma_f32_16x16x32_bf16 v[204:207], a[48:51], a[156:159], v[204:207]
  v_mfma_f32_16x16x32_bf16 v[220:223], a[52:55], a[156:159], v[220:223]
  buffer_load_dwordx4 a[220:223], v236, s[36:39], s63 offen offset:0 sc1
  v_mfma_f32_16x16x32_bf16 v[216:219], a[52:55], a[152:155], v[216:219]
  v_mfma_f32_16x16x32_bf16 v[212:215], a[52:55], a[148:151], v[212:215]
  v_mfma_f32_16x16x32_bf16 v[208:211], a[52:55], a[144:147], v[208:211]
  s_waitcnt vmcnt(16) lgkmcnt(0)
  v_mfma_f32_16x16x32_bf16 v[0:3], a[56:59], a[160:163], v[0:3]
  s_waitcnt vmcnt(25)
  s_barrier
  v_mfma_f32_16x16x32_bf16 v[4:7], a[56:59], a[164:167], v[4:7]
  ds_read_b64_tr_b16 a[0:1], v224 offset:28672
  v_mfma_f32_16x16x32_bf16 v[8:11], a[56:59], a[168:171], v[8:11]
  buffer_load_dwordx4 a[224:227], v233, s[36:39], s63 offen offset:1024 sc1
  v_mfma_f32_16x16x32_bf16 v[12:15], a[56:59], a[172:175], v[12:15]
  ds_read_b64_tr_b16 a[2:3], v224 offset:32256
  v_mfma_f32_16x16x32_bf16 v[28:31], a[60:63], a[172:175], v[28:31]
  ds_read_b64_tr_b16 a[4:5], v224 offset:43008
  v_mfma_f32_16x16x32_bf16 v[24:27], a[60:63], a[168:171], v[24:27]
  buffer_load_dwordx4 a[228:231], v234, s[36:39], s63 offen offset:1024 sc1
  v_mfma_f32_16x16x32_bf16 v[20:23], a[60:63], a[164:167], v[20:23]
  ds_read_b64_tr_b16 a[6:7], v224 offset:46592
  v_mfma_f32_16x16x32_bf16 v[16:19], a[60:63], a[160:163], v[16:19]
  buffer_load_dwordx4 a[232:235], v235, s[36:39], s63 offen offset:1024 sc1
  v_mfma_f32_16x16x32_bf16 v[32:35], a[64:67], a[160:163], v[32:35]
  ds_read_b64_tr_b16 a[8:9], v224 offset:28704
  v_mfma_f32_16x16x32_bf16 v[36:39], a[64:67], a[164:167], v[36:39]
  ds_read_b64_tr_b16 a[10:11], v224 offset:32288
  v_mfma_f32_16x16x32_bf16 v[40:43], a[64:67], a[168:171], v[40:43]
  buffer_load_dwordx4 a[236:239], v236, s[36:39], s63 offen offset:1024 sc1
  v_mfma_f32_16x16x32_bf16 v[44:47], a[64:67], a[172:175], v[44:47]
  ds_read_b64_tr_b16 a[12:13], v224 offset:43040
  v_mfma_f32_16x16x32_bf16 v[60:63], a[68:71], a[172:175], v[60:63]
  s_lshl_b32 s80, s31, 2
  v_mfma_f32_16x16x32_bf16 v[56:59], a[68:71], a[168:171], v[56:59]
  ds_read_b64_tr_b16 a[14:15], v224 offset:46624
  v_mfma_f32_16x16x32_bf16 v[52:55], a[68:71], a[164:167], v[52:55]
  ds_read_b64_tr_b16 a[16:17], v224 offset:28736
  v_mfma_f32_16x16x32_bf16 v[48:51], a[68:71], a[160:163], v[48:51]
  s_add_u32 s80, s80, s3
  v_mfma_f32_16x16x32_bf16 v[64:67], a[72:75], a[160:163], v[64:67]
  ds_read_b64_tr_b16 a[18:19], v224 offset:32320
  v_mfma_f32_16x16x32_bf16 v[68:71], a[72:75], a[164:167], v[68:71]
  s_mul_i32 s80, s80, 14
  v_mfma_f32_16x16x32_bf16 v[72:75], a[72:75], a[168:171], v[72:75]
  ds_read_b64_tr_b16 a[20:21], v224 offset:43072
  v_mfma_f32_16x16x32_bf16 v[76:79], a[72:75], a[172:175], v[76:79]
  ds_read_b64_tr_b16 a[22:23], v224 offset:46656
  v_mfma_f32_16x16x32_bf16 v[92:95], a[76:79], a[172:175], v[92:95]
  s_add_u32 s80, s80, 0
  v_mfma_f32_16x16x32_bf16 v[88:91], a[76:79], a[168:171], v[88:91]
  ds_read_b64_tr_b16 a[24:25], v224 offset:28768
  v_mfma_f32_16x16x32_bf16 v[84:87], a[76:79], a[164:167], v[84:87]
  s_and_b32 s81, s30, 1
  v_mfma_f32_16x16x32_bf16 v[80:83], a[76:79], a[160:163], v[80:83]
  ds_read_b64_tr_b16 a[26:27], v224 offset:32352
  v_mfma_f32_16x16x32_bf16 v[96:99], a[80:83], a[160:163], v[96:99]
  ds_read_b64_tr_b16 a[28:29], v224 offset:43104
  v_mfma_f32_16x16x32_bf16 v[100:103], a[80:83], a[164:167], v[100:103]
  s_mul_i32 s81, s81, 1792
  v_mfma_f32_16x16x32_bf16 v[104:107], a[80:83], a[168:171], v[104:107]
  ds_read_b64_tr_b16 a[30:31], v224 offset:46688
  v_mfma_f32_16x16x32_bf16 v[108:111], a[80:83], a[172:175], v[108:111]
  s_add_u32 s80, s80, s81
  v_mfma_f32_16x16x32_bf16 v[124:127], a[84:87], a[172:175], v[124:127]
  ds_read_b64_tr_b16 a[32:33], v224 offset:28800
  v_mfma_f32_16x16x32_bf16 v[120:123], a[84:87], a[168:171], v[120:123]
  ds_read_b64_tr_b16 a[34:35], v224 offset:32384
  v_mfma_f32_16x16x32_bf16 v[116:119], a[84:87], a[164:167], v[116:119]
  s_lshl_b32 s80, s80, 11
  v_mfma_f32_16x16x32_bf16 v[112:115], a[84:87], a[160:163], v[112:115]
  ds_read_b64_tr_b16 a[36:37], v224 offset:43136
  v_mfma_f32_16x16x32_bf16 v[128:131], a[88:91], a[160:163], v[128:131]
  s_lshr_b32 s81, s30, 2
  v_mfma_f32_16x16x32_bf16 v[132:135], a[88:91], a[164:167], v[132:135]
  ds_read_b64_tr_b16 a[38:39], v224 offset:46720
  v_mfma_f32_16x16x32_bf16 v[136:139], a[88:91], a[168:171], v[136:139]
  ds_read_b64_tr_b16 a[40:41], v224 offset:28832
  v_mfma_f32_16x16x32_bf16 v[140:143], a[88:91], a[172:175], v[140:143]
  s_lshl_b32 s81, s81, 10
  v_mfma_f32_16x16x32_bf16 v[156:159], a[92:95], a[172:175], v[156:159]
  ds_read_b64_tr_b16 a[42:43], v224 offset:32416
  v_mfma_f32_16x16x32_bf16 v[152:155], a[92:95], a[168:171], v[152:155]
  s_add_u32 s80, s80, s81
  v_mfma_f32_16x16x32_bf16 v[148:151], a[92:95], a[164:167], v[148:151]
  ds_read_b64_tr_b16 a[44:45], v224 offset:43168
  v_mfma_f32_16x16x32_bf16 v[144:147], a[92:95], a[160:163], v[144:147]
  ds_read_b64_tr_b16 a[46:47], v224 offset:46752
  v_mfma_f32_16x16x32_bf16 v[160:163], a[96:99], a[160:163], v[160:163]
  v_min_u32 v253, 55, v237
  v_mfma_f32_16x16x32_bf16 v[164:167], a[96:99], a[164:167], v[164:167]
  ds_read_b64_tr_b16 a[48:49], v224 offset:28864
  v_mfma_f32_16x16x32_bf16 v[168:171], a[96:99], a[168:171], v[168:171]
  v_lshrrev_b32 v254, 3, v253
  v_mfma_f32_16x16x32_bf16 v[172:175], a[96:99], a[172:175], v[172:175]
  ds_read_b64_tr_b16 a[50:51], v224 offset:32448
  v_mfma_f32_16x16x32_bf16 v[188:191], a[100:103], a[172:175], v[188:191]
  ds_read_b64_tr_b16 a[52:53], v224 offset:43200
  v_mfma_f32_16x16x32_bf16 v[184:187], a[100:103], a[168:171], v[184:187]
  v_lshlrev_b32 v254, 11, v254
  v_mfma_f32_16x16x32_bf16 v[180:183], a[100:103], a[164:167], v[180:183]
  ds_read_b64_tr_b16 a[54:55], v224 offset:46784
  v_mfma_f32_16x16x32_bf16 v[176:179], a[100:103], a[160:163], v[176:179]
  v_and_b32 v253, 7, v253
  v_mfma_f32_16x16x32_bf16 v[192:195], a[104:107], a[160:163], v[192:195]
  v_mfma_f32_16x16x32_bf16 v[196:199], a[104:107], a[164:167], v[196:199]
  v_lshl_add_u32 v253, v253, 7, v254
  v_mfma_f32_16x16x32_bf16 v[200:203], a[104:107], a[168:171], v[200:203]
  v_mfma_f32_16x16x32_bf16 v[204:207], a[104:107], a[172:175], v[204:207]
  v_mfma_f32_16x16x32_bf16 v[220:223], a[108:111], a[172:175], v[220:223]
  v_add_u32 v253, s80, v253
  v_mfma_f32_16x16x32_bf16 v[216:219], a[108:111], a[168:171], v[216:219]
  v_mfma_f32_16x16x32_bf16 v[212:215], a[108:111], a[164:167], v[212:215]
  global_load_dword v240, v253, s[18:19]
  v_mfma_f32_16x16x32_bf16 v[208:211], a[108:111], a[160:163], v[208:211]
  s_waitcnt vmcnt(13) lgkmcnt(0)
  v_mfma_f32_16x16x32_bf16 v[0:3], a[0:3], a[176:179], v[0:3]
  ds_read_b64_tr_b16 a[56:57], v224 offset:35840
  v_mfma_f32_16x16x32_bf16 v[4:7], a[0:3], a[180:183], v[4:7]
  s_lshl_b32 s80, s31, 2
  v_mfma_f32_16x16x32_bf16 v[8:11], a[0:3], a[184:187], v[8:11]
  ds_read_b64_tr_b16 a[58:59], v224 offset:39424
  v_mfma_f32_16x16x32_bf16 v[12:15], a[0:3], a[188:191], v[12:15]
  ds_read_b64_tr_b16 a[60:61], v224 offset:50176
  v_mfma_f32_16x16x32_bf16 v[28:31], a[4:7], a[188:191], v[28:31]
  s_add_u32 s80, s80, s3
  v_mfma_f32_16x16x32_bf16 v[24:27], a[4:7], a[184:187], v[24:27]
  ds_read_b64_tr_b16 a[62:63], v224 offset:53760
  v_mfma_f32_16x16x32_bf16 v[20:23], a[4:7], a[180:183], v[20:23]
  ds_read_b64_tr_b16 a[64:65], v224 offset:35872
  v_mfma_f32_16x16x32_bf16 v[16:19], a[4:7], a[176:179], v[16:19]
  s_mul_i32 s80, s80, 14
  v_mfma_f32_16x16x32_bf16 v[32:35], a[8:11], a[176:179], v[32:35]
  ds_read_b64_tr_b16 a[66:67], v224 offset:39456
  v_mfma_f32_16x16x32_bf16 v[36:39], a[8:11], a[180:183], v[36:39]
  v_mfma_f32_16x16x32_bf16 v[40:43], a[8:11], a[184:187], v[40:43]
  ds_read_b64_tr_b16 a[68:69], v224 offset:50208
  v_mfma_f32_16x16x32_bf16 v[44:47], a[8:11], a[188:191], v[44:47]
  s_add_u32 s80, s80, 7
  v_mfma_f32_16x16x32_bf16 v[60:63], a[12:15], a[188:191], v[60:63]
  ds_read_b64_tr_b16 a[70:71], v224 offset:53792
  v_mfma_f32_16x16x32_bf16 v[56:59], a[12:15], a[184:187], v[56:59]
  ds_read_b64_tr_b16 a[72:73], v224 offset:35904
  v_mfma_f32_16x16x32_bf16 v[52:55], a[12:15], a[180:183], v[52:55]
  s_and_b32 s81, s30, 1
  v_mfma_f32_16x16x32_bf16 v[48:51], a[12:15], a[176:179], v[48:51]
  ds_read_b64_tr_b16 a[74:75], v224 offset:39488
  v_mfma_f32_16x16x32_bf16 v[64:67], a[16:19], a[176:179], v[64:67]
  v_mfma_f32_16x16x32_bf16 v[68:71], a[16:19], a[180:183], v[68:71]
  s_mul_i32 s81, s81, 1792
  v_mfma_f32_16x16x32_bf16 v[72:75], a[16:19], a[184:187], v[72:75]
  ds_read_b64_tr_b16 a[76:77], v224 offset:50240
  v_mfma_f32_16x16x32_bf16 v[76:79], a[16:19], a[188:191], v[76:79]
  ds_read_b64_tr_b16 a[78:79], v224 offset:53824
  v_mfma_f32_16x16x32_bf16 v[92:95], a[20:23], a[188:191], v[92:95]
  s_add_u32 s80, s80, s81
  v_mfma_f32_16x16x32_bf16 v[88:91], a[20:23], a[184:187], v[88:91]
  ds_read_b64_tr_b16 a[80:81], v224 offset:35936
  v_mfma_f32_16x16x32_bf16 v[84:87], a[20:23], a[180:183], v[84:87]
  ds_read_b64_tr_b16 a[82:83], v224 offset:39520
  v_mfma_f32_16x16x32_bf16 v[80:83], a[20:23], a[176:179], v[80:83]
  s_lshl_b32 s80, s80, 11
  v_mfma_f32_16x16x32_bf16 v[96:99], a[24:27], a[176:179], v[96:99]
  ds_read_b64_tr_b16 a[84:85], v224 offset:50272
  v_mfma_f32_16x16x32_bf16 v[100:103], a[24:27], a[180:183], v[100:103]
  ds_read_b64_tr_b16 a[86:87], v224 offset:53856
  v_mfma_f32_16x16x32_bf16 v[104:107], a[24:27], a[184:187], v[104:107]
  s_lshr_b32 s81, s30, 2
  v_mfma_f32_16x16x32_bf16 v[108:111], a[24:27], a[188:191], v[108:111]
  ds_read_b64_tr_b16 a[88:89], v224 offset:35968
  v_mfma_f32_16x16x32_bf16 v[124:127], a[28:31], a[188:191], v[124:127]
  v_mfma_f32_16x16x32_bf16 v[120:123], a[28:31], a[184:187], v[120:123]
  ds_read_b64_tr_b16 a[90:91], v224 offset:39552
  v_mfma_f32_16x16x32_bf16 v[116:119], a[28:31], a[180:183], v[116:119]
  s_lshl_b32 s81, s81, 10
  v_mfma_f32_16x16x32_bf16 v[112:115], a[28:31], a[176:179], v[112:115]
  ds_read_b64_tr_b16 a[92:93], v224 offset:50304
  v_mfma_f32_16x16x32_bf16 v[128:131], a[32:35], a[176:179], v[128:131]
  ds_read_b64_tr_b16 a[94:95], v224 offset:53888
  v_mfma_f32_16x16x32_bf16 v[132:135], a[32:35], a[180:183], v[132:135]
  s_add_u32 s80, s80, s81
  v_mfma_f32_16x16x32_bf16 v[136:139], a[32:35], a[184:187], v[136:139]
  ds_read_b64_tr_b16 a[96:97], v224 offset:36000
  v_mfma_f32_16x16x32_bf16 v[140:143], a[32:35], a[188:191], v[140:143]
  v_min_u32 v253, 55, v237
  v_mfma_f32_16x16x32_bf16 v[156:159], a[36:39], a[188:191], v[156:159]
  ds_read_b64_tr_b16 a[98:99], v224 offset:39584
  v_mfma_f32_16x16x32_bf16 v[152:155], a[36:39], a[184:187], v[152:155]
  ds_read_b64_tr_b16 a[100:101], v224 offset:50336
  v_mfma_f32_16x16x32_bf16 v[148:151], a[36:39], a[180:183], v[148:151]
  v_lshrrev_b32 v254, 3, v253
  v_mfma_f32_16x16x32_bf16 v[144:147], a[36:39], a[176:179], v[144:147]
  ds_read_b64_tr_b16 a[102:103], v224 offset:53920
  v_mfma_f32_16x16x32_bf16 v[160:163], a[40:43], a[176:179], v[160:163]
  v_mfma_f32_16x16x32_bf16 v[164:167], a[40:43], a[180:183], v[164:167]
  ds_read_b64_tr_b16 a[104:105], v224 offset:36032
  v_mfma_f32_16x16x32_bf16 v[168:171], a[40:43], a[184:187], v[168:171]
  v_lshlrev_b32 v254, 11, v254
  v_mfma_f32_16x16x32_bf16 v[172:175], a[40:43], a[188:191], v[172:175]
  ds_read_b64_tr_b16 a[106:107], v224 offset:39616
  v_mfma_f32_16x16x32_bf16 v[188:191], a[44:47], a[188:191], v[188:191]
  ds_read_b64_tr_b16 a[108:109], v224 offset:50368
  v_mfma_f32_16x16x32_bf16 v[184:187], a[44:47], a[184:187], v[184:187]
  v_and_b32 v253, 7, v253
  v_mfma_f32_16x16x32_bf16 v[180:183], a[44:47], a[180:183], v[180:183]
  ds_read_b64_tr_b16 a[110:111], v224 offset:53952
  v_mfma_f32_16x16x32_bf16 v[176:179], a[44:47], a[176:179], v[176:179]
  v_mfma_f32_16x16x32_bf16 v[192:195], a[48:51], a[176:179], v[192:195]
  v_lshl_add_u32 v253, v253, 7, v254
  v_mfma_f32_16x16x32_bf16 v[196:199], a[48:51], a[180:183], v[196:199]
  v_mfma_f32_16x16x32_bf16 v[200:203], a[48:51], a[184:187], v[200:203]
  v_mfma_f32_16x16x32_bf16 v[204:207], a[48:51], a[188:191], v[204:207]
  v_add_u32 v253, s80, v253
  v_mfma_f32_16x16x32_bf16 v[220:223], a[52:55], a[188:191], v[220:223]
  v_mfma_f32_16x16x32_bf16 v[216:219], a[52:55], a[184:187], v[216:219]
  v_mfma_f32_16x16x32_bf16 v[212:215], a[52:55], a[180:183], v[212:215]
  global_load_dword v240, v253, s[18:19]
  v_mfma_f32_16x16x32_bf16 v[208:211], a[52:55], a[176:179], v[208:211]
  s_waitcnt vmcnt(10) lgkmcnt(0)
  v_mfma_f32_16x16x32_bf16 v[0:3], a[56:59], a[192:195], v[0:3]
  s_waitcnt vmcnt(15)
  s_barrier
  v_mfma_f32_16x16x32_bf16 v[4:7], a[56:59], a[196:199], v[4:7]
  ds_read_b64_tr_b16 a[0:1], v224 offset:0
  v_mfma_f32_16x16x32_bf16 v[8:11], a[56:59], a[200:203], v[8:11]
  ds_read_b64_tr_b16 a[2:3], v224 offset:3584
  v_mfma_f32_16x16x32_bf16 v[12:15], a[56:59], a[204:207], v[12:15]
  s_add_u32 s61, s21, 0
  v_mfma_f32_16x16x32_bf16 v[28:31], a[60:63], a[204:207], v[28:31]
  ds_read_b64_tr_b16 a[4:5], v224 offset:14336
  v_mfma_f32_16x16x32_bf16 v[24:27], a[60:63], a[200:203], v[24:27]
  v_mfma_f32_16x16x32_bf16 v[20:23], a[60:63], a[196:199], v[20:23]
  ds_read_b64_tr_b16 a[6:7], v224 offset:17920
  v_mfma_f32_16x16x32_bf16 v[16:19], a[60:63], a[192:195], v[16:19]
  s_and_b32 s61, s61, 3
  v_mfma_f32_16x16x32_bf16 v[32:35], a[64:67], a[192:195], v[32:35]
  ds_read_b64_tr_b16 a[8:9], v224 offset:32
  v_mfma_f32_16x16x32_bf16 v[36:39], a[64:67], a[196:199], v[36:39]
  ds_read_b64_tr_b16 a[10:11], v224 offset:3616
  v_mfma_f32_16x16x32_bf16 v[40:43], a[64:67], a[200:203], v[40:43]
  s_and_b32 s75, s61, 1
  v_mfma_f32_16x16x32_bf16 v[44:47], a[64:67], a[204:207], v[44:47]
  ds_read_b64_tr_b16 a[12:13], v224 offset:14368
  v_mfma_f32_16x16x32_bf16 v[60:63], a[68:71], a[204:207], v[60:63]
  ds_read_b64_tr_b16 a[14:15], v224 offset:17952
  v_mfma_f32_16x16x32_bf16 v[56:59], a[68:71], a[200:203], v[56:59]
  s_and_b32 s61, s61, 6
  v_mfma_f32_16x16x32_bf16 v[52:55], a[68:71], a[196:199], v[52:55]
  ds_read_b64_tr_b16 a[16:17], v224 offset:64
  v_mfma_f32_16x16x32_bf16 v[48:51], a[68:71], a[192:195], v[48:51]
  v_mfma_f32_16x16x32_bf16 v[64:67], a[72:75], a[192:195], v[64:67]
  ds_read_b64_tr_b16 a[18:19], v224 offset:3648
  v_mfma_f32_16x16x32_bf16 v[68:71], a[72:75], a[196:199], v[68:71]
  s_lshl_b32 s61, s61, 1
  v_mfma_f32_16x16x32_bf16 v[72:75], a[72:75], a[200:203], v[72:75]
  ds_read_b64_tr_b16 a[20:21], v224 offset:14400
  v_mfma_f32_16x16x32_bf16 v[76:79], a[72:75], a[204:207], v[76:79]
  ds_read_b64_tr_b16 a[22:23], v224 offset:17984
  v_mfma_f32_16x16x32_bf16 v[92:95], a[76:79], a[204:207], v[92:95]
  s_mul_i32 s75, s75, 3
  v_mfma_f32_16x16x32_bf16 v[88:91], a[76:79], a[200:203], v[88:91]
  ds_read_b64_tr_b16 a[24:25], v224 offset:96
  v_mfma_f32_16x16x32_bf16 v[84:87], a[76:79], a[196:199], v[84:87]
  ds_read_b64_tr_b16 a[26:27], v224 offset:3680
  v_mfma_f32_16x16x32_bf16 v[80:83], a[76:79], a[192:195], v[80:83]
  s_add_u32 s61, s61, s75
  v_mfma_f32_16x16x32_bf16 v[96:99], a[80:83], a[192:195], v[96:99]
  ds_read_b64_tr_b16 a[28:29], v224 offset:14432
  v_mfma_f32_16x16x32_bf16 v[100:103], a[80:83], a[196:199], v[100:103]
  v_mfma_f32_16x16x32_bf16 v[104:107], a[80:83], a[200:203], v[104:107]
  ds_read_b64_tr_b16 a[30:31], v224 offset:18016
  v_mfma_f32_16x16x32_bf16 v[108:111], a[80:83], a[204:207], v[108:111]
  s_mul_i32 s61, s61, 229376
  v_mfma_f32_16x16x32_bf16 v[124:127], a[84:87], a[204:207], v[124:127]
  ds_read_b64_tr_b16 a[32:33], v224 offset:128
  v_mfma_f32_16x16x32_bf16 v[120:123], a[84:87], a[200:203], v[120:123]
  ds_read_b64_tr_b16 a[34:35], v224 offset:3712
  v_mfma_f32_16x16x32_bf16 v[116:119], a[84:87], a[196:199], v[116:119]
  s_add_u32 m0, s76, 129792
  v_mfma_f32_16x16x32_bf16 v[112:115], a[84:87], a[192:195], v[112:115]
  ds_read_b64_tr_b16 a[36:37], v224 offset:14464
  v_mfma_f32_16x16x32_bf16 v[128:131], a[88:91], a[192:195], v[128:131]
  ds_read_b64_tr_b16 a[38:39], v224 offset:18048
  v_mfma_f32_16x16x32_bf16 v[132:135], a[88:91], a[196:199], v[132:135]
  buffer_load_dwordx4 v244, s[32:35], s61 offen lds
  v_mfma_f32_16x16x32_bf16 v[136:139], a[88:91], a[200:203], v[136:139]
  ds_read_b64_tr_b16 a[40:41], v224 offset:160
  v_mfma_f32_16x16x32_bf16 v[140:143], a[88:91], a[204:207], v[140:143]
  v_mfma_f32_16x16x32_bf16 v[156:159], a[92:95], a[204:207], v[156:159]
  ds_read_b64_tr_b16 a[42:43], v224 offset:3744
  v_mfma_f32_16x16x32_bf16 v[152:155], a[92:95], a[200:203], v[152:155]
  s_add_u32 m0, s76, 128800
  v_mfma_f32_16x16x32_bf16 v[148:151], a[92:95], a[196:199], v[148:151]
  ds_read_b64_tr_b16 a[44:45], v224 offset:14496
  v_mfma_f32_16x16x32_bf16 v[144:147], a[92:95], a[192:195], v[144:147]
  ds_read_b64_tr_b16 a[46:47], v224 offset:18080
  v_mfma_f32_16x16x32_bf16 v[160:163], a[96:99], a[192:195], v[160:163]
  buffer_load_dwordx4 v244, s[32:35], s61 offen offset:2048 lds
  v_mfma_f32_16x16x32_bf16 v[164:167], a[96:99], a[196:199], v[164:167]
  ds_read_b64_tr_b16 a[48:49], v224 offset:192
  v_mfma_f32_16x16x32_bf16 v[168:171], a[96:99], a[200:203], v[168:171]
  ds_read_b64_tr_b16 a[50:51], v224 offset:3776
  v_mfma_f32_16x16x32_bf16 v[172:175], a[96:99], a[204:207], v[172:175]
  s_add_u32 m0, s76, 138240
  v_mfma_f32_16x16x32_bf16 v[188:191], a[100:103], a[204:207], v[188:191]
  ds_read_b64_tr_b16 a[52:53], v224 offset:14528
  v_mfma_f32_16x16x32_bf16 v[184:187], a[100:103], a[200:203], v[184:187]
  v_mfma_f32_16x16x32_bf16 v[180:183], a[100:103], a[196:199], v[180:183]
  ds_read_b64_tr_b16 a[54:55], v224 offset:18112
  v_mfma_f32_16x16x32_bf16 v[176:179], a[100:103], a[192:195], v[176:179]
  buffer_load_dwordx4 v245, s[32:35], s61 offen lds
  v_mfma_f32_16x16x32_bf16 v[192:195], a[104:107], a[192:195], v[192:195]
  v_mfma_f32_16x16x32_bf16 v[196:199], a[104:107], a[196:199], v[196:199]
  v_mfma_f32_16x16x32_bf16 v[200:203], a[104:107], a[200:203], v[200:203]
  s_add_u32 m0, s76, 137248
  v_mfma_f32_16x16x32_bf16 v[204:207], a[104:107], a[204:207], v[204:207]
  v_mfma_f32_16x16x32_bf16 v[220:223], a[108:111], a[204:207], v[220:223]
  v_mfma_f32_16x16x32_bf16 v[216:219], a[108:111], a[200:203], v[216:219]
  v_mfma_f32_16x16x32_bf16 v[212:215], a[108:111], a[196:199], v[212:215]
  buffer_load_dwordx4 v245, s[32:35], s61 offen offset:2048 lds
  v_mfma_f32_16x16x32_bf16 v[208:211], a[108:111], a[192:195], v[208:211]
  s_waitcnt vmcnt(10) lgkmcnt(0)
  v_mfma_f32_16x16x32_bf16 v[0:3], a[0:3], a[208:211], v[0:3]
  ds_read_b64_tr_b16 a[56:57], v224 offset:7168
  v_mfma_f32_16x16x32_bf16 v[4:7], a[0:3], a[212:215], v[4:7]
  ds_read_b64_tr_b16 a[58:59], v224 offset:10752
  v_mfma_f32_16x16x32_bf16 v[8:11], a[0:3], a[216:219], v[8:11]
  s_add_u32 s60, s21, 1
  v_mfma_f32_16x16x32_bf16 v[12:15], a[0:3], a[220:223], v[12:15]
  ds_read_b64_tr_b16 a[60:61], v224 offset:21504
  v_mfma_f32_16x16x32_bf16 v[28:31], a[4:7], a[220:223], v[28:31]
  v_mfma_f32_16x16x32_bf16 v[24:27], a[4:7], a[216:219], v[24:27]
  ds_read_b64_tr_b16 a[62:63], v224 offset:25088
  v_mfma_f32_16x16x32_bf16 v[20:23], a[4:7], a[212:215], v[20:23]
  s_and_b32 s60, s60, 3
  v_mfma_f32_16x16x32_bf16 v[16:19], a[4:7], a[208:211], v[16:19]
  ds_read_b64_tr_b16 a[64:65], v224 offset:7200
  v_mfma_f32_16x16x32_bf16 v[32:35], a[8:11], a[208:211], v[32:35]
  ds_read_b64_tr_b16 a[66:67], v224 offset:10784
  v_mfma_f32_16x16x32_bf16 v[36:39], a[8:11], a[212:215], v[36:39]
  s_and_b32 s75, s60, 1
  v_mfma_f32_16x16x32_bf16 v[40:43], a[8:11], a[216:219], v[40:43]
  ds_read_b64_tr_b16 a[68:69], v224 offset:21536
  v_mfma_f32_16x16x32_bf16 v[44:47], a[8:11], a[220:223], v[44:47]
  v_mfma_f32_16x16x32_bf16 v[60:63], a[12:15], a[220:223], v[60:63]
  ds_read_b64_tr_b16 a[70:71], v224 offset:25120
  v_mfma_f32_16x16x32_bf16 v[56:59], a[12:15], a[216:219], v[56:59]
  s_and_b32 s60, s60, 6
  v_mfma_f32_16x16x32_bf16 v[52:55], a[12:15], a[212:215], v[52:55]
  ds_read_b64_tr_b16 a[72:73], v224 offset:7232
  v_mfma_f32_16x16x32_bf16 v[48:51], a[12:15], a[208:211], v[48:51]
  ds_read_b64_tr_b16 a[74:75], v224 offset:10816
  v_mfma_f32_16x16x32_bf16 v[64:67], a[16:19], a[208:211], v[64:67]
  s_lshl_b32 s60, s60, 1
  v_mfma_f32_16x16x32_bf16 v[68:71], a[16:19], a[212:215], v[68:71]
  ds_read_b64_tr_b16 a[76:77], v224 offset:21568
  v_mfma_f32_16x16x32_bf16 v[72:75], a[16:19], a[216:219], v[72:75]
  ds_read_b64_tr_b16 a[78:79], v224 offset:25152
  v_mfma_f32_16x16x32_bf16 v[76:79], a[16:19], a[220:223], v[76:79]
  s_mul_i32 s75, s75, 3
  v_mfma_f32_16x16x32_bf16 v[92:95], a[20:23], a[220:223], v[92:95]
  ds_read_b64_tr_b16 a[80:81], v224 offset:7264
  v_mfma_f32_16x16x32_bf16 v[88:91], a[20:23], a[216:219], v[88:91]
  v_mfma_f32_16x16x32_bf16 v[84:87], a[20:23], a[212:215], v[84:87]
  ds_read_b64_tr_b16 a[82:83], v224 offset:10848
  v_mfma_f32_16x16x32_bf16 v[80:83], a[20:23], a[208:211], v[80:83]
  s_add_u32 s60, s60, s75
  v_mfma_f32_16x16x32_bf16 v[96:99], a[24:27], a[208:211], v[96:99]
  ds_read_b64_tr_b16 a[84:85], v224 offset:21600
  v_mfma_f32_16x16x32_bf16 v[100:103], a[24:27], a[212:215], v[100:103]
  ds_read_b64_tr_b16 a[86:87], v224 offset:25184
  v_mfma_f32_16x16x32_bf16 v[104:107], a[24:27], a[216:219], v[104:107]
  s_mul_i32 s60, s60, 229376
  v_mfma_f32_16x16x32_bf16 v[108:111], a[24:27], a[220:223], v[108:111]
  ds_read_b64_tr_b16 a[88:89], v224 offset:7296
  v_mfma_f32_16x16x32_bf16 v[124:127], a[28:31], a[220:223], v[124:127]
  v_mfma_f32_16x16x32_bf16 v[120:123], a[28:31], a[216:219], v[120:123]
  ds_read_b64_tr_b16 a[90:91], v224 offset:10880
  v_mfma_f32_16x16x32_bf16 v[116:119], a[28:31], a[212:215], v[116:119]
  s_add_u32 m0, s76, 146688
  v_mfma_f32_16x16x32_bf16 v[112:115], a[28:31], a[208:211], v[112:115]
  ds_read_b64_tr_b16 a[92:93], v224 offset:21632
  v_mfma_f32_16x16x32_bf16 v[128:131], a[32:35], a[208:211], v[128:131]
  ds_read_b64_tr_b16 a[94:95], v224 offset:25216
  v_mfma_f32_16x16x32_bf16 v[132:135], a[32:35], a[212:215], v[132:135]
  buffer_load_dwordx4 v244, s[32:35], s60 offen lds
  v_mfma_f32_16x16x32_bf16 v[136:139], a[32:35], a[216:219], v[136:139]
  ds_read_b64_tr_b16 a[96:97], v224 offset:7328
  v_mfma_f32_16x16x32_bf16 v[140:143], a[32:35], a[220:223], v[140:143]
  v_mfma_f32_16x16x32_bf16 v[156:159], a[36:39], a[220:223], v[156:159]
  ds_read_b64_tr_b16 a[98:99], v224 offset:10912
  v_mfma_f32_16x16x32_bf16 v[152:155], a[36:39], a[216:219], v[152:155]
  s_add_u32 m0, s76, 145696
  v_mfma_f32_16x16x32_bf16 v[148:151], a[36:39], a[212:215], v[148:151]
  ds_read_b64_tr_b16 a[100:101], v224 offset:21664
  v_mfma_f32_16x16x32_bf16 v[144:147], a[36:39], a[208:211], v[144:147]
  ds_read_b64_tr_b16 a[102:103], v224 offset:25248
  v_mfma_f32_16x16x32_bf16 v[160:163], a[40:43], a[208:211], v[160:163]
  buffer_load_dwordx4 v244, s[32:35], s60 offen offset:2048 lds
  v_mfma_f32_16x16x32_bf16 v[164:167], a[40:43], a[212:215], v[164:167]
  ds_read_b64_tr_b16 a[104:105], v224 offset:7360
  v_mfma_f32_16x16x32_bf16 v[168:171], a[40:43], a[216:219], v[168:171]
  ds_read_b64_tr_b16 a[106:107], v224 offset:10944
  v_mfma_f32_16x16x32_bf16 v[172:175], a[40:43], a[220:223], v[172:175]
  s_add_u32 m0, s76, 155136
  v_mfma_f32_16x16x32_bf16 v[188:191], a[44:47], a[220:223], v[188:191]
  ds_read_b64_tr_b16 a[108:109], v224 offset:21696
  v_mfma_f32_16x16x32_bf16 v[184:187], a[44:47], a[216:219], v[184:187]
  v_mfma_f32_16x16x32_bf16 v[180:183], a[44:47], a[212:215], v[180:183]
  ds_read_b64_tr_b16 a[110:111], v224 offset:25280
  v_mfma_f32_16x16x32_bf16 v[176:179], a[44:47], a[208:211], v[176:179]
  buffer_load_dwordx4 v245, s[32:35], s60 offen lds
  v_mfma_f32_16x16x32_bf16 v[192:195], a[48:51], a[208:211], v[192:195]
  v_mfma_f32_16x16x32_bf16 v[196:199], a[48:51], a[212:215], v[196:199]
  v_mfma_f32_16x16x32_bf16 v[200:203], a[48:51], a[216:219], v[200:203]
  s_add_u32 m0, s76, 154144
  v_mfma_f32_16x16x32_bf16 v[204:207], a[48:51], a[220:223], v[204:207]
  v_mfma_f32_16x16x32_bf16 v[220:223], a[52:55], a[220:223], v[220:223]
  v_mfma_f32_16x16x32_bf16 v[216:219], a[52:55], a[216:219], v[216:219]
  v_mfma_f32_16x16x32_bf16 v[212:215], a[52:55], a[212:215], v[212:215]
  buffer_load_dwordx4 v245, s[32:35], s60 offen offset:2048 lds
  v_mfma_f32_16x16x32_bf16 v[208:211], a[52:55], a[208:211], v[208:211]
  s_waitcnt vmcnt(10) lgkmcnt(0)
  v_mfma_f32_16x16x32_bf16 v[0:3], a[56:59], a[224:227], v[0:3]
  v_add_u32 v250, s21, v248
  v_mfma_f32_16x16x32_bf16 v[4:7], a[56:59], a[228:231], v[4:7]
  v_mfma_f32_16x16x32_bf16 v[8:11], a[56:59], a[232:235], v[8:11]
  v_and_b32 v250, 3, v250
  v_mfma_f32_16x16x32_bf16 v[12:15], a[56:59], a[236:239], v[12:15]
  v_and_b32 v251, -4, v248
  v_mfma_f32_16x16x32_bf16 v[28:31], a[60:63], a[236:239], v[28:31]
  v_or_b32 v250, v250, v251
  v_mfma_f32_16x16x32_bf16 v[24:27], a[60:63], a[232:235], v[24:27]
  v_mfma_f32_16x16x32_bf16 v[20:23], a[60:63], a[228:231], v[20:23]
  v_add_u32 v251, s20, v248
  v_mfma_f32_16x16x32_bf16 v[16:19], a[60:63], a[224:227], v[16:19]
  v_and_b32 v251, 7, v251
  v_mfma_f32_16x16x32_bf16 v[32:35], a[64:67], a[224:227], v[32:35]
  v_mfma_f32_16x16x32_bf16 v[36:39], a[64:67], a[228:231], v[36:39]
  v_and_b32 v253, -8, v248
  v_mfma_f32_16x16x32_bf16 v[40:43], a[64:67], a[232:235], v[40:43]
  v_or_b32 v251, v251, v253
  v_mfma_f32_16x16x32_bf16 v[44:47], a[64:67], a[236:239], v[44:47]
  v_subrev_u32 v253, 8, v248
  v_mfma_f32_16x16x32_bf16 v[60:63], a[68:71], a[236:239], v[60:63]
  v_mfma_f32_16x16x32_bf16 v[56:59], a[68:71], a[232:235], v[56:59]
  v_cmp_gt_u32 vcc, 16, v253
  v_mfma_f32_16x16x32_bf16 v[52:55], a[68:71], a[228:231], v[52:55]
  s_nop 1
  v_mfma_f32_16x16x32_bf16 v[48:51], a[68:71], a[224:227], v[48:51]
  v_mfma_f32_16x16x32_bf16 v[64:67], a[72:75], a[224:227], v[64:67]
  v_cndmask_b32 v250, v250, v251, vcc
  v_mfma_f32_16x16x32_bf16 v[68:71], a[72:75], a[228:231], v[68:71]
  v_and_b32 v251, 1, v250
  v_mfma_f32_16x16x32_bf16 v[72:75], a[72:75], a[232:235], v[72:75]
  v_mul_u32_u24 v253, 3, v251
  v_mfma_f32_16x16x32_bf16 v[76:79], a[72:75], a[236:239], v[76:79]
  v_mfma_f32_16x16x32_bf16 v[92:95], a[76:79], a[236:239], v[92:95]
  v_add_u32 v251, 1, v251
  v_mfma_f32_16x16x32_bf16 v[88:91], a[76:79], a[232:235], v[88:91]
  v_cmp_gt_u32 vcc, 8, v248
  v_mfma_f32_16x16x32_bf16 v[84:87], a[76:79], a[228:231], v[84:87]
  v_mfma_f32_16x16x32_bf16 v[80:83], a[76:79], a[224:227], v[80:83]
  s_nop 1
  v_mfma_f32_16x16x32_bf16 v[96:99], a[80:83], a[224:227], v[96:99]
  v_cndmask_b32 v251, v251, v253, vcc
  v_mfma_f32_16x16x32_bf16 v[100:103], a[80:83], a[228:231], v[100:103]
  v_and_b32 v253, 6, v250
  v_mfma_f32_16x16x32_bf16 v[104:107], a[80:83], a[232:235], v[104:107]
  v_mfma_f32_16x16x32_bf16 v[108:111], a[80:83], a[236:239], v[108:111]
  v_lshl_add_u32 v251, v253, 1, v251
  v_mfma_f32_16x16x32_bf16 v[124:127], a[84:87], a[236:239], v[124:127]
  v_mul_u32_u24 v239, 229376, v251
  v_mfma_f32_16x16x32_bf16 v[120:123], a[84:87], a[232:235], v[120:123]
  v_mfma_f32_16x16x32_bf16 v[116:119], a[84:87], a[228:231], v[116:119]
  v_mul_u32_u24 v232, 3584, v251
  v_mfma_f32_16x16x32_bf16 v[112:115], a[84:87], a[224:227], v[112:115]
  v_subrev_u32 v251, 16, v250
  v_mfma_f32_16x16x32_bf16 v[128:131], a[88:91], a[224:227], v[128:131]
  v_mul_u32_u24 v253, 458752, v251
  v_mfma_f32_16x16x32_bf16 v[132:135], a[88:91], a[228:231], v[132:135]
  v_mfma_f32_16x16x32_bf16 v[136:139], a[88:91], a[232:235], v[136:139]
  v_add_u32 v253, 131072, v253
  v_mfma_f32_16x16x32_bf16 v[140:143], a[88:91], a[236:239], v[140:143]
  v_add_u32 v253, s6, v253
  v_mfma_f32_16x16x32_bf16 v[156:159], a[92:95], a[236:239], v[156:159]
  v_mfma_f32_16x16x32_bf16 v[152:155], a[92:95], a[232:235], v[152:155]
  v_cmp_lt_u32 vcc, 15, v248
  v_mfma_f32_16x16x32_bf16 v[148:151], a[92:95], a[228:231], v[148:151]
  v_mul_u32_u24 v251, 7168, v251
  v_mfma_f32_16x16x32_bf16 v[144:147], a[92:95], a[224:227], v[144:147]
  v_add_u32 v251, 2048, v251
  v_mfma_f32_16x16x32_bf16 v[160:163], a[96:99], a[224:227], v[160:163]
  v_mfma_f32_16x16x32_bf16 v[164:167], a[96:99], a[228:231], v[164:167]
  v_cndmask_b32 v239, v239, v253, vcc
  v_mfma_f32_16x16x32_bf16 v[168:171], a[96:99], a[232:235], v[168:171]
  v_cndmask_b32 v232, v232, v251, vcc
  v_mfma_f32_16x16x32_bf16 v[172:175], a[96:99], a[236:239], v[172:175]
  v_mfma_f32_16x16x32_bf16 v[188:191], a[100:103], a[236:239], v[188:191]
  v_subrev_u32 v251, 24, v250
  v_mfma_f32_16x16x32_bf16 v[184:187], a[100:103], a[232:235], v[184:187]
  v_mul_u32_u24 v253, 917504, v251
  v_mfma_f32_16x16x32_bf16 v[180:183], a[100:103], a[228:231], v[180:183]
  v_add_u32 v253, 196608, v253
  v_mfma_f32_16x16x32_bf16 v[176:179], a[100:103], a[224:227], v[176:179]
  v_mfma_f32_16x16x32_bf16 v[192:195], a[104:107], a[224:227], v[192:195]
  v_add_u32 v253, s7, v253
  v_mfma_f32_16x16x32_bf16 v[196:199], a[104:107], a[228:231], v[196:199]
  v_cmp_lt_u32 vcc, 23, v248
  v_mfma_f32_16x16x32_bf16 v[200:203], a[104:107], a[232:235], v[200:203]
  v_mfma_f32_16x16x32_bf16 v[204:207], a[104:107], a[236:239], v[204:207]
  v_mul_u32_u24 v251, 14336, v251
  v_mfma_f32_16x16x32_bf16 v[220:223], a[108:111], a[236:239], v[220:223]
  v_add_u32 v251, 3072, v251
  v_mfma_f32_16x16x32_bf16 v[216:219], a[108:111], a[232:235], v[216:219]
  v_cndmask_b32 v239, v239, v253, vcc
  v_mfma_f32_16x16x32_bf16 v[212:215], a[108:111], a[228:231], v[212:215]
  v_mfma_f32_16x16x32_bf16 v[208:211], a[108:111], a[224:227], v[208:211]
  v_cndmask_b32 v232, v232, v251, vcc
  s_nop 7
  s_barrier
  s_nop 0
  v_pk_mul_f32 v[16:17], v[0:1], v[16:17]
  v_pk_mul_f32 v[0:1], v[0:1], s[12:13]
  v_pk_mul_f32 v[18:19], v[2:3], v[18:19]
  v_pk_mul_f32 v[2:3], v[2:3], s[12:13]
  v_pk_mul_f32 v[48:49], v[32:33], v[48:49]
  v_pk_mul_f32 v[32:33], v[32:33], s[12:13]
  v_pk_mul_f32 v[50:51], v[34:35], v[50:51]
  v_pk_mul_f32 v[34:35], v[34:35], s[12:13]
  v_exp_f32 v0, v0
  v_exp_f32 v1, v1
  v_exp_f32 v2, v2
  v_exp_f32 v3, v3
  v_exp_f32 v32, v32
  v_exp_f32 v33, v33
  v_exp_f32 v34, v34
  v_exp_f32 v35, v35
  v_pk_add_f32 v[0:1], v[0:1], 1.0 op_sel_hi:[1,0]
  v_pk_add_f32 v[2:3], v[2:3], 1.0 op_sel_hi:[1,0]
  v_pk_add_f32 v[32:33], v[32:33], 1.0 op_sel_hi:[1,0]
  v_pk_add_f32 v[34:35], v[34:35], 1.0 op_sel_hi:[1,0]
  v_rcp_f32 v0, v0
  v_rcp_f32 v1, v1
  v_rcp_f32 v2, v2
  v_rcp_f32 v3, v3
  v_rcp_f32 v32, v32
  v_rcp_f32 v33, v33
  v_rcp_f32 v34, v34
  v_rcp_f32 v35, v35
  v_pk_mul_f32 v[16:17], v[16:17], v[0:1]
  v_pk_mul_f32 v[18:19], v[18:19], v[2:3]
  v_pk_mul_f32 v[48:49], v[48:49], v[32:33]
  v_pk_mul_f32 v[50:51], v[50:51], v[34:35]
  v_cvt_pk_bf16_f32 v0, v16, v17
  v_cvt_pk_bf16_f32 v1, v18, v19
  v_cvt_pk_bf16_f32 v2, v48, v49
  v_cvt_pk_bf16_f32 v3, v50, v51
  buffer_store_dwordx4 v[0:3], v238, s[48:51], s8 offen offset:0 sc1
  v_pk_mul_f32 v[20:21], v[4:5], v[20:21]
  v_pk_mul_f32 v[4:5], v[4:5], s[12:13]
  v_pk_mul_f32 v[22:23], v[6:7], v[22:23]
  v_pk_mul_f32 v[6:7], v[6:7], s[12:13]
  v_pk_mul_f32 v[52:53], v[36:37], v[52:53]
  v_pk_mul_f32 v[36:37], v[36:37], s[12:13]
  v_pk_mul_f32 v[54:55], v[38:39], v[54:55]
  v_pk_mul_f32 v[38:39], v[38:39], s[12:13]
  v_exp_f32 v4, v4
  v_exp_f32 v5, v5
  v_exp_f32 v6, v6
  v_exp_f32 v7, v7
  v_exp_f32 v36, v36
  v_exp_f32 v37, v37
  v_exp_f32 v38, v38
  v_exp_f32 v39, v39
  v_pk_add_f32 v[4:5], v[4:5], 1.0 op_sel_hi:[1,0]
  v_pk_add_f32 v[6:7], v[6:7], 1.0 op_sel_hi:[1,0]
  v_pk_add_f32 v[36:37], v[36:37], 1.0 op_sel_hi:[1,0]
  v_pk_add_f32 v[38:39], v[38:39], 1.0 op_sel_hi:[1,0]
  v_rcp_f32 v4, v4
  v_rcp_f32 v5, v5
  v_rcp_f32 v6, v6
  v_rcp_f32 v7, v7
  v_rcp_f32 v36, v36
  v_rcp_f32 v37, v37
  v_rcp_f32 v38, v38
  v_rcp_f32 v39, v39
  v_pk_mul_f32 v[20:21], v[20:21], v[4:5]
  v_pk_mul_f32 v[22:23], v[22:23], v[6:7]
  v_pk_mul_f32 v[52:53], v[52:53], v[36:37]
  v_pk_mul_f32 v[54:55], v[54:55], v[38:39]
  v_cvt_pk_bf16_f32 v4, v20, v21
  v_cvt_pk_bf16_f32 v5, v22, v23
  v_cvt_pk_bf16_f32 v6, v52, v53
  v_cvt_pk_bf16_f32 v7, v54, v55
  buffer_store_dwordx4 v[4:7], v238, s[48:51], s9 offen offset:0 sc1
  v_pk_mul_f32 v[24:25], v[8:9], v[24:25]
  v_pk_mul_f32 v[8:9], v[8:9], s[12:13]
  v_pk_mul_f32 v[26:27], v[10:11], v[26:27]
  v_pk_mul_f32 v[10:11], v[10:11], s[12:13]
  v_pk_mul_f32 v[56:57], v[40:41], v[56:57]
  v_pk_mul_f32 v[40:41], v[40:41], s[12:13]
  v_pk_mul_f32 v[58:59], v[42:43], v[58:59]
  v_pk_mul_f32 v[42:43], v[42:43], s[12:13]
  v_exp_f32 v8, v8
  v_exp_f32 v9, v9
  v_exp_f32 v10, v10
  v_exp_f32 v11, v11
  v_exp_f32 v40, v40
  v_exp_f32 v41, v41
  v_exp_f32 v42, v42
  v_exp_f32 v43, v43
  v_pk_add_f32 v[8:9], v[8:9], 1.0 op_sel_hi:[1,0]
  v_pk_add_f32 v[10:11], v[10:11], 1.0 op_sel_hi:[1,0]
  v_pk_add_f32 v[40:41], v[40:41], 1.0 op_sel_hi:[1,0]
  v_pk_add_f32 v[42:43], v[42:43], 1.0 op_sel_hi:[1,0]
  v_rcp_f32 v8, v8
  v_rcp_f32 v9, v9
  v_rcp_f32 v10, v10
  v_rcp_f32 v11, v11
  v_rcp_f32 v40, v40
  v_rcp_f32 v41, v41
  v_rcp_f32 v42, v42
  v_rcp_f32 v43, v43
  v_pk_mul_f32 v[24:25], v[24:25], v[8:9]
  v_pk_mul_f32 v[26:27], v[26:27], v[10:11]
  v_pk_mul_f32 v[56:57], v[56:57], v[40:41]
  v_pk_mul_f32 v[58:59], v[58:59], v[42:43]
  v_cvt_pk_bf16_f32 v8, v24, v25
  v_cvt_pk_bf16_f32 v9, v26, v27
  v_cvt_pk_bf16_f32 v10, v56, v57
  v_cvt_pk_bf16_f32 v11, v58, v59
  buffer_store_dwordx4 v[8:11], v238, s[48:51], s10 offen offset:0 sc1
  v_pk_mul_f32 v[28:29], v[12:13], v[28:29]
  v_pk_mul_f32 v[12:13], v[12:13], s[12:13]
  v_pk_mul_f32 v[30:31], v[14:15], v[30:31]
  v_pk_mul_f32 v[14:15], v[14:15], s[12:13]
  v_pk_mul_f32 v[60:61], v[44:45], v[60:61]
  v_pk_mul_f32 v[44:45], v[44:45], s[12:13]
  v_pk_mul_f32 v[62:63], v[46:47], v[62:63]
  v_pk_mul_f32 v[46:47], v[46:47], s[12:13]
  v_exp_f32 v12, v12
  v_exp_f32 v13, v13
  v_exp_f32 v14, v14
  v_exp_f32 v15, v15
  v_exp_f32 v44, v44
  v_exp_f32 v45, v45
  v_exp_f32 v46, v46
  v_exp_f32 v47, v47
  v_pk_add_f32 v[12:13], v[12:13], 1.0 op_sel_hi:[1,0]
  v_pk_add_f32 v[14:15], v[14:15], 1.0 op_sel_hi:[1,0]
  v_pk_add_f32 v[44:45], v[44:45], 1.0 op_sel_hi:[1,0]
  v_pk_add_f32 v[46:47], v[46:47], 1.0 op_sel_hi:[1,0]
  v_rcp_f32 v12, v12
  v_rcp_f32 v13, v13
  v_rcp_f32 v14, v14
  v_rcp_f32 v15, v15
  v_rcp_f32 v44, v44
  v_rcp_f32 v45, v45
  v_rcp_f32 v46, v46
  v_rcp_f32 v47, v47
  v_pk_mul_f32 v[28:29], v[28:29], v[12:13]
  v_pk_mul_f32 v[30:31], v[30:31], v[14:15]
  v_pk_mul_f32 v[60:61], v[60:61], v[44:45]
  v_pk_mul_f32 v[62:63], v[62:63], v[46:47]
  v_cvt_pk_bf16_f32 v12, v28, v29
  v_cvt_pk_bf16_f32 v13, v30, v31
  v_cvt_pk_bf16_f32 v14, v60, v61
  v_cvt_pk_bf16_f32 v15, v62, v63
  buffer_store_dwordx4 v[12:15], v238, s[48:51], s11 offen offset:0 sc1
  v_pk_mul_f32 v[80:81], v[64:65], v[80:81]
  v_pk_mul_f32 v[64:65], v[64:65], s[12:13]
  v_pk_mul_f32 v[82:83], v[66:67], v[82:83]
  v_pk_mul_f32 v[66:67], v[66:67], s[12:13]
  v_pk_mul_f32 v[112:113], v[96:97], v[112:113]
  v_pk_mul_f32 v[96:97], v[96:97], s[12:13]
  v_pk_mul_f32 v[114:115], v[98:99], v[114:115]
  v_pk_mul_f32 v[98:99], v[98:99], s[12:13]
  v_exp_f32 v64, v64
  v_exp_f32 v65, v65
  v_exp_f32 v66, v66
  v_exp_f32 v67, v67
  v_exp_f32 v96, v96
  v_exp_f32 v97, v97
  v_exp_f32 v98, v98
  v_exp_f32 v99, v99
  v_pk_add_f32 v[64:65], v[64:65], 1.0 op_sel_hi:[1,0]
  v_pk_add_f32 v[66:67], v[66:67], 1.0 op_sel_hi:[1,0]
  v_pk_add_f32 v[96:97], v[96:97], 1.0 op_sel_hi:[1,0]
  v_pk_add_f32 v[98:99], v[98:99], 1.0 op_sel_hi:[1,0]
  v_rcp_f32 v64, v64
  v_rcp_f32 v65, v65
  v_rcp_f32 v66, v66
  v_rcp_f32 v67, v67
  v_rcp_f32 v96, v96
  v_rcp_f32 v97, v97
  v_rcp_f32 v98, v98
  v_rcp_f32 v99, v99
  v_pk_mul_f32 v[80:81], v[80:81], v[64:65]
  v_pk_mul_f32 v[82:83], v[82:83], v[66:67]
  v_pk_mul_f32 v[112:113], v[112:113], v[96:97]
  v_pk_mul_f32 v[114:115], v[114:115], v[98:99]
  v_cvt_pk_bf16_f32 v64, v80, v81
  v_cvt_pk_bf16_f32 v65, v82, v83
  v_cvt_pk_bf16_f32 v66, v112, v113
  v_cvt_pk_bf16_f32 v67, v114, v115
  buffer_store_dwordx4 v[64:67], v238, s[48:51], s8 offen offset:1024 sc1
  v_pk_mul_f32 v[84:85], v[68:69], v[84:85]
  v_pk_mul_f32 v[68:69], v[68:69], s[12:13]
  v_pk_mul_f32 v[86:87], v[70:71], v[86:87]
  v_pk_mul_f32 v[70:71], v[70:71], s[12:13]
  v_pk_mul_f32 v[116:117], v[100:101], v[116:117]
  v_pk_mul_f32 v[100:101], v[100:101], s[12:13]
  v_pk_mul_f32 v[118:119], v[102:103], v[118:119]
  v_pk_mul_f32 v[102:103], v[102:103], s[12:13]
  v_exp_f32 v68, v68
  v_exp_f32 v69, v69
  v_exp_f32 v70, v70
  v_exp_f32 v71, v71
  v_exp_f32 v100, v100
  v_exp_f32 v101, v101
  v_exp_f32 v102, v102
  v_exp_f32 v103, v103
  v_pk_add_f32 v[68:69], v[68:69], 1.0 op_sel_hi:[1,0]
  v_pk_add_f32 v[70:71], v[70:71], 1.0 op_sel_hi:[1,0]
  v_pk_add_f32 v[100:101], v[100:101], 1.0 op_sel_hi:[1,0]
  v_pk_add_f32 v[102:103], v[102:103], 1.0 op_sel_hi:[1,0]
  v_rcp_f32 v68, v68
  v_rcp_f32 v69, v69
  v_rcp_f32 v70, v70
  v_rcp_f32 v71, v71
  v_rcp_f32 v100, v100
  v_rcp_f32 v101, v101
  v_rcp_f32 v102, v102
  v_rcp_f32 v103, v103
  v_pk_mul_f32 v[84:85], v[84:85], v[68:69]
  v_pk_mul_f32 v[86:87], v[86:87], v[70:71]
  v_pk_mul_f32 v[116:117], v[116:117], v[100:101]
  v_pk_mul_f32 v[118:119], v[118:119], v[102:103]
  v_cvt_pk_bf16_f32 v68, v84, v85
  v_cvt_pk_bf16_f32 v69, v86, v87
  v_cvt_pk_bf16_f32 v70, v116, v117
  v_cvt_pk_bf16_f32 v71, v118, v119
  buffer_store_dwordx4 v[68:71], v238, s[48:51], s9 offen offset:1024 sc1
  v_pk_mul_f32 v[88:89], v[72:73], v[88:89]
  v_pk_mul_f32 v[72:73], v[72:73], s[12:13]
  v_pk_mul_f32 v[90:91], v[74:75], v[90:91]
  v_pk_mul_f32 v[74:75], v[74:75], s[12:13]
  v_pk_mul_f32 v[120:121], v[104:105], v[120:121]
  v_pk_mul_f32 v[104:105], v[104:105], s[12:13]
  v_pk_mul_f32 v[122:123], v[106:107], v[122:123]
  v_pk_mul_f32 v[106:107], v[106:107], s[12:13]
  v_exp_f32 v72, v72
  v_exp_f32 v73, v73
  v_exp_f32 v74, v74
  v_exp_f32 v75, v75
  v_exp_f32 v104, v104
  v_exp_f32 v105, v105
  v_exp_f32 v106, v106
  v_exp_f32 v107, v107
  v_pk_add_f32 v[72:73], v[72:73], 1.0 op_sel_hi:[1,0]
  v_pk_add_f32 v[74:75], v[74:75], 1.0 op_sel_hi:[1,0]
  v_pk_add_f32 v[104:105], v[104:105], 1.0 op_sel_hi:[1,0]
  v_pk_add_f32 v[106:107], v[106:107], 1.0 op_sel_hi:[1,0]
  v_rcp_f32 v72, v72
  v_rcp_f32 v73, v73
  v_rcp_f32 v74, v74
  v_rcp_f32 v75, v75
  v_rcp_f32 v104, v104
  v_rcp_f32 v105, v105
  v_rcp_f32 v106, v106
  v_rcp_f32 v107, v107
  v_pk_mul_f32 v[88:89], v[88:89], v[72:73]
  v_pk_mul_f32 v[90:91], v[90:91], v[74:75]
  v_pk_mul_f32 v[120:121], v[120:121], v[104:105]
  v_pk_mul_f32 v[122:123], v[122:123], v[106:107]
  v_cvt_pk_bf16_f32 v72, v88, v89
  v_cvt_pk_bf16_f32 v73, v90, v91
  v_cvt_pk_bf16_f32 v74, v120, v121
  v_cvt_pk_bf16_f32 v75, v122, v123
  buffer_store_dwordx4 v[72:75], v238, s[48:51], s10 offen offset:1024 sc1
  v_pk_mul_f32 v[92:93], v[76:77], v[92:93]
  v_pk_mul_f32 v[76:77], v[76:77], s[12:13]
  v_pk_mul_f32 v[94:95], v[78:79], v[94:95]
  v_pk_mul_f32 v[78:79], v[78:79], s[12:13]
  v_pk_mul_f32 v[124:125], v[108:109], v[124:125]
  v_pk_mul_f32 v[108:109], v[108:109], s[12:13]
  v_pk_mul_f32 v[126:127], v[110:111], v[126:127]
  v_pk_mul_f32 v[110:111], v[110:111], s[12:13]
  v_exp_f32 v76, v76
  v_exp_f32 v77, v77
  v_exp_f32 v78, v78
  v_exp_f32 v79, v79
  v_exp_f32 v108, v108
  v_exp_f32 v109, v109
  v_exp_f32 v110, v110
  v_exp_f32 v111, v111
  v_pk_add_f32 v[76:77], v[76:77], 1.0 op_sel_hi:[1,0]
  v_pk_add_f32 v[78:79], v[78:79], 1.0 op_sel_hi:[1,0]
  v_pk_add_f32 v[108:109], v[108:109], 1.0 op_sel_hi:[1,0]
  v_pk_add_f32 v[110:111], v[110:111], 1.0 op_sel_hi:[1,0]
  v_rcp_f32 v76, v76
  v_rcp_f32 v77, v77
  v_rcp_f32 v78, v78
  v_rcp_f32 v79, v79
  v_rcp_f32 v108, v108
  v_rcp_f32 v109, v109
  v_rcp_f32 v110, v110
  v_rcp_f32 v111, v111
  v_pk_mul_f32 v[92:93], v[92:93], v[76:77]
  v_pk_mul_f32 v[94:95], v[94:95], v[78:79]
  v_pk_mul_f32 v[124:125], v[124:125], v[108:109]
  v_pk_mul_f32 v[126:127], v[126:127], v[110:111]
  v_cvt_pk_bf16_f32 v76, v92, v93
  v_cvt_pk_bf16_f32 v77, v94, v95
  v_cvt_pk_bf16_f32 v78, v124, v125
  v_cvt_pk_bf16_f32 v79, v126, v127
  buffer_store_dwordx4 v[76:79], v238, s[48:51], s11 offen offset:1024 sc1
  v_pk_mul_f32 v[144:145], v[128:129], v[144:145]
  v_pk_mul_f32 v[128:129], v[128:129], s[12:13]
  v_pk_mul_f32 v[146:147], v[130:131], v[146:147]
  v_pk_mul_f32 v[130:131], v[130:131], s[12:13]
  v_pk_mul_f32 v[176:177], v[160:161], v[176:177]
  v_pk_mul_f32 v[160:161], v[160:161], s[12:13]
  v_pk_mul_f32 v[178:179], v[162:163], v[178:179]
  v_pk_mul_f32 v[162:163], v[162:163], s[12:13]
  v_exp_f32 v128, v128
  v_exp_f32 v129, v129
  v_exp_f32 v130, v130
  v_exp_f32 v131, v131
  v_exp_f32 v160, v160
  v_exp_f32 v161, v161
  v_exp_f32 v162, v162
  v_exp_f32 v163, v163
  v_pk_add_f32 v[128:129], v[128:129], 1.0 op_sel_hi:[1,0]
  v_pk_add_f32 v[130:131], v[130:131], 1.0 op_sel_hi:[1,0]
  v_pk_add_f32 v[160:161], v[160:161], 1.0 op_sel_hi:[1,0]
  v_pk_add_f32 v[162:163], v[162:163], 1.0 op_sel_hi:[1,0]
  v_rcp_f32 v128, v128
  v_rcp_f32 v129, v129
  v_rcp_f32 v130, v130
  v_rcp_f32 v131, v131
  v_rcp_f32 v160, v160
  v_rcp_f32 v161, v161
  v_rcp_f32 v162, v162
  v_rcp_f32 v163, v163
  v_pk_mul_f32 v[144:145], v[144:145], v[128:129]
  v_pk_mul_f32 v[146:147], v[146:147], v[130:131]
  v_pk_mul_f32 v[176:177], v[176:177], v[160:161]
  v_pk_mul_f32 v[178:179], v[178:179], v[162:163]
  v_cvt_pk_bf16_f32 v128, v144, v145
  v_cvt_pk_bf16_f32 v129, v146, v147
  v_cvt_pk_bf16_f32 v130, v176, v177
  v_cvt_pk_bf16_f32 v131, v178, v179
  buffer_store_dwordx4 v[128:131], v238, s[48:51], s8 offen offset:2048 sc1
  v_pk_mul_f32 v[148:149], v[132:133], v[148:149]
  v_pk_mul_f32 v[132:133], v[132:133], s[12:13]
  v_pk_mul_f32 v[150:151], v[134:135], v[150:151]
  v_pk_mul_f32 v[134:135], v[134:135], s[12:13]
  v_pk_mul_f32 v[180:181], v[164:165], v[180:181]
  v_pk_mul_f32 v[164:165], v[164:165], s[12:13]
  v_pk_mul_f32 v[182:183], v[166:167], v[182:183]
  v_pk_mul_f32 v[166:167], v[166:167], s[12:13]
  v_exp_f32 v132, v132
  v_exp_f32 v133, v133
  v_exp_f32 v134, v134
  v_exp_f32 v135, v135
  v_exp_f32 v164, v164
  v_exp_f32 v165, v165
  v_exp_f32 v166, v166
  v_exp_f32 v167, v167
  v_pk_add_f32 v[132:133], v[132:133], 1.0 op_sel_hi:[1,0]
  v_pk_add_f32 v[134:135], v[134:135], 1.0 op_sel_hi:[1,0]
  v_pk_add_f32 v[164:165], v[164:165], 1.0 op_sel_hi:[1,0]
  v_pk_add_f32 v[166:167], v[166:167], 1.0 op_sel_hi:[1,0]
  v_rcp_f32 v132, v132
  v_rcp_f32 v133, v133
  v_rcp_f32 v134, v134
  v_rcp_f32 v135, v135
  v_rcp_f32 v164, v164
  v_rcp_f32 v165, v165
  v_rcp_f32 v166, v166
  v_rcp_f32 v167, v167
  v_pk_mul_f32 v[148:149], v[148:149], v[132:133]
  v_pk_mul_f32 v[150:151], v[150:151], v[134:135]
  v_pk_mul_f32 v[180:181], v[180:181], v[164:165]
  v_pk_mul_f32 v[182:183], v[182:183], v[166:167]
  v_cvt_pk_bf16_f32 v132, v148, v149
  v_cvt_pk_bf16_f32 v133, v150, v151
  v_cvt_pk_bf16_f32 v134, v180, v181
  v_cvt_pk_bf16_f32 v135, v182, v183
  buffer_store_dwordx4 v[132:135], v238, s[48:51], s9 offen offset:2048 sc1
  v_mov_b32 v252, 1
  v_mov_b32 v253, 0
  s_waitcnt vmcnt(2)
  s_nop 0
  buffer_store_dword v252, v253, s[56:59], s93 offen sc1
  v_pk_mul_f32 v[152:153], v[136:137], v[152:153]
  v_pk_mul_f32 v[136:137], v[136:137], s[12:13]
  v_pk_mul_f32 v[154:155], v[138:139], v[154:155]
  v_pk_mul_f32 v[138:139], v[138:139], s[12:13]
  v_pk_mul_f32 v[184:185], v[168:169], v[184:185]
  s_add_u32 s61, s21, 2
  s_and_b32 s61, s61, 3
  s_and_b32 s75, s61, 1
  s_and_b32 s61, s61, 6
  s_lshl_b32 s61, s61, 1
  s_mul_i32 s75, s75, 3
  s_add_u32 s61, s61, s75
  s_mul_i32 s61, s61, 229376
  s_add_u32 m0, s76, 1024
  s_nop 0
  buffer_load_dwordx4 v244, s[32:35], s61 offen lds
  v_pk_mul_f32 v[168:169], v[168:169], s[12:13]
  v_pk_mul_f32 v[186:187], v[170:171], v[186:187]
  v_pk_mul_f32 v[170:171], v[170:171], s[12:13]
  v_exp_f32 v136, v136
  v_exp_f32 v137, v137
  v_exp_f32 v138, v138
  v_exp_f32 v139, v139
  v_exp_f32 v168, v168
  s_add_u32 m0, s76, 32
  s_nop 0
  buffer_load_dwordx4 v244, s[32:35], s61 offen offset:2048 lds
  v_exp_f32 v169, v169
  v_exp_f32 v170, v170
  v_exp_f32 v171, v171
  v_pk_add_f32 v[136:137], v[136:137], 1.0 op_sel_hi:[1,0]
  v_pk_add_f32 v[138:139], v[138:139], 1.0 op_sel_hi:[1,0]
  v_pk_add_f32 v[168:169], v[168:169], 1.0 op_sel_hi:[1,0]
  v_pk_add_f32 v[170:171], v[170:171], 1.0 op_sel_hi:[1,0]
  v_rcp_f32 v136, v136
  s_add_u32 m0, s76, 9472
  s_nop 0
  buffer_load_dwordx4 v245, s[32:35], s61 offen lds
  v_rcp_f32 v137, v137
  v_rcp_f32 v138, v138
  v_rcp_f32 v139, v139
  v_rcp_f32 v168, v168
  v_rcp_f32 v169, v169
  v_rcp_f32 v170, v170
  v_rcp_f32_e64 v171, v171
  v_pk_mul_f32 v[152:153], v[152:153], v[136:137]
  s_add_u32 m0, s76, 8480
  s_nop 0
  s_nop 0
  buffer_load_dwordx4 v245, s[32:35], s61 offen offset:2048 lds
  v_pk_mul_f32 v[154:155], v[154:155], v[138:139]
  v_pk_mul_f32 v[184:185], v[184:185], v[168:169]
  v_pk_mul_f32 v[186:187], v[186:187], v[170:171]
  v_cvt_pk_bf16_f32 v136, v152, v153
  v_cvt_pk_bf16_f32 v137, v154, v155
  v_cvt_pk_bf16_f32 v138, v184, v185
  v_cvt_pk_bf16_f32 v139, v186, v187
  buffer_store_dwordx4 v[136:139], v238, s[48:51], s10 offen offset:2048 sc1
  s_add_u32 s60, s21, 3
  s_and_b32 s60, s60, 3
  s_and_b32 s75, s60, 1
  s_and_b32 s60, s60, 6
  s_lshl_b32 s60, s60, 1
  s_mul_i32 s75, s75, 3
  s_add_u32 s60, s60, s75
  s_mul_i32 s60, s60, 229376
  s_add_u32 m0, s76, 17920
  s_nop 0
  buffer_load_dwordx4 v244, s[32:35], s60 offen lds
  v_pk_mul_f32 v[156:157], v[140:141], v[156:157]
  v_pk_mul_f32 v[140:141], v[140:141], s[12:13]
  v_pk_mul_f32 v[158:159], v[142:143], v[158:159]
  v_pk_mul_f32 v[142:143], v[142:143], s[12:13]
  v_pk_mul_f32 v[188:189], v[172:173], v[188:189]
  v_pk_mul_f32 v[172:173], v[172:173], s[12:13]
  v_pk_mul_f32 v[190:191], v[174:175], v[190:191]
  v_pk_mul_f32 v[174:175], v[174:175], s[12:13]
  s_add_u32 m0, s76, 16928
  s_nop 0
  buffer_load_dwordx4 v244, s[32:35], s60 offen offset:2048 lds
  v_exp_f32 v140, v140
  v_exp_f32 v141, v141
  v_exp_f32 v142, v142
  v_exp_f32 v143, v143
  v_exp_f32 v172, v172
  v_exp_f32 v173, v173
  v_exp_f32 v174, v174
  v_exp_f32 v175, v175
  s_add_u32 m0, s76, 26368
  s_nop 0
  buffer_load_dwordx4 v245, s[32:35], s60 offen lds
  v_pk_add_f32 v[140:141], v[140:141], 1.0 op_sel_hi:[1,0]
  v_pk_add_f32 v[142:143], v[142:143], 1.0 op_sel_hi:[1,0]
  v_pk_add_f32 v[172:173], v[172:173], 1.0 op_sel_hi:[1,0]
  v_pk_add_f32 v[174:175], v[174:175], 1.0 op_sel_hi:[1,0]
  v_rcp_f32 v140, v140
  v_rcp_f32 v141, v141
  v_rcp_f32 v142, v142
  v_rcp_f32 v143, v143
  s_add_u32 m0, s76, 25376
  s_nop 0
  buffer_load_dwordx4 v245, s[32:35], s60 offen offset:2048 lds
  v_rcp_f32 v172, v172
  v_rcp_f32 v173, v173
  v_rcp_f32 v174, v174
  v_rcp_f32_e64 v175, v175
  v_pk_mul_f32 v[156:157], v[156:157], v[140:141]
  v_pk_mul_f32 v[158:159], v[158:159], v[142:143]
  v_pk_mul_f32 v[188:189], v[188:189], v[172:173]
  v_pk_mul_f32 v[190:191], v[190:191], v[174:175]
  v_cvt_pk_bf16_f32 v140, v156, v157
  v_cvt_pk_bf16_f32 v141, v158, v159
  v_cvt_pk_bf16_f32 v142, v188, v189
  v_cvt_pk_bf16_f32 v143, v190, v191
  buffer_store_dwordx4 v[140:143], v238, s[48:51], s11 offen offset:2048 sc1
  v_pk_mul_f32 v[208:209], v[192:193], v[208:209]
  v_pk_mul_f32 v[192:193], v[192:193], s[12:13]
  v_pk_mul_f32 v[210:211], v[194:195], v[210:211]
  v_pk_mul_f32 v[194:195], v[194:195], s[12:13]
  v_exp_f32 v192, v192
  v_exp_f32 v193, v193
  v_exp_f32 v194, v194
  v_exp_f32 v195, v195
  v_pk_add_f32 v[192:193], v[192:193], 1.0 op_sel_hi:[1,0]
  v_pk_add_f32 v[194:195], v[194:195], 1.0 op_sel_hi:[1,0]
  v_rcp_f32 v192, v192
  v_rcp_f32 v193, v193
  v_rcp_f32 v194, v194
  v_rcp_f32 v195, v195
  v_pk_mul_f32 v[208:209], v[208:209], v[192:193]
  v_pk_mul_f32 v[210:211], v[210:211], v[194:195]
  v_cvt_pk_bf16_f32 v192, v208, v209
  v_cvt_pk_bf16_f32 v193, v210, v211
  buffer_store_dwordx2 v[192:193], v241, s[48:51], s8 offen offset:3072 sc1
  v_pk_mul_f32 v[212:213], v[196:197], v[212:213]
  v_pk_mul_f32 v[196:197], v[196:197], s[12:13]
  v_pk_mul_f32 v[214:215], v[198:199], v[214:215]
  v_pk_mul_f32 v[198:199], v[198:199], s[12:13]
  v_exp_f32 v196, v196
  v_exp_f32 v197, v197
  v_exp_f32 v198, v198
  v_exp_f32 v199, v199
  v_pk_add_f32 v[196:197], v[196:197], 1.0 op_sel_hi:[1,0]
  v_pk_add_f32 v[198:199], v[198:199], 1.0 op_sel_hi:[1,0]
  v_rcp_f32 v196, v196
  v_rcp_f32 v197, v197
  v_rcp_f32 v198, v198
  v_rcp_f32 v199, v199
  v_pk_mul_f32 v[212:213], v[212:213], v[196:197]
  v_pk_mul_f32 v[214:215], v[214:215], v[198:199]
  v_cvt_pk_bf16_f32 v196, v212, v213
  v_cvt_pk_bf16_f32 v197, v214, v215
  buffer_store_dwordx2 v[196:197], v241, s[48:51], s9 offen offset:3072 sc1
  v_pk_mul_f32 v[216:217], v[200:201], v[216:217]
  v_pk_mul_f32 v[200:201], v[200:201], s[12:13]
  v_pk_mul_f32 v[218:219], v[202:203], v[218:219]
  v_pk_mul_f32 v[202:203], v[202:203], s[12:13]
  v_exp_f32 v200, v200
  v_exp_f32 v201, v201
  v_exp_f32 v202, v202
  v_exp_f32 v203, v203
  v_pk_add_f32 v[200:201], v[200:201], 1.0 op_sel_hi:[1,0]
  v_pk_add_f32 v[202:203], v[202:203], 1.0 op_sel_hi:[1,0]
  v_rcp_f32 v200, v200
  v_rcp_f32 v201, v201
  v_rcp_f32 v202, v202
  v_rcp_f32 v203, v203
  v_pk_mul_f32 v[216:217], v[216:217], v[200:201]
  v_pk_mul_f32 v[218:219], v[218:219], v[202:203]
  v_cvt_pk_bf16_f32 v200, v216, v217
  v_cvt_pk_bf16_f32 v201, v218, v219
  buffer_store_dwordx2 v[200:201], v241, s[48:51], s10 offen offset:3072 sc1
  v_pk_mul_f32 v[220:221], v[204:205], v[220:221]
  v_pk_mul_f32 v[204:205], v[204:205], s[12:13]
  v_pk_mul_f32 v[222:223], v[206:207], v[222:223]
  v_pk_mul_f32 v[206:207], v[206:207], s[12:13]
  v_exp_f32 v204, v204
  v_exp_f32 v205, v205
  v_exp_f32 v206, v206
  v_exp_f32 v207, v207
  v_pk_add_f32 v[204:205], v[204:205], 1.0 op_sel_hi:[1,0]
  v_pk_add_f32 v[206:207], v[206:207], 1.0 op_sel_hi:[1,0]
  v_rcp_f32 v204, v204
  v_rcp_f32 v205, v205
  v_rcp_f32 v206, v206
  v_rcp_f32 v207, v207
  v_pk_mul_f32 v[220:221], v[220:221], v[204:205]
  v_pk_mul_f32 v[222:223], v[222:223], v[206:207]
  v_cvt_pk_bf16_f32 v204, v220, v221
  v_cvt_pk_bf16_f32 v205, v222, v223
  buffer_store_dwordx2 v[204:205], v241, s[48:51], s11 offen offset:3072 sc1
  s_add_u32 s36, s28, 67108864
  s_addc_u32 s37, s29, 0
  s_mov_b32 s38, 14680064
  s_mov_b32 s39, 0x20000
  s_mov_b32 s40, s24
  s_mov_b32 s41, s25
  s_mov_b32 s42, 4194304
  s_mov_b32 s43, 0x20000
  s_add_u32 s44, s28, 25165824
  s_addc_u32 s45, s29, 0
  s_mov_b32 s46, 8388608
  s_mov_b32 s47, 0x20000
  v_accvgpr_read_b32 v80, a240
  v_accvgpr_read_b32 v81, a241
  v_accvgpr_read_b32 v82, a242
  v_accvgpr_read_b32 v83, a243
  v_accvgpr_read_b32 v84, a244
  v_accvgpr_read_b32 v85, a245
  v_accvgpr_read_b32 v86, a246
  v_accvgpr_read_b32 v87, a247
  v_accvgpr_read_b32 v88, a248
  v_accvgpr_read_b32 v89, a249
  v_accvgpr_read_b32 v90, a250
  v_accvgpr_read_b32 v91, a251
  v_accvgpr_read_b32 v92, a252
  v_accvgpr_read_b32 v93, a253
  v_accvgpr_read_b32 v94, a254
  v_accvgpr_read_b32 v95, a255
  v_and_b32 v72, 15, v248
  v_lshlrev_b32 v72, 6, v72
  s_lshl_b32 s84, s26, 1
  s_lshr_b32 s85, s3, 1
  s_add_u32 s84, s84, s85
  s_lshl_b32 s84, s84, 11
  s_add_u32 s84, s84, 262144
  s_and_b32 s85, s27, 1
  s_lshl_b32 s85, s85, 10
  s_add_u32 s84, s84, s85
  v_mov_b32 v252, v72
  s_add_u32 s85, s84, 131072
  s_mov_b32 s97, 0
  s_add_u32 s80, s21, 0
  s_and_b32 s80, s80, 3
  s_and_b32 s75, s80, 1
  s_and_b32 s80, s80, 6
  s_lshl_b32 s80, s80, 1
  s_mul_i32 s75, s75, 3
  s_add_u32 s80, s80, s75
  s_lshl_b32 s81, 1, s80
  s_or_b32 s97, s97, s81
  s_add_u32 s80, s21, 1
  s_and_b32 s80, s80, 3
  s_and_b32 s75, s80, 1
  s_and_b32 s80, s80, 6
  s_lshl_b32 s80, s80, 1
  s_mul_i32 s75, s75, 3
  s_add_u32 s80, s80, s75
  s_lshl_b32 s81, 1, s80
  s_or_b32 s97, s97, s81
  s_add_u32 s80, s21, 2
  s_and_b32 s80, s80, 3
  s_and_b32 s75, s80, 1
  s_and_b32 s80, s80, 6
  s_lshl_b32 s80, s80, 1
  s_mul_i32 s75, s75, 3
  s_add_u32 s80, s80, s75
  s_lshl_b32 s81, 1, s80
  s_or_b32 s97, s97, s81
  s_add_u32 s80, s21, 3
  s_and_b32 s80, s80, 3
  s_and_b32 s75, s80, 1
  s_and_b32 s80, s80, 6
  s_lshl_b32 s80, s80, 1
  s_mul_i32 s75, s75, 3
  s_add_u32 s80, s80, s75
  s_lshl_b32 s81, 1, s80
  s_or_b32 s97, s97, s81
  s_add_u32 s80, s21, 0
  s_and_b32 s80, s80, 3
  s_add_u32 s80, s80, 4
  s_and_b32 s75, s80, 1
  s_and_b32 s80, s80, 6
  s_lshl_b32 s80, s80, 1
  s_mul_i32 s75, s75, 3
  s_add_u32 s80, s80, s75
  s_lshl_b32 s81, 1, s80
  s_or_b32 s97, s97, s81
  s_add_u32 s80, s21, 1
  s_and_b32 s80, s80, 3
  s_add_u32 s80, s80, 4
  s_and_b32 s75, s80, 1
  s_and_b32 s80, s80, 6
  s_lshl_b32 s80, s80, 1
  s_mul_i32 s75, s75, 3
  s_add_u32 s80, s80, s75
  s_lshl_b32 s81, 1, s80
  s_or_b32 s97, s97, s81
  s_add_u32 s80, s21, 2
  s_and_b32 s80, s80, 3
  s_add_u32 s80, s80, 4
  s_and_b32 s75, s80, 1
  s_and_b32 s80, s80, 6
  s_lshl_b32 s80, s80, 1
  s_mul_i32 s75, s75, 3
  s_add_u32 s80, s80, s75
  s_lshl_b32 s81, 1, s80
  s_or_b32 s97, s97, s81
  s_add_u32 s80, s21, 3
  s_and_b32 s80, s80, 3
  s_add_u32 s80, s80, 4
  s_and_b32 s75, s80, 1
  s_and_b32 s80, s80, 6
  s_lshl_b32 s80, s80, 1
  s_mul_i32 s75, s75, 3
  s_add_u32 s80, s80, s75
  s_lshl_b32 s81, 1, s80
  s_or_b32 s97, s97, s81
  buffer_load_dword v253, v252, s[56:59], s84 offen sc1
  v_mov_b32 v70, 1
  v_mov_b32 v71, 0
  s_waitcnt vmcnt(1)
  buffer_store_dword v70, v71, s[56:59], s94 offen sc1
  s_waitcnt vmcnt(1)
  v_cmp_eq_u32 vcc, 0, v253
  s_nop 0
  s_and_b32 s81, vcc_lo, s97
  s_cbranch_scc0 L_ok_42
  s_mov_b32 s96, 0
L_poll_41:
  buffer_load_dword v253, v252, s[56:59], s84 offen sc1
  s_waitcnt vmcnt(0)
  v_cmp_eq_u32 vcc, 0, v253
  s_add_u32 s96, s96, 1
  s_and_b32 s81, vcc_lo, s97
  s_cbranch_scc0 L_ok_42
  s_sleep 2
  s_cmp_lt_u32 s96, 0x200000
  s_cbranch_scc1 L_poll_41
L_ok_42:
  s_add_u32 s62, s21, 0
  s_and_b32 s62, s62, 3
  s_and_b32 s75, s62, 1
  s_and_b32 s62, s62, 6
  s_lshl_b32 s62, s62, 1
  s_mul_i32 s75, s75, 3
  s_add_u32 s62, s62, s75
  s_mul_i32 s62, s62, 3584
  buffer_load_dwordx4 a[64:67], v246, s[36:39], s62 offen offset:0 sc1
  buffer_load_dwordx4 a[68:71], v247, s[36:39], s62 offen offset:0 sc1
  buffer_load_dwordx4 a[72:75], v246, s[36:39], s62 offen offset:1024 sc1
  buffer_load_dwordx4 a[76:79], v247, s[36:39], s62 offen offset:1024 sc1
  s_add_u32 s63, s21, 1
  s_and_b32 s63, s63, 3
  s_and_b32 s75, s63, 1
  s_and_b32 s63, s63, 6
  s_lshl_b32 s63, s63, 1
  s_mul_i32 s75, s75, 3
  s_add_u32 s63, s63, s75
  s_mul_i32 s63, s63, 3584
  buffer_load_dwordx4 a[80:83], v246, s[36:39], s63 offen offset:0 sc1
  buffer_load_dwordx4 a[84:87], v247, s[36:39], s63 offen offset:0 sc1
  buffer_load_dwordx4 a[88:91], v246, s[36:39], s63 offen offset:1024 sc1
  buffer_load_dwordx4 a[92:95], v247, s[36:39], s63 offen offset:1024 sc1
  s_add_u32 s62, s21, 2
  s_and_b32 s62, s62, 3
  s_and_b32 s75, s62, 1
  s_and_b32 s62, s62, 6
  s_lshl_b32 s62, s62, 1
  s_mul_i32 s75, s75, 3
  s_add_u32 s62, s62, s75
  s_mul_i32 s62, s62, 3584
  buffer_load_dwordx4 a[96:99], v246, s[36:39], s62 offen offset:0 sc1
  buffer_load_dwordx4 a[100:103], v247, s[36:39], s62 offen offset:0 sc1
  buffer_load_dwordx4 a[104:107], v246, s[36:39], s62 offen offset:1024 sc1
  buffer_load_dwordx4 a[108:111], v247, s[36:39], s62 offen offset:1024 sc1
  v_lshrrev_b32 v72, 4, v248
  v_lshlrev_b32 v76, 4, v72
  v_add_u32 v76, 128000, v76
  v_and_b32 v73, 15, v248
  v_lshlrev_b32 v73, 11, v73
  v_and_b32 v74, 1, v72
  v_lshl_add_u32 v73, v74, 5, v73
  v_lshrrev_b32 v74, 1, v72
  v_lshl_add_u32 v77, v74, 4, v73
  s_lshl_b32 s86, s26, 3
  s_lshl_b32 s87, s3, 1
  s_add_u32 s86, s86, s87
  s_lshl_b32 s86, s86, 15
  s_lshl_b32 s87, s27, 7
  s_add_u32 s86, s86, s87
  s_add_u32 s87, s86, 32768
  s_lshl_b32 s88, s26, 4
  s_add_u32 s88, s88, s27
  s_lshl_b32 s88, s88, 2
  s_add_u32 s88, s88, s3
  s_xor_b32 s89, s88, 4
  s_lshl_b32 s90, s88, 13
  s_add_u32 s91, s90, 4096
  s_lshl_b32 s92, s89, 13
  s_add_u32 s93, s92, 4096
  s_lshl_b32 s88, s88, 6
  s_add_u32 s88, s88, 327680
  s_lshl_b32 s89, s89, 6
  s_add_u32 s89, s89, 327680
  v_add_u32 v68, 51712, v243
  v_lshrrev_b32 v72, 5, v248
  v_mul_u32_u24 v72, 196608, v72
  v_add_u32 v64, v244, v72
  v_add_u32 v65, v245, v72
  v_add_u32 v69, 992, v244
  v_add_u32 v75, 992, v245
  v_add_u32 v79, 992, v64
  v_add_u32 v71, 992, v65
  v_lshrrev_b32 v72, 1, v249
  v_sub_u32 v66, v246, v72
  v_sub_u32 v67, v247, v72
  v_mov_b32 v72, 1
  v_mov_b32 v73, 0
  s_waitcnt vmcnt(12)
  s_barrier
  s_nop 0
  ds_read_b64_tr_b16 a[0:1], v242 offset:0
  ds_read_b64_tr_b16 a[2:3], v242 offset:512
  ds_read_b64_tr_b16 a[4:5], v242 offset:32
  ds_read_b64_tr_b16 a[6:7], v242 offset:544
  ds_read_b64_tr_b16 a[8:9], v242 offset:64
  ds_read_b64_tr_b16 a[10:11], v242 offset:576
  ds_read_b64_tr_b16 a[12:13], v242 offset:96
  ds_read_b64_tr_b16 a[14:15], v242 offset:608
  ds_read_b64_tr_b16 a[16:17], v242 offset:8448
  ds_read_b64_tr_b16 a[18:19], v242 offset:8960
  ds_read_b64_tr_b16 a[20:21], v242 offset:8480
  ds_read_b64_tr_b16 a[22:23], v242 offset:8992
  ds_read_b64_tr_b16 a[24:25], v242 offset:8512
  ds_read_b64_tr_b16 a[26:27], v242 offset:9024
  ds_read_b64_tr_b16 a[28:29], v242 offset:8544
  ds_read_b64_tr_b16 a[30:31], v242 offset:9056
  s_waitcnt vmcnt(10) lgkmcnt(0)
  v_mfma_f32_16x16x32_bf16 v[0:3], a[0:3], a[64:67], 0
  ds_read_b64_tr_b16 a[32:33], v242 offset:4224
  s_add_u32 s63, s21, 3
  ds_read_b64_tr_b16 a[34:35], v242 offset:4736
  v_mfma_f32_16x16x32_bf16 v[4:7], a[0:3], a[68:71], 0
  s_and_b32 s63, s63, 3
  ds_read_b64_tr_b16 a[36:37], v242 offset:4256
  s_and_b32 s75, s63, 1
  v_mfma_f32_16x16x32_bf16 v[12:15], a[4:7], a[68:71], 0
  s_and_b32 s63, s63, 6
  ds_read_b64_tr_b16 a[38:39], v242 offset:4768
  s_lshl_b32 s63, s63, 1
  v_mfma_f32_16x16x32_bf16 v[8:11], a[4:7], a[64:67], 0
  ds_read_b64_tr_b16 a[40:41], v242 offset:4288
  s_mul_i32 s75, s75, 3
  ds_read_b64_tr_b16 a[42:43], v242 offset:4800
  v_mfma_f32_16x16x32_bf16 v[16:19], a[8:11], a[64:67], 0
  s_add_u32 s63, s63, s75
  ds_read_b64_tr_b16 a[44:45], v242 offset:4320
  s_mul_i32 s63, s63, 3584
  v_mfma_f32_16x16x32_bf16 v[20:23], a[8:11], a[68:71], 0
  buffer_load_dwordx4 a[112:115], v246, s[36:39], s63 offen offset:0 sc1
  ds_read_b64_tr_b16 a[46:47], v242 offset:4832
  v_readlane_b32 s62, v232, 4
  v_mfma_f32_16x16x32_bf16 v[28:31], a[12:15], a[68:71], 0
  ds_read_b64_tr_b16 a[48:49], v242 offset:12672
  s_add_u32 s61, s21, 0
  ds_read_b64_tr_b16 a[50:51], v242 offset:13184
  v_mfma_f32_16x16x32_bf16 v[24:27], a[12:15], a[64:67], 0
  s_and_b32 s61, s61, 3
  ds_read_b64_tr_b16 a[52:53], v242 offset:12704
  s_add_u32 s61, s61, 4
  v_mfma_f32_16x16x32_bf16 v[32:35], a[16:19], a[64:67], 0
  ds_read_b64_tr_b16 a[54:55], v242 offset:13216
  s_and_b32 s75, s61, 1
  s_and_b32 s61, s61, 6
  v_mfma_f32_16x16x32_bf16 v[36:39], a[16:19], a[68:71], 0
  ds_read_b64_tr_b16 a[56:57], v242 offset:12736
  s_lshl_b32 s61, s61, 1
  ds_read_b64_tr_b16 a[58:59], v242 offset:13248
  v_mfma_f32_16x16x32_bf16 v[44:47], a[20:23], a[68:71], 0
  s_mul_i32 s75, s75, 3
  ds_read_b64_tr_b16 a[60:61], v242 offset:12768
  s_add_u32 s61, s61, s75
  v_mfma_f32_16x16x32_bf16 v[40:43], a[20:23], a[64:67], 0
  ds_read_b64_tr_b16 a[62:63], v242 offset:13280
  s_mul_i32 s61, s61, 229376
  v_mfma_f32_16x16x32_bf16 v[48:51], a[24:27], a[64:67], 0
  s_add_u32 m0, s76, 34816
  s_nop 0
  buffer_load_dwordx4 v244, s[32:35], s61 offen lds
  v_mfma_f32_16x16x32_bf16 v[52:55], a[24:27], a[68:71], 0
  buffer_load_dwordx4 a[116:119], v247, s[36:39], s63 offen offset:0 sc1
  v_mfma_f32_16x16x32_bf16 v[60:63], a[28:31], a[68:71], 0
  buffer_load_dwordx4 v69, s[32:35], s61 offen offset:1056 lds
  v_mfma_f32_16x16x32_bf16 v[56:59], a[28:31], a[64:67], 0
  s_add_u32 m0, s76, 43264
  s_nop 0
  buffer_load_dwordx4 v245, s[32:35], s61 offen lds
  s_waitcnt vmcnt(13) lgkmcnt(0)
  v_mfma_f32_16x16x32_bf16 v[0:3], a[32:35], a[72:75], v[0:3]
  s_waitcnt vmcnt(17)
  s_barrier
  v_mfma_f32_16x16x32_bf16 v[4:7], a[32:35], a[76:79], v[4:7]
  ds_read_b64_tr_b16 a[0:1], v242 offset:16896
  ds_read_b64_tr_b16 a[2:3], v242 offset:17408
  v_mfma_f32_16x16x32_bf16 v[12:15], a[36:39], a[76:79], v[12:15]
  buffer_load_dwordx4 a[120:123], v246, s[36:39], s63 offen offset:1024 sc1
  ds_read_b64_tr_b16 a[4:5], v242 offset:16928
  v_mfma_f32_16x16x32_bf16 v[8:11], a[36:39], a[72:75], v[8:11]
  ds_read_b64_tr_b16 a[6:7], v242 offset:17440
  ds_read_b64_tr_b16 a[8:9], v242 offset:16960
  v_mfma_f32_16x16x32_bf16 v[16:19], a[40:43], a[72:75], v[16:19]
  ds_read_b64_tr_b16 a[10:11], v242 offset:17472
  v_mfma_f32_16x16x32_bf16 v[20:23], a[40:43], a[76:79], v[20:23]
  ds_read_b64_tr_b16 a[12:13], v242 offset:16992
  ds_read_b64_tr_b16 a[14:15], v242 offset:17504
  v_mfma_f32_16x16x32_bf16 v[28:31], a[44:47], a[76:79], v[28:31]
  buffer_load_dwordx4 v75, s[32:35], s61 offen offset:1056 lds
  ds_read_b64_tr_b16 a[16:17], v242 offset:25344
  v_mfma_f32_16x16x32_bf16 v[24:27], a[44:47], a[72:75], v[24:27]
  ds_read_b64_tr_b16 a[18:19], v242 offset:25856
  ds_read_b64_tr_b16 a[20:21], v242 offset:25376
  v_mfma_f32_16x16x32_bf16 v[32:35], a[48:51], a[72:75], v[32:35]
  buffer_load_dwordx4 a[124:127], v247, s[36:39], s63 offen offset:1024 sc1
  ds_read_b64_tr_b16 a[22:23], v242 offset:25888
  v_mfma_f32_16x16x32_bf16 v[36:39], a[48:51], a[76:79], v[36:39]
  ds_read_b64_tr_b16 a[24:25], v242 offset:25408
  ds_read_b64_tr_b16 a[26:27], v242 offset:25920
  v_mfma_f32_16x16x32_bf16 v[44:47], a[52:55], a[76:79], v[44:47]
  ds_read_b64_tr_b16 a[28:29], v242 offset:25440
  buffer_load_dwordx4 a[128:131], v246, s[36:39], s62 offen offset:0 sc1
  v_mfma_f32_16x16x32_bf16 v[40:43], a[52:55], a[72:75], v[40:43]
  ds_read_b64_tr_b16 a[30:31], v242 offset:25952
  v_mfma_f32_16x16x32_bf16 v[48:51], a[56:59], a[72:75], v[48:51]
  v_readlane_b32 s63, v232, 5
  v_mfma_f32_16x16x32_bf16 v[52:55], a[56:59], a[76:79], v[52:55]
  v_mfma_f32_16x16x32_bf16 v[60:63], a[60:63], a[76:79], v[60:63]
  buffer_load_dwordx4 a[132:135], v247, s[36:39], s62 offen offset:0 sc1
  v_mfma_f32_16x16x32_bf16 v[56:59], a[60:63], a[72:75], v[56:59]
  s_waitcnt vmcnt(16) lgkmcnt(0)
  v_mfma_f32_16x16x32_bf16 v[0:3], a[0:3], a[80:83], v[0:3]
  ds_read_b64_tr_b16 a[32:33], v242 offset:21120
  buffer_load_dwordx4 a[136:139], v246, s[36:39], s62 offen offset:1024 sc1
  ds_read_b64_tr_b16 a[34:35], v242 offset:21632
  v_mfma_f32_16x16x32_bf16 v[4:7], a[0:3], a[84:87], v[4:7]
  s_add_u32 s60, s21, 1
  ds_read_b64_tr_b16 a[36:37], v242 offset:21152
  v_mfma_f32_16x16x32_bf16 v[12:15], a[4:7], a[84:87], v[12:15]
  s_and_b32 s60, s60, 3
  ds_read_b64_tr_b16 a[38:39], v242 offset:21664
  v_mfma_f32_16x16x32_bf16 v[8:11], a[4:7], a[80:83], v[8:11]
  ds_read_b64_tr_b16 a[40:41], v242 offset:21184
  s_add_u32 s60, s60, 4
  ds_read_b64_tr_b16 a[42:43], v242 offset:21696
  v_mfma_f32_16x16x32_bf16 v[16:19], a[8:11], a[80:83], v[16:19]
  s_and_b32 s75, s60, 1
  ds_read_b64_tr_b16 a[44:45], v242 offset:21216
  s_and_b32 s60, s60, 6
  v_mfma_f32_16x16x32_bf16 v[20:23], a[8:11], a[84:87], v[20:23]
  ds_read_b64_tr_b16 a[46:47], v242 offset:21728
  s_lshl_b32 s60, s60, 1
  v_mfma_f32_16x16x32_bf16 v[28:31], a[12:15], a[84:87], v[28:31]
  ds_read_b64_tr_b16 a[48:49], v242 offset:29568
  s_mul_i32 s75, s75, 3
  ds_read_b64_tr_b16 a[50:51], v242 offset:30080
  v_mfma_f32_16x16x32_bf16 v[24:27], a[12:15], a[80:83], v[24:27]
  ds_read_b64_tr_b16 a[52:53], v242 offset:29600
  s_add_u32 s60, s60, s75
  v_mfma_f32_16x16x32_bf16 v[32:35], a[16:19], a[80:83], v[32:35]
  ds_read_b64_tr_b16 a[54:55], v242 offset:30112
  s_mul_i32 s60, s60, 229376
  v_mfma_f32_16x16x32_bf16 v[36:39], a[16:19], a[84:87], v[36:39]
  ds_read_b64_tr_b16 a[56:57], v242 offset:29632
  s_add_u32 m0, s76, 51712
  ds_read_b64_tr_b16 a[58:59], v242 offset:30144
  v_mfma_f32_16x16x32_bf16 v[44:47], a[20:23], a[84:87], v[44:47]
  buffer_load_dwordx4 v244, s[32:35], s60 offen lds
  ds_read_b64_tr_b16 a[60:61], v242 offset:29664
  v_mfma_f32_16x16x32_bf16 v[40:43], a[20:23], a[80:83], v[40:43]
  ds_read_b64_tr_b16 a[62:63], v242 offset:30176
  v_mfma_f32_16x16x32_bf16 v[48:51], a[24:27], a[80:83], v[48:51]
  buffer_load_dwordx4 v69, s[32:35], s60 offen offset:1056 lds
  s_add_u32 m0, s76, 60160
  v_mfma_f32_16x16x32_bf16 v[52:55], a[24:27], a[84:87], v[52:55]
  buffer_load_dwordx4 v245, s[32:35], s60 offen lds
  v_mfma_f32_16x16x32_bf16 v[60:63], a[28:31], a[84:87], v[60:63]
  v_mfma_f32_16x16x32_bf16 v[56:59], a[28:31], a[80:83], v[56:59]
  buffer_load_dwordx4 v75, s[32:35], s60 offen offset:1056 lds
  s_waitcnt vmcnt(19) lgkmcnt(0)
  v_mfma_f32_16x16x32_bf16 v[0:3], a[32:35], a[88:91], v[0:3]
  s_waitcnt vmcnt(27)
  s_barrier
  v_mfma_f32_16x16x32_bf16 v[4:7], a[32:35], a[92:95], v[4:7]
  ds_read_b64_tr_b16 a[0:1], v243 offset:1024
  buffer_load_dwordx4 a[140:143], v247, s[36:39], s62 offen offset:1024 sc1
  ds_read_b64_tr_b16 a[2:3], v243 offset:1536
  v_mfma_f32_16x16x32_bf16 v[12:15], a[36:39], a[92:95], v[12:15]
  s_add_u32 s61, s21, 2
  ds_read_b64_tr_b16 a[4:5], v243 offset:1056
  v_mfma_f32_16x16x32_bf16 v[8:11], a[36:39], a[88:91], v[8:11]
  ds_read_b64_tr_b16 a[6:7], v243 offset:1568
  s_and_b32 s61, s61, 3
  ds_read_b64_tr_b16 a[8:9], v243 offset:1088
  v_mfma_f32_16x16x32_bf16 v[16:19], a[40:43], a[88:91], v[16:19]
  s_add_u32 s61, s61, 4
  ds_read_b64_tr_b16 a[10:11], v243 offset:1600
  s_and_b32 s75, s61, 1
  v_mfma_f32_16x16x32_bf16 v[20:23], a[40:43], a[92:95], v[20:23]
  ds_read_b64_tr_b16 a[12:13], v243 offset:1120
  ds_read_b64_tr_b16 a[14:15], v243 offset:1632
  s_and_b32 s61, s61, 6
  v_mfma_f32_16x16x32_bf16 v[28:31], a[44:47], a[92:95], v[28:31]
  ds_read_b64_tr_b16 a[16:17], v243 offset:9472
  s_lshl_b32 s61, s61, 1
  v_mfma_f32_16x16x32_bf16 v[24:27], a[44:47], a[88:91], v[24:27]
  ds_read_b64_tr_b16 a[18:19], v243 offset:9984
  s_mul_i32 s75, s75, 3
  ds_read_b64_tr_b16 a[20:21], v243 offset:9504
  v_mfma_f32_16x16x32_bf16 v[32:35], a[48:51], a[88:91], v[32:35]
  s_add_u32 s61, s61, s75
  ds_read_b64_tr_b16 a[22:23], v243 offset:10016
  v_mfma_f32_16x16x32_bf16 v[36:39], a[48:51], a[92:95], v[36:39]
  ds_read_b64_tr_b16 a[24:25], v243 offset:9536
  s_mul_i32 s61, s61, 229376
  ds_read_b64_tr_b16 a[26:27], v243 offset:10048
  v_mfma_f32_16x16x32_bf16 v[44:47], a[52:55], a[92:95], v[44:47]
  s_add_u32 m0, s76, 68608
  ds_read_b64_tr_b16 a[28:29], v243 offset:9568
  v_mfma_f32_16x16x32_bf16 v[40:43], a[52:55], a[88:91], v[40:43]
  buffer_load_dwordx4 v244, s[32:35], s61 offen lds
  ds_read_b64_tr_b16 a[30:31], v243 offset:10080
  v_mfma_f32_16x16x32_bf16 v[48:51], a[56:59], a[88:91], v[48:51]
  buffer_load_dwordx4 a[144:147], v246, s[36:39], s63 offen offset:0 sc1
  v_readlane_b32 s62, v232, 6
  v_mfma_f32_16x16x32_bf16 v[52:55], a[56:59], a[92:95], v[52:55]
  v_mfma_f32_16x16x32_bf16 v[60:63], a[60:63], a[92:95], v[60:63]
  buffer_load_dwordx4 v69, s[32:35], s61 offen offset:1056 lds
  v_mfma_f32_16x16x32_bf16 v[56:59], a[60:63], a[88:91], v[56:59]
  buffer_load_dwordx4 a[148:151], v247, s[36:39], s63 offen offset:0 sc1
  s_waitcnt vmcnt(22) lgkmcnt(0)
  v_mfma_f32_16x16x32_bf16 v[0:3], a[0:3], a[96:99], v[0:3]
  ds_read_b64_tr_b16 a[32:33], v243 offset:5248
  ds_read_b64_tr_b16 a[34:35], v243 offset:5760
  v_mfma_f32_16x16x32_bf16 v[4:7], a[0:3], a[100:103], v[4:7]
  buffer_load_dwordx4 a[152:155], v246, s[36:39], s63 offen offset:1024 sc1
  ds_read_b64_tr_b16 a[36:37], v243 offset:5280
  v_mfma_f32_16x16x32_bf16 v[12:15], a[4:7], a[100:103], v[12:15]
  ds_read_b64_tr_b16 a[38:39], v243 offset:5792
  v_mfma_f32_16x16x32_bf16 v[8:11], a[4:7], a[96:99], v[8:11]
  ds_read_b64_tr_b16 a[40:41], v243 offset:5312
  s_add_u32 m0, s76, 77056
  v_mfma_f32_16x16x32_bf16 v[16:19], a[8:11], a[96:99], v[16:19]
  ds_read_b64_tr_b16 a[42:43], v243 offset:5824
  ds_read_b64_tr_b16 a[44:45], v243 offset:5344
  v_mfma_f32_16x16x32_bf16 v[20:23], a[8:11], a[100:103], v[20:23]
  buffer_load_dwordx4 v245, s[32:35], s61 offen lds
  ds_read_b64_tr_b16 a[46:47], v243 offset:5856
  v_mfma_f32_16x16x32_bf16 v[28:31], a[12:15], a[100:103], v[28:31]
  ds_read_b64_tr_b16 a[48:49], v243 offset:13696
  ds_read_b64_tr_b16 a[50:51], v243 offset:14208
  v_mfma_f32_16x16x32_bf16 v[24:27], a[12:15], a[96:99], v[24:27]
  buffer_load_dwordx4 a[156:159], v247, s[36:39], s63 offen offset:1024 sc1
  ds_read_b64_tr_b16 a[52:53], v243 offset:13728
  v_mfma_f32_16x16x32_bf16 v[32:35], a[16:19], a[96:99], v[32:35]
  ds_read_b64_tr_b16 a[54:55], v243 offset:14240
  v_mfma_f32_16x16x32_bf16 v[36:39], a[16:19], a[100:103], v[36:39]
  ds_read_b64_tr_b16 a[56:57], v243 offset:13760
  v_mfma_f32_16x16x32_bf16 v[44:47], a[20:23], a[100:103], v[44:47]
  ds_read_b64_tr_b16 a[58:59], v243 offset:14272
  ds_read_b64_tr_b16 a[60:61], v243 offset:13792
  v_mfma_f32_16x16x32_bf16 v[40:43], a[20:23], a[96:99], v[40:43]
  buffer_load_dwordx4 v75, s[32:35], s61 offen offset:1056 lds
  ds_read_b64_tr_b16 a[62:63], v243 offset:14304
  v_mfma_f32_16x16x32_bf16 v[48:51], a[24:27], a[96:99], v[48:51]
  v_mfma_f32_16x16x32_bf16 v[52:55], a[24:27], a[100:103], v[52:55]
  buffer_load_dwordx4 a[160:163], v246, s[36:39], s62 offen offset:0 sc1
  v_mfma_f32_16x16x32_bf16 v[60:63], a[28:31], a[100:103], v[60:63]
  v_mfma_f32_16x16x32_bf16 v[56:59], a[28:31], a[96:99], v[56:59]
  v_readlane_b32 s63, v232, 7
  s_waitcnt vmcnt(25) lgkmcnt(0)
  v_mfma_f32_16x16x32_bf16 v[0:3], a[32:35], a[104:107], v[0:3]
  s_waitcnt vmcnt(37)
  s_barrier
  v_mfma_f32_16x16x32_bf16 v[4:7], a[32:35], a[108:111], v[4:7]
  ds_read_b64_tr_b16 a[0:1], v243 offset:17920
  buffer_load_dwordx4 a[164:167], v247, s[36:39], s62 offen offset:0 sc1
  ds_read_b64_tr_b16 a[2:3], v243 offset:18432
  v_mfma_f32_16x16x32_bf16 v[12:15], a[36:39], a[108:111], v[12:15]
  s_add_u32 s60, s21, 3
  ds_read_b64_tr_b16 a[4:5], v243 offset:17952
  s_and_b32 s60, s60, 3
  v_mfma_f32_16x16x32_bf16 v[8:11], a[36:39], a[104:107], v[8:11]
  ds_read_b64_tr_b16 a[6:7], v243 offset:18464
  ds_read_b64_tr_b16 a[8:9], v243 offset:17984
  s_add_u32 s60, s60, 4
  v_mfma_f32_16x16x32_bf16 v[16:19], a[40:43], a[104:107], v[16:19]
  ds_read_b64_tr_b16 a[10:11], v243 offset:18496
  s_and_b32 s75, s60, 1
  v_mfma_f32_16x16x32_bf16 v[20:23], a[40:43], a[108:111], v[20:23]
  ds_read_b64_tr_b16 a[12:13], v243 offset:18016
  s_and_b32 s60, s60, 6
  ds_read_b64_tr_b16 a[14:15], v243 offset:18528
  v_mfma_f32_16x16x32_bf16 v[28:31], a[44:47], a[108:111], v[28:31]
  s_lshl_b32 s60, s60, 1
  ds_read_b64_tr_b16 a[16:17], v243 offset:26368
  s_mul_i32 s75, s75, 3
  v_mfma_f32_16x16x32_bf16 v[24:27], a[44:47], a[104:107], v[24:27]
  ds_read_b64_tr_b16 a[18:19], v243 offset:26880
  s_add_u32 s60, s60, s75
  ds_read_b64_tr_b16 a[20:21], v243 offset:26400
  v_mfma_f32_16x16x32_bf16 v[32:35], a[48:51], a[104:107], v[32:35]
  s_mul_i32 s60, s60, 229376
  ds_read_b64_tr_b16 a[22:23], v243 offset:26912
  v_mfma_f32_16x16x32_bf16 v[36:39], a[48:51], a[108:111], v[36:39]
  ds_read_b64_tr_b16 a[24:25], v243 offset:26432
  s_add_u32 m0, s76, 85504
  ds_read_b64_tr_b16 a[26:27], v243 offset:26944
  v_mfma_f32_16x16x32_bf16 v[44:47], a[52:55], a[108:111], v[44:47]
  buffer_load_dwordx4 v244, s[32:35], s60 offen lds
  ds_read_b64_tr_b16 a[28:29], v243 offset:26464
  v_readlane_b32 s61, v239, 8
  v_mfma_f32_16x16x32_bf16 v[40:43], a[52:55], a[104:107], v[40:43]
  ds_read_b64_tr_b16 a[30:31], v243 offset:26976
  v_mfma_f32_16x16x32_bf16 v[48:51], a[56:59], a[104:107], v[48:51]
  buffer_load_dwordx4 v69, s[32:35], s60 offen offset:1056 lds
  v_mfma_f32_16x16x32_bf16 v[52:55], a[56:59], a[108:111], v[52:55]
  s_add_u32 m0, s76, 93952
  v_mfma_f32_16x16x32_bf16 v[60:63], a[60:63], a[108:111], v[60:63]
  buffer_load_dwordx4 v245, s[32:35], s60 offen lds
  v_mfma_f32_16x16x32_bf16 v[56:59], a[60:63], a[104:107], v[56:59]
  buffer_load_dwordx4 v75, s[32:35], s60 offen offset:1056 lds
  s_waitcnt vmcnt(27) lgkmcnt(0)
  v_mfma_f32_16x16x32_bf16 v[0:3], a[0:3], a[112:115], v[0:3]
  ds_read_b64_tr_b16 a[32:33], v243 offset:22144
  ds_read_b64_tr_b16 a[34:35], v243 offset:22656
  v_mfma_f32_16x16x32_bf16 v[4:7], a[0:3], a[116:119], v[4:7]
  buffer_load_dwordx4 a[168:171], v246, s[36:39], s62 offen offset:1024 sc1
  ds_read_b64_tr_b16 a[36:37], v243 offset:22176
  v_mfma_f32_16x16x32_bf16 v[12:15], a[4:7], a[116:119], v[12:15]
  ds_read_b64_tr_b16 a[38:39], v243 offset:22688
  v_mfma_f32_16x16x32_bf16 v[8:11], a[4:7], a[112:115], v[8:11]
  ds_read_b64_tr_b16 a[40:41], v243 offset:22208
  s_add_u32 m0, s76, 129792
  v_mfma_f32_16x16x32_bf16 v[16:19], a[8:11], a[112:115], v[16:19]
  ds_read_b64_tr_b16 a[42:43], v243 offset:22720
  ds_read_b64_tr_b16 a[44:45], v243 offset:22240
  v_mfma_f32_16x16x32_bf16 v[20:23], a[8:11], a[116:119], v[20:23]
  buffer_load_dwordx4 v244, s[32:35], s61 offen lds
  ds_read_b64_tr_b16 a[46:47], v243 offset:22752
  v_mfma_f32_16x16x32_bf16 v[28:31], a[12:15], a[116:119], v[28:31]
  ds_read_b64_tr_b16 a[48:49], v243 offset:30592
  ds_read_b64_tr_b16 a[50:51], v243 offset:31104
  v_mfma_f32_16x16x32_bf16 v[24:27], a[12:15], a[112:115], v[24:27]
  v_readlane_b32 s60, v239, 9
  ds_read_b64_tr_b16 a[52:53], v243 offset:30624
  v_mfma_f32_16x16x32_bf16 v[32:35], a[16:19], a[112:115], v[32:35]
  ds_read_b64_tr_b16 a[54:55], v243 offset:31136
  v_mfma_f32_16x16x32_bf16 v[36:39], a[16:19], a[116:119], v[36:39]
  ds_read_b64_tr_b16 a[56:57], v243 offset:30656
  buffer_load_dwordx4 a[172:175], v247, s[36:39], s62 offen offset:1024 sc1
  v_mfma_f32_16x16x32_bf16 v[44:47], a[20:23], a[116:119], v[44:47]
  ds_read_b64_tr_b16 a[58:59], v243 offset:31168
  ds_read_b64_tr_b16 a[60:61], v243 offset:30688
  v_mfma_f32_16x16x32_bf16 v[40:43], a[20:23], a[112:115], v[40:43]
  buffer_load_dwordx4 a[176:179], v246, s[36:39], s63 offen offset:0 sc1
  ds_read_b64_tr_b16 a[62:63], v243 offset:31200
  v_mfma_f32_16x16x32_bf16 v[48:51], a[24:27], a[112:115], v[48:51]
  v_mfma_f32_16x16x32_bf16 v[52:55], a[24:27], a[116:119], v[52:55]
  v_readlane_b32 s62, v232, 8
  v_mfma_f32_16x16x32_bf16 v[60:63], a[28:31], a[116:119], v[60:63]
  v_mfma_f32_16x16x32_bf16 v[56:59], a[28:31], a[112:115], v[56:59]
  buffer_load_dwordx4 a[180:183], v247, s[36:39], s63 offen offset:0 sc1
  s_waitcnt vmcnt(27) lgkmcnt(0)
  v_mfma_f32_16x16x32_bf16 v[0:3], a[32:35], a[120:123], v[0:3]
  s_waitcnt vmcnt(28)
  s_barrier
  v_mfma_f32_16x16x32_bf16 v[4:7], a[32:35], a[124:127], v[4:7]
  ds_read_b64_tr_b16 a[0:1], v243 offset:34816
  ds_read_b64_tr_b16 a[2:3], v243 offset:35328
  v_mfma_f32_16x16x32_bf16 v[12:15], a[36:39], a[124:127], v[12:15]
  buffer_load_dword v253, v252, s[56:59], s84 offen sc1
  ds_read_b64_tr_b16 a[4:5], v243 offset:34848
  v_mfma_f32_16x16x32_bf16 v[8:11], a[36:39], a[120:123], v[8:11]
  ds_read_b64_tr_b16 a[6:7], v243 offset:35360
  buffer_load_dwordx4 a[184:187], v246, s[36:39], s63 offen offset:1024 sc1
  v_mfma_f32_16x16x32_bf16 v[16:19], a[40:43], a[120:123], v[16:19]
  ds_read_b64_tr_b16 a[8:9], v243 offset:34880
  ds_read_b64_tr_b16 a[10:11], v243 offset:35392
  v_mfma_f32_16x16x32_bf16 v[20:23], a[40:43], a[124:127], v[20:23]
  ds_read_b64_tr_b16 a[12:13], v243 offset:34912
  v_mfma_f32_16x16x32_bf16 v[28:31], a[44:47], a[124:127], v[28:31]
  ds_read_b64_tr_b16 a[14:15], v243 offset:35424
  ds_read_b64_tr_b16 a[16:17], v243 offset:43264
  v_mfma_f32_16x16x32_bf16 v[24:27], a[44:47], a[120:123], v[24:27]
  buffer_load_dwordx4 v69, s[32:35], s61 offen offset:1056 lds
  ds_read_b64_tr_b16 a[18:19], v243 offset:43776
  v_mfma_f32_16x16x32_bf16 v[32:35], a[48:51], a[120:123], v[32:35]
  ds_read_b64_tr_b16 a[20:21], v243 offset:43296
  buffer_load_dwordx4 a[188:191], v247, s[36:39], s63 offen offset:1024 sc1
  v_mfma_f32_16x16x32_bf16 v[36:39], a[48:51], a[124:127], v[36:39]
  ds_read_b64_tr_b16 a[22:23], v243 offset:43808
  ds_read_b64_tr_b16 a[24:25], v243 offset:43328
  v_mfma_f32_16x16x32_bf16 v[44:47], a[52:55], a[124:127], v[44:47]
  ds_read_b64_tr_b16 a[26:27], v243 offset:43840
  s_add_u32 m0, s76, 138240
  v_mfma_f32_16x16x32_bf16 v[40:43], a[52:55], a[120:123], v[40:43]
  ds_read_b64_tr_b16 a[28:29], v243 offset:43360
  ds_read_b64_tr_b16 a[30:31], v243 offset:43872
  v_mfma_f32_16x16x32_bf16 v[48:51], a[56:59], a[120:123], v[48:51]
  buffer_load_dwordx4 v245, s[32:35], s61 offen lds
  v_mfma_f32_16x16x32_bf16 v[52:55], a[56:59], a[124:127], v[52:55]
  v_mfma_f32_16x16x32_bf16 v[60:63], a[60:63], a[124:127], v[60:63]
  v_mfma_f32_16x16x32_bf16 v[56:59], a[60:63], a[120:123], v[56:59]
  buffer_load_dwordx4 v75, s[32:35], s61 offen offset:1056 lds
  s_waitcnt vmcnt(31) lgkmcnt(0)
  v_mfma_f32_16x16x32_bf16 v[0:3], a[0:3], a[128:131], v[0:3]
  ds_read_b64_tr_b16 a[32:33], v243 offset:39040
  s_waitcnt vmcnt(5)
  v_mfma_f32_16x16x32_bf16 v[4:7], a[0:3], a[132:135], v[4:7]
  ds_read_b64_tr_b16 a[34:35], v243 offset:39552
  ds_read_b64_tr_b16 a[36:37], v243 offset:39072
  v_mfma_f32_16x16x32_bf16 v[12:15], a[4:7], a[132:135], v[12:15]
  v_cmp_eq_u32 vcc, 0, v253
  s_cmp_eq_u64 vcc, 0
  s_cbranch_scc1 L_gok_43
  s_mov_b32 s96, 0
L_poll_44:
  buffer_load_dword v253, v252, s[56:59], s84 offen sc1
  s_waitcnt vmcnt(0)
  v_cmp_eq_u32 vcc, 0, v253
  s_add_u32 s96, s96, 1
  s_cmp_eq_u64 vcc, 0
  s_cbranch_scc1 L_ok_45
  s_sleep 2
  s_cmp_lt_u32 s96, 0x200000
  s_cbranch_scc1 L_poll_44
L_ok_45:
L_gok_43:
  ds_read_b64_tr_b16 a[38:39], v243 offset:39584
  v_mfma_f32_16x16x32_bf16 v[8:11], a[4:7], a[128:131], v[8:11]
  ds_read_b64_tr_b16 a[40:41], v243 offset:39104
  buffer_load_dwordx4 a[192:195], v246, s[36:39], s62 offen offset:0 sc1
  v_mfma_f32_16x16x32_bf16 v[16:19], a[8:11], a[128:131], v[16:19]
  ds_read_b64_tr_b16 a[42:43], v243 offset:39616
  ds_read_b64_tr_b16 a[44:45], v243 offset:39136
  v_mfma_f32_16x16x32_bf16 v[20:23], a[8:11], a[132:135], v[20:23]
  v_readlane_b32 s63, v232, 9
  ds_read_b64_tr_b16 a[46:47], v243 offset:39648
  v_mfma_f32_16x16x32_bf16 v[28:31], a[12:15], a[132:135], v[28:31]
  ds_read_b64_tr_b16 a[48:49], v243 offset:47488
  s_add_u32 m0, s76, 146688
  v_mfma_f32_16x16x32_bf16 v[24:27], a[12:15], a[128:131], v[24:27]
  ds_read_b64_tr_b16 a[50:51], v243 offset:48000
  buffer_load_dwordx4 v244, s[32:35], s60 offen lds
  v_mfma_f32_16x16x32_bf16 v[32:35], a[16:19], a[128:131], v[32:35]
  ds_read_b64_tr_b16 a[52:53], v243 offset:47520
  ds_read_b64_tr_b16 a[54:55], v243 offset:48032
  v_mfma_f32_16x16x32_bf16 v[36:39], a[16:19], a[132:135], v[36:39]
  v_readlane_b32 s61, v239, 10
  ds_read_b64_tr_b16 a[56:57], v243 offset:47552
  v_mfma_f32_16x16x32_bf16 v[44:47], a[20:23], a[132:135], v[44:47]
  ds_read_b64_tr_b16 a[58:59], v243 offset:48064
  buffer_load_dwordx4 a[196:199], v247, s[36:39], s62 offen offset:0 sc1
  v_mfma_f32_16x16x32_bf16 v[40:43], a[20:23], a[128:131], v[40:43]
  ds_read_b64_tr_b16 a[60:61], v243 offset:47584
  ds_read_b64_tr_b16 a[62:63], v243 offset:48096
  v_mfma_f32_16x16x32_bf16 v[48:51], a[24:27], a[128:131], v[48:51]
  s_nop 0
  buffer_load_dwordx4 v69, s[32:35], s60 offen offset:1056 lds
  v_mfma_f32_16x16x32_bf16 v[52:55], a[24:27], a[132:135], v[52:55]
  v_mfma_f32_16x16x32_bf16 v[60:63], a[28:31], a[132:135], v[60:63]
  s_add_u32 m0, s76, 155136
  v_mfma_f32_16x16x32_bf16 v[56:59], a[28:31], a[128:131], v[56:59]
  buffer_load_dwordx4 v245, s[32:35], s60 offen lds
  s_waitcnt vmcnt(30) lgkmcnt(0)
  v_mfma_f32_16x16x32_bf16 v[0:3], a[32:35], a[136:139], v[0:3]
  s_waitcnt vmcnt(31)
  s_barrier
  v_mfma_f32_16x16x32_bf16 v[4:7], a[32:35], a[140:143], v[4:7]
  ds_read_b64_tr_b16 a[0:1], v68 offset:0
  ds_read_b64_tr_b16 a[2:3], v68 offset:512
  v_mfma_f32_16x16x32_bf16 v[12:15], a[36:39], a[140:143], v[12:15]
  buffer_load_dwordx4 a[200:203], v246, s[36:39], s62 offen offset:1024 sc1
  ds_read_b64_tr_b16 a[4:5], v68 offset:32
  v_mfma_f32_16x16x32_bf16 v[8:11], a[36:39], a[136:139], v[8:11]
  ds_read_b64_tr_b16 a[6:7], v68 offset:544
  ds_read_b64_tr_b16 a[8:9], v68 offset:64
  v_mfma_f32_16x16x32_bf16 v[16:19], a[40:43], a[136:139], v[16:19]
  ds_read_b64_tr_b16 a[10:11], v68 offset:576
  v_mfma_f32_16x16x32_bf16 v[20:23], a[40:43], a[140:143], v[20:23]
  ds_read_b64_tr_b16 a[12:13], v68 offset:96
  ds_read_b64_tr_b16 a[14:15], v68 offset:608
  v_mfma_f32_16x16x32_bf16 v[28:31], a[44:47], a[140:143], v[28:31]
  buffer_load_dwordx4 v75, s[32:35], s60 offen offset:1056 lds
  ds_read_b64_tr_b16 a[16:17], v68 offset:8448
  v_mfma_f32_16x16x32_bf16 v[24:27], a[44:47], a[136:139], v[24:27]
  ds_read_b64_tr_b16 a[18:19], v68 offset:8960
  ds_read_b64_tr_b16 a[20:21], v68 offset:8480
  v_mfma_f32_16x16x32_bf16 v[32:35], a[48:51], a[136:139], v[32:35]
  buffer_load_dwordx4 a[204:207], v247, s[36:39], s62 offen offset:1024 sc1
  ds_read_b64_tr_b16 a[22:23], v68 offset:8992
  v_mfma_f32_16x16x32_bf16 v[36:39], a[48:51], a[140:143], v[36:39]
  ds_read_b64_tr_b16 a[24:25], v68 offset:8512
  ds_read_b64_tr_b16 a[26:27], v68 offset:9024
  v_mfma_f32_16x16x32_bf16 v[44:47], a[52:55], a[140:143], v[44:47]
  ds_read_b64_tr_b16 a[28:29], v68 offset:8544
  buffer_load_dwordx4 a[208:211], v246, s[36:39], s63 offen offset:0 sc1
  v_mfma_f32_16x16x32_bf16 v[40:43], a[52:55], a[136:139], v[40:43]
  ds_read_b64_tr_b16 a[30:31], v68 offset:9056
  v_mfma_f32_16x16x32_bf16 v[48:51], a[56:59], a[136:139], v[48:51]
  v_readlane_b32 s62, v232, 10
  v_mfma_f32_16x16x32_bf16 v[52:55], a[56:59], a[140:143], v[52:55]
  v_mfma_f32_16x16x32_bf16 v[60:63], a[60:63], a[140:143], v[60:63]
  buffer_load_dwordx4 a[212:215], v247, s[36:39], s63 offen offset:0 sc1
  v_mfma_f32_16x16x32_bf16 v[56:59], a[60:63], a[136:139], v[56:59]
  s_waitcnt vmcnt(31) lgkmcnt(0)
  v_mfma_f32_16x16x32_bf16 v[0:3], a[0:3], a[144:147], v[0:3]
  ds_read_b64_tr_b16 a[32:33], v68 offset:4224
  ds_read_b64_tr_b16 a[34:35], v68 offset:4736
  v_mfma_f32_16x16x32_bf16 v[4:7], a[0:3], a[148:151], v[4:7]
  buffer_load_dwordx4 a[216:219], v246, s[36:39], s63 offen offset:1024 sc1
  ds_read_b64_tr_b16 a[36:37], v68 offset:4256
  v_mfma_f32_16x16x32_bf16 v[12:15], a[4:7], a[148:151], v[12:15]
  ds_read_b64_tr_b16 a[38:39], v68 offset:4768
  s_add_u32 m0, s76, 1024
  v_mfma_f32_16x16x32_bf16 v[8:11], a[4:7], a[144:147], v[8:11]
  ds_read_b64_tr_b16 a[40:41], v68 offset:4288
  ds_read_b64_tr_b16 a[42:43], v68 offset:4800
  v_mfma_f32_16x16x32_bf16 v[16:19], a[8:11], a[144:147], v[16:19]
  buffer_load_dwordx4 v244, s[32:35], s61 offen lds
  ds_read_b64_tr_b16 a[44:45], v68 offset:4320
  v_mfma_f32_16x16x32_bf16 v[20:23], a[8:11], a[148:151], v[20:23]
  ds_read_b64_tr_b16 a[46:47], v68 offset:4832
  v_readlane_b32 s60, v239, 11
  v_mfma_f32_16x16x32_bf16 v[28:31], a[12:15], a[148:151], v[28:31]
  ds_read_b64_tr_b16 a[48:49], v68 offset:12672
  ds_read_b64_tr_b16 a[50:51], v68 offset:13184
  v_mfma_f32_16x16x32_bf16 v[24:27], a[12:15], a[144:147], v[24:27]
  ds_read_b64_tr_b16 a[52:53], v68 offset:12704
  v_mfma_f32_16x16x32_bf16 v[32:35], a[16:19], a[144:147], v[32:35]
  ds_read_b64_tr_b16 a[54:55], v68 offset:13216
  buffer_load_dwordx4 v69, s[32:35], s61 offen offset:1056 lds
  v_mfma_f32_16x16x32_bf16 v[36:39], a[16:19], a[148:151], v[36:39]
  ds_read_b64_tr_b16 a[56:57], v68 offset:12736
  ds_read_b64_tr_b16 a[58:59], v68 offset:13248
  v_mfma_f32_16x16x32_bf16 v[44:47], a[20:23], a[148:151], v[44:47]
  s_add_u32 m0, s76, 9472
  ds_read_b64_tr_b16 a[60:61], v68 offset:12768
  v_mfma_f32_16x16x32_bf16 v[40:43], a[20:23], a[144:147], v[40:43]
  ds_read_b64_tr_b16 a[62:63], v68 offset:13280
  v_mfma_f32_16x16x32_bf16 v[48:51], a[24:27], a[144:147], v[48:51]
  buffer_load_dwordx4 v245, s[32:35], s61 offen lds
  v_mfma_f32_16x16x32_bf16 v[52:55], a[24:27], a[148:151], v[52:55]
  v_mfma_f32_16x16x32_bf16 v[60:63], a[28:31], a[148:151], v[60:63]
  v_mfma_f32_16x16x32_bf16 v[56:59], a[28:31], a[144:147], v[56:59]
  buffer_load_dwordx4 v75, s[32:35], s61 offen offset:1056 lds
  s_waitcnt vmcnt(33) lgkmcnt(0)
  v_mfma_f32_16x16x32_bf16 v[0:3], a[32:35], a[152:155], v[0:3]
  s_waitcnt vmcnt(32)
  s_barrier
  v_mfma_f32_16x16x32_bf16 v[4:7], a[32:35], a[156:159], v[4:7]
  ds_read_b64_tr_b16 a[0:1], v68 offset:16896
  ds_read_b64_tr_b16 a[2:3], v68 offset:17408
  v_mfma_f32_16x16x32_bf16 v[12:15], a[36:39], a[156:159], v[12:15]
  buffer_load_dwordx4 a[220:223], v247, s[36:39], s63 offen offset:1024 sc1
  ds_read_b64_tr_b16 a[4:5], v68 offset:16928
  v_mfma_f32_16x16x32_bf16 v[8:11], a[36:39], a[152:155], v[8:11]
  ds_read_b64_tr_b16 a[6:7], v68 offset:17440
  s_add_u32 m0, s76, 17920
  v_mfma_f32_16x16x32_bf16 v[16:19], a[40:43], a[152:155], v[16:19]
  ds_read_b64_tr_b16 a[8:9], v68 offset:16960
  ds_read_b64_tr_b16 a[10:11], v68 offset:17472
  v_mfma_f32_16x16x32_bf16 v[20:23], a[40:43], a[156:159], v[20:23]
  ds_read_b64_tr_b16 a[12:13], v68 offset:16992
  buffer_load_dwordx4 v244, s[32:35], s60 offen lds
  v_mfma_f32_16x16x32_bf16 v[28:31], a[44:47], a[156:159], v[28:31]
  ds_read_b64_tr_b16 a[14:15], v68 offset:17504
  ds_read_b64_tr_b16 a[16:17], v68 offset:25344
  v_mfma_f32_16x16x32_bf16 v[24:27], a[44:47], a[152:155], v[24:27]
  v_readlane_b32 s61, v239, 12
  ds_read_b64_tr_b16 a[18:19], v68 offset:25856
  v_mfma_f32_16x16x32_bf16 v[32:35], a[48:51], a[152:155], v[32:35]
  ds_read_b64_tr_b16 a[20:21], v68 offset:25376
  buffer_load_dwordx4 a[224:227], v246, s[36:39], s62 offen offset:0 sc1
  v_mfma_f32_16x16x32_bf16 v[36:39], a[48:51], a[156:159], v[36:39]
  ds_read_b64_tr_b16 a[22:23], v68 offset:25888
  ds_read_b64_tr_b16 a[24:25], v68 offset:25408
  v_mfma_f32_16x16x32_bf16 v[44:47], a[52:55], a[156:159], v[44:47]
  ds_read_b64_tr_b16 a[26:27], v68 offset:25920
  v_readlane_b32 s63, v232, 11
  v_mfma_f32_16x16x32_bf16 v[40:43], a[52:55], a[152:155], v[40:43]
  ds_read_b64_tr_b16 a[28:29], v68 offset:25440
  ds_read_b64_tr_b16 a[30:31], v68 offset:25952
  v_mfma_f32_16x16x32_bf16 v[48:51], a[56:59], a[152:155], v[48:51]
  v_mfma_f32_16x16x32_bf16 v[52:55], a[56:59], a[156:159], v[52:55]
  buffer_load_dwordx4 v69, s[32:35], s60 offen offset:1056 lds
  v_mfma_f32_16x16x32_bf16 v[60:63], a[60:63], a[156:159], v[60:63]
  v_mfma_f32_16x16x32_bf16 v[56:59], a[60:63], a[152:155], v[56:59]
  buffer_load_dwordx4 a[228:231], v247, s[36:39], s62 offen offset:0 sc1
  s_waitcnt vmcnt(35) lgkmcnt(0)
  v_mfma_f32_16x16x32_bf16 v[0:3], a[0:3], a[160:163], v[0:3]
  ds_read_b64_tr_b16 a[32:33], v68 offset:21120
  ds_read_b64_tr_b16 a[34:35], v68 offset:21632
  v_mfma_f32_16x16x32_bf16 v[4:7], a[0:3], a[164:167], v[4:7]
  buffer_load_dwordx4 a[232:235], v246, s[36:39], s62 offen offset:1024 sc1
  ds_read_b64_tr_b16 a[36:37], v68 offset:21152
  v_mfma_f32_16x16x32_bf16 v[12:15], a[4:7], a[164:167], v[12:15]
  ds_read_b64_tr_b16 a[38:39], v68 offset:21664
  v_mfma_f32_16x16x32_bf16 v[8:11], a[4:7], a[160:163], v[8:11]
  ds_read_b64_tr_b16 a[40:41], v68 offset:21184
  s_add_u32 m0, s76, 26368
  v_mfma_f32_16x16x32_bf16 v[16:19], a[8:11], a[160:163], v[16:19]
  ds_read_b64_tr_b16 a[42:43], v68 offset:21696
  ds_read_b64_tr_b16 a[44:45], v68 offset:21216
  v_mfma_f32_16x16x32_bf16 v[20:23], a[8:11], a[164:167], v[20:23]
  buffer_load_dwordx4 v245, s[32:35], s60 offen lds
  ds_read_b64_tr_b16 a[46:47], v68 offset:21728
  v_mfma_f32_16x16x32_bf16 v[28:31], a[12:15], a[164:167], v[28:31]
  ds_read_b64_tr_b16 a[48:49], v68 offset:29568
  ds_read_b64_tr_b16 a[50:51], v68 offset:30080
  v_mfma_f32_16x16x32_bf16 v[24:27], a[12:15], a[160:163], v[24:27]
  buffer_load_dwordx4 a[236:239], v247, s[36:39], s62 offen offset:1024 sc1
  ds_read_b64_tr_b16 a[52:53], v68 offset:29600
  v_mfma_f32_16x16x32_bf16 v[32:35], a[16:19], a[160:163], v[32:35]
  ds_read_b64_tr_b16 a[54:55], v68 offset:30112
  v_mfma_f32_16x16x32_bf16 v[36:39], a[16:19], a[164:167], v[36:39]
  ds_read_b64_tr_b16 a[56:57], v68 offset:29632
  v_mfma_f32_16x16x32_bf16 v[44:47], a[20:23], a[164:167], v[44:47]
  ds_read_b64_tr_b16 a[58:59], v68 offset:30144
  ds_read_b64_tr_b16 a[60:61], v68 offset:29664
  v_mfma_f32_16x16x32_bf16 v[40:43], a[20:23], a[160:163], v[40:43]
  buffer_load_dwordx4 v75, s[32:35], s60 offen offset:1056 lds
  ds_read_b64_tr_b16 a[62:63], v68 offset:30176
  v_mfma_f32_16x16x32_bf16 v[48:51], a[24:27], a[160:163], v[48:51]
  v_mfma_f32_16x16x32_bf16 v[52:55], a[24:27], a[164:167], v[52:55]
  buffer_load_dwordx4 a[240:243], v246, s[36:39], s63 offen offset:0 sc1
  v_mfma_f32_16x16x32_bf16 v[60:63], a[28:31], a[164:167], v[60:63]
  v_mfma_f32_16x16x32_bf16 v[56:59], a[28:31], a[160:163], v[56:59]
  v_readlane_b32 s62, v232, 12
  s_waitcnt vmcnt(33) lgkmcnt(0)
  v_mfma_f32_16x16x32_bf16 v[0:3], a[32:35], a[168:171], v[0:3]
  s_waitcnt vmcnt(36)
  s_barrier
  v_mfma_f32_16x16x32_bf16 v[4:7], a[32:35], a[172:175], v[4:7]
  ds_read_b64_tr_b16 a[0:1], v68 offset:33792
  ds_read_b64_tr_b16 a[2:3], v68 offset:34304
  v_mfma_f32_16x16x32_bf16 v[12:15], a[36:39], a[172:175], v[12:15]
  buffer_load_dwordx4 a[244:247], v247, s[36:39], s63 offen offset:0 sc1
  ds_read_b64_tr_b16 a[4:5], v68 offset:33824
  v_mfma_f32_16x16x32_bf16 v[8:11], a[36:39], a[168:171], v[8:11]
  ds_read_b64_tr_b16 a[6:7], v68 offset:34336
  s_add_u32 m0, s76, 34816
  v_mfma_f32_16x16x32_bf16 v[16:19], a[40:43], a[168:171], v[16:19]
  ds_read_b64_tr_b16 a[8:9], v68 offset:33856
  ds_read_b64_tr_b16 a[10:11], v68 offset:34368
  v_mfma_f32_16x16x32_bf16 v[20:23], a[40:43], a[172:175], v[20:23]
  buffer_load_dwordx4 v244, s[32:35], s61 offen lds
  ds_read_b64_tr_b16 a[12:13], v68 offset:33888
  v_mfma_f32_16x16x32_bf16 v[28:31], a[44:47], a[172:175], v[28:31]
  ds_read_b64_tr_b16 a[14:15], v68 offset:34400
  v_readlane_b32 s60, v239, 13
  v_mfma_f32_16x16x32_bf16 v[24:27], a[44:47], a[168:171], v[24:27]
  ds_read_b64_tr_b16 a[16:17], v68 offset:42240
  ds_read_b64_tr_b16 a[18:19], v68 offset:42752
  v_mfma_f32_16x16x32_bf16 v[32:35], a[48:51], a[168:171], v[32:35]
  ds_read_b64_tr_b16 a[20:21], v68 offset:42272
  v_mfma_f32_16x16x32_bf16 v[36:39], a[48:51], a[172:175], v[36:39]
  ds_read_b64_tr_b16 a[22:23], v68 offset:42784
  ds_read_b64_tr_b16 a[24:25], v68 offset:42304
  v_mfma_f32_16x16x32_bf16 v[44:47], a[52:55], a[172:175], v[44:47]
  buffer_load_dwordx4 v69, s[32:35], s61 offen offset:1056 lds
  ds_read_b64_tr_b16 a[26:27], v68 offset:42816
  v_mfma_f32_16x16x32_bf16 v[40:43], a[52:55], a[168:171], v[40:43]
  ds_read_b64_tr_b16 a[28:29], v68 offset:42336
  s_add_u32 m0, s76, 43264
  v_mfma_f32_16x16x32_bf16 v[48:51], a[56:59], a[168:171], v[48:51]
  ds_read_b64_tr_b16 a[30:31], v68 offset:42848
  buffer_load_dwordx4 v245, s[32:35], s61 offen lds
  v_mfma_f32_16x16x32_bf16 v[52:55], a[56:59], a[172:175], v[52:55]
  v_mfma_f32_16x16x32_bf16 v[60:63], a[60:63], a[172:175], v[60:63]
  v_mfma_f32_16x16x32_bf16 v[56:59], a[60:63], a[168:171], v[56:59]
  buffer_load_dwordx4 v75, s[32:35], s61 offen offset:1056 lds
  s_waitcnt vmcnt(36) lgkmcnt(0)
  v_mfma_f32_16x16x32_bf16 v[0:3], a[0:3], a[176:179], v[0:3]
  ds_read_b64_tr_b16 a[32:33], v68 offset:38016
  ds_read_b64_tr_b16 a[34:35], v68 offset:38528
  v_mfma_f32_16x16x32_bf16 v[4:7], a[0:3], a[180:183], v[4:7]
  buffer_load_dwordx4 a[248:251], v246, s[36:39], s63 offen offset:1024 sc1
  ds_read_b64_tr_b16 a[36:37], v68 offset:38048
  v_mfma_f32_16x16x32_bf16 v[12:15], a[4:7], a[180:183], v[12:15]
  ds_read_b64_tr_b16 a[38:39], v68 offset:38560
  v_mfma_f32_16x16x32_bf16 v[8:11], a[4:7], a[176:179], v[8:11]
  ds_read_b64_tr_b16 a[40:41], v68 offset:38080
  s_add_u32 m0, s76, 51712
  v_mfma_f32_16x16x32_bf16 v[16:19], a[8:11], a[176:179], v[16:19]
  ds_read_b64_tr_b16 a[42:43], v68 offset:38592
  ds_read_b64_tr_b16 a[44:45], v68 offset:38112
  v_mfma_f32_16x16x32_bf16 v[20:23], a[8:11], a[180:183], v[20:23]
  buffer_load_dwordx4 v244, s[32:35], s60 offen lds
  ds_read_b64_tr_b16 a[46:47], v68 offset:38624
  v_mfma_f32_16x16x32_bf16 v[28:31], a[12:15], a[180:183], v[28:31]
  ds_read_b64_tr_b16 a[48:49], v68 offset:46464
  ds_read_b64_tr_b16 a[50:51], v68 offset:46976
  v_mfma_f32_16x16x32_bf16 v[24:27], a[12:15], a[176:179], v[24:27]
  v_readlane_b32 s61, v239, 14
  ds_read_b64_tr_b16 a[52:53], v68 offset:46496
  v_mfma_f32_16x16x32_bf16 v[32:35], a[16:19], a[176:179], v[32:35]
  ds_read_b64_tr_b16 a[54:55], v68 offset:47008
  v_mfma_f32_16x16x32_bf16 v[36:39], a[16:19], a[180:183], v[36:39]
  ds_read_b64_tr_b16 a[56:57], v68 offset:46528
  buffer_load_dwordx4 a[252:255], v247, s[36:39], s63 offen offset:1024 sc1
  v_mfma_f32_16x16x32_bf16 v[44:47], a[20:23], a[180:183], v[44:47]
  ds_read_b64_tr_b16 a[58:59], v68 offset:47040
  ds_read_b64_tr_b16 a[60:61], v68 offset:46560
  v_mfma_f32_16x16x32_bf16 v[40:43], a[20:23], a[176:179], v[40:43]
  buffer_load_dwordx4 a[64:67], v246, s[36:39], s62 offen offset:0 sc1
  ds_read_b64_tr_b16 a[62:63], v68 offset:47072
  v_mfma_f32_16x16x32_bf16 v[48:51], a[24:27], a[176:179], v[48:51]
  v_mfma_f32_16x16x32_bf16 v[52:55], a[24:27], a[180:183], v[52:55]
  v_readlane_b32 s63, v232, 13
  v_mfma_f32_16x16x32_bf16 v[60:63], a[28:31], a[180:183], v[60:63]
  v_mfma_f32_16x16x32_bf16 v[56:59], a[28:31], a[176:179], v[56:59]
  buffer_load_dwordx4 a[68:71], v247, s[36:39], s62 offen offset:0 sc1
  s_waitcnt vmcnt(37) lgkmcnt(0)
  v_mfma_f32_16x16x32_bf16 v[0:3], a[32:35], a[184:187], v[0:3]
  s_waitcnt vmcnt(35)
  s_barrier
  v_mfma_f32_16x16x32_bf16 v[4:7], a[32:35], a[188:191], v[4:7]
  ds_read_b64_tr_b16 a[0:1], v242 offset:0
  ds_read_b64_tr_b16 a[2:3], v242 offset:512
  v_mfma_f32_16x16x32_bf16 v[12:15], a[36:39], a[188:191], v[12:15]
  buffer_load_dwordx4 a[72:75], v246, s[36:39], s62 offen offset:1024 sc1
  ds_read_b64_tr_b16 a[4:5], v242 offset:32
  v_mfma_f32_16x16x32_bf16 v[8:11], a[36:39], a[184:187], v[8:11]
  ds_read_b64_tr_b16 a[6:7], v242 offset:544
  ds_read_b64_tr_b16 a[8:9], v242 offset:64
  v_mfma_f32_16x16x32_bf16 v[16:19], a[40:43], a[184:187], v[16:19]
  ds_read_b64_tr_b16 a[10:11], v242 offset:576
  v_mfma_f32_16x16x32_bf16 v[20:23], a[40:43], a[188:191], v[20:23]
  ds_read_b64_tr_b16 a[12:13], v242 offset:96
  buffer_load_dwordx4 v69, s[32:35], s60 offen offset:1056 lds
  v_mfma_f32_16x16x32_bf16 v[28:31], a[44:47], a[188:191], v[28:31]
  ds_read_b64_tr_b16 a[14:15], v242 offset:608
  ds_read_b64_tr_b16 a[16:17], v242 offset:8448
  v_mfma_f32_16x16x32_bf16 v[24:27], a[44:47], a[184:187], v[24:27]
  ds_read_b64_tr_b16 a[18:19], v242 offset:8960
  buffer_load_dwordx4 a[76:79], v247, s[36:39], s62 offen offset:1024 sc1
  v_mfma_f32_16x16x32_bf16 v[32:35], a[48:51], a[184:187], v[32:35]
  ds_read_b64_tr_b16 a[20:21], v242 offset:8480
  ds_read_b64_tr_b16 a[22:23], v242 offset:8992
  v_mfma_f32_16x16x32_bf16 v[36:39], a[48:51], a[188:191], v[36:39]
  ds_read_b64_tr_b16 a[24:25], v242 offset:8512
  s_add_u32 m0, s76, 60160
  v_mfma_f32_16x16x32_bf16 v[44:47], a[52:55], a[188:191], v[44:47]
  ds_read_b64_tr_b16 a[26:27], v242 offset:9024
  ds_read_b64_tr_b16 a[28:29], v242 offset:8544
  v_mfma_f32_16x16x32_bf16 v[40:43], a[52:55], a[184:187], v[40:43]
  ds_read_b64_tr_b16 a[30:31], v242 offset:9056
  buffer_load_dwordx4 v245, s[32:35], s60 offen lds
  v_mfma_f32_16x16x32_bf16 v[48:51], a[56:59], a[184:187], v[48:51]
  v_mfma_f32_16x16x32_bf16 v[52:55], a[56:59], a[188:191], v[52:55]
  v_mfma_f32_16x16x32_bf16 v[60:63], a[60:63], a[188:191], v[60:63]
  v_mfma_f32_16x16x32_bf16 v[56:59], a[60:63], a[184:187], v[56:59]
  buffer_load_dwordx4 v75, s[32:35], s60 offen offset:1056 lds
  s_waitcnt vmcnt(37) lgkmcnt(0)
  v_mfma_f32_16x16x32_bf16 v[0:3], a[0:3], a[192:195], v[0:3]
  ds_read_b64_tr_b16 a[32:33], v242 offset:4224
  ds_read_b64_tr_b16 a[34:35], v242 offset:4736
  v_mfma_f32_16x16x32_bf16 v[4:7], a[0:3], a[196:199], v[4:7]
  buffer_load_dwordx4 a[80:83], v246, s[36:39], s63 offen offset:0 sc1
  ds_read_b64_tr_b16 a[36:37], v242 offset:4256
  v_mfma_f32_16x16x32_bf16 v[12:15], a[4:7], a[196:199], v[12:15]
  ds_read_b64_tr_b16 a[38:39], v242 offset:4768
  v_readlane_b32 s62, v232, 14
  v_mfma_f32_16x16x32_bf16 v[8:11], a[4:7], a[192:195], v[8:11]
  ds_read_b64_tr_b16 a[40:41], v242 offset:4288
  ds_read_b64_tr_b16 a[42:43], v242 offset:4800
  v_mfma_f32_16x16x32_bf16 v[16:19], a[8:11], a[192:195], v[16:19]
  s_add_u32 m0, s76, 68608
  ds_read_b64_tr_b16 a[44:45], v242 offset:4320
  v_mfma_f32_16x16x32_bf16 v[20:23], a[8:11], a[196:199], v[20:23]
  ds_read_b64_tr_b16 a[46:47], v242 offset:4832
  buffer_load_dwordx4 v244, s[32:35], s61 offen lds
  v_mfma_f32_16x16x32_bf16 v[28:31], a[12:15], a[196:199], v[28:31]
  ds_read_b64_tr_b16 a[48:49], v242 offset:12672
  ds_read_b64_tr_b16 a[50:51], v242 offset:13184
  v_mfma_f32_16x16x32_bf16 v[24:27], a[12:15], a[192:195], v[24:27]
  v_readlane_b32 s60, v239, 15
  ds_read_b64_tr_b16 a[52:53], v242 offset:12704
  v_mfma_f32_16x16x32_bf16 v[32:35], a[16:19], a[192:195], v[32:35]
  ds_read_b64_tr_b16 a[54:55], v242 offset:13216
  buffer_load_dwordx4 a[84:87], v247, s[36:39], s63 offen offset:0 sc1
  v_mfma_f32_16x16x32_bf16 v[36:39], a[16:19], a[196:199], v[36:39]
  ds_read_b64_tr_b16 a[56:57], v242 offset:12736
  ds_read_b64_tr_b16 a[58:59], v242 offset:13248
  v_mfma_f32_16x16x32_bf16 v[44:47], a[20:23], a[196:199], v[44:47]
  ds_read_b64_tr_b16 a[60:61], v242 offset:12768
  v_mfma_f32_16x16x32_bf16 v[40:43], a[20:23], a[192:195], v[40:43]
  ds_read_b64_tr_b16 a[62:63], v242 offset:13280
  v_mfma_f32_16x16x32_bf16 v[48:51], a[24:27], a[192:195], v[48:51]
  buffer_load_dwordx4 v69, s[32:35], s61 offen offset:1056 lds
  v_mfma_f32_16x16x32_bf16 v[52:55], a[24:27], a[196:199], v[52:55]
  s_add_u32 m0, s76, 77056
  v_mfma_f32_16x16x32_bf16 v[60:63], a[28:31], a[196:199], v[60:63]
  v_mfma_f32_16x16x32_bf16 v[56:59], a[28:31], a[192:195], v[56:59]
  buffer_load_dwordx4 v245, s[32:35], s61 offen lds
  s_waitcnt vmcnt(37) lgkmcnt(0)
  v_mfma_f32_16x16x32_bf16 v[0:3], a[32:35], a[200:203], v[0:3]
  s_waitcnt vmcnt(38)
  s_barrier
  v_mfma_f32_16x16x32_bf16 v[4:7], a[32:35], a[204:207], v[4:7]
  ds_read_b64_tr_b16 a[0:1], v242 offset:16896
  ds_read_b64_tr_b16 a[2:3], v242 offset:17408
  v_mfma_f32_16x16x32_bf16 v[12:15], a[36:39], a[204:207], v[12:15]
  buffer_load_dwordx4 a[88:91], v246, s[36:39], s63 offen offset:1024 sc1
  ds_read_b64_tr_b16 a[4:5], v242 offset:16928
  v_mfma_f32_16x16x32_bf16 v[8:11], a[36:39], a[200:203], v[8:11]
  ds_read_b64_tr_b16 a[6:7], v242 offset:17440
  ds_read_b64_tr_b16 a[8:9], v242 offset:16960
  v_mfma_f32_16x16x32_bf16 v[16:19], a[40:43], a[200:203], v[16:19]
  ds_read_b64_tr_b16 a[10:11], v242 offset:17472
  v_mfma_f32_16x16x32_bf16 v[20:23], a[40:43], a[204:207], v[20:23]
  ds_read_b64_tr_b16 a[12:13], v242 offset:16992
  ds_read_b64_tr_b16 a[14:15], v242 offset:17504
  v_mfma_f32_16x16x32_bf16 v[28:31], a[44:47], a[204:207], v[28:31]
  buffer_load_dwordx4 v75, s[32:35], s61 offen offset:1056 lds
  ds_read_b64_tr_b16 a[16:17], v242 offset:25344
  v_mfma_f32_16x16x32_bf16 v[24:27], a[44:47], a[200:203], v[24:27]
  ds_read_b64_tr_b16 a[18:19], v242 offset:25856
  ds_read_b64_tr_b16 a[20:21], v242 offset:25376
  v_mfma_f32_16x16x32_bf16 v[32:35], a[48:51], a[200:203], v[32:35]
  buffer_load_dwordx4 a[92:95], v247, s[36:39], s63 offen offset:1024 sc1
  ds_read_b64_tr_b16 a[22:23], v242 offset:25888
  v_mfma_f32_16x16x32_bf16 v[36:39], a[48:51], a[204:207], v[36:39]
  ds_read_b64_tr_b16 a[24:25], v242 offset:25408
  ds_read_b64_tr_b16 a[26:27], v242 offset:25920
  v_mfma_f32_16x16x32_bf16 v[44:47], a[52:55], a[204:207], v[44:47]
  ds_read_b64_tr_b16 a[28:29], v242 offset:25440
  buffer_load_dwordx4 a[96:99], v246, s[36:39], s62 offen offset:0 sc1
  v_mfma_f32_16x16x32_bf16 v[40:43], a[52:55], a[200:203], v[40:43]
  ds_read_b64_tr_b16 a[30:31], v242 offset:25952
  v_mfma_f32_16x16x32_bf16 v[48:51], a[56:59], a[200:203], v[48:51]
  v_readlane_b32 s63, v232, 15
  v_mfma_f32_16x16x32_bf16 v[52:55], a[56:59], a[204:207], v[52:55]
  v_mfma_f32_16x16x32_bf16 v[60:63], a[60:63], a[204:207], v[60:63]
  buffer_load_dwordx4 a[100:103], v247, s[36:39], s62 offen offset:0 sc1
  v_mfma_f32_16x16x32_bf16 v[56:59], a[60:63], a[200:203], v[56:59]
  s_waitcnt vmcnt(40) lgkmcnt(0)
  v_mfma_f32_16x16x32_bf16 v[0:3], a[0:3], a[208:211], v[0:3]
  ds_read_b64_tr_b16 a[32:33], v242 offset:21120
  ds_read_b64_tr_b16 a[34:35], v242 offset:21632
  v_mfma_f32_16x16x32_bf16 v[4:7], a[0:3], a[212:215], v[4:7]
  buffer_load_dwordx4 a[104:107], v246, s[36:39], s62 offen offset:1024 sc1
  ds_read_b64_tr_b16 a[36:37], v242 offset:21152
  v_mfma_f32_16x16x32_bf16 v[12:15], a[4:7], a[212:215], v[12:15]
  ds_read_b64_tr_b16 a[38:39], v242 offset:21664
  s_add_u32 m0, s76, 85504
  v_mfma_f32_16x16x32_bf16 v[8:11], a[4:7], a[208:211], v[8:11]
  ds_read_b64_tr_b16 a[40:41], v242 offset:21184
  ds_read_b64_tr_b16 a[42:43], v242 offset:21696
  v_mfma_f32_16x16x32_bf16 v[16:19], a[8:11], a[208:211], v[16:19]
  buffer_load_dwordx4 v244, s[32:35], s60 offen lds
  ds_read_b64_tr_b16 a[44:45], v242 offset:21216
  v_mfma_f32_16x16x32_bf16 v[20:23], a[8:11], a[212:215], v[20:23]
  ds_read_b64_tr_b16 a[46:47], v242 offset:21728
  v_readlane_b32 s61, v239, 16
  v_mfma_f32_16x16x32_bf16 v[28:31], a[12:15], a[212:215], v[28:31]
  ds_read_b64_tr_b16 a[48:49], v242 offset:29568
  ds_read_b64_tr_b16 a[50:51], v242 offset:30080
  v_mfma_f32_16x16x32_bf16 v[24:27], a[12:15], a[208:211], v[24:27]
  ds_read_b64_tr_b16 a[52:53], v242 offset:29600
  v_mfma_f32_16x16x32_bf16 v[32:35], a[16:19], a[208:211], v[32:35]
  ds_read_b64_tr_b16 a[54:55], v242 offset:30112
  buffer_load_dwordx4 v69, s[32:35], s60 offen offset:1056 lds
  v_mfma_f32_16x16x32_bf16 v[36:39], a[16:19], a[212:215], v[36:39]
  ds_read_b64_tr_b16 a[56:57], v242 offset:29632
  ds_read_b64_tr_b16 a[58:59], v242 offset:30144
  v_mfma_f32_16x16x32_bf16 v[44:47], a[20:23], a[212:215], v[44:47]
  s_add_u32 m0, s76, 93952
  ds_read_b64_tr_b16 a[60:61], v242 offset:29664
  v_mfma_f32_16x16x32_bf16 v[40:43], a[20:23], a[208:211], v[40:43]
  ds_read_b64_tr_b16 a[62:63], v242 offset:30176
  v_mfma_f32_16x16x32_bf16 v[48:51], a[24:27], a[208:211], v[48:51]
  buffer_load_dwordx4 v245, s[32:35], s60 offen lds
  v_mfma_f32_16x16x32_bf16 v[52:55], a[24:27], a[212:215], v[52:55]
  v_mfma_f32_16x16x32_bf16 v[60:63], a[28:31], a[212:215], v[60:63]
  v_mfma_f32_16x16x32_bf16 v[56:59], a[28:31], a[208:211], v[56:59]
  buffer_load_dwordx4 v75, s[32:35], s60 offen offset:1056 lds
  s_waitcnt vmcnt(39) lgkmcnt(0)
  v_mfma_f32_16x16x32_bf16 v[0:3], a[32:35], a[216:219], v[0:3]
  s_waitcnt vmcnt(40)
  s_barrier
  v_mfma_f32_16x16x32_bf16 v[4:7], a[32:35], a[220:223], v[4:7]
  ds_read_b64_tr_b16 a[0:1], v243 offset:1024
  ds_read_b64_tr_b16 a[2:3], v243 offset:1536
  v_mfma_f32_16x16x32_bf16 v[12:15], a[36:39], a[220:223], v[12:15]
  buffer_load_dword v253, v252, s[56:59], s85 offen sc1
  ds_read_b64_tr_b16 a[4:5], v243 offset:1056
  v_mfma_f32_16x16x32_bf16 v[8:11], a[36:39], a[216:219], v[8:11]
  ds_read_b64_tr_b16 a[6:7], v243 offset:1568
  buffer_load_dwordx4 a[108:111], v247, s[36:39], s62 offen offset:1024 sc1
  v_mfma_f32_16x16x32_bf16 v[16:19], a[40:43], a[216:219], v[16:19]
  ds_read_b64_tr_b16 a[8:9], v243 offset:1088
  ds_read_b64_tr_b16 a[10:11], v243 offset:1600
  v_mfma_f32_16x16x32_bf16 v[20:23], a[40:43], a[220:223], v[20:23]
  s_add_u32 m0, s76, 129792
  ds_read_b64_tr_b16 a[12:13], v243 offset:1120
  v_mfma_f32_16x16x32_bf16 v[28:31], a[44:47], a[220:223], v[28:31]
  ds_read_b64_tr_b16 a[14:15], v243 offset:1632
  buffer_load_dwordx4 v244, s[32:35], s61 offen lds
  v_mfma_f32_16x16x32_bf16 v[24:27], a[44:47], a[216:219], v[24:27]
  ds_read_b64_tr_b16 a[16:17], v243 offset:9472
  ds_read_b64_tr_b16 a[18:19], v243 offset:9984
  v_mfma_f32_16x16x32_bf16 v[32:35], a[48:51], a[216:219], v[32:35]
  v_readlane_b32 s60, v239, 17
  ds_read_b64_tr_b16 a[20:21], v243 offset:9504
  v_mfma_f32_16x16x32_bf16 v[36:39], a[48:51], a[220:223], v[36:39]
  ds_read_b64_tr_b16 a[22:23], v243 offset:10016
  ds_read_b64_tr_b16 a[24:25], v243 offset:9536
  v_mfma_f32_16x16x32_bf16 v[44:47], a[52:55], a[220:223], v[44:47]
  buffer_load_dwordx4 a[112:115], v246, s[36:39], s63 offen offset:0 sc1
  ds_read_b64_tr_b16 a[26:27], v243 offset:10048
  v_mfma_f32_16x16x32_bf16 v[40:43], a[52:55], a[216:219], v[40:43]
  ds_read_b64_tr_b16 a[28:29], v243 offset:9568
  v_readlane_b32 s62, v232, 16
  v_mfma_f32_16x16x32_bf16 v[48:51], a[56:59], a[216:219], v[48:51]
  ds_read_b64_tr_b16 a[30:31], v243 offset:10080
  v_mfma_f32_16x16x32_bf16 v[52:55], a[56:59], a[220:223], v[52:55]
  buffer_load_dwordx4 v69, s[32:35], s61 offen offset:1056 lds
  v_mfma_f32_16x16x32_bf16 v[60:63], a[60:63], a[220:223], v[60:63]
  v_mfma_f32_16x16x32_bf16 v[56:59], a[60:63], a[216:219], v[56:59]
  buffer_load_dwordx4 a[116:119], v247, s[36:39], s63 offen offset:0 sc1
  s_waitcnt vmcnt(41) lgkmcnt(0)
  v_mfma_f32_16x16x32_bf16 v[0:3], a[0:3], a[224:227], v[0:3]
  ds_read_b64_tr_b16 a[32:33], v243 offset:5248
  s_waitcnt vmcnt(5)
  v_mfma_f32_16x16x32_bf16 v[4:7], a[0:3], a[228:231], v[4:7]
  ds_read_b64_tr_b16 a[34:35], v243 offset:5760
  ds_read_b64_tr_b16 a[36:37], v243 offset:5280
  v_mfma_f32_16x16x32_bf16 v[12:15], a[4:7], a[228:231], v[12:15]
  v_cmp_eq_u32 vcc, 0, v253
  s_cmp_eq_u64 vcc, 0
  s_cbranch_scc1 L_gok_46
  s_mov_b32 s96, 0
L_poll_47:
  buffer_load_dword v253, v252, s[56:59], s85 offen sc1
  s_waitcnt vmcnt(0)
  v_cmp_eq_u32 vcc, 0, v253
  s_add_u32 s96, s96, 1
  s_cmp_eq_u64 vcc, 0
  s_cbranch_scc1 L_ok_48
  s_sleep 2
  s_cmp_lt_u32 s96, 0x200000
  s_cbranch_scc1 L_poll_47
L_ok_48:
L_gok_46:
  ds_read_b64_tr_b16 a[38:39], v243 offset:5792
  v_mfma_f32_16x16x32_bf16 v[8:11], a[4:7], a[224:227], v[8:11]
  ds_read_b64_tr_b16 a[40:41], v243 offset:5312
  buffer_load_dwordx4 a[120:123], v246, s[36:39], s63 offen offset:1024 sc1
  v_mfma_f32_16x16x32_bf16 v[16:19], a[8:11], a[224:227], v[16:19]
  ds_read_b64_tr_b16 a[42:43], v243 offset:5824
  ds_read_b64_tr_b16 a[44:45], v243 offset:5344
  v_mfma_f32_16x16x32_bf16 v[20:23], a[8:11], a[228:231], v[20:23]
  s_add_u32 m0, s76, 138240
  ds_read_b64_tr_b16 a[46:47], v243 offset:5856
  v_mfma_f32_16x16x32_bf16 v[28:31], a[12:15], a[228:231], v[28:31]
  ds_read_b64_tr_b16 a[48:49], v243 offset:13696
  buffer_load_dwordx4 v244, s[32:35], s60 offen lds
  v_mfma_f32_16x16x32_bf16 v[24:27], a[12:15], a[224:227], v[24:27]
  ds_read_b64_tr_b16 a[50:51], v243 offset:14208
  ds_read_b64_tr_b16 a[52:53], v243 offset:13728
  v_mfma_f32_16x16x32_bf16 v[32:35], a[16:19], a[224:227], v[32:35]
  v_readlane_b32 s61, v239, 18
  ds_read_b64_tr_b16 a[54:55], v243 offset:14240
  v_mfma_f32_16x16x32_bf16 v[36:39], a[16:19], a[228:231], v[36:39]
  ds_read_b64_tr_b16 a[56:57], v243 offset:13760
  buffer_load_dwordx4 a[124:127], v247, s[36:39], s63 offen offset:1024 sc1
  v_mfma_f32_16x16x32_bf16 v[44:47], a[20:23], a[228:231], v[44:47]
  ds_read_b64_tr_b16 a[58:59], v243 offset:14272
  ds_read_b64_tr_b16 a[60:61], v243 offset:13792
  v_mfma_f32_16x16x32_bf16 v[40:43], a[20:23], a[224:227], v[40:43]
  ds_read_b64_tr_b16 a[62:63], v243 offset:14304
  v_mfma_f32_16x16x32_bf16 v[48:51], a[24:27], a[224:227], v[48:51]
  buffer_load_dwordx4 v69, s[32:35], s60 offen offset:1056 lds
  v_mfma_f32_16x16x32_bf16 v[52:55], a[24:27], a[228:231], v[52:55]
  buffer_load_dwordx4 a[128:131], v246, s[36:39], s62 offen offset:0 sc1
  v_mfma_f32_16x16x32_bf16 v[60:63], a[28:31], a[228:231], v[60:63]
  v_mfma_f32_16x16x32_bf16 v[56:59], a[28:31], a[224:227], v[56:59]
  v_readlane_b32 s63, v232, 17
  s_waitcnt vmcnt(43) lgkmcnt(0)
  v_mfma_f32_16x16x32_bf16 v[0:3], a[32:35], a[232:235], v[0:3]
  s_waitcnt vmcnt(42)
  s_barrier
  v_mfma_f32_16x16x32_bf16 v[4:7], a[32:35], a[236:239], v[4:7]
  ds_read_b64_tr_b16 a[0:1], v243 offset:17920
  ds_read_b64_tr_b16 a[2:3], v243 offset:18432
  v_mfma_f32_16x16x32_bf16 v[12:15], a[36:39], a[236:239], v[12:15]
  buffer_load_dwordx4 a[132:135], v247, s[36:39], s62 offen offset:0 sc1
  ds_read_b64_tr_b16 a[4:5], v243 offset:17952
  v_mfma_f32_16x16x32_bf16 v[8:11], a[36:39], a[232:235], v[8:11]
  ds_read_b64_tr_b16 a[6:7], v243 offset:18464
  ds_read_b64_tr_b16 a[8:9], v243 offset:17984
  v_mfma_f32_16x16x32_bf16 v[16:19], a[40:43], a[232:235], v[16:19]
  s_add_u32 m0, s76, 146688
  ds_read_b64_tr_b16 a[10:11], v243 offset:18496
  v_mfma_f32_16x16x32_bf16 v[20:23], a[40:43], a[236:239], v[20:23]
  ds_read_b64_tr_b16 a[12:13], v243 offset:18016
  buffer_load_dwordx4 v244, s[32:35], s61 offen lds
  v_mfma_f32_16x16x32_bf16 v[28:31], a[44:47], a[236:239], v[28:31]
  ds_read_b64_tr_b16 a[14:15], v243 offset:18528
  ds_read_b64_tr_b16 a[16:17], v243 offset:26368
  v_mfma_f32_16x16x32_bf16 v[24:27], a[44:47], a[232:235], v[24:27]
  ds_read_b64_tr_b16 a[18:19], v243 offset:26880
  v_readlane_b32 s60, v239, 19
  v_mfma_f32_16x16x32_bf16 v[32:35], a[48:51], a[232:235], v[32:35]
  ds_read_b64_tr_b16 a[20:21], v243 offset:26400
  ds_read_b64_tr_b16 a[22:23], v243 offset:26912
  v_mfma_f32_16x16x32_bf16 v[36:39], a[48:51], a[236:239], v[36:39]
  ds_read_b64_tr_b16 a[24:25], v243 offset:26432
  buffer_load_dwordx4 a[136:139], v246, s[36:39], s62 offen offset:3584 sc1
  v_mfma_f32_16x16x32_bf16 v[44:47], a[52:55], a[236:239], v[44:47]
  ds_read_b64_tr_b16 a[26:27], v243 offset:26944
  ds_read_b64_tr_b16 a[28:29], v243 offset:26464
  v_mfma_f32_16x16x32_bf16 v[40:43], a[52:55], a[232:235], v[40:43]
  ds_read_b64_tr_b16 a[30:31], v243 offset:26976
  v_mfma_f32_16x16x32_bf16 v[48:51], a[56:59], a[232:235], v[48:51]
  v_mfma_f32_16x16x32_bf16 v[52:55], a[56:59], a[236:239], v[52:55]
  buffer_load_dwordx4 v69, s[32:35], s61 offen offset:1056 lds
  v_mfma_f32_16x16x32_bf16 v[60:63], a[60:63], a[236:239], v[60:63]
  v_mfma_f32_16x16x32_bf16 v[56:59], a[60:63], a[232:235], v[56:59]
  buffer_load_dwordx4 a[140:143], v247, s[36:39], s62 offen offset:3584 sc1
  s_waitcnt vmcnt(45) lgkmcnt(0)
  v_mfma_f32_16x16x32_bf16 v[0:3], a[0:3], a[240:243], v[0:3]
  ds_read_b64_tr_b16 a[32:33], v243 offset:22144
  ds_read_b64_tr_b16 a[34:35], v243 offset:22656
  v_mfma_f32_16x16x32_bf16 v[4:7], a[0:3], a[244:247], v[4:7]
  buffer_load_dwordx4 a[144:147], v246, s[36:39], s63 offen offset:0 sc1
  ds_read_b64_tr_b16 a[36:37], v243 offset:22176
  v_mfma_f32_16x16x32_bf16 v[12:15], a[4:7], a[244:247], v[12:15]
  ds_read_b64_tr_b16 a[38:39], v243 offset:22688
  v_readlane_b32 s62, v232, 18
  v_mfma_f32_16x16x32_bf16 v[8:11], a[4:7], a[240:243], v[8:11]
  ds_read_b64_tr_b16 a[40:41], v243 offset:22208
  ds_read_b64_tr_b16 a[42:43], v243 offset:22720
  v_mfma_f32_16x16x32_bf16 v[16:19], a[8:11], a[240:243], v[16:19]
  s_add_u32 m0, s76, 155136
  ds_read_b64_tr_b16 a[44:45], v243 offset:22240
  v_mfma_f32_16x16x32_bf16 v[20:23], a[8:11], a[244:247], v[20:23]
  ds_read_b64_tr_b16 a[46:47], v243 offset:22752
  v_mfma_f32_16x16x32_bf16 v[28:31], a[12:15], a[244:247], v[28:31]
  ds_read_b64_tr_b16 a[48:49], v243 offset:30592
  buffer_load_dwordx4 v244, s[32:35], s60 offen lds
  v_mfma_f32_16x16x32_bf16 v[24:27], a[12:15], a[240:243], v[24:27]
  ds_read_b64_tr_b16 a[50:51], v243 offset:31104
  ds_read_b64_tr_b16 a[52:53], v243 offset:30624
  v_mfma_f32_16x16x32_bf16 v[32:35], a[16:19], a[240:243], v[32:35]
  v_readlane_b32 s61, v239, 20
  ds_read_b64_tr_b16 a[54:55], v243 offset:31136
  v_mfma_f32_16x16x32_bf16 v[36:39], a[16:19], a[244:247], v[36:39]
  ds_read_b64_tr_b16 a[56:57], v243 offset:30656
  ds_read_b64_tr_b16 a[58:59], v243 offset:31168
  v_mfma_f32_16x16x32_bf16 v[44:47], a[20:23], a[244:247], v[44:47]
  buffer_load_dwordx4 a[148:151], v247, s[36:39], s63 offen offset:0 sc1
  ds_read_b64_tr_b16 a[60:61], v243 offset:30688
  v_mfma_f32_16x16x32_bf16 v[40:43], a[20:23], a[240:243], v[40:43]
  ds_read_b64_tr_b16 a[62:63], v243 offset:31200
  v_mfma_f32_16x16x32_bf16 v[48:51], a[24:27], a[240:243], v[48:51]
  v_mfma_f32_16x16x32_bf16 v[52:55], a[24:27], a[244:247], v[52:55]
  buffer_load_dwordx4 v69, s[32:35], s60 offen offset:1056 lds
  v_mfma_f32_16x16x32_bf16 v[60:63], a[28:31], a[244:247], v[60:63]
  v_mfma_f32_16x16x32_bf16 v[56:59], a[28:31], a[240:243], v[56:59]
  buffer_load_dwordx4 a[152:155], v246, s[36:39], s63 offen offset:3584 sc1
  s_waitcnt vmcnt(43) lgkmcnt(0)
  v_mfma_f32_16x16x32_bf16 v[0:3], a[32:35], a[248:251], v[0:3]
  s_waitcnt vmcnt(46)
  s_barrier
  v_mfma_f32_16x16x32_bf16 v[4:7], a[32:35], a[252:255], v[4:7]
  ds_read_b64_tr_b16 a[0:1], v243 offset:34816
  ds_read_b64_tr_b16 a[2:3], v243 offset:35328
  v_mfma_f32_16x16x32_bf16 v[12:15], a[36:39], a[252:255], v[12:15]
  buffer_load_dwordx4 a[156:159], v247, s[36:39], s63 offen offset:3584 sc1
  ds_read_b64_tr_b16 a[4:5], v243 offset:34848
  v_mfma_f32_16x16x32_bf16 v[8:11], a[36:39], a[248:251], v[8:11]
  ds_read_b64_tr_b16 a[6:7], v243 offset:35360
  ds_read_b64_tr_b16 a[8:9], v243 offset:34880
  v_mfma_f32_16x16x32_bf16 v[16:19], a[40:43], a[248:251], v[16:19]
  ds_read_b64_tr_b16 a[10:11], v243 offset:35392
  buffer_load_dwordx4 a[160:163], v246, s[36:39], s62 offen offset:0 sc1
  v_mfma_f32_16x16x32_bf16 v[20:23], a[40:43], a[252:255], v[20:23]
  ds_read_b64_tr_b16 a[12:13], v243 offset:34912
  ds_read_b64_tr_b16 a[14:15], v243 offset:35424
  v_mfma_f32_16x16x32_bf16 v[28:31], a[44:47], a[252:255], v[28:31]
  ds_read_b64_tr_b16 a[16:17], v243 offset:43264
  v_mfma_f32_16x16x32_bf16 v[24:27], a[44:47], a[248:251], v[24:27]
  ds_read_b64_tr_b16 a[18:19], v243 offset:43776
  v_readlane_b32 s63, v232, 19
  v_mfma_f32_16x16x32_bf16 v[32:35], a[48:51], a[248:251], v[32:35]
  ds_read_b64_tr_b16 a[20:21], v243 offset:43296
  ds_read_b64_tr_b16 a[22:23], v243 offset:43808
  v_mfma_f32_16x16x32_bf16 v[36:39], a[48:51], a[252:255], v[36:39]
  ds_read_b64_tr_b16 a[24:25], v243 offset:43328
  buffer_load_dwordx4 a[164:167], v247, s[36:39], s62 offen offset:0 sc1
  v_mfma_f32_16x16x32_bf16 v[44:47], a[52:55], a[252:255], v[44:47]
  ds_read_b64_tr_b16 a[26:27], v243 offset:43840
  ds_read_b64_tr_b16 a[28:29], v243 offset:43360
  v_mfma_f32_16x16x32_bf16 v[40:43], a[52:55], a[248:251], v[40:43]
  ds_read_b64_tr_b16 a[30:31], v243 offset:43872
  v_mfma_f32_16x16x32_bf16 v[48:51], a[56:59], a[248:251], v[48:51]
  buffer_load_dwordx4 a[168:171], v246, s[36:39], s62 offen offset:3584 sc1
  v_mfma_f32_16x16x32_bf16 v[52:55], a[56:59], a[252:255], v[52:55]
  v_mfma_f32_16x16x32_bf16 v[60:63], a[60:63], a[252:255], v[60:63]
  buffer_load_dwordx4 a[172:175], v247, s[36:39], s62 offen offset:3584 sc1
  v_mfma_f32_16x16x32_bf16 v[56:59], a[60:63], a[248:251], v[56:59]
  s_waitcnt vmcnt(46) lgkmcnt(0)
  v_mfma_f32_16x16x32_bf16 v[0:3], a[0:3], a[64:67], v[0:3]
  ds_read_b64_tr_b16 a[32:33], v243 offset:39040
  buffer_load_dwordx4 a[176:179], v246, s[36:39], s63 offen offset:0 sc1
  v_mfma_f32_16x16x32_bf16 v[4:7], a[0:3], a[68:71], v[4:7]
  ds_read_b64_tr_b16 a[34:35], v243 offset:39552
  ds_read_b64_tr_b16 a[36:37], v243 offset:39072
  v_mfma_f32_16x16x32_bf16 v[12:15], a[4:7], a[68:71], v[12:15]
  v_readlane_b32 s62, v232, 20
  ds_read_b64_tr_b16 a[38:39], v243 offset:39584
  v_mfma_f32_16x16x32_bf16 v[8:11], a[4:7], a[64:67], v[8:11]
  ds_read_b64_tr_b16 a[40:41], v243 offset:39104
  s_add_u32 m0, s76, 1024
  v_mfma_f32_16x16x32_bf16 v[16:19], a[8:11], a[64:67], v[16:19]
  ds_read_b64_tr_b16 a[42:43], v243 offset:39616
  ds_read_b64_tr_b16 a[44:45], v243 offset:39136
  v_mfma_f32_16x16x32_bf16 v[20:23], a[8:11], a[68:71], v[20:23]
  buffer_load_dwordx4 v244, s[32:35], s61 offen lds
  ds_read_b64_tr_b16 a[46:47], v243 offset:39648
  v_mfma_f32_16x16x32_bf16 v[28:31], a[12:15], a[68:71], v[28:31]
  ds_read_b64_tr_b16 a[48:49], v243 offset:47488
  v_readlane_b32 s60, v239, 21
  v_mfma_f32_16x16x32_bf16 v[24:27], a[12:15], a[64:67], v[24:27]
  ds_read_b64_tr_b16 a[50:51], v243 offset:48000
  v_mfma_f32_16x16x32_bf16 v[32:35], a[16:19], a[64:67], v[32:35]
  ds_read_b64_tr_b16 a[52:53], v243 offset:47520
  ds_read_b64_tr_b16 a[54:55], v243 offset:48032
  v_mfma_f32_16x16x32_bf16 v[36:39], a[16:19], a[68:71], v[36:39]
  buffer_load_dwordx4 v69, s[32:35], s61 offen offset:1056 lds
  ds_read_b64_tr_b16 a[56:57], v243 offset:47552
  v_mfma_f32_16x16x32_bf16 v[44:47], a[20:23], a[68:71], v[44:47]
  ds_read_b64_tr_b16 a[58:59], v243 offset:48064
  s_add_u32 m0, s76, 9472
  v_mfma_f32_16x16x32_bf16 v[40:43], a[20:23], a[64:67], v[40:43]
  ds_read_b64_tr_b16 a[60:61], v243 offset:47584
  ds_read_b64_tr_b16 a[62:63], v243 offset:48096
  v_mfma_f32_16x16x32_bf16 v[48:51], a[24:27], a[64:67], v[48:51]
  buffer_load_dwordx4 v244, s[32:35], s60 offen lds
  v_readlane_b32 s61, v239, 22
  v_mfma_f32_16x16x32_bf16 v[52:55], a[24:27], a[68:71], v[52:55]
  v_mfma_f32_16x16x32_bf16 v[60:63], a[28:31], a[68:71], v[60:63]
  v_mfma_f32_16x16x32_bf16 v[56:59], a[28:31], a[64:67], v[56:59]
  buffer_load_dwordx4 v69, s[32:35], s60 offen offset:1056 lds
  s_waitcnt vmcnt(48) lgkmcnt(0)
  v_mfma_f32_16x16x32_bf16 v[0:3], a[32:35], a[72:75], v[0:3]
  s_waitcnt vmcnt(46)
  s_barrier
  v_mfma_f32_16x16x32_bf16 v[4:7], a[32:35], a[76:79], v[4:7]
  ds_read_b64_tr_b16 a[0:1], v68 offset:0
  ds_read_b64_tr_b16 a[2:3], v68 offset:512
  v_mfma_f32_16x16x32_bf16 v[12:15], a[36:39], a[76:79], v[12:15]
  buffer_load_dwordx4 a[180:183], v247, s[36:39], s63 offen offset:0 sc1
  ds_read_b64_tr_b16 a[4:5], v68 offset:32
  v_mfma_f32_16x16x32_bf16 v[8:11], a[36:39], a[72:75], v[8:11]
  ds_read_b64_tr_b16 a[6:7], v68 offset:544
  ds_read_b64_tr_b16 a[8:9], v68 offset:64
  v_mfma_f32_16x16x32_bf16 v[16:19], a[40:43], a[72:75], v[16:19]
  ds_read_b64_tr_b16 a[10:11], v68 offset:576
  buffer_load_dwordx4 a[184:187], v246, s[36:39], s63 offen offset:3584 sc1
  v_mfma_f32_16x16x32_bf16 v[20:23], a[40:43], a[76:79], v[20:23]
  ds_read_b64_tr_b16 a[12:13], v68 offset:96
  ds_read_b64_tr_b16 a[14:15], v68 offset:608
  v_mfma_f32_16x16x32_bf16 v[28:31], a[44:47], a[76:79], v[28:31]
  ds_read_b64_tr_b16 a[16:17], v68 offset:8448
  v_mfma_f32_16x16x32_bf16 v[24:27], a[44:47], a[72:75], v[24:27]
  ds_read_b64_tr_b16 a[18:19], v68 offset:8960
  buffer_load_dwordx4 a[188:191], v247, s[36:39], s63 offen offset:3584 sc1
  v_mfma_f32_16x16x32_bf16 v[32:35], a[48:51], a[72:75], v[32:35]
  ds_read_b64_tr_b16 a[20:21], v68 offset:8480
  ds_read_b64_tr_b16 a[22:23], v68 offset:8992
  v_mfma_f32_16x16x32_bf16 v[36:39], a[48:51], a[76:79], v[36:39]
  ds_read_b64_tr_b16 a[24:25], v68 offset:8512
  buffer_load_dwordx4 a[192:195], v246, s[36:39], s62 offen offset:0 sc1
  v_mfma_f32_16x16x32_bf16 v[44:47], a[52:55], a[76:79], v[44:47]
  ds_read_b64_tr_b16 a[26:27], v68 offset:9024
  ds_read_b64_tr_b16 a[28:29], v68 offset:8544
  v_mfma_f32_16x16x32_bf16 v[40:43], a[52:55], a[72:75], v[40:43]
  ds_read_b64_tr_b16 a[30:31], v68 offset:9056
  v_mfma_f32_16x16x32_bf16 v[48:51], a[56:59], a[72:75], v[48:51]
  v_readlane_b32 s63, v232, 21
  v_mfma_f32_16x16x32_bf16 v[52:55], a[56:59], a[76:79], v[52:55]
  v_mfma_f32_16x16x32_bf16 v[60:63], a[60:63], a[76:79], v[60:63]
  buffer_load_dwordx4 a[196:199], v247, s[36:39], s62 offen offset:0 sc1
  v_mfma_f32_16x16x32_bf16 v[56:59], a[60:63], a[72:75], v[56:59]
  s_waitcnt vmcnt(48) lgkmcnt(0)
  v_mfma_f32_16x16x32_bf16 v[0:3], a[0:3], a[80:83], v[0:3]
  ds_read_b64_tr_b16 a[32:33], v68 offset:4224
  ds_read_b64_tr_b16 a[34:35], v68 offset:4736
  v_mfma_f32_16x16x32_bf16 v[4:7], a[0:3], a[84:87], v[4:7]
  buffer_load_dwordx4 a[200:203], v246, s[36:39], s62 offen offset:3584 sc1
  ds_read_b64_tr_b16 a[36:37], v68 offset:4256
  v_mfma_f32_16x16x32_bf16 v[12:15], a[4:7], a[84:87], v[12:15]
  ds_read_b64_tr_b16 a[38:39], v68 offset:4768
  s_add_u32 m0, s76, 17920
  v_mfma_f32_16x16x32_bf16 v[8:11], a[4:7], a[80:83], v[8:11]
  ds_read_b64_tr_b16 a[40:41], v68 offset:4288
  ds_read_b64_tr_b16 a[42:43], v68 offset:4800
  v_mfma_f32_16x16x32_bf16 v[16:19], a[8:11], a[80:83], v[16:19]
  buffer_load_dwordx4 v244, s[32:35], s61 offen lds
  ds_read_b64_tr_b16 a[44:45], v68 offset:4320
  v_mfma_f32_16x16x32_bf16 v[20:23], a[8:11], a[84:87], v[20:23]
  ds_read_b64_tr_b16 a[46:47], v68 offset:4832
  v_readlane_b32 s60, v239, 23
  v_mfma_f32_16x16x32_bf16 v[28:31], a[12:15], a[84:87], v[28:31]
  ds_read_b64_tr_b16 a[48:49], v68 offset:12672
  ds_read_b64_tr_b16 a[50:51], v68 offset:13184
  v_mfma_f32_16x16x32_bf16 v[24:27], a[12:15], a[80:83], v[24:27]
  buffer_load_dwordx4 a[204:207], v247, s[36:39], s62 offen offset:3584 sc1
  ds_read_b64_tr_b16 a[52:53], v68 offset:12704
  v_mfma_f32_16x16x32_bf16 v[32:35], a[16:19], a[80:83], v[32:35]
  ds_read_b64_tr_b16 a[54:55], v68 offset:13216
  v_mfma_f32_16x16x32_bf16 v[36:39], a[16:19], a[84:87], v[36:39]
  ds_read_b64_tr_b16 a[56:57], v68 offset:12736
  ds_read_b64_tr_b16 a[58:59], v68 offset:13248
  v_mfma_f32_16x16x32_bf16 v[44:47], a[20:23], a[84:87], v[44:47]
  buffer_load_dwordx4 v69, s[32:35], s61 offen offset:1056 lds
  ds_read_b64_tr_b16 a[60:61], v68 offset:12768
  v_mfma_f32_16x16x32_bf16 v[40:43], a[20:23], a[80:83], v[40:43]
  ds_read_b64_tr_b16 a[62:63], v68 offset:13280
  v_mfma_f32_16x16x32_bf16 v[48:51], a[24:27], a[80:83], v[48:51]
  s_add_u32 m0, s76, 26368
  v_mfma_f32_16x16x32_bf16 v[52:55], a[24:27], a[84:87], v[52:55]
  buffer_load_dwordx4 v244, s[32:35], s60 offen lds
  v_mfma_f32_16x16x32_bf16 v[60:63], a[28:31], a[84:87], v[60:63]
  v_mfma_f32_16x16x32_bf16 v[56:59], a[28:31], a[80:83], v[56:59]
  v_readlane_b32 s61, v239, 24
  s_waitcnt vmcnt(48) lgkmcnt(0)
  v_mfma_f32_16x16x32_bf16 v[0:3], a[32:35], a[88:91], v[0:3]
  s_waitcnt vmcnt(49)
  s_barrier
  v_mfma_f32_16x16x32_bf16 v[4:7], a[32:35], a[92:95], v[4:7]
  ds_read_b64_tr_b16 a[0:1], v68 offset:16896
  ds_read_b64_tr_b16 a[2:3], v68 offset:17408
  v_mfma_f32_16x16x32_bf16 v[12:15], a[36:39], a[92:95], v[12:15]
  buffer_load_dwordx4 a[208:211], v246, s[36:39], s63 offen offset:0 sc1
  ds_read_b64_tr_b16 a[4:5], v68 offset:16928
  v_mfma_f32_16x16x32_bf16 v[8:11], a[36:39], a[88:91], v[8:11]
  ds_read_b64_tr_b16 a[6:7], v68 offset:17440
  ds_read_b64_tr_b16 a[8:9], v68 offset:16960
  v_mfma_f32_16x16x32_bf16 v[16:19], a[40:43], a[88:91], v[16:19]
  v_readlane_b32 s62, v232, 22
  ds_read_b64_tr_b16 a[10:11], v68 offset:17472
  v_mfma_f32_16x16x32_bf16 v[20:23], a[40:43], a[92:95], v[20:23]
  ds_read_b64_tr_b16 a[12:13], v68 offset:16992
  ds_read_b64_tr_b16 a[14:15], v68 offset:17504
  v_mfma_f32_16x16x32_bf16 v[28:31], a[44:47], a[92:95], v[28:31]
  ds_read_b64_tr_b16 a[16:17], v68 offset:25344
  v_mfma_f32_16x16x32_bf16 v[24:27], a[44:47], a[88:91], v[24:27]
  ds_read_b64_tr_b16 a[18:19], v68 offset:25856
  ds_read_b64_tr_b16 a[20:21], v68 offset:25376
  v_mfma_f32_16x16x32_bf16 v[32:35], a[48:51], a[88:91], v[32:35]
  buffer_load_dwordx4 v69, s[32:35], s60 offen offset:1056 lds
  ds_read_b64_tr_b16 a[22:23], v68 offset:25888
  v_mfma_f32_16x16x32_bf16 v[36:39], a[48:51], a[92:95], v[36:39]
  ds_read_b64_tr_b16 a[24:25], v68 offset:25408
  ds_read_b64_tr_b16 a[26:27], v68 offset:25920
  v_mfma_f32_16x16x32_bf16 v[44:47], a[52:55], a[92:95], v[44:47]
  ds_read_b64_tr_b16 a[28:29], v68 offset:25440
  buffer_load_dwordx4 a[212:215], v247, s[36:39], s63 offen offset:0 sc1
  v_mfma_f32_16x16x32_bf16 v[40:43], a[52:55], a[88:91], v[40:43]
  ds_read_b64_tr_b16 a[30:31], v68 offset:25952
  v_mfma_f32_16x16x32_bf16 v[48:51], a[56:59], a[88:91], v[48:51]
  buffer_load_dwordx4 a[216:219], v246, s[36:39], s63 offen offset:3584 sc1
  v_mfma_f32_16x16x32_bf16 v[52:55], a[56:59], a[92:95], v[52:55]
  v_mfma_f32_16x16x32_bf16 v[60:63], a[60:63], a[92:95], v[60:63]
  buffer_load_dwordx4 a[220:223], v247, s[36:39], s63 offen offset:3584 sc1
  v_mfma_f32_16x16x32_bf16 v[56:59], a[60:63], a[88:91], v[56:59]
  s_waitcnt vmcnt(51) lgkmcnt(0)
  v_mfma_f32_16x16x32_bf16 v[0:3], a[0:3], a[96:99], v[0:3]
  ds_read_b64_tr_b16 a[32:33], v68 offset:21120
  ds_read_b64_tr_b16 a[34:35], v68 offset:21632
  v_mfma_f32_16x16x32_bf16 v[4:7], a[0:3], a[100:103], v[4:7]
  buffer_load_dwordx4 a[224:227], v246, s[36:39], s62 offen offset:0 sc1
  ds_read_b64_tr_b16 a[36:37], v68 offset:21152
  v_mfma_f32_16x16x32_bf16 v[12:15], a[4:7], a[100:103], v[12:15]
  ds_read_b64_tr_b16 a[38:39], v68 offset:21664
  v_mfma_f32_16x16x32_bf16 v[8:11], a[4:7], a[96:99], v[8:11]
  ds_read_b64_tr_b16 a[40:41], v68 offset:21184
  v_readlane_b32 s63, v232, 23
  v_mfma_f32_16x16x32_bf16 v[16:19], a[8:11], a[96:99], v[16:19]
  ds_read_b64_tr_b16 a[42:43], v68 offset:21696
  ds_read_b64_tr_b16 a[44:45], v68 offset:21216
  v_mfma_f32_16x16x32_bf16 v[20:23], a[8:11], a[100:103], v[20:23]
  s_add_u32 m0, s76, 34816
  ds_read_b64_tr_b16 a[46:47], v68 offset:21728
  v_mfma_f32_16x16x32_bf16 v[28:31], a[12:15], a[100:103], v[28:31]
  ds_read_b64_tr_b16 a[48:49], v68 offset:29568
  ds_read_b64_tr_b16 a[50:51], v68 offset:30080
  v_mfma_f32_16x16x32_bf16 v[24:27], a[12:15], a[96:99], v[24:27]
  buffer_load_dwordx4 v64, s[32:35], s61 offen lds
  ds_read_b64_tr_b16 a[52:53], v68 offset:29600
  v_mfma_f32_16x16x32_bf16 v[32:35], a[16:19], a[96:99], v[32:35]
  ds_read_b64_tr_b16 a[54:55], v68 offset:30112
  v_mfma_f32_16x16x32_bf16 v[36:39], a[16:19], a[100:103], v[36:39]
  ds_read_b64_tr_b16 a[56:57], v68 offset:29632
  v_readlane_b32 s60, v239, 25
  v_mfma_f32_16x16x32_bf16 v[44:47], a[20:23], a[100:103], v[44:47]
  ds_read_b64_tr_b16 a[58:59], v68 offset:30144
  ds_read_b64_tr_b16 a[60:61], v68 offset:29664
  v_mfma_f32_16x16x32_bf16 v[40:43], a[20:23], a[96:99], v[40:43]
  buffer_load_dwordx4 a[228:231], v247, s[36:39], s62 offen offset:0 sc1
  ds_read_b64_tr_b16 a[62:63], v68 offset:30176
  v_mfma_f32_16x16x32_bf16 v[48:51], a[24:27], a[96:99], v[48:51]
  v_mfma_f32_16x16x32_bf16 v[52:55], a[24:27], a[100:103], v[52:55]
  buffer_load_dwordx4 a[232:235], v246, s[36:39], s62 offen offset:3584 sc1
  v_mfma_f32_16x16x32_bf16 v[60:63], a[28:31], a[100:103], v[60:63]
  v_mfma_f32_16x16x32_bf16 v[56:59], a[28:31], a[96:99], v[56:59]
  buffer_load_dwordx4 a[236:239], v247, s[36:39], s62 offen offset:3584 sc1
  s_waitcnt vmcnt(49) lgkmcnt(0)
  v_mfma_f32_16x16x32_bf16 v[0:3], a[32:35], a[104:107], v[0:3]
  s_waitcnt vmcnt(51)
  s_barrier
  v_mfma_f32_16x16x32_bf16 v[4:7], a[32:35], a[108:111], v[4:7]
  ds_read_b64_tr_b16 a[0:1], v68 offset:33792
  ds_read_b64_tr_b16 a[2:3], v68 offset:34304
  v_mfma_f32_16x16x32_bf16 v[12:15], a[36:39], a[108:111], v[12:15]
  buffer_load_dwordx4 a[240:243], v246, s[36:39], s63 offen offset:0 sc1
  ds_read_b64_tr_b16 a[4:5], v68 offset:33824
  v_mfma_f32_16x16x32_bf16 v[8:11], a[36:39], a[104:107], v[8:11]
  ds_read_b64_tr_b16 a[6:7], v68 offset:34336
  v_readlane_b32 s62, v232, 24
  v_mfma_f32_16x16x32_bf16 v[16:19], a[40:43], a[104:107], v[16:19]
  ds_read_b64_tr_b16 a[8:9], v68 offset:33856
  ds_read_b64_tr_b16 a[10:11], v68 offset:34368
  v_mfma_f32_16x16x32_bf16 v[20:23], a[40:43], a[108:111], v[20:23]
  ds_read_b64_tr_b16 a[12:13], v68 offset:33888
  v_mfma_f32_16x16x32_bf16 v[28:31], a[44:47], a[108:111], v[28:31]
  ds_read_b64_tr_b16 a[14:15], v68 offset:34400
  buffer_load_dwordx4 v79, s[32:35], s61 offen offset:1056 lds
  v_mfma_f32_16x16x32_bf16 v[24:27], a[44:47], a[104:107], v[24:27]
  ds_read_b64_tr_b16 a[16:17], v68 offset:42240
  ds_read_b64_tr_b16 a[18:19], v68 offset:42752
  v_mfma_f32_16x16x32_bf16 v[32:35], a[48:51], a[104:107], v[32:35]
  buffer_load_dwordx4 a[244:247], v247, s[36:39], s63 offen offset:0 sc1
  ds_read_b64_tr_b16 a[20:21], v68 offset:42272
  v_mfma_f32_16x16x32_bf16 v[36:39], a[48:51], a[108:111], v[36:39]
  ds_read_b64_tr_b16 a[22:23], v68 offset:42784
  ds_read_b64_tr_b16 a[24:25], v68 offset:42304
  v_mfma_f32_16x16x32_bf16 v[44:47], a[52:55], a[108:111], v[44:47]
  s_add_u32 m0, s76, 43264
  ds_read_b64_tr_b16 a[26:27], v68 offset:42816
  v_mfma_f32_16x16x32_bf16 v[40:43], a[52:55], a[104:107], v[40:43]
  ds_read_b64_tr_b16 a[28:29], v68 offset:42336
  buffer_load_dwordx4 v64, s[32:35], s60 offen lds
  v_mfma_f32_16x16x32_bf16 v[48:51], a[56:59], a[104:107], v[48:51]
  ds_read_b64_tr_b16 a[30:31], v68 offset:42848
  v_readlane_b32 s61, v239, 26
  v_mfma_f32_16x16x32_bf16 v[52:55], a[56:59], a[108:111], v[52:55]
  v_mfma_f32_16x16x32_bf16 v[60:63], a[60:63], a[108:111], v[60:63]
  v_mfma_f32_16x16x32_bf16 v[56:59], a[60:63], a[104:107], v[56:59]
  buffer_load_dwordx4 v79, s[32:35], s60 offen offset:1056 lds
  s_waitcnt vmcnt(50) lgkmcnt(0)
  v_mfma_f32_16x16x32_bf16 v[0:3], a[0:3], a[112:115], v[0:3]
  ds_read_b64_tr_b16 a[32:33], v68 offset:38016
  ds_read_b64_tr_b16 a[34:35], v68 offset:38528
  v_mfma_f32_16x16x32_bf16 v[4:7], a[0:3], a[116:119], v[4:7]
  buffer_load_dwordx4 a[248:251], v246, s[36:39], s63 offen offset:3584 sc1
  ds_read_b64_tr_b16 a[36:37], v68 offset:38048
  v_mfma_f32_16x16x32_bf16 v[12:15], a[4:7], a[116:119], v[12:15]
  ds_read_b64_tr_b16 a[38:39], v68 offset:38560
  buffer_load_dwordx4 a[252:255], v247, s[36:39], s63 offen offset:3584 sc1
  v_mfma_f32_16x16x32_bf16 v[8:11], a[4:7], a[112:115], v[8:11]
  ds_read_b64_tr_b16 a[40:41], v68 offset:38080
  ds_read_b64_tr_b16 a[42:43], v68 offset:38592
  v_mfma_f32_16x16x32_bf16 v[16:19], a[8:11], a[112:115], v[16:19]
  buffer_load_dwordx2 a[64:65], v66, s[36:39], s62 offen sc1
  ds_read_b64_tr_b16 a[44:45], v68 offset:38112
  v_mfma_f32_16x16x32_bf16 v[20:23], a[8:11], a[116:119], v[20:23]
  ds_read_b64_tr_b16 a[46:47], v68 offset:38624
  buffer_load_dwordx2 a[66:67], v66, s[36:39], s62 offen offset:3584 sc1
  v_mfma_f32_16x16x32_bf16 v[28:31], a[12:15], a[116:119], v[28:31]
  ds_read_b64_tr_b16 a[48:49], v68 offset:46464
  ds_read_b64_tr_b16 a[50:51], v68 offset:46976
  v_mfma_f32_16x16x32_bf16 v[24:27], a[12:15], a[112:115], v[24:27]
  v_readlane_b32 s63, v232, 25
  ds_read_b64_tr_b16 a[52:53], v68 offset:46496
  v_mfma_f32_16x16x32_bf16 v[32:35], a[16:19], a[112:115], v[32:35]
  ds_read_b64_tr_b16 a[54:55], v68 offset:47008
  buffer_load_dwordx2 a[68:69], v67, s[36:39], s62 offen sc1
  v_mfma_f32_16x16x32_bf16 v[36:39], a[16:19], a[116:119], v[36:39]
  ds_read_b64_tr_b16 a[56:57], v68 offset:46528
  ds_read_b64_tr_b16 a[58:59], v68 offset:47040
  v_mfma_f32_16x16x32_bf16 v[44:47], a[20:23], a[116:119], v[44:47]
  buffer_load_dwordx2 a[70:71], v67, s[36:39], s62 offen offset:3584 sc1
  ds_read_b64_tr_b16 a[60:61], v68 offset:46560
  v_mfma_f32_16x16x32_bf16 v[40:43], a[20:23], a[112:115], v[40:43]
  ds_read_b64_tr_b16 a[62:63], v68 offset:47072
  v_mfma_f32_16x16x32_bf16 v[48:51], a[24:27], a[112:115], v[48:51]
  s_add_u32 s62, s62, 7168
  v_mfma_f32_16x16x32_bf16 v[52:55], a[24:27], a[116:119], v[52:55]
  buffer_load_dwordx2 a[72:73], v66, s[36:39], s62 offen sc1
  v_mfma_f32_16x16x32_bf16 v[60:63], a[28:31], a[116:119], v[60:63]
  v_mfma_f32_16x16x32_bf16 v[56:59], a[28:31], a[112:115], v[56:59]
  buffer_load_dwordx2 a[74:75], v66, s[36:39], s62 offen offset:3584 sc1
  s_waitcnt vmcnt(55) lgkmcnt(0)
  v_mfma_f32_16x16x32_bf16 v[0:3], a[32:35], a[120:123], v[0:3]
  s_waitcnt vmcnt(54)
  s_barrier
  v_mfma_f32_16x16x32_bf16 v[4:7], a[32:35], a[124:127], v[4:7]
  ds_read_b64_tr_b16 a[0:1], v242 offset:0
  buffer_load_dwordx2 a[76:77], v67, s[36:39], s62 offen sc1
  v_mfma_f32_16x16x32_bf16 v[12:15], a[36:39], a[124:127], v[12:15]
  ds_read_b64_tr_b16 a[2:3], v242 offset:512
  ds_read_b64_tr_b16 a[4:5], v242 offset:32
  v_mfma_f32_16x16x32_bf16 v[8:11], a[36:39], a[120:123], v[8:11]
  buffer_load_dwordx2 a[78:79], v67, s[36:39], s62 offen offset:3584 sc1
  ds_read_b64_tr_b16 a[6:7], v242 offset:544
  v_mfma_f32_16x16x32_bf16 v[16:19], a[40:43], a[120:123], v[16:19]
  ds_read_b64_tr_b16 a[8:9], v242 offset:64
  s_add_u32 m0, s76, 51712
  v_mfma_f32_16x16x32_bf16 v[20:23], a[40:43], a[124:127], v[20:23]
  ds_read_b64_tr_b16 a[10:11], v242 offset:576
  ds_read_b64_tr_b16 a[12:13], v242 offset:96
  v_mfma_f32_16x16x32_bf16 v[28:31], a[44:47], a[124:127], v[28:31]
  buffer_load_dwordx4 v64, s[32:35], s61 offen lds
  ds_read_b64_tr_b16 a[14:15], v242 offset:608
  v_mfma_f32_16x16x32_bf16 v[24:27], a[44:47], a[120:123], v[24:27]
  ds_read_b64_tr_b16 a[16:17], v242 offset:4224
  v_readlane_b32 s60, v239, 27
  v_mfma_f32_16x16x32_bf16 v[32:35], a[48:51], a[120:123], v[32:35]
  ds_read_b64_tr_b16 a[18:19], v242 offset:4736
  ds_read_b64_tr_b16 a[20:21], v242 offset:4256
  v_mfma_f32_16x16x32_bf16 v[36:39], a[48:51], a[124:127], v[36:39]
  ds_read_b64_tr_b16 a[22:23], v242 offset:4768
  v_mfma_f32_16x16x32_bf16 v[44:47], a[52:55], a[124:127], v[44:47]
  buffer_load_dwordx4 v79, s[32:35], s61 offen offset:1056 lds
  ds_read_b64_tr_b16 a[24:25], v242 offset:4288
  v_mfma_f32_16x16x32_bf16 v[40:43], a[52:55], a[120:123], v[40:43]
  ds_read_b64_tr_b16 a[26:27], v242 offset:4800
  s_add_u32 m0, s76, 60160
  v_mfma_f32_16x16x32_bf16 v[48:51], a[56:59], a[120:123], v[48:51]
  ds_read_b64_tr_b16 a[28:29], v242 offset:4320
  ds_read_b64_tr_b16 a[30:31], v242 offset:4832
  v_mfma_f32_16x16x32_bf16 v[52:55], a[56:59], a[124:127], v[52:55]
  buffer_load_dwordx4 v64, s[32:35], s60 offen lds
  v_readlane_b32 s61, v239, 16
  v_mfma_f32_16x16x32_bf16 v[60:63], a[60:63], a[124:127], v[60:63]
  v_mfma_f32_16x16x32_bf16 v[56:59], a[60:63], a[120:123], v[56:59]
  buffer_load_dwordx4 v79, s[32:35], s60 offen offset:1056 lds
  s_waitcnt vmcnt(54) lgkmcnt(0)
  v_mfma_f32_16x16x32_bf16 v[0:3], a[0:3], a[128:131], v[0:3]
  ds_read_b64_tr_b16 a[32:33], v242 offset:8448
  buffer_load_dwordx2 a[80:81], v66, s[36:39], s63 offen sc1
  v_mfma_f32_16x16x32_bf16 v[4:7], a[0:3], a[132:135], v[4:7]
  ds_read_b64_tr_b16 a[34:35], v242 offset:8960
  ds_read_b64_tr_b16 a[36:37], v242 offset:8480
  v_mfma_f32_16x16x32_bf16 v[12:15], a[4:7], a[132:135], v[12:15]
  buffer_load_dwordx2 a[82:83], v66, s[36:39], s63 offen offset:3584 sc1
  ds_read_b64_tr_b16 a[38:39], v242 offset:8992
  v_mfma_f32_16x16x32_bf16 v[8:11], a[4:7], a[128:131], v[8:11]
  ds_read_b64_tr_b16 a[40:41], v242 offset:8512
  v_readlane_b32 s62, v232, 26
  v_mfma_f32_16x16x32_bf16 v[16:19], a[8:11], a[128:131], v[16:19]
  ds_read_b64_tr_b16 a[42:43], v242 offset:9024
  buffer_load_dwordx2 a[84:85], v67, s[36:39], s63 offen sc1
  v_mfma_f32_16x16x32_bf16 v[20:23], a[8:11], a[132:135], v[20:23]
  ds_read_b64_tr_b16 a[44:45], v242 offset:8544
  ds_read_b64_tr_b16 a[46:47], v242 offset:9056
  v_mfma_f32_16x16x32_bf16 v[28:31], a[12:15], a[132:135], v[28:31]
  buffer_load_dwordx2 a[86:87], v67, s[36:39], s63 offen offset:3584 sc1
  ds_read_b64_tr_b16 a[48:49], v242 offset:12672
  v_mfma_f32_16x16x32_bf16 v[24:27], a[12:15], a[128:131], v[24:27]
  ds_read_b64_tr_b16 a[50:51], v242 offset:13184
  s_add_u32 s63, s63, 7168
  v_mfma_f32_16x16x32_bf16 v[0:3], a[16:19], a[136:139], v[0:3]
  ds_read_b64_tr_b16 a[52:53], v242 offset:12704
  buffer_load_dwordx2 a[88:89], v66, s[36:39], s63 offen sc1
  v_mfma_f32_16x16x32_bf16 v[4:7], a[16:19], a[140:143], v[4:7]
  ds_read_b64_tr_b16 a[54:55], v242 offset:13216
  ds_read_b64_tr_b16 a[56:57], v242 offset:12736
  v_mfma_f32_16x16x32_bf16 v[12:15], a[20:23], a[140:143], v[12:15]
  buffer_load_dwordx2 a[90:91], v66, s[36:39], s63 offen offset:3584 sc1
  ds_read_b64_tr_b16 a[58:59], v242 offset:13248
  v_mfma_f32_16x16x32_bf16 v[8:11], a[20:23], a[136:139], v[8:11]
  buffer_load_dwordx2 a[92:93], v67, s[36:39], s63 offen sc1
  ds_read_b64_tr_b16 a[60:61], v242 offset:12768
  v_mfma_f32_16x16x32_bf16 v[16:19], a[24:27], a[136:139], v[16:19]
  ds_read_b64_tr_b16 a[62:63], v242 offset:13280
  buffer_load_dwordx2 a[94:95], v67, s[36:39], s63 offen offset:3584 sc1
  v_mfma_f32_16x16x32_bf16 v[20:23], a[24:27], a[140:143], v[20:23]
  buffer_load_dwordx2 a[96:97], v66, s[36:39], s62 offen sc1
  v_mfma_f32_16x16x32_bf16 v[28:31], a[28:31], a[140:143], v[28:31]
  buffer_load_dwordx2 a[98:99], v66, s[36:39], s62 offen offset:3584 sc1
  v_mfma_f32_16x16x32_bf16 v[24:27], a[28:31], a[136:139], v[24:27]
  v_readlane_b32 s63, v232, 27
  s_waitcnt vmcnt(58) lgkmcnt(0)
  v_mfma_f32_16x16x32_bf16 v[0:3], a[32:35], a[144:147], v[0:3]
  s_waitcnt vmcnt(60)
  s_barrier
  v_mfma_f32_16x16x32_bf16 v[4:7], a[32:35], a[148:151], v[4:7]
  ds_read_b64_tr_b16 a[0:1], v242 offset:16896
  buffer_load_dwordx2 a[100:101], v67, s[36:39], s62 offen sc1
  v_mfma_f32_16x16x32_bf16 v[12:15], a[36:39], a[148:151], v[12:15]
  ds_read_b64_tr_b16 a[2:3], v242 offset:17408
  ds_read_b64_tr_b16 a[4:5], v242 offset:16928
  v_mfma_f32_16x16x32_bf16 v[8:11], a[36:39], a[144:147], v[8:11]
  buffer_load_dwordx2 a[102:103], v67, s[36:39], s62 offen offset:3584 sc1
  ds_read_b64_tr_b16 a[6:7], v242 offset:17440
  v_mfma_f32_16x16x32_bf16 v[16:19], a[40:43], a[144:147], v[16:19]
  ds_read_b64_tr_b16 a[8:9], v242 offset:16960
  s_add_u32 m0, s76, 68608
  v_mfma_f32_16x16x32_bf16 v[20:23], a[40:43], a[148:151], v[20:23]
  ds_read_b64_tr_b16 a[10:11], v242 offset:17472
  ds_read_b64_tr_b16 a[12:13], v242 offset:16992
  v_mfma_f32_16x16x32_bf16 v[28:31], a[44:47], a[148:151], v[28:31]
  buffer_load_dwordx4 v245, s[32:35], s61 offen lds
  ds_read_b64_tr_b16 a[14:15], v242 offset:17504
  v_mfma_f32_16x16x32_bf16 v[24:27], a[44:47], a[144:147], v[24:27]
  ds_read_b64_tr_b16 a[16:17], v242 offset:21120
  v_readlane_b32 s60, v239, 17
  v_mfma_f32_16x16x32_bf16 v[0:3], a[48:51], a[152:155], v[0:3]
  ds_read_b64_tr_b16 a[18:19], v242 offset:21632
  ds_read_b64_tr_b16 a[20:21], v242 offset:21152
  v_mfma_f32_16x16x32_bf16 v[4:7], a[48:51], a[156:159], v[4:7]
  s_add_u32 s62, s62, 7168
  ds_read_b64_tr_b16 a[22:23], v242 offset:21664
  v_mfma_f32_16x16x32_bf16 v[12:15], a[52:55], a[156:159], v[12:15]
  buffer_load_dwordx2 a[104:105], v66, s[36:39], s62 offen sc1
  ds_read_b64_tr_b16 a[24:25], v242 offset:21184
  v_mfma_f32_16x16x32_bf16 v[8:11], a[52:55], a[152:155], v[8:11]
  ds_read_b64_tr_b16 a[26:27], v242 offset:21696
  buffer_load_dwordx2 a[106:107], v66, s[36:39], s62 offen offset:3584 sc1
  v_mfma_f32_16x16x32_bf16 v[16:19], a[56:59], a[152:155], v[16:19]
  ds_read_b64_tr_b16 a[28:29], v242 offset:21216
  ds_read_b64_tr_b16 a[30:31], v242 offset:21728
  v_mfma_f32_16x16x32_bf16 v[20:23], a[56:59], a[156:159], v[20:23]
  s_nop 0
  buffer_load_dwordx4 v75, s[32:35], s61 offen offset:1056 lds
  v_mfma_f32_16x16x32_bf16 v[28:31], a[60:63], a[156:159], v[28:31]
  buffer_load_dwordx2 a[108:109], v67, s[36:39], s62 offen sc1
  v_mfma_f32_16x16x32_bf16 v[24:27], a[60:63], a[152:155], v[24:27]
  buffer_load_dwordx2 a[110:111], v67, s[36:39], s62 offen offset:3584 sc1
  s_waitcnt vmcnt(62) lgkmcnt(0)
  v_mfma_f32_16x16x32_bf16 v[0:3], a[0:3], a[160:163], v[0:3]
  ds_read_b64_tr_b16 a[32:33], v242 offset:25344
  buffer_load_dwordx2 a[112:113], v66, s[36:39], s63 offen sc1
  v_mfma_f32_16x16x32_bf16 v[4:7], a[0:3], a[164:167], v[4:7]
  ds_read_b64_tr_b16 a[34:35], v242 offset:25856
  ds_read_b64_tr_b16 a[36:37], v242 offset:25376
  v_mfma_f32_16x16x32_bf16 v[12:15], a[4:7], a[164:167], v[12:15]
  buffer_load_dwordx2 a[114:115], v66, s[36:39], s63 offen offset:3584 sc1
  ds_read_b64_tr_b16 a[38:39], v242 offset:25888
  v_mfma_f32_16x16x32_bf16 v[8:11], a[4:7], a[160:163], v[8:11]
  ds_read_b64_tr_b16 a[40:41], v242 offset:25408
  s_add_u32 m0, s76, 77056
  v_mfma_f32_16x16x32_bf16 v[16:19], a[8:11], a[160:163], v[16:19]
  ds_read_b64_tr_b16 a[42:43], v242 offset:25920
  ds_read_b64_tr_b16 a[44:45], v242 offset:25440
  v_mfma_f32_16x16x32_bf16 v[20:23], a[8:11], a[164:167], v[20:23]
  buffer_load_dwordx4 v245, s[32:35], s60 offen lds
  ds_read_b64_tr_b16 a[46:47], v242 offset:25952
  v_mfma_f32_16x16x32_bf16 v[28:31], a[12:15], a[164:167], v[28:31]
  ds_read_b64_tr_b16 a[48:49], v242 offset:29568
  v_readlane_b32 s61, v239, 18
  v_mfma_f32_16x16x32_bf16 v[24:27], a[12:15], a[160:163], v[24:27]
  ds_read_b64_tr_b16 a[50:51], v242 offset:30080
  buffer_load_dwordx2 a[116:117], v67, s[36:39], s63 offen sc1
  v_mfma_f32_16x16x32_bf16 v[0:3], a[16:19], a[168:171], v[0:3]
  ds_read_b64_tr_b16 a[52:53], v242 offset:29600
  ds_read_b64_tr_b16 a[54:55], v242 offset:30112
  v_mfma_f32_16x16x32_bf16 v[4:7], a[16:19], a[172:175], v[4:7]
  buffer_load_dwordx2 a[118:119], v67, s[36:39], s63 offen offset:3584 sc1
  ds_read_b64_tr_b16 a[56:57], v242 offset:29632
  v_mfma_f32_16x16x32_bf16 v[12:15], a[20:23], a[172:175], v[12:15]
  ds_read_b64_tr_b16 a[58:59], v242 offset:30144
  v_mfma_f32_16x16x32_bf16 v[8:11], a[20:23], a[168:171], v[8:11]
  ds_read_b64_tr_b16 a[60:61], v242 offset:29664
  ds_read_b64_tr_b16 a[62:63], v242 offset:30176
  v_mfma_f32_16x16x32_bf16 v[16:19], a[24:27], a[168:171], v[16:19]
  buffer_load_dwordx4 v75, s[32:35], s60 offen offset:1056 lds
  s_add_u32 s63, s63, 7168
  v_mfma_f32_16x16x32_bf16 v[20:23], a[24:27], a[172:175], v[20:23]
  v_mfma_f32_16x16x32_bf16 v[28:31], a[28:31], a[172:175], v[28:31]
  buffer_load_dwordx2 a[120:121], v66, s[36:39], s63 offen sc1
  v_mfma_f32_16x16x32_bf16 v[24:27], a[28:31], a[168:171], v[24:27]
  buffer_load_dwordx2 a[122:123], v66, s[36:39], s63 offen offset:3584 sc1
  s_waitcnt vmcnt(62) lgkmcnt(0)
  v_mfma_f32_16x16x32_bf16 v[0:3], a[32:35], a[176:179], v[0:3]
  s_waitcnt vmcnt(63)
  s_barrier
  v_mfma_f32_16x16x32_bf16 v[4:7], a[32:35], a[180:183], v[4:7]
  ds_read_b64_tr_b16 a[0:1], v243 offset:1024
  buffer_load_dwordx2 a[124:125], v67, s[36:39], s63 offen sc1
  v_mfma_f32_16x16x32_bf16 v[12:15], a[36:39], a[180:183], v[12:15]
  ds_read_b64_tr_b16 a[2:3], v243 offset:1536
  ds_read_b64_tr_b16 a[4:5], v243 offset:1056
  v_mfma_f32_16x16x32_bf16 v[8:11], a[36:39], a[176:179], v[8:11]
  buffer_load_dwordx2 a[126:127], v67, s[36:39], s63 offen offset:3584 sc1
  ds_read_b64_tr_b16 a[6:7], v243 offset:1568
  v_mfma_f32_16x16x32_bf16 v[16:19], a[40:43], a[176:179], v[16:19]
  ds_read_b64_tr_b16 a[8:9], v243 offset:1088
  s_add_u32 m0, s76, 85504
  v_mfma_f32_16x16x32_bf16 v[20:23], a[40:43], a[180:183], v[20:23]
  ds_read_b64_tr_b16 a[10:11], v243 offset:1600
  ds_read_b64_tr_b16 a[12:13], v243 offset:1120
  v_mfma_f32_16x16x32_bf16 v[28:31], a[44:47], a[180:183], v[28:31]
  buffer_load_dwordx4 v245, s[32:35], s61 offen lds
  ds_read_b64_tr_b16 a[14:15], v243 offset:1632
  v_mfma_f32_16x16x32_bf16 v[24:27], a[44:47], a[176:179], v[24:27]
  ds_read_b64_tr_b16 a[16:17], v243 offset:5248
  v_readlane_b32 s60, v239, 19
  v_mfma_f32_16x16x32_bf16 v[0:3], a[48:51], a[184:187], v[0:3]
  ds_read_b64_tr_b16 a[18:19], v243 offset:5760
  ds_read_b64_tr_b16 a[20:21], v243 offset:5280
  v_mfma_f32_16x16x32_bf16 v[4:7], a[48:51], a[188:191], v[4:7]
  ds_read_b64_tr_b16 a[22:23], v243 offset:5792
  v_mfma_f32_16x16x32_bf16 v[12:15], a[52:55], a[188:191], v[12:15]
  buffer_load_dwordx4 v75, s[32:35], s61 offen offset:1056 lds
  ds_read_b64_tr_b16 a[24:25], v243 offset:5312
  v_mfma_f32_16x16x32_bf16 v[8:11], a[52:55], a[184:187], v[8:11]
  ds_read_b64_tr_b16 a[26:27], v243 offset:5824
  s_add_u32 m0, s76, 93952
  v_mfma_f32_16x16x32_bf16 v[16:19], a[56:59], a[184:187], v[16:19]
  ds_read_b64_tr_b16 a[28:29], v243 offset:5344
  ds_read_b64_tr_b16 a[30:31], v243 offset:5856
  v_mfma_f32_16x16x32_bf16 v[20:23], a[56:59], a[188:191], v[20:23]
  buffer_load_dwordx4 v245, s[32:35], s60 offen lds
  v_readlane_b32 s61, v239, 20
  v_mfma_f32_16x16x32_bf16 v[28:31], a[60:63], a[188:191], v[28:31]
  v_mfma_f32_16x16x32_bf16 v[24:27], a[60:63], a[184:187], v[24:27]
  buffer_load_dwordx4 v75, s[32:35], s60 offen offset:1056 lds
  s_waitcnt vmcnt(63) lgkmcnt(0)
  v_mfma_f32_16x16x32_bf16 v[0:3], a[0:3], a[192:195], v[0:3]
  ds_read_b64_tr_b16 a[32:33], v243 offset:9472
  s_add_u32 m0, s76, 129792
  v_mfma_f32_16x16x32_bf16 v[4:7], a[0:3], a[196:199], v[4:7]
  ds_read_b64_tr_b16 a[34:35], v243 offset:9984
  ds_read_b64_tr_b16 a[36:37], v243 offset:9504
  v_mfma_f32_16x16x32_bf16 v[12:15], a[4:7], a[196:199], v[12:15]
  buffer_load_dwordx4 v245, s[32:35], s61 offen lds
  ds_read_b64_tr_b16 a[38:39], v243 offset:10016
  v_mfma_f32_16x16x32_bf16 v[8:11], a[4:7], a[192:195], v[8:11]
  ds_read_b64_tr_b16 a[40:41], v243 offset:9536
  v_readlane_b32 s60, v239, 21
  v_mfma_f32_16x16x32_bf16 v[16:19], a[8:11], a[192:195], v[16:19]
  ds_read_b64_tr_b16 a[42:43], v243 offset:10048
  v_mfma_f32_16x16x32_bf16 v[20:23], a[8:11], a[196:199], v[20:23]
  ds_read_b64_tr_b16 a[44:45], v243 offset:9568
  ds_read_b64_tr_b16 a[46:47], v243 offset:10080
  v_mfma_f32_16x16x32_bf16 v[28:31], a[12:15], a[196:199], v[28:31]
  buffer_load_dwordx4 v75, s[32:35], s61 offen offset:1056 lds
  ds_read_b64_tr_b16 a[48:49], v243 offset:13696
  v_mfma_f32_16x16x32_bf16 v[24:27], a[12:15], a[192:195], v[24:27]
  ds_read_b64_tr_b16 a[50:51], v243 offset:14208
  s_add_u32 m0, s76, 138240
  v_mfma_f32_16x16x32_bf16 v[0:3], a[16:19], a[200:203], v[0:3]
  ds_read_b64_tr_b16 a[52:53], v243 offset:13728
  buffer_load_dwordx4 v245, s[32:35], s60 offen lds
  v_mfma_f32_16x16x32_bf16 v[4:7], a[16:19], a[204:207], v[4:7]
  ds_read_b64_tr_b16 a[54:55], v243 offset:14240
  ds_read_b64_tr_b16 a[56:57], v243 offset:13760
  v_mfma_f32_16x16x32_bf16 v[12:15], a[20:23], a[204:207], v[12:15]
  v_readlane_b32 s61, v239, 22
  ds_read_b64_tr_b16 a[58:59], v243 offset:14272
  v_mfma_f32_16x16x32_bf16 v[8:11], a[20:23], a[200:203], v[8:11]
  ds_read_b64_tr_b16 a[60:61], v243 offset:13792
  v_mfma_f32_16x16x32_bf16 v[16:19], a[24:27], a[200:203], v[16:19]
  ds_read_b64_tr_b16 a[62:63], v243 offset:14304
  buffer_load_dwordx4 v75, s[32:35], s60 offen offset:1056 lds
  v_mfma_f32_16x16x32_bf16 v[20:23], a[24:27], a[204:207], v[20:23]
  s_add_u32 m0, s76, 146688
  v_mfma_f32_16x16x32_bf16 v[28:31], a[28:31], a[204:207], v[28:31]
  buffer_load_dwordx4 v245, s[32:35], s61 offen lds
  v_mfma_f32_16x16x32_bf16 v[24:27], a[28:31], a[200:203], v[24:27]
  v_readlane_b32 s60, v239, 23
  s_waitcnt vmcnt(61) lgkmcnt(0)
  v_mfma_f32_16x16x32_bf16 v[0:3], a[32:35], a[208:211], v[0:3]
  s_waitcnt vmcnt(63)
  s_barrier
  v_mfma_f32_16x16x32_bf16 v[4:7], a[32:35], a[212:215], v[4:7]
  ds_read_b64_tr_b16 a[0:1], v243 offset:17920
  v_mfma_f32_16x16x32_bf16 v[12:15], a[36:39], a[212:215], v[12:15]
  ds_read_b64_tr_b16 a[2:3], v243 offset:18432
  ds_read_b64_tr_b16 a[4:5], v243 offset:17952
  v_mfma_f32_16x16x32_bf16 v[8:11], a[36:39], a[208:211], v[8:11]
  buffer_load_dwordx4 v75, s[32:35], s61 offen offset:1056 lds
  ds_read_b64_tr_b16 a[6:7], v243 offset:18464
  v_mfma_f32_16x16x32_bf16 v[16:19], a[40:43], a[208:211], v[16:19]
  ds_read_b64_tr_b16 a[8:9], v243 offset:17984
  s_add_u32 m0, s76, 155136
  v_mfma_f32_16x16x32_bf16 v[20:23], a[40:43], a[212:215], v[20:23]
  ds_read_b64_tr_b16 a[10:11], v243 offset:18496
  ds_read_b64_tr_b16 a[12:13], v243 offset:18016
  v_mfma_f32_16x16x32_bf16 v[28:31], a[44:47], a[212:215], v[28:31]
  buffer_load_dwordx4 v245, s[32:35], s60 offen lds
  ds_read_b64_tr_b16 a[14:15], v243 offset:18528
  v_mfma_f32_16x16x32_bf16 v[24:27], a[44:47], a[208:211], v[24:27]
  ds_read_b64_tr_b16 a[16:17], v243 offset:22144
  v_readlane_b32 s61, v239, 24
  v_mfma_f32_16x16x32_bf16 v[0:3], a[48:51], a[216:219], v[0:3]
  ds_read_b64_tr_b16 a[18:19], v243 offset:22656
  ds_read_b64_tr_b16 a[20:21], v243 offset:22176
  v_mfma_f32_16x16x32_bf16 v[4:7], a[48:51], a[220:223], v[4:7]
  ds_read_b64_tr_b16 a[22:23], v243 offset:22688
  v_mfma_f32_16x16x32_bf16 v[12:15], a[52:55], a[220:223], v[12:15]
  buffer_load_dwordx4 v75, s[32:35], s60 offen offset:1056 lds
  ds_read_b64_tr_b16 a[24:25], v243 offset:22208
  v_mfma_f32_16x16x32_bf16 v[8:11], a[52:55], a[216:219], v[8:11]
  ds_read_b64_tr_b16 a[26:27], v243 offset:22720
  s_add_u32 m0, s76, 1024
  v_mfma_f32_16x16x32_bf16 v[16:19], a[56:59], a[216:219], v[16:19]
  ds_read_b64_tr_b16 a[28:29], v243 offset:22240
  ds_read_b64_tr_b16 a[30:31], v243 offset:22752
  v_mfma_f32_16x16x32_bf16 v[20:23], a[56:59], a[220:223], v[20:23]
  buffer_load_dwordx4 v65, s[32:35], s61 offen lds
  v_readlane_b32 s60, v239, 25
  v_mfma_f32_16x16x32_bf16 v[28:31], a[60:63], a[220:223], v[28:31]
  v_mfma_f32_16x16x32_bf16 v[24:27], a[60:63], a[216:219], v[24:27]
  buffer_load_dwordx4 v71, s[32:35], s61 offen offset:1056 lds
  s_waitcnt vmcnt(61) lgkmcnt(0)
  v_mfma_f32_16x16x32_bf16 v[0:3], a[0:3], a[224:227], v[0:3]
  ds_read_b64_tr_b16 a[32:33], v243 offset:26368
  ds_read_b64_tr_b16 a[34:35], v243 offset:26880
  v_mfma_f32_16x16x32_bf16 v[4:7], a[0:3], a[228:231], v[4:7]
  ds_read_b64_tr_b16 a[36:37], v243 offset:26400
  s_add_u32 m0, s76, 9472
  v_mfma_f32_16x16x32_bf16 v[12:15], a[4:7], a[228:231], v[12:15]
  ds_read_b64_tr_b16 a[38:39], v243 offset:26912
  v_mfma_f32_16x16x32_bf16 v[8:11], a[4:7], a[224:227], v[8:11]
  ds_read_b64_tr_b16 a[40:41], v243 offset:26432
  ds_read_b64_tr_b16 a[42:43], v243 offset:26944
  v_mfma_f32_16x16x32_bf16 v[16:19], a[8:11], a[224:227], v[16:19]
  ds_read_b64_tr_b16 a[44:45], v243 offset:26464
  buffer_load_dwordx4 v65, s[32:35], s60 offen lds
  v_mfma_f32_16x16x32_bf16 v[20:23], a[8:11], a[228:231], v[20:23]
  ds_read_b64_tr_b16 a[46:47], v243 offset:26976
  v_mfma_f32_16x16x32_bf16 v[28:31], a[12:15], a[228:231], v[28:31]
  ds_read_b64_tr_b16 a[48:49], v243 offset:30592
  ds_read_b64_tr_b16 a[50:51], v243 offset:31104
  v_mfma_f32_16x16x32_bf16 v[24:27], a[12:15], a[224:227], v[24:27]
  ds_read_b64_tr_b16 a[52:53], v243 offset:30624
  v_mfma_f32_16x16x32_bf16 v[0:3], a[16:19], a[232:235], v[0:3]
  v_readlane_b32 s61, v239, 26
  ds_read_b64_tr_b16 a[54:55], v243 offset:31136
  v_mfma_f32_16x16x32_bf16 v[4:7], a[16:19], a[236:239], v[4:7]
  ds_read_b64_tr_b16 a[56:57], v243 offset:30656
  ds_read_b64_tr_b16 a[58:59], v243 offset:31168
  v_mfma_f32_16x16x32_bf16 v[12:15], a[20:23], a[236:239], v[12:15]
  ds_read_b64_tr_b16 a[60:61], v243 offset:30688
  v_mfma_f32_16x16x32_bf16 v[8:11], a[20:23], a[232:235], v[8:11]
  ds_read_b64_tr_b16 a[62:63], v243 offset:31200
  v_mfma_f32_16x16x32_bf16 v[16:19], a[24:27], a[232:235], v[16:19]
  v_mfma_f32_16x16x32_bf16 v[20:23], a[24:27], a[236:239], v[20:23]
  v_mfma_f32_16x16x32_bf16 v[28:31], a[28:31], a[236:239], v[28:31]
  buffer_load_dwordx4 v71, s[32:35], s60 offen offset:1056 lds
  v_mfma_f32_16x16x32_bf16 v[24:27], a[28:31], a[232:235], v[24:27]
  s_waitcnt vmcnt(56) lgkmcnt(0)
  v_mfma_f32_16x16x32_bf16 v[0:3], a[32:35], a[240:243], v[0:3]
  s_waitcnt vmcnt(58)
  s_barrier
  v_mfma_f32_16x16x32_bf16 v[4:7], a[32:35], a[244:247], v[4:7]
  ds_read_b64_tr_b16 a[0:1], v243 offset:34816
  ds_read_b64_tr_b16 a[2:3], v243 offset:35328
  v_mfma_f32_16x16x32_bf16 v[12:15], a[36:39], a[244:247], v[12:15]
  s_add_u32 m0, s76, 17920
  ds_read_b64_tr_b16 a[4:5], v243 offset:34848
  v_mfma_f32_16x16x32_bf16 v[8:11], a[36:39], a[240:243], v[8:11]
  ds_read_b64_tr_b16 a[6:7], v243 offset:35360
  buffer_load_dwordx4 v65, s[32:35], s61 offen lds
  v_mfma_f32_16x16x32_bf16 v[16:19], a[40:43], a[240:243], v[16:19]
  ds_read_b64_tr_b16 a[8:9], v243 offset:34880
  ds_read_b64_tr_b16 a[10:11], v243 offset:35392
  v_mfma_f32_16x16x32_bf16 v[20:23], a[40:43], a[244:247], v[20:23]
  ds_read_b64_tr_b16 a[12:13], v243 offset:34912
  v_readlane_b32 s60, v239, 27
  v_mfma_f32_16x16x32_bf16 v[28:31], a[44:47], a[244:247], v[28:31]
  ds_read_b64_tr_b16 a[14:15], v243 offset:35424
  ds_read_b64_tr_b16 a[16:17], v243 offset:39040
  v_mfma_f32_16x16x32_bf16 v[24:27], a[44:47], a[240:243], v[24:27]
  ds_read_b64_tr_b16 a[18:19], v243 offset:39552
  v_mfma_f32_16x16x32_bf16 v[0:3], a[48:51], a[248:251], v[0:3]
  ds_read_b64_tr_b16 a[20:21], v243 offset:39072
  buffer_load_dwordx4 v71, s[32:35], s61 offen offset:1056 lds
  v_mfma_f32_16x16x32_bf16 v[4:7], a[48:51], a[252:255], v[4:7]
  ds_read_b64_tr_b16 a[22:23], v243 offset:39584
  ds_read_b64_tr_b16 a[24:25], v243 offset:39104
  v_mfma_f32_16x16x32_bf16 v[12:15], a[52:55], a[252:255], v[12:15]
  ds_read_b64_tr_b16 a[26:27], v243 offset:39616
  s_add_u32 m0, s76, 26368
  v_mfma_f32_16x16x32_bf16 v[8:11], a[52:55], a[248:251], v[8:11]
  ds_read_b64_tr_b16 a[28:29], v243 offset:39136
  ds_read_b64_tr_b16 a[30:31], v243 offset:39648
  v_mfma_f32_16x16x32_bf16 v[16:19], a[56:59], a[248:251], v[16:19]
  buffer_load_dwordx4 v65, s[32:35], s60 offen lds
  v_mfma_f32_16x16x32_bf16 v[20:23], a[56:59], a[252:255], v[20:23]
  v_mfma_f32_16x16x32_bf16 v[28:31], a[60:63], a[252:255], v[28:31]
  v_mfma_f32_16x16x32_bf16 v[24:27], a[60:63], a[248:251], v[24:27]
  buffer_load_dwordx4 v71, s[32:35], s60 offen offset:1056 lds
  s_waitcnt vmcnt(52) lgkmcnt(0)
  v_mfma_f32_16x16x32_bf16 v[0:3], a[0:3], a[64:67], v[0:3]
  ds_read_b64_tr_b16 a[32:33], v243 offset:43264
  v_mfma_f32_16x16x32_bf16 v[4:7], a[0:3], a[68:71], v[4:7]
  ds_read_b64_tr_b16 a[34:35], v243 offset:43776
  v_mfma_f32_16x16x32_bf16 v[12:15], a[4:7], a[68:71], v[12:15]
  ds_read_b64_tr_b16 a[36:37], v243 offset:43296
  v_mfma_f32_16x16x32_bf16 v[8:11], a[4:7], a[64:67], v[8:11]
  ds_read_b64_tr_b16 a[38:39], v243 offset:43808
  v_mfma_f32_16x16x32_bf16 v[16:19], a[8:11], a[64:67], v[16:19]
  ds_read_b64_tr_b16 a[40:41], v243 offset:43328
  v_mfma_f32_16x16x32_bf16 v[20:23], a[8:11], a[68:71], v[20:23]
  ds_read_b64_tr_b16 a[42:43], v243 offset:43840
  v_mfma_f32_16x16x32_bf16 v[28:31], a[12:15], a[68:71], v[28:31]
  ds_read_b64_tr_b16 a[44:45], v243 offset:43360
  v_mfma_f32_16x16x32_bf16 v[24:27], a[12:15], a[64:67], v[24:27]
  ds_read_b64_tr_b16 a[46:47], v243 offset:43872
  v_mfma_f32_16x16x32_bf16 v[0:3], a[16:19], a[72:75], v[0:3]
  ds_read_b64_tr_b16 a[48:49], v243 offset:47488
  v_mfma_f32_16x16x32_bf16 v[4:7], a[16:19], a[76:79], v[4:7]
  ds_read_b64_tr_b16 a[50:51], v243 offset:48000
  v_mfma_f32_16x16x32_bf16 v[12:15], a[20:23], a[76:79], v[12:15]
  ds_read_b64_tr_b16 a[52:53], v243 offset:47520
  v_mfma_f32_16x16x32_bf16 v[8:11], a[20:23], a[72:75], v[8:11]
  ds_read_b64_tr_b16 a[54:55], v243 offset:48032
  v_mfma_f32_16x16x32_bf16 v[16:19], a[24:27], a[72:75], v[16:19]
  ds_read_b64_tr_b16 a[56:57], v243 offset:47552
  v_mfma_f32_16x16x32_bf16 v[20:23], a[24:27], a[76:79], v[20:23]
  ds_read_b64_tr_b16 a[58:59], v243 offset:48064
  v_mfma_f32_16x16x32_bf16 v[28:31], a[28:31], a[76:79], v[28:31]
  ds_read_b64_tr_b16 a[60:61], v243 offset:47584
  v_mfma_f32_16x16x32_bf16 v[24:27], a[28:31], a[72:75], v[24:27]
  ds_read_b64_tr_b16 a[62:63], v243 offset:48096
  s_waitcnt vmcnt(40) lgkmcnt(0)
  v_mfma_f32_16x16x32_bf16 v[0:3], a[32:35], a[80:83], v[0:3]
  s_waitcnt vmcnt(48)
  s_barrier
  v_mfma_f32_16x16x32_bf16 v[4:7], a[32:35], a[84:87], v[4:7]
  ds_read_b64_tr_b16 a[0:1], v68 offset:0
  ds_read_b64_tr_b16 a[2:3], v68 offset:512
  v_mfma_f32_16x16x32_bf16 v[12:15], a[36:39], a[84:87], v[12:15]
  ds_read_b64_tr_b16 a[4:5], v68 offset:32
  v_mfma_f32_16x16x32_bf16 v[8:11], a[36:39], a[80:83], v[8:11]
  ds_read_b64_tr_b16 a[6:7], v68 offset:544
  ds_read_b64_tr_b16 a[8:9], v68 offset:64
  v_mfma_f32_16x16x32_bf16 v[16:19], a[40:43], a[80:83], v[16:19]
  ds_read_b64_tr_b16 a[10:11], v68 offset:576
  v_mfma_f32_16x16x32_bf16 v[20:23], a[40:43], a[84:87], v[20:23]
  ds_read_b64_tr_b16 a[12:13], v68 offset:96
  ds_read_b64_tr_b16 a[14:15], v68 offset:608
  v_mfma_f32_16x16x32_bf16 v[28:31], a[44:47], a[84:87], v[28:31]
  ds_read_b64_tr_b16 a[16:17], v68 offset:4224
  v_mfma_f32_16x16x32_bf16 v[24:27], a[44:47], a[80:83], v[24:27]
  ds_read_b64_tr_b16 a[18:19], v68 offset:4736
  ds_read_b64_tr_b16 a[20:21], v68 offset:4256
  v_mfma_f32_16x16x32_bf16 v[0:3], a[48:51], a[88:91], v[0:3]
  ds_read_b64_tr_b16 a[22:23], v68 offset:4768
  v_mfma_f32_16x16x32_bf16 v[4:7], a[48:51], a[92:95], v[4:7]
  ds_read_b64_tr_b16 a[24:25], v68 offset:4288
  ds_read_b64_tr_b16 a[26:27], v68 offset:4800
  v_mfma_f32_16x16x32_bf16 v[12:15], a[52:55], a[92:95], v[12:15]
  ds_read_b64_tr_b16 a[28:29], v68 offset:4320
  v_mfma_f32_16x16x32_bf16 v[8:11], a[52:55], a[88:91], v[8:11]
  ds_read_b64_tr_b16 a[30:31], v68 offset:4832
  v_mfma_f32_16x16x32_bf16 v[16:19], a[56:59], a[88:91], v[16:19]
  v_mfma_f32_16x16x32_bf16 v[20:23], a[56:59], a[92:95], v[20:23]
  v_mfma_f32_16x16x32_bf16 v[28:31], a[60:63], a[92:95], v[28:31]
  v_mfma_f32_16x16x32_bf16 v[24:27], a[60:63], a[88:91], v[24:27]
  s_waitcnt vmcnt(30) lgkmcnt(0)
  v_mfma_f32_16x16x32_bf16 v[0:3], a[0:3], a[96:99], v[0:3]
  ds_read_b64_tr_b16 a[32:33], v68 offset:8448
  v_mfma_f32_16x16x32_bf16 v[4:7], a[0:3], a[100:103], v[4:7]
  ds_read_b64_tr_b16 a[34:35], v68 offset:8960
  v_mfma_f32_16x16x32_bf16 v[12:15], a[4:7], a[100:103], v[12:15]
  ds_read_b64_tr_b16 a[36:37], v68 offset:8480
  v_mfma_f32_16x16x32_bf16 v[8:11], a[4:7], a[96:99], v[8:11]
  ds_read_b64_tr_b16 a[38:39], v68 offset:8992
  v_mfma_f32_16x16x32_bf16 v[16:19], a[8:11], a[96:99], v[16:19]
  ds_read_b64_tr_b16 a[40:41], v68 offset:8512
  v_mfma_f32_16x16x32_bf16 v[20:23], a[8:11], a[100:103], v[20:23]
  ds_read_b64_tr_b16 a[42:43], v68 offset:9024
  v_mfma_f32_16x16x32_bf16 v[28:31], a[12:15], a[100:103], v[28:31]
  ds_read_b64_tr_b16 a[44:45], v68 offset:8544
  v_mfma_f32_16x16x32_bf16 v[24:27], a[12:15], a[96:99], v[24:27]
  ds_read_b64_tr_b16 a[46:47], v68 offset:9056
  v_mfma_f32_16x16x32_bf16 v[0:3], a[16:19], a[104:107], v[0:3]
  ds_read_b64_tr_b16 a[48:49], v68 offset:12672
  v_mfma_f32_16x16x32_bf16 v[4:7], a[16:19], a[108:111], v[4:7]
  ds_read_b64_tr_b16 a[50:51], v68 offset:13184
  v_mfma_f32_16x16x32_bf16 v[12:15], a[20:23], a[108:111], v[12:15]
  ds_read_b64_tr_b16 a[52:53], v68 offset:12704
  v_mfma_f32_16x16x32_bf16 v[8:11], a[20:23], a[104:107], v[8:11]
  ds_read_b64_tr_b16 a[54:55], v68 offset:13216
  v_mfma_f32_16x16x32_bf16 v[16:19], a[24:27], a[104:107], v[16:19]
  ds_read_b64_tr_b16 a[56:57], v68 offset:12736
  v_mfma_f32_16x16x32_bf16 v[20:23], a[24:27], a[108:111], v[20:23]
  ds_read_b64_tr_b16 a[58:59], v68 offset:13248
  v_mfma_f32_16x16x32_bf16 v[28:31], a[28:31], a[108:111], v[28:31]
  ds_read_b64_tr_b16 a[60:61], v68 offset:12768
  v_mfma_f32_16x16x32_bf16 v[24:27], a[28:31], a[104:107], v[24:27]
  ds_read_b64_tr_b16 a[62:63], v68 offset:13280
  s_waitcnt vmcnt(20) lgkmcnt(0)
  v_mfma_f32_16x16x32_bf16 v[0:3], a[32:35], a[112:115], v[0:3]
  s_waitcnt vmcnt(24)
  s_barrier
  v_mfma_f32_16x16x32_bf16 v[4:7], a[32:35], a[116:119], v[4:7]
  ds_read_b64_tr_b16 a[0:1], v68 offset:16896
  ds_read_b64_tr_b16 a[2:3], v68 offset:17408
  v_mfma_f32_16x16x32_bf16 v[12:15], a[36:39], a[116:119], v[12:15]
  ds_read_b64_tr_b16 a[4:5], v68 offset:16928
  v_mfma_f32_16x16x32_bf16 v[8:11], a[36:39], a[112:115], v[8:11]
  ds_read_b64_tr_b16 a[6:7], v68 offset:17440
  ds_read_b64_tr_b16 a[8:9], v68 offset:16960
  v_mfma_f32_16x16x32_bf16 v[16:19], a[40:43], a[112:115], v[16:19]
  ds_read_b64_tr_b16 a[10:11], v68 offset:17472
  v_mfma_f32_16x16x32_bf16 v[20:23], a[40:43], a[116:119], v[20:23]
  ds_read_b64_tr_b16 a[12:13], v68 offset:16992
  ds_read_b64_tr_b16 a[14:15], v68 offset:17504
  v_mfma_f32_16x16x32_bf16 v[28:31], a[44:47], a[116:119], v[28:31]
  ds_read_b64_tr_b16 a[16:17], v68 offset:21120
  v_mfma_f32_16x16x32_bf16 v[24:27], a[44:47], a[112:115], v[24:27]
  ds_read_b64_tr_b16 a[18:19], v68 offset:21632
  ds_read_b64_tr_b16 a[20:21], v68 offset:21152
  v_mfma_f32_16x16x32_bf16 v[0:3], a[48:51], a[120:123], v[0:3]
  ds_read_b64_tr_b16 a[22:23], v68 offset:21664
  v_mfma_f32_16x16x32_bf16 v[4:7], a[48:51], a[124:127], v[4:7]
  ds_read_b64_tr_b16 a[24:25], v68 offset:21184
  ds_read_b64_tr_b16 a[26:27], v68 offset:21696
  v_mfma_f32_16x16x32_bf16 v[12:15], a[52:55], a[124:127], v[12:15]
  ds_read_b64_tr_b16 a[28:29], v68 offset:21216
  v_mfma_f32_16x16x32_bf16 v[8:11], a[52:55], a[120:123], v[8:11]
  ds_read_b64_tr_b16 a[30:31], v68 offset:21728
  v_mfma_f32_16x16x32_bf16 v[16:19], a[56:59], a[120:123], v[16:19]
  v_mfma_f32_16x16x32_bf16 v[20:23], a[56:59], a[124:127], v[20:23]
  v_mfma_f32_16x16x32_bf16 v[28:31], a[60:63], a[124:127], v[28:31]
  v_mfma_f32_16x16x32_bf16 v[24:27], a[60:63], a[120:123], v[24:27]
  s_waitcnt lgkmcnt(0)
  v_mfma_f32_16x16x32_bf16 v[32:35], a[0:3], a[128:131], v[32:35]
  ds_read_b64_tr_b16 a[32:33], v68 offset:25344
  v_mfma_f32_16x16x32_bf16 v[36:39], a[0:3], a[132:135], v[36:39]
  ds_read_b64_tr_b16 a[34:35], v68 offset:25856
  v_mfma_f32_16x16x32_bf16 v[44:47], a[4:7], a[132:135], v[44:47]
  ds_read_b64_tr_b16 a[36:37], v68 offset:25376
  v_mfma_f32_16x16x32_bf16 v[40:43], a[4:7], a[128:131], v[40:43]
  ds_read_b64_tr_b16 a[38:39], v68 offset:25888
  v_mfma_f32_16x16x32_bf16 v[48:51], a[8:11], a[128:131], v[48:51]
  ds_read_b64_tr_b16 a[40:41], v68 offset:25408
  v_mfma_f32_16x16x32_bf16 v[52:55], a[8:11], a[132:135], v[52:55]
  ds_read_b64_tr_b16 a[42:43], v68 offset:25920
  v_mfma_f32_16x16x32_bf16 v[60:63], a[12:15], a[132:135], v[60:63]
  ds_read_b64_tr_b16 a[44:45], v68 offset:25440
  v_mfma_f32_16x16x32_bf16 v[56:59], a[12:15], a[128:131], v[56:59]
  ds_read_b64_tr_b16 a[46:47], v68 offset:25952
  v_mfma_f32_16x16x32_bf16 v[32:35], a[16:19], a[136:139], v[32:35]
  ds_read_b64_tr_b16 a[48:49], v68 offset:29568
  v_mfma_f32_16x16x32_bf16 v[36:39], a[16:19], a[140:143], v[36:39]
  ds_read_b64_tr_b16 a[50:51], v68 offset:30080
  v_mfma_f32_16x16x32_bf16 v[44:47], a[20:23], a[140:143], v[44:47]
  ds_read_b64_tr_b16 a[52:53], v68 offset:29600
  v_mfma_f32_16x16x32_bf16 v[40:43], a[20:23], a[136:139], v[40:43]
  ds_read_b64_tr_b16 a[54:55], v68 offset:30112
  v_mfma_f32_16x16x32_bf16 v[48:51], a[24:27], a[136:139], v[48:51]
  ds_read_b64_tr_b16 a[56:57], v68 offset:29632
  v_mfma_f32_16x16x32_bf16 v[52:55], a[24:27], a[140:143], v[52:55]
  ds_read_b64_tr_b16 a[58:59], v68 offset:30144
  v_mfma_f32_16x16x32_bf16 v[60:63], a[28:31], a[140:143], v[60:63]
  ds_read_b64_tr_b16 a[60:61], v68 offset:29664
  v_mfma_f32_16x16x32_bf16 v[56:59], a[28:31], a[136:139], v[56:59]
  ds_read_b64_tr_b16 a[62:63], v68 offset:30176
  s_waitcnt lgkmcnt(0)
  v_mfma_f32_16x16x32_bf16 v[32:35], a[32:35], a[144:147], v[32:35]
  s_waitcnt vmcnt(16)
  s_barrier
  v_mfma_f32_16x16x32_bf16 v[36:39], a[32:35], a[148:151], v[36:39]
  ds_read_b64_tr_b16 a[0:1], v68 offset:33792
  ds_read_b64_tr_b16 a[2:3], v68 offset:34304
  v_mfma_f32_16x16x32_bf16 v[44:47], a[36:39], a[148:151], v[44:47]
  ds_read_b64_tr_b16 a[4:5], v68 offset:33824
  buffer_store_dwordx4 v[0:3], v249, s[44:47], s90 offen offset:0 sc1
  v_mfma_f32_16x16x32_bf16 v[40:43], a[36:39], a[144:147], v[40:43]
  ds_read_b64_tr_b16 a[6:7], v68 offset:34336
  ds_read_b64_tr_b16 a[8:9], v68 offset:33856
  v_mfma_f32_16x16x32_bf16 v[48:51], a[40:43], a[144:147], v[48:51]
  ds_read_b64_tr_b16 a[10:11], v68 offset:34368
  v_mfma_f32_16x16x32_bf16 v[52:55], a[40:43], a[148:151], v[52:55]
  ds_read_b64_tr_b16 a[12:13], v68 offset:33888
  ds_read_b64_tr_b16 a[14:15], v68 offset:34400
  v_mfma_f32_16x16x32_bf16 v[60:63], a[44:47], a[148:151], v[60:63]
  ds_read_b64_tr_b16 a[16:17], v68 offset:38016
  buffer_store_dwordx4 v[4:7], v249, s[44:47], s90 offen offset:1024 sc1
  v_mfma_f32_16x16x32_bf16 v[56:59], a[44:47], a[144:147], v[56:59]
  ds_read_b64_tr_b16 a[18:19], v68 offset:38528
  ds_read_b64_tr_b16 a[20:21], v68 offset:38048
  v_mfma_f32_16x16x32_bf16 v[32:35], a[48:51], a[152:155], v[32:35]
  ds_read_b64_tr_b16 a[22:23], v68 offset:38560
  v_mfma_f32_16x16x32_bf16 v[36:39], a[48:51], a[156:159], v[36:39]
  ds_read_b64_tr_b16 a[24:25], v68 offset:38080
  ds_read_b64_tr_b16 a[26:27], v68 offset:38592
  v_mfma_f32_16x16x32_bf16 v[44:47], a[52:55], a[156:159], v[44:47]
  buffer_store_dwordx4 v[8:11], v249, s[44:47], s90 offen offset:2048 sc1
  ds_read_b64_tr_b16 a[28:29], v68 offset:38112
  v_mfma_f32_16x16x32_bf16 v[40:43], a[52:55], a[152:155], v[40:43]
  ds_read_b64_tr_b16 a[30:31], v68 offset:38624
  v_mfma_f32_16x16x32_bf16 v[48:51], a[56:59], a[152:155], v[48:51]
  v_mfma_f32_16x16x32_bf16 v[52:55], a[56:59], a[156:159], v[52:55]
  v_mfma_f32_16x16x32_bf16 v[60:63], a[60:63], a[156:159], v[60:63]
  buffer_store_dwordx4 v[12:15], v249, s[44:47], s90 offen offset:3072 sc1
  v_mfma_f32_16x16x32_bf16 v[56:59], a[60:63], a[152:155], v[56:59]
  s_waitcnt lgkmcnt(0)
  v_mfma_f32_16x16x32_bf16 v[32:35], a[0:3], a[160:163], v[32:35]
  ds_read_b64_tr_b16 a[32:33], v68 offset:42240
  ds_read_b64_tr_b16 a[34:35], v68 offset:42752
  v_mfma_f32_16x16x32_bf16 v[36:39], a[0:3], a[164:167], v[36:39]
  ds_read_b64_tr_b16 a[36:37], v68 offset:42272
  v_mfma_f32_16x16x32_bf16 v[44:47], a[4:7], a[164:167], v[44:47]
  buffer_store_dwordx4 v[16:19], v249, s[44:47], s91 offen offset:0 sc1
  ds_read_b64_tr_b16 a[38:39], v68 offset:42784
  v_mfma_f32_16x16x32_bf16 v[40:43], a[4:7], a[160:163], v[40:43]
  ds_read_b64_tr_b16 a[40:41], v68 offset:42304
  ds_read_b64_tr_b16 a[42:43], v68 offset:42816
  v_mfma_f32_16x16x32_bf16 v[48:51], a[8:11], a[160:163], v[48:51]
  ds_read_b64_tr_b16 a[44:45], v68 offset:42336
  v_mfma_f32_16x16x32_bf16 v[52:55], a[8:11], a[164:167], v[52:55]
  ds_read_b64_tr_b16 a[46:47], v68 offset:42848
  v_mfma_f32_16x16x32_bf16 v[60:63], a[12:15], a[164:167], v[60:63]
  ds_read_b64_tr_b16 a[48:49], v68 offset:46464
  buffer_store_dwordx4 v[20:23], v249, s[44:47], s91 offen offset:1024 sc1
  v_mfma_f32_16x16x32_bf16 v[56:59], a[12:15], a[160:163], v[56:59]
  ds_read_b64_tr_b16 a[50:51], v68 offset:46976
  ds_read_b64_tr_b16 a[52:53], v68 offset:46496
  v_mfma_f32_16x16x32_bf16 v[32:35], a[16:19], a[168:171], v[32:35]
  ds_read_b64_tr_b16 a[54:55], v68 offset:47008
  v_mfma_f32_16x16x32_bf16 v[36:39], a[16:19], a[172:175], v[36:39]
  ds_read_b64_tr_b16 a[56:57], v68 offset:46528
  ds_read_b64_tr_b16 a[58:59], v68 offset:47040
  v_mfma_f32_16x16x32_bf16 v[44:47], a[20:23], a[172:175], v[44:47]
  buffer_store_dwordx4 v[24:27], v249, s[44:47], s91 offen offset:2048 sc1
  ds_read_b64_tr_b16 a[60:61], v68 offset:46560
  v_mfma_f32_16x16x32_bf16 v[40:43], a[20:23], a[168:171], v[40:43]
  ds_read_b64_tr_b16 a[62:63], v68 offset:47072
  v_mfma_f32_16x16x32_bf16 v[48:51], a[24:27], a[168:171], v[48:51]
  v_mfma_f32_16x16x32_bf16 v[52:55], a[24:27], a[172:175], v[52:55]
  v_mfma_f32_16x16x32_bf16 v[60:63], a[28:31], a[172:175], v[60:63]
  buffer_store_dwordx4 v[28:31], v249, s[44:47], s91 offen offset:3072 sc1
  v_mfma_f32_16x16x32_bf16 v[56:59], a[28:31], a[168:171], v[56:59]
  s_waitcnt lgkmcnt(0)
  v_mfma_f32_16x16x32_bf16 v[32:35], a[32:35], a[176:179], v[32:35]
  s_waitcnt vmcnt(20)
  s_barrier
  v_mfma_f32_16x16x32_bf16 v[36:39], a[32:35], a[180:183], v[36:39]
  ds_read_b64_tr_b16 a[0:1], v242 offset:0
  ds_read_b64_tr_b16 a[2:3], v242 offset:512
  v_mfma_f32_16x16x32_bf16 v[44:47], a[36:39], a[180:183], v[44:47]
  ds_read_b64_tr_b16 a[4:5], v242 offset:32
  v_mfma_f32_16x16x32_bf16 v[40:43], a[36:39], a[176:179], v[40:43]
  ds_read_b64_tr_b16 a[6:7], v242 offset:544
  ds_read_b64_tr_b16 a[8:9], v242 offset:64
  v_mfma_f32_16x16x32_bf16 v[48:51], a[40:43], a[176:179], v[48:51]
  ds_read_b64_tr_b16 a[10:11], v242 offset:576
  v_mfma_f32_16x16x32_bf16 v[52:55], a[40:43], a[180:183], v[52:55]
  ds_read_b64_tr_b16 a[12:13], v242 offset:96
  ds_read_b64_tr_b16 a[14:15], v242 offset:608
  v_mfma_f32_16x16x32_bf16 v[60:63], a[44:47], a[180:183], v[60:63]
  ds_read_b64_tr_b16 a[16:17], v242 offset:4224
  v_mfma_f32_16x16x32_bf16 v[56:59], a[44:47], a[176:179], v[56:59]
  ds_read_b64_tr_b16 a[18:19], v242 offset:4736
  ds_read_b64_tr_b16 a[20:21], v242 offset:4256
  v_mfma_f32_16x16x32_bf16 v[32:35], a[48:51], a[184:187], v[32:35]
  ds_read_b64_tr_b16 a[22:23], v242 offset:4768
  v_mfma_f32_16x16x32_bf16 v[36:39], a[48:51], a[188:191], v[36:39]
  ds_read_b64_tr_b16 a[24:25], v242 offset:4288
  ds_read_b64_tr_b16 a[26:27], v242 offset:4800
  v_mfma_f32_16x16x32_bf16 v[44:47], a[52:55], a[188:191], v[44:47]
  ds_read_b64_tr_b16 a[28:29], v242 offset:4320
  v_mfma_f32_16x16x32_bf16 v[40:43], a[52:55], a[184:187], v[40:43]
  ds_read_b64_tr_b16 a[30:31], v242 offset:4832
  v_mfma_f32_16x16x32_bf16 v[48:51], a[56:59], a[184:187], v[48:51]
  v_mfma_f32_16x16x32_bf16 v[52:55], a[56:59], a[188:191], v[52:55]
  v_mfma_f32_16x16x32_bf16 v[60:63], a[60:63], a[188:191], v[60:63]
  v_mfma_f32_16x16x32_bf16 v[56:59], a[60:63], a[184:187], v[56:59]
  s_waitcnt lgkmcnt(0)
  v_mfma_f32_16x16x32_bf16 v[32:35], a[0:3], a[192:195], v[32:35]
  ds_read_b64_tr_b16 a[32:33], v242 offset:8448
  v_mfma_f32_16x16x32_bf16 v[36:39], a[0:3], a[196:199], v[36:39]
  ds_read_b64_tr_b16 a[34:35], v242 offset:8960
  v_mfma_f32_16x16x32_bf16 v[44:47], a[4:7], a[196:199], v[44:47]
  ds_read_b64_tr_b16 a[36:37], v242 offset:8480
  v_mfma_f32_16x16x32_bf16 v[40:43], a[4:7], a[192:195], v[40:43]
  ds_read_b64_tr_b16 a[38:39], v242 offset:8992
  v_mfma_f32_16x16x32_bf16 v[48:51], a[8:11], a[192:195], v[48:51]
  ds_read_b64_tr_b16 a[40:41], v242 offset:8512
  v_mfma_f32_16x16x32_bf16 v[52:55], a[8:11], a[196:199], v[52:55]
  ds_read_b64_tr_b16 a[42:43], v242 offset:9024
  v_mfma_f32_16x16x32_bf16 v[60:63], a[12:15], a[196:199], v[60:63]
  ds_read_b64_tr_b16 a[44:45], v242 offset:8544
  v_mfma_f32_16x16x32_bf16 v[56:59], a[12:15], a[192:195], v[56:59]
  ds_read_b64_tr_b16 a[46:47], v242 offset:9056
  v_mfma_f32_16x16x32_bf16 v[32:35], a[16:19], a[200:203], v[32:35]
  ds_read_b64_tr_b16 a[48:49], v242 offset:12672
  v_mfma_f32_16x16x32_bf16 v[36:39], a[16:19], a[204:207], v[36:39]
  ds_read_b64_tr_b16 a[50:51], v242 offset:13184
  v_mfma_f32_16x16x32_bf16 v[44:47], a[20:23], a[204:207], v[44:47]
  ds_read_b64_tr_b16 a[52:53], v242 offset:12704
  v_mfma_f32_16x16x32_bf16 v[40:43], a[20:23], a[200:203], v[40:43]
  ds_read_b64_tr_b16 a[54:55], v242 offset:13216
  v_mfma_f32_16x16x32_bf16 v[48:51], a[24:27], a[200:203], v[48:51]
  ds_read_b64_tr_b16 a[56:57], v242 offset:12736
  v_mfma_f32_16x16x32_bf16 v[52:55], a[24:27], a[204:207], v[52:55]
  ds_read_b64_tr_b16 a[58:59], v242 offset:13248
  v_mfma_f32_16x16x32_bf16 v[60:63], a[28:31], a[204:207], v[60:63]
  ds_read_b64_tr_b16 a[60:61], v242 offset:12768
  v_mfma_f32_16x16x32_bf16 v[56:59], a[28:31], a[200:203], v[56:59]
  ds_read_b64_tr_b16 a[62:63], v242 offset:13280
  s_waitcnt lgkmcnt(0)
  v_mfma_f32_16x16x32_bf16 v[32:35], a[32:35], a[208:211], v[32:35]
  s_waitcnt vmcnt(16)
  s_barrier
  v_mfma_f32_16x16x32_bf16 v[36:39], a[32:35], a[212:215], v[36:39]
  ds_read_b64_tr_b16 a[0:1], v242 offset:16896
  ds_read_b64_tr_b16 a[2:3], v242 offset:17408
  v_mfma_f32_16x16x32_bf16 v[44:47], a[36:39], a[212:215], v[44:47]
  ds_read_b64_tr_b16 a[4:5], v242 offset:16928
  v_mfma_f32_16x16x32_bf16 v[40:43], a[36:39], a[208:211], v[40:43]
  ds_read_b64_tr_b16 a[6:7], v242 offset:17440
  ds_read_b64_tr_b16 a[8:9], v242 offset:16960
  v_mfma_f32_16x16x32_bf16 v[48:51], a[40:43], a[208:211], v[48:51]
  ds_read_b64_tr_b16 a[10:11], v242 offset:17472
  v_mfma_f32_16x16x32_bf16 v[52:55], a[40:43], a[212:215], v[52:55]
  ds_read_b64_tr_b16 a[12:13], v242 offset:16992
  ds_read_b64_tr_b16 a[14:15], v242 offset:17504
  v_mfma_f32_16x16x32_bf16 v[60:63], a[44:47], a[212:215], v[60:63]
  ds_read_b64_tr_b16 a[16:17], v242 offset:21120
  v_mfma_f32_16x16x32_bf16 v[56:59], a[44:47], a[208:211], v[56:59]
  ds_read_b64_tr_b16 a[18:19], v242 offset:21632
  ds_read_b64_tr_b16 a[20:21], v242 offset:21152
  v_mfma_f32_16x16x32_bf16 v[32:35], a[48:51], a[216:219], v[32:35]
  ds_read_b64_tr_b16 a[22:23], v242 offset:21664
  v_mfma_f32_16x16x32_bf16 v[36:39], a[48:51], a[220:223], v[36:39]
  ds_read_b64_tr_b16 a[24:25], v242 offset:21184
  ds_read_b64_tr_b16 a[26:27], v242 offset:21696
  v_mfma_f32_16x16x32_bf16 v[44:47], a[52:55], a[220:223], v[44:47]
  ds_read_b64_tr_b16 a[28:29], v242 offset:21216
  v_mfma_f32_16x16x32_bf16 v[40:43], a[52:55], a[216:219], v[40:43]
  ds_read_b64_tr_b16 a[30:31], v242 offset:21728
  v_mfma_f32_16x16x32_bf16 v[48:51], a[56:59], a[216:219], v[48:51]
  v_mfma_f32_16x16x32_bf16 v[52:55], a[56:59], a[220:223], v[52:55]
  v_mfma_f32_16x16x32_bf16 v[60:63], a[60:63], a[220:223], v[60:63]
  v_mfma_f32_16x16x32_bf16 v[56:59], a[60:63], a[216:219], v[56:59]
  s_waitcnt lgkmcnt(0)
  v_mfma_f32_16x16x32_bf16 v[32:35], a[0:3], a[224:227], v[32:35]
  ds_read_b64_tr_b16 a[32:33], v242 offset:25344
  ds_read_b64_tr_b16 a[34:35], v242 offset:25856
  v_mfma_f32_16x16x32_bf16 v[36:39], a[0:3], a[228:231], v[36:39]
  ds_read_b64_tr_b16 a[36:37], v242 offset:25376
  v_mfma_f32_16x16x32_bf16 v[44:47], a[4:7], a[228:231], v[44:47]
  ds_read_b64_tr_b16 a[38:39], v242 offset:25888
  v_mfma_f32_16x16x32_bf16 v[40:43], a[4:7], a[224:227], v[40:43]
  ds_read_b64_tr_b16 a[40:41], v242 offset:25408
  ds_read_b64_tr_b16 a[42:43], v242 offset:25920
  v_mfma_f32_16x16x32_bf16 v[48:51], a[8:11], a[224:227], v[48:51]
  s_waitcnt vmcnt(0)
  ds_read_b64_tr_b16 a[44:45], v242 offset:25440
  v_mfma_f32_16x16x32_bf16 v[52:55], a[8:11], a[228:231], v[52:55]
  ds_read_b64_tr_b16 a[46:47], v242 offset:25952
  v_mfma_f32_16x16x32_bf16 v[60:63], a[12:15], a[228:231], v[60:63]
  ds_read_b64_tr_b16 a[48:49], v242 offset:29568
  ds_read_b64_tr_b16 a[50:51], v242 offset:30080
  v_mfma_f32_16x16x32_bf16 v[56:59], a[12:15], a[224:227], v[56:59]
  ds_read_b64_tr_b16 a[52:53], v242 offset:29600
  v_mfma_f32_16x16x32_bf16 v[32:35], a[16:19], a[232:235], v[32:35]
  ds_read_b64_tr_b16 a[54:55], v242 offset:30112
  v_mfma_f32_16x16x32_bf16 v[36:39], a[16:19], a[236:239], v[36:39]
  ds_read_b64_tr_b16 a[56:57], v242 offset:29632
  ds_read_b64_tr_b16 a[58:59], v242 offset:30144
  v_mfma_f32_16x16x32_bf16 v[44:47], a[20:23], a[236:239], v[44:47]
  ds_read_b64_tr_b16 a[60:61], v242 offset:29664
  v_mfma_f32_16x16x32_bf16 v[40:43], a[20:23], a[232:235], v[40:43]
  ds_read_b64_tr_b16 a[62:63], v242 offset:30176
  v_mfma_f32_16x16x32_bf16 v[48:51], a[24:27], a[232:235], v[48:51]
  buffer_store_dword v72, v73, s[56:59], s88 offen sc1
  v_mfma_f32_16x16x32_bf16 v[52:55], a[24:27], a[236:239], v[52:55]
  v_mfma_f32_16x16x32_bf16 v[60:63], a[28:31], a[236:239], v[60:63]
  v_mfma_f32_16x16x32_bf16 v[56:59], a[28:31], a[232:235], v[56:59]
  s_waitcnt lgkmcnt(0)
  v_mfma_f32_16x16x32_bf16 v[32:35], a[32:35], a[240:243], v[32:35]
  s_waitcnt vmcnt(13)
  s_barrier
  v_mfma_f32_16x16x32_bf16 v[36:39], a[32:35], a[244:247], v[36:39]
  ds_read_b64_tr_b16 a[0:1], v243 offset:1024
  ds_read_b64_tr_b16 a[2:3], v243 offset:1536
  v_mfma_f32_16x16x32_bf16 v[44:47], a[36:39], a[244:247], v[44:47]
  ds_read_b64_tr_b16 a[4:5], v243 offset:1056
  v_mfma_f32_16x16x32_bf16 v[40:43], a[36:39], a[240:243], v[40:43]
  ds_read_b64_tr_b16 a[6:7], v243 offset:1568
  ds_read_b64_tr_b16 a[8:9], v243 offset:1088
  v_mfma_f32_16x16x32_bf16 v[48:51], a[40:43], a[240:243], v[48:51]
  ds_read_b64_tr_b16 a[10:11], v243 offset:1600
  v_mfma_f32_16x16x32_bf16 v[52:55], a[40:43], a[244:247], v[52:55]
  ds_read_b64_tr_b16 a[12:13], v243 offset:1120
  ds_read_b64_tr_b16 a[14:15], v243 offset:1632
  v_mfma_f32_16x16x32_bf16 v[60:63], a[44:47], a[244:247], v[60:63]
  ds_read_b64_tr_b16 a[16:17], v243 offset:5248
  v_mfma_f32_16x16x32_bf16 v[56:59], a[44:47], a[240:243], v[56:59]
  ds_read_b64_tr_b16 a[18:19], v243 offset:5760
  ds_read_b64_tr_b16 a[20:21], v243 offset:5280
  v_mfma_f32_16x16x32_bf16 v[32:35], a[48:51], a[248:251], v[32:35]
  ds_read_b64_tr_b16 a[22:23], v243 offset:5792
  v_mfma_f32_16x16x32_bf16 v[36:39], a[48:51], a[252:255], v[36:39]
  ds_read_b64_tr_b16 a[24:25], v243 offset:5312
  ds_read_b64_tr_b16 a[26:27], v243 offset:5824
  v_mfma_f32_16x16x32_bf16 v[44:47], a[52:55], a[252:255], v[44:47]
  ds_read_b64_tr_b16 a[28:29], v243 offset:5344
  v_mfma_f32_16x16x32_bf16 v[40:43], a[52:55], a[248:251], v[40:43]
  ds_read_b64_tr_b16 a[30:31], v243 offset:5856
  v_mfma_f32_16x16x32_bf16 v[48:51], a[56:59], a[248:251], v[48:51]
  v_mfma_f32_16x16x32_bf16 v[52:55], a[56:59], a[252:255], v[52:55]
  v_mfma_f32_16x16x32_bf16 v[60:63], a[60:63], a[252:255], v[60:63]
  v_mfma_f32_16x16x32_bf16 v[56:59], a[60:63], a[248:251], v[56:59]
  s_waitcnt lgkmcnt(0)
  v_mfma_f32_16x16x32_bf16 v[32:35], a[0:3], a[64:67], v[32:35]
  ds_read_b64_tr_b16 a[32:33], v243 offset:9472
  v_mfma_f32_16x16x32_bf16 v[36:39], a[0:3], a[68:71], v[36:39]
  ds_read_b64_tr_b16 a[34:35], v243 offset:9984
  v_mfma_f32_16x16x32_bf16 v[44:47], a[4:7], a[68:71], v[44:47]
  ds_read_b64_tr_b16 a[36:37], v243 offset:9504
  v_mfma_f32_16x16x32_bf16 v[40:43], a[4:7], a[64:67], v[40:43]
  ds_read_b64_tr_b16 a[38:39], v243 offset:10016
  v_mfma_f32_16x16x32_bf16 v[48:51], a[8:11], a[64:67], v[48:51]
  ds_read_b64_tr_b16 a[40:41], v243 offset:9536
  v_mfma_f32_16x16x32_bf16 v[52:55], a[8:11], a[68:71], v[52:55]
  ds_read_b64_tr_b16 a[42:43], v243 offset:10048
  v_mfma_f32_16x16x32_bf16 v[60:63], a[12:15], a[68:71], v[60:63]
  ds_read_b64_tr_b16 a[44:45], v243 offset:9568
  v_mfma_f32_16x16x32_bf16 v[56:59], a[12:15], a[64:67], v[56:59]
  ds_read_b64_tr_b16 a[46:47], v243 offset:10080
  v_mfma_f32_16x16x32_bf16 v[32:35], a[16:19], a[72:75], v[32:35]
  ds_read_b64_tr_b16 a[48:49], v243 offset:13696
  v_mfma_f32_16x16x32_bf16 v[36:39], a[16:19], a[76:79], v[36:39]
  ds_read_b64_tr_b16 a[50:51], v243 offset:14208
  v_mfma_f32_16x16x32_bf16 v[44:47], a[20:23], a[76:79], v[44:47]
  ds_read_b64_tr_b16 a[52:53], v243 offset:13728
  v_mfma_f32_16x16x32_bf16 v[40:43], a[20:23], a[72:75], v[40:43]
  ds_read_b64_tr_b16 a[54:55], v243 offset:14240
  v_mfma_f32_16x16x32_bf16 v[48:51], a[24:27], a[72:75], v[48:51]
  ds_read_b64_tr_b16 a[56:57], v243 offset:13760
  v_mfma_f32_16x16x32_bf16 v[52:55], a[24:27], a[76:79], v[52:55]
  ds_read_b64_tr_b16 a[58:59], v243 offset:14272
  v_mfma_f32_16x16x32_bf16 v[60:63], a[28:31], a[76:79], v[60:63]
  ds_read_b64_tr_b16 a[60:61], v243 offset:13792
  v_mfma_f32_16x16x32_bf16 v[56:59], a[28:31], a[72:75], v[56:59]
  ds_read_b64_tr_b16 a[62:63], v243 offset:14304
  s_waitcnt lgkmcnt(0)
  v_mfma_f32_16x16x32_bf16 v[32:35], a[32:35], a[80:83], v[32:35]
  s_waitcnt vmcnt(9)
  s_barrier
  v_mfma_f32_16x16x32_bf16 v[36:39], a[32:35], a[84:87], v[36:39]
  ds_read_b64_tr_b16 a[0:1], v243 offset:17920
  ds_read_b64_tr_b16 a[2:3], v243 offset:18432
  v_mfma_f32_16x16x32_bf16 v[44:47], a[36:39], a[84:87], v[44:47]
  ds_read_b64_tr_b16 a[4:5], v243 offset:17952
  v_mfma_f32_16x16x32_bf16 v[40:43], a[36:39], a[80:83], v[40:43]
  ds_read_b64_tr_b16 a[6:7], v243 offset:18464
  ds_read_b64_tr_b16 a[8:9], v243 offset:17984
  v_mfma_f32_16x16x32_bf16 v[48:51], a[40:43], a[80:83], v[48:51]
  ds_read_b64_tr_b16 a[10:11], v243 offset:18496
  v_mfma_f32_16x16x32_bf16 v[52:55], a[40:43], a[84:87], v[52:55]
  ds_read_b64_tr_b16 a[12:13], v243 offset:18016
  ds_read_b64_tr_b16 a[14:15], v243 offset:18528
  v_mfma_f32_16x16x32_bf16 v[60:63], a[44:47], a[84:87], v[60:63]
  ds_read_b64_tr_b16 a[16:17], v243 offset:22144
  v_mfma_f32_16x16x32_bf16 v[56:59], a[44:47], a[80:83], v[56:59]
  ds_read_b64_tr_b16 a[18:19], v243 offset:22656
  ds_read_b64_tr_b16 a[20:21], v243 offset:22176
  v_mfma_f32_16x16x32_bf16 v[32:35], a[48:51], a[88:91], v[32:35]
  buffer_load_dword v78, v73, s[56:59], s89 offen sc1
  ds_read_b64_tr_b16 a[22:23], v243 offset:22688
  v_mfma_f32_16x16x32_bf16 v[36:39], a[48:51], a[92:95], v[36:39]
  ds_read_b64_tr_b16 a[24:25], v243 offset:22208
  ds_read_b64_tr_b16 a[26:27], v243 offset:22720
  v_mfma_f32_16x16x32_bf16 v[44:47], a[52:55], a[92:95], v[44:47]
  ds_read_b64_tr_b16 a[28:29], v243 offset:22240
  v_mfma_f32_16x16x32_bf16 v[40:43], a[52:55], a[88:91], v[40:43]
  ds_read_b64_tr_b16 a[30:31], v243 offset:22752
  v_mfma_f32_16x16x32_bf16 v[48:51], a[56:59], a[88:91], v[48:51]
  v_mfma_f32_16x16x32_bf16 v[52:55], a[56:59], a[92:95], v[52:55]
  v_mfma_f32_16x16x32_bf16 v[60:63], a[60:63], a[92:95], v[60:63]
  v_mfma_f32_16x16x32_bf16 v[56:59], a[60:63], a[88:91], v[56:59]
  s_waitcnt lgkmcnt(0)
  v_mfma_f32_16x16x32_bf16 v[32:35], a[0:3], a[96:99], v[32:35]
  ds_read_b64_tr_b16 a[32:33], v243 offset:26368
  v_mfma_f32_16x16x32_bf16 v[36:39], a[0:3], a[100:103], v[36:39]
  ds_read_b64_tr_b16 a[34:35], v243 offset:26880
  v_mfma_f32_16x16x32_bf16 v[44:47], a[4:7], a[100:103], v[44:47]
  ds_read_b64_tr_b16 a[36:37], v243 offset:26400
  v_mfma_f32_16x16x32_bf16 v[40:43], a[4:7], a[96:99], v[40:43]
  ds_read_b64_tr_b16 a[38:39], v243 offset:26912
  v_mfma_f32_16x16x32_bf16 v[48:51], a[8:11], a[96:99], v[48:51]
  ds_read_b64_tr_b16 a[40:41], v243 offset:26432
  v_mfma_f32_16x16x32_bf16 v[52:55], a[8:11], a[100:103], v[52:55]
  ds_read_b64_tr_b16 a[42:43], v243 offset:26944
  v_mfma_f32_16x16x32_bf16 v[60:63], a[12:15], a[100:103], v[60:63]
  ds_read_b64_tr_b16 a[44:45], v243 offset:26464
  v_mfma_f32_16x16x32_bf16 v[56:59], a[12:15], a[96:99], v[56:59]
  ds_read_b64_tr_b16 a[46:47], v243 offset:26976
  v_mfma_f32_16x16x32_bf16 v[32:35], a[16:19], a[104:107], v[32:35]
  ds_read_b64_tr_b16 a[48:49], v243 offset:30592
  v_mfma_f32_16x16x32_bf16 v[36:39], a[16:19], a[108:111], v[36:39]
  ds_read_b64_tr_b16 a[50:51], v243 offset:31104
  v_mfma_f32_16x16x32_bf16 v[44:47], a[20:23], a[108:111], v[44:47]
  ds_read_b64_tr_b16 a[52:53], v243 offset:30624
  v_mfma_f32_16x16x32_bf16 v[40:43], a[20:23], a[104:107], v[40:43]
  ds_read_b64_tr_b16 a[54:55], v243 offset:31136
  v_mfma_f32_16x16x32_bf16 v[48:51], a[24:27], a[104:107], v[48:51]
  ds_read_b64_tr_b16 a[56:57], v243 offset:30656
  v_mfma_f32_16x16x32_bf16 v[52:55], a[24:27], a[108:111], v[52:55]
  ds_read_b64_tr_b16 a[58:59], v243 offset:31168
  v_mfma_f32_16x16x32_bf16 v[60:63], a[28:31], a[108:111], v[60:63]
  ds_read_b64_tr_b16 a[60:61], v243 offset:30688
  v_mfma_f32_16x16x32_bf16 v[56:59], a[28:31], a[104:107], v[56:59]
  ds_read_b64_tr_b16 a[62:63], v243 offset:31200
  s_waitcnt lgkmcnt(0)
  v_mfma_f32_16x16x32_bf16 v[32:35], a[32:35], a[112:115], v[32:35]
  ds_read_b128 v[96:99], v76 offset:768
  v_mfma_f32_16x16x32_bf16 v[36:39], a[32:35], a[116:119], v[36:39]
  s_waitcnt vmcnt(0)
  v_mfma_f32_16x16x32_bf16 v[44:47], a[36:39], a[116:119], v[44:47]
  v_cmp_eq_u32 vcc, 0, v78
  s_cmp_eq_u64 vcc, 0
  s_cbranch_scc1 L_pok_49
  s_mov_b32 s96, 0
L_poll_50:
  buffer_load_dword v78, v73, s[56:59], s89 offen sc1
  s_waitcnt vmcnt(0)
  v_cmp_eq_u32 vcc, 0, v78
  s_add_u32 s96, s96, 1
  s_cmp_eq_u64 vcc, 0
  s_cbranch_scc1 L_ok_51
  s_sleep 2
  s_cmp_lt_u32 s96, 0x200000
  s_cbranch_scc1 L_poll_50
L_ok_51:
L_pok_49:
  v_mfma_f32_16x16x32_bf16 v[40:43], a[36:39], a[112:115], v[40:43]
  ds_read_b128 v[100:103], v76 offset:832
  v_mfma_f32_16x16x32_bf16 v[48:51], a[40:43], a[112:115], v[48:51]
  buffer_load_dwordx4 v[128:131], v249, s[44:47], s92 offen offset:0 sc1
  v_mfma_f32_16x16x32_bf16 v[52:55], a[40:43], a[116:119], v[52:55]
  buffer_load_dwordx4 v[132:135], v249, s[44:47], s92 offen offset:1024 sc1
  v_mfma_f32_16x16x32_bf16 v[60:63], a[44:47], a[116:119], v[60:63]
  ds_read_b128 v[104:107], v76 offset:896
  v_mfma_f32_16x16x32_bf16 v[56:59], a[44:47], a[112:115], v[56:59]
  buffer_load_dwordx4 v[136:139], v249, s[44:47], s92 offen offset:2048 sc1
  v_mfma_f32_16x16x32_bf16 v[32:35], a[48:51], a[120:123], v[32:35]
  buffer_load_dwordx4 v[140:143], v249, s[44:47], s92 offen offset:3072 sc1
  v_mfma_f32_16x16x32_bf16 v[36:39], a[48:51], a[124:127], v[36:39]
  ds_read_b128 v[108:111], v76 offset:960
  v_mfma_f32_16x16x32_bf16 v[44:47], a[52:55], a[124:127], v[44:47]
  buffer_load_dwordx4 v[144:147], v249, s[44:47], s93 offen offset:0 sc1
  v_mfma_f32_16x16x32_bf16 v[40:43], a[52:55], a[120:123], v[40:43]
  v_mfma_f32_16x16x32_bf16 v[48:51], a[56:59], a[120:123], v[48:51]
  buffer_load_dwordx4 v[148:151], v249, s[44:47], s93 offen offset:1024 sc1
  v_mfma_f32_16x16x32_bf16 v[52:55], a[56:59], a[124:127], v[52:55]
  buffer_load_dwordx4 v[152:155], v249, s[44:47], s93 offen offset:2048 sc1
  v_mfma_f32_16x16x32_bf16 v[60:63], a[60:63], a[124:127], v[60:63]
  v_mfma_f32_16x16x32_bf16 v[56:59], a[60:63], a[120:123], v[56:59]
  buffer_load_dwordx4 v[156:159], v249, s[44:47], s93 offen offset:3072 sc1
  v_lshlrev_b32 v160, 16, v80
  v_and_b32 v161, 0xffff0000, v80
  v_lshlrev_b32 v162, 16, v81
  v_and_b32 v163, 0xffff0000, v81
  v_lshlrev_b32 v164, 16, v82
  v_and_b32 v165, 0xffff0000, v82
  v_lshlrev_b32 v166, 16, v83
  v_and_b32 v167, 0xffff0000, v83
  v_lshlrev_b32 v168, 16, v84
  v_and_b32 v169, 0xffff0000, v84
  v_lshlrev_b32 v170, 16, v85
  v_and_b32 v171, 0xffff0000, v85
  v_lshlrev_b32 v172, 16, v86
  v_and_b32 v173, 0xffff0000, v86
  v_lshlrev_b32 v174, 16, v87
  v_and_b32 v175, 0xffff0000, v87
  v_lshlrev_b32 v176, 16, v88
  v_and_b32 v177, 0xffff0000, v88
  v_lshlrev_b32 v178, 16, v89
  v_and_b32 v179, 0xffff0000, v89
  v_lshlrev_b32 v180, 16, v90
  v_and_b32 v181, 0xffff0000, v90
  v_lshlrev_b32 v182, 16, v91
  v_and_b32 v183, 0xffff0000, v91
  v_lshlrev_b32 v184, 16, v92
  v_and_b32 v185, 0xffff0000, v92
  v_lshlrev_b32 v186, 16, v93
  v_and_b32 v187, 0xffff0000, v93
  v_lshlrev_b32 v188, 16, v94
  v_and_b32 v189, 0xffff0000, v94
  v_lshlrev_b32 v190, 16, v95
  v_and_b32 v191, 0xffff0000, v95
  s_waitcnt vmcnt(0) lgkmcnt(0)
  s_nop 0
  v_pk_add_f32 v[32:33], v[32:33], v[128:129]
  v_pk_add_f32 v[34:35], v[34:35], v[130:131]
  v_pk_fma_f32 v[32:33], v[32:33], v[96:97], v[160:161]
  v_pk_fma_f32 v[34:35], v[34:35], v[98:99], v[162:163]
  v_pk_add_f32 v[40:41], v[40:41], v[136:137]
  v_pk_add_f32 v[42:43], v[42:43], v[138:139]
  v_pk_fma_f32 v[40:41], v[40:41], v[100:101], v[164:165]
  v_pk_fma_f32 v[42:43], v[42:43], v[102:103], v[166:167]
  v_pk_add_f32 v[48:49], v[48:49], v[144:145]
  v_pk_add_f32 v[50:51], v[50:51], v[146:147]
  v_pk_fma_f32 v[48:49], v[48:49], v[104:105], v[168:169]
  v_pk_fma_f32 v[50:51], v[50:51], v[106:107], v[170:171]
  v_pk_add_f32 v[56:57], v[56:57], v[152:153]
  v_pk_add_f32 v[58:59], v[58:59], v[154:155]
  v_pk_fma_f32 v[56:57], v[56:57], v[108:109], v[172:173]
  v_pk_fma_f32 v[58:59], v[58:59], v[110:111], v[174:175]
  v_cvt_pk_bf16_f32 v112, v32, v33
  v_cvt_pk_bf16_f32 v113, v34, v35
  v_cvt_pk_bf16_f32 v114, v40, v41
  v_cvt_pk_bf16_f32 v115, v42, v43
  v_cvt_pk_bf16_f32 v116, v48, v49
  v_cvt_pk_bf16_f32 v117, v50, v51
  v_cvt_pk_bf16_f32 v118, v56, v57
  v_cvt_pk_bf16_f32 v119, v58, v59
  s_nop 1
  v_permlane16_swap_b32 v112, v114
  v_permlane16_swap_b32 v113, v115
  v_permlane16_swap_b32 v116, v118
  v_permlane16_swap_b32 v117, v119
  s_nop 0
  buffer_store_dwordx4 v[112:115], v77, s[40:43], s86 offen offset:0
  buffer_store_dwordx4 v[116:119], v77, s[40:43], s86 offen offset:64
  v_pk_add_f32 v[36:37], v[36:37], v[132:133]
  v_pk_add_f32 v[38:39], v[38:39], v[134:135]
  v_pk_fma_f32 v[36:37], v[36:37], v[96:97], v[176:177]
  v_pk_fma_f32 v[38:39], v[38:39], v[98:99], v[178:179]
  v_pk_add_f32 v[44:45], v[44:45], v[140:141]
  v_pk_add_f32 v[46:47], v[46:47], v[142:143]
  v_pk_fma_f32 v[44:45], v[44:45], v[100:101], v[180:181]
  v_pk_fma_f32 v[46:47], v[46:47], v[102:103], v[182:183]
  v_pk_add_f32 v[52:53], v[52:53], v[148:149]
  v_pk_add_f32 v[54:55], v[54:55], v[150:151]
  v_pk_fma_f32 v[52:53], v[52:53], v[104:105], v[184:185]
  v_pk_fma_f32 v[54:55], v[54:55], v[106:107], v[186:187]
  v_pk_add_f32 v[60:61], v[60:61], v[156:157]
  v_pk_add_f32 v[62:63], v[62:63], v[158:159]
  v_pk_fma_f32 v[60:61], v[60:61], v[108:109], v[188:189]
  v_pk_fma_f32 v[62:63], v[62:63], v[110:111], v[190:191]
  v_cvt_pk_bf16_f32 v120, v36, v37
  v_cvt_pk_bf16_f32 v121, v38, v39
  v_cvt_pk_bf16_f32 v122, v44, v45
  v_cvt_pk_bf16_f32 v123, v46, v47
  v_cvt_pk_bf16_f32 v124, v52, v53
  v_cvt_pk_bf16_f32 v125, v54, v55
  v_cvt_pk_bf16_f32 v126, v60, v61
  v_cvt_pk_bf16_f32 v127, v62, v63
  s_nop 1
  v_permlane16_swap_b32 v120, v122
  v_permlane16_swap_b32 v121, v123
  v_permlane16_swap_b32 v124, v126
  v_permlane16_swap_b32 v125, v127
  buffer_store_dwordx4 v[120:123], v77, s[40:43], s87 offen offset:0
  buffer_store_dwordx4 v[124:127], v77, s[40:43], s87 offen offset:64
  s_endpgm
adaLN_cond__linear_kernel_hedgehog__glu_gated_swiglu__prompt_kernel_end:
.section .rodata,"a"
.p2align 6
.amdhsa_kernel adaLN_cond__linear_kernel_hedgehog__glu_gated_swiglu__prompt_kernel
  .amdhsa_next_free_vgpr 512
  .amdhsa_next_free_sgpr 102
  .amdhsa_accum_offset 256
  .amdhsa_group_segment_fixed_size 0
  .amdhsa_kernarg_size 104
  .amdhsa_user_sgpr_count 2
  .amdhsa_user_sgpr_kernarg_segment_ptr 1
  .amdhsa_system_sgpr_workgroup_id_x 1
  .amdhsa_float_denorm_mode_32 3
.end_amdhsa_kernel
```
